```python
import torch

def _softmax(x, axis=-1):
    return torch.softmax(x, dim=axis)

def _gelu(x):
    return torch.nn.functional.gelu(x, approximate='tanh')

def _silu(x):
    return torch.nn.functional.silu(x)

def _sigmoid(x):
    return torch.sigmoid(x)

def _layernorm(x, axis=-1, eps=1e-05):
    m = x.mean(dim=axis, keepdim=True)
    v = x.var(dim=axis, keepdim=True, unbiased=False)
    return (x - m) / torch.sqrt(v + eps)

def _scatter_add(tgt, idx, src, axis=0):
    return tgt.clone().index_add_(axis, idx, src)

def _segment_sum(src, seg, n):
    out = torch.zeros((n,) + src.shape[1:], dtype=src.dtype)
    return out.index_add_(0, seg, src)

def _pad(x, pw):
    flat = tuple((v for pair in reversed(pw) for v in pair))
    return torch.nn.functional.pad(x, flat)
kernel_name = 'parallel_sum__memory_aug_recurrent_mem_tr__geglu_ffn__prompt'

def setup_inputs():

    _w = lambda a: (lambda t: t.to(torch.bfloat16) if t.is_floating_point() else t)(torch.as_tensor(a))

    def _A_setup():
        B, S, Dm = (1, 2048, 640)
        H, Dh = (32, 192)
        M, seg = (8, 32)
        seg = min(seg, S)
        S = S // seg * seg
        return {'x': _w((lambda *s: torch.randn(*s, dtype=torch.bfloat16) * 0.05)(B, S, Dm)), 'mem0': _w((lambda *s: torch.randn(*s, dtype=torch.bfloat16) * 1.6)(B, M, Dm)), 'Wq': _w((lambda *s: torch.randn(*s, dtype=torch.bfloat16) * 0.8)(Dm, H, Dh) * Dm ** (-0.5)), 'Wk': _w((lambda *s: torch.randn(*s, dtype=torch.bfloat16) * 0.8)(Dm, H, Dh) * Dm ** (-0.5)), 'Wv': _w((lambda *s: torch.randn(*s, dtype=torch.bfloat16) * 1.6)(Dm, H, Dh) * Dm ** (-0.5)), 'Wo': _w((lambda *s: torch.randn(*s, dtype=torch.bfloat16) * 1.6)(H, Dh, Dm) * (H * Dh) ** (-0.5)), 'seg_len': seg}
    _A_in = _A_setup()

    def _B_setup():
        B, S, D, F = (1, 2048, 640, 1536)
        return {'x': _w((lambda *s: torch.randn(*s, dtype=torch.bfloat16) * 0.05)(B, S, D)), 'w_gate': _w((lambda *s: torch.randn(*s, dtype=torch.bfloat16) * 0.05)(D, F)), 'w_up': _w((lambda *s: torch.randn(*s, dtype=torch.bfloat16) * 0.05)(D, F)), 'w_down': _w((lambda *s: torch.randn(*s, dtype=torch.bfloat16) * 0.05)(F, D))}
    _B_in = _B_setup()
    return {'A_x': _A_in['x'], 'A_mem0': _A_in['mem0'], 'A_Wq': _A_in['Wq'], 'A_Wk': _A_in['Wk'], 'A_Wv': _A_in['Wv'], 'A_Wo': _A_in['Wo'], 'A_seg_len': _A_in['seg_len'], 'B_x': _B_in['x'], 'B_w_gate': _B_in['w_gate'], 'B_w_up': _B_in['w_up'], 'B_w_down': _B_in['w_down']}

def reference(A_x, A_mem0, A_Wq, A_Wk, A_Wv, A_Wo, A_seg_len, B_x, B_w_gate, B_w_up, B_w_down):

    def _A_ref(x, mem0, Wq, Wk, Wv, Wo, seg_len):
        B, S, Dm = x.shape
        H, Dh = (Wq.shape[1], Wq.shape[2])
        M = mem0.shape[1]
        scale = Dh ** (-0.5)
        n_seg = S // seg_len
        L = M + seg_len
        idx = torch.arange(L)
        mask = (idx[:, None] < M) | (idx[:, None] >= idx[None, :])
        mem = mem0
        outs = []
        for s in range(n_seg):
            xs = x[:, s * seg_len:(s + 1) * seg_len, :].clone()
            h = torch.concatenate([mem, xs], axis=1)
            q = torch.einsum('btd,dhe->bhte', h, Wq)
            k = torch.einsum('btd,dhe->bhte', h, Wk)
            v = torch.einsum('btd,dhe->bhte', h, Wv)
            scores = torch.einsum('bhqe,bhke->bhqk', q, k) * scale
            scores = torch.where(mask[None, None], scores, -1000000000.0)
            p = _softmax(scores, axis=-1)
            o = torch.einsum('bhqk,bhke->bhqe', p, v)
            o = torch.einsum('bhte,hed->btd', o, Wo)
            mem = o[:, :M, :].clone()
            outs.append(o[:, M:, :])
        return torch.concatenate(outs, axis=1)

    def _B_ref(x, w_gate, w_up, w_down):
        return _gelu(x @ w_gate) * (x @ w_up) @ w_down
    x = A_x
    xn = _layernorm(x, axis=-1)
    return x + _A_ref(xn, A_mem0, A_Wq, A_Wk, A_Wv, A_Wo, A_seg_len) + _B_ref(xn, B_w_gate, B_w_up, B_w_down)
```

```asm
; @launch grid=(256,1,1) block=(256,1,1) lds=163840
.amdgcn_target "amdgcn-amd-amdhsa--gfx950"
.text
.globl parallel_sum__memory_aug_recurrent_mem_tr__geglu_ffn__prompt_kernel
.p2align 8
.type parallel_sum__memory_aug_recurrent_mem_tr__geglu_ffn__prompt_kernel,@function
parallel_sum__memory_aug_recurrent_mem_tr__geglu_ffn__prompt_kernel:
    s_cmp_ge_u32 s2, 256
    s_cbranch_scc1 M_end
    s_load_dwordx2 s[4:5], s[0:1], 96
    s_load_dwordx2 s[6:7], s[0:1], 104
    s_getreg_b32 s8, hwreg(HW_REG_XCC_ID, 0, 4)
    v_lshrrev_b32 v20, 6, v0
    v_and_b32 v1, 63, v0
    s_nop 0
    v_readfirstlane_b32 s9, v20
    s_waitcnt lgkmcnt(0)
    s_mov_b32 s12, s6
    s_and_b32 s13, s7, 0xffff
    s_mov_b32 s14, 0x10000000
    s_mov_b32 s15, 0x00020000
    s_mov_b32 s20, s4
    s_and_b32 s21, s5, 0xffff
    s_mov_b32 s22, 0x100
    s_mov_b32 s23, 0x00020000
    s_add_u32 s49, s6, 0x1fffff
    s_and_b32 s49, s49, 0xffe00000
    s_sub_u32 s49, s49, s6
    s_cmp_lg_u32 s9, 0
    s_cbranch_scc1 M_role1
    s_lshl_b32 s24, s8, 2
    v_mov_b32 v20, s24
    v_mov_b32 v21, 1
    s_mov_b64 exec, 1
    buffer_atomic_add v21, v20, s[20:23], 0 offen sc0
    s_waitcnt vmcnt(0)
    v_mov_b32 v20, 0
    ds_write_b32 v20, v21
    s_waitcnt lgkmcnt(0)
    s_mov_b64 exec, -1
M_role1:
    s_barrier
    v_mov_b32 v20, 0
    ds_read_b32 v21, v20
    s_waitcnt lgkmcnt(0)
    v_readfirstlane_b32 s10, v21
    s_nop 3
    s_barrier
    s_mov_b32 s62, s49
    s_cmp_ge_u32 s8, 4
    s_cbranch_scc1 M_hi
    s_mul_i32 s11, s10, 43
    s_lshr_b32 s11, s11, 7
    s_mul_i32 s24, s11, 3
    s_sub_u32 s24, s10, s24
    s_lshl_b32 s25, s8, 3
    s_add_u32 s25, s25, s11
    s_lshl_b32 s26, s24, 2
    s_add_u32 s26, s26, s9
    s_cmp_ge_u32 s10, 24
    s_cbranch_scc1 C_idB
    s_cmp_ge_u32 s10, 12
    s_cselect_b32 s27, 1, 0
    s_mul_i32 s28, s27, 12
    s_sub_u32 s28, s10, s28
    s_lshl_b32 s28, s28, 1
    s_branch C_idJ
C_idB:
    s_sub_u32 s28, s10, 24
    s_lshr_b32 s27, s28, 2
    s_and_b32 s28, s28, 3
    s_lshl_b32 s28, s28, 2
    s_add_u32 s28, s28, 24
C_idJ:
    s_lshl_b32 s52, s8, 3
    s_lshl_b32 s40, s27, 2
    s_add_u32 s52, s52, s40
    s_add_u32 s52, s52, s9
    s_load_dwordx2 s[4:5], s[0:1], 96
    s_waitcnt lgkmcnt(0)
    s_mov_b32 s20, s4
    s_and_b32 s21, s5, 0xffff
    s_mov_b32 s22, 0x100
    s_mov_b32 s23, 0x00020000
    s_cmp_ge_u32 s10, 24
    s_cbranch_scc1 C_swB
    s_load_dwordx2 s[16:17], s[0:1], 40
    s_load_dwordx2 s[56:57], s[0:1], 32
    s_waitcnt lgkmcnt(0)
    s_and_b32 s17, s17, 0xffff
    s_mov_b32 s18, 0x780000
    s_mov_b32 s19, 0x00020000
    s_and_b32 s57, s57, 0xffff
    s_mov_b32 s58, 0x780000
    s_mov_b32 s59, 0x00020000
    v_lshrrev_b32 v2, 2, v1
    v_mul_u32_u24 v2, 1280, v2
    v_and_b32 v3, 3, v1
    v_lshl_add_u32 v2, v3, 4, v2
    s_mul_i32 s40, s52, 245760
    s_lshl_b32 s41, s28, 5
    s_add_u32 s40, s40, s41
    s_mul_i32 s42, s9, 12288
    s_mov_b32 s43, s42
    s_mov_b32 m0, s43
    s_add_u32 s43, s43, 1024
    buffer_load_dwordx4 v2, s[16:19], s40 offen lds
    s_add_u32 s40, s40, 20480
    s_mov_b32 m0, s43
    s_add_u32 s43, s43, 1024
    buffer_load_dwordx4 v2, s[16:19], s40 offen lds
    s_add_u32 s40, s40, 20480
    s_mov_b32 m0, s43
    s_add_u32 s43, s43, 1024
    buffer_load_dwordx4 v2, s[16:19], s40 offen lds
    s_add_u32 s40, s40, 20480
    s_mov_b32 m0, s43
    s_add_u32 s43, s43, 1024
    buffer_load_dwordx4 v2, s[16:19], s40 offen lds
    s_add_u32 s40, s40, 20480
    s_mov_b32 m0, s43
    s_add_u32 s43, s43, 1024
    buffer_load_dwordx4 v2, s[16:19], s40 offen lds
    s_add_u32 s40, s40, 20480
    s_mov_b32 m0, s43
    s_add_u32 s43, s43, 1024
    buffer_load_dwordx4 v2, s[16:19], s40 offen lds
    s_add_u32 s40, s40, 20480
    s_mov_b32 m0, s43
    s_add_u32 s43, s43, 1024
    buffer_load_dwordx4 v2, s[16:19], s40 offen lds
    s_add_u32 s40, s40, 20480
    s_mov_b32 m0, s43
    s_add_u32 s43, s43, 1024
    buffer_load_dwordx4 v2, s[16:19], s40 offen lds
    s_add_u32 s40, s40, 20480
    s_mov_b32 m0, s43
    s_add_u32 s43, s43, 1024
    buffer_load_dwordx4 v2, s[16:19], s40 offen lds
    s_add_u32 s40, s40, 20480
    s_mov_b32 m0, s43
    s_add_u32 s43, s43, 1024
    buffer_load_dwordx4 v2, s[16:19], s40 offen lds
    s_add_u32 s40, s40, 20480
    s_mov_b32 m0, s43
    s_add_u32 s43, s43, 1024
    buffer_load_dwordx4 v2, s[16:19], s40 offen lds
    s_add_u32 s40, s40, 20480
    s_mov_b32 m0, s43
    s_add_u32 s43, s43, 1024
    buffer_load_dwordx4 v2, s[16:19], s40 offen lds
    s_add_u32 s40, s40, 20480
    s_mov_b32 s60, s42
    s_load_dwordx2 s[64:65], s[0:1], 16
    s_waitcnt lgkmcnt(0)
    s_and_b32 s65, s65, 0xffff
    s_mov_b32 s66, 0x780000
    s_mov_b32 s67, 0x00020000
    v_lshrrev_b32 v11, 3, v1
    s_lshl_b32 s40, s9, 3
    v_add_u32 v11, s40, v11
    s_mov_b32 s41, 12288
    v_mul_lo_u32 v11, v11, s41
    v_and_b32 v12, 7, v1
    v_lshlrev_b32 v12, 4, v12
    v_add_u32 v11, v11, v12
    s_mul_i32 s42, s25, 384
    s_lshl_b32 s43, s24, 7
    s_add_u32 s42, s42, s43
    s_lshl_b32 s41, s9, 10
    s_add_u32 s43, s41, 76800
    s_mov_b32 m0, s43
    s_add_u32 s40, s42, 0
    buffer_load_dwordx4 v11, s[64:67], s40 offen lds
    s_add_u32 s43, s41, 80896
    s_mov_b32 m0, s43
    s_add_u32 s40, s42, 393216
    buffer_load_dwordx4 v11, s[64:67], s40 offen lds
    s_add_u32 s43, s41, 84992
    s_mov_b32 m0, s43
    s_add_u32 s40, s42, 786432
    buffer_load_dwordx4 v11, s[64:67], s40 offen lds
    s_add_u32 s43, s41, 89088
    s_mov_b32 m0, s43
    s_add_u32 s40, s42, 1179648
    buffer_load_dwordx4 v11, s[64:67], s40 offen lds
    s_add_u32 s43, s41, 93184
    s_mov_b32 m0, s43
    s_add_u32 s40, s42, 1572864
    buffer_load_dwordx4 v11, s[64:67], s40 offen lds
    s_add_u32 s43, s41, 97280
    s_mov_b32 m0, s43
    s_add_u32 s40, s42, 1966080
    buffer_load_dwordx4 v11, s[64:67], s40 offen lds
    s_add_u32 s43, s41, 101376
    s_mov_b32 m0, s43
    s_add_u32 s40, s42, 2359296
    buffer_load_dwordx4 v11, s[64:67], s40 offen lds
    s_add_u32 s43, s41, 105472
    s_mov_b32 m0, s43
    s_add_u32 s40, s42, 2752512
    buffer_load_dwordx4 v11, s[64:67], s40 offen lds
    s_add_u32 s43, s41, 109568
    s_mov_b32 m0, s43
    s_add_u32 s40, s42, 3145728
    buffer_load_dwordx4 v11, s[64:67], s40 offen lds
    s_add_u32 s43, s41, 113664
    s_mov_b32 m0, s43
    s_add_u32 s40, s42, 3538944
    buffer_load_dwordx4 v11, s[64:67], s40 offen lds
    s_add_u32 s43, s41, 117760
    s_mov_b32 m0, s43
    s_add_u32 s40, s42, 3932160
    buffer_load_dwordx4 v11, s[64:67], s40 offen lds
    s_add_u32 s43, s41, 121856
    s_mov_b32 m0, s43
    s_add_u32 s40, s42, 4325376
    buffer_load_dwordx4 v11, s[64:67], s40 offen lds
    s_add_u32 s43, s41, 125952
    s_mov_b32 m0, s43
    s_add_u32 s40, s42, 4718592
    buffer_load_dwordx4 v11, s[64:67], s40 offen lds
    s_add_u32 s43, s41, 130048
    s_mov_b32 m0, s43
    s_add_u32 s40, s42, 5111808
    buffer_load_dwordx4 v11, s[64:67], s40 offen lds
    s_add_u32 s43, s41, 134144
    s_mov_b32 m0, s43
    s_add_u32 s40, s42, 5505024
    buffer_load_dwordx4 v11, s[64:67], s40 offen lds
    s_add_u32 s43, s41, 138240
    s_mov_b32 m0, s43
    s_add_u32 s40, s42, 5898240
    buffer_load_dwordx4 v11, s[64:67], s40 offen lds
    s_add_u32 s43, s41, 142336
    s_mov_b32 m0, s43
    s_add_u32 s40, s42, 6291456
    buffer_load_dwordx4 v11, s[64:67], s40 offen lds
    s_add_u32 s43, s41, 146432
    s_mov_b32 m0, s43
    s_add_u32 s40, s42, 6684672
    buffer_load_dwordx4 v11, s[64:67], s40 offen lds
    s_add_u32 s43, s41, 150528
    s_mov_b32 m0, s43
    s_add_u32 s40, s42, 7077888
    buffer_load_dwordx4 v11, s[64:67], s40 offen lds
    s_add_u32 s43, s41, 154624
    s_mov_b32 m0, s43
    s_add_u32 s40, s42, 7471104
    buffer_load_dwordx4 v11, s[64:67], s40 offen lds
    s_sub_u32 s56, s56, 4096
    s_subb_u32 s57, s57, 0
    s_add_u32 s58, s58, 4096
    v_add_u32 v11, 0, v1
    v_mul_u32_u24 v12, 2622, v11
    v_lshrrev_b32 v12, 16, v12
    v_mul_u32_u24 v13, 25, v12
    v_sub_u32 v13, v11, v13
    v_min_u32 v13, 23, v13
    v_min_u32 v12, 15, v12
    s_mov_b32 s40, 12288
    v_mul_lo_u32 v12, v12, s40
    v_lshl_add_u32 v12, v13, 4, v12
    v_add_u32 v4, 4096, v12
    v_add_u32 v11, 64, v1
    v_mul_u32_u24 v12, 2622, v11
    v_lshrrev_b32 v12, 16, v12
    v_mul_u32_u24 v13, 25, v12
    v_sub_u32 v13, v11, v13
    v_min_u32 v13, 23, v13
    v_min_u32 v12, 15, v12
    s_mov_b32 s40, 12288
    v_mul_lo_u32 v12, v12, s40
    v_lshl_add_u32 v12, v13, 4, v12
    v_add_u32 v5, 3072, v12
    v_add_u32 v11, 128, v1
    v_mul_u32_u24 v12, 2622, v11
    v_lshrrev_b32 v12, 16, v12
    v_mul_u32_u24 v13, 25, v12
    v_sub_u32 v13, v11, v13
    v_min_u32 v13, 23, v13
    v_min_u32 v12, 15, v12
    s_mov_b32 s40, 12288
    v_mul_lo_u32 v12, v12, s40
    v_lshl_add_u32 v12, v13, 4, v12
    v_add_u32 v6, 2048, v12
    v_add_u32 v11, 192, v1
    v_mul_u32_u24 v12, 2622, v11
    v_lshrrev_b32 v12, 16, v12
    v_mul_u32_u24 v13, 25, v12
    v_sub_u32 v13, v11, v13
    v_min_u32 v13, 23, v13
    v_min_u32 v12, 15, v12
    s_mov_b32 s40, 12288
    v_mul_lo_u32 v12, v12, s40
    v_lshl_add_u32 v12, v13, 4, v12
    v_add_u32 v7, 1024, v12
    v_add_u32 v11, 256, v1
    v_mul_u32_u24 v12, 2622, v11
    v_lshrrev_b32 v12, 16, v12
    v_mul_u32_u24 v13, 25, v12
    v_sub_u32 v13, v11, v13
    v_min_u32 v13, 23, v13
    v_min_u32 v12, 15, v12
    s_mov_b32 s40, 12288
    v_mul_lo_u32 v12, v12, s40
    v_lshl_add_u32 v12, v13, 4, v12
    v_add_u32 v8, 4096, v12
    v_add_u32 v11, 320, v1
    v_mul_u32_u24 v12, 2622, v11
    v_lshrrev_b32 v12, 16, v12
    v_mul_u32_u24 v13, 25, v12
    v_sub_u32 v13, v11, v13
    v_min_u32 v13, 23, v13
    v_min_u32 v12, 15, v12
    s_mov_b32 s40, 12288
    v_mul_lo_u32 v12, v12, s40
    v_lshl_add_u32 v12, v13, 4, v12
    v_add_u32 v9, 3072, v12
    v_add_u32 v11, 384, v1
    v_mul_u32_u24 v12, 2622, v11
    v_lshrrev_b32 v12, 16, v12
    v_mul_u32_u24 v13, 25, v12
    v_sub_u32 v13, v11, v13
    v_min_u32 v13, 23, v13
    v_min_u32 v12, 15, v12
    s_mov_b32 s40, 12288
    v_mul_lo_u32 v12, v12, s40
    v_lshl_add_u32 v12, v13, 4, v12
    v_add_u32 v10, 2048, v12
    v_and_b32 v11, 15, v1
    v_lshrrev_b32 v12, 4, v1
    v_lshrrev_b32 v13, 2, v11
    v_lshl_add_u32 v13, v12, 3, v13
    v_mul_u32_u24 v13, 64, v13
    v_and_b32 v14, 3, v1
    v_lshl_add_u32 v13, v14, 3, v13
    v_add_u32 v13, s60, v13
    v_mul_u32_u24 v14, 400, v11
    v_lshl_add_u32 v14, v12, 4, v14
    s_mul_i32 s61, s9, 19200
    s_mul_i32 s38, s52, 384
    s_waitcnt vmcnt(20)
    ds_read_b64_tr_b16 v[40:41], v13 offset:0
    ds_read_b64_tr_b16 v[42:43], v13 offset:256
    ds_read_b64_tr_b16 v[44:45], v13 offset:2048
    ds_read_b64_tr_b16 v[46:47], v13 offset:2304
    ds_read_b64_tr_b16 v[48:49], v13 offset:4096
    ds_read_b64_tr_b16 v[50:51], v13 offset:4352
    ds_read_b64_tr_b16 v[52:53], v13 offset:6144
    ds_read_b64_tr_b16 v[54:55], v13 offset:6400
    ds_read_b64_tr_b16 v[56:57], v13 offset:8192
    ds_read_b64_tr_b16 v[58:59], v13 offset:8448
    ds_read_b64_tr_b16 v[60:61], v13 offset:10240
    ds_read_b64_tr_b16 v[62:63], v13 offset:10496
    s_waitcnt lgkmcnt(0)
    ds_read_b64_tr_b16 v[64:65], v13 offset:32
    ds_read_b64_tr_b16 v[66:67], v13 offset:288
    ds_read_b64_tr_b16 v[68:69], v13 offset:2080
    ds_read_b64_tr_b16 v[70:71], v13 offset:2336
    ds_read_b64_tr_b16 v[72:73], v13 offset:4128
    ds_read_b64_tr_b16 v[74:75], v13 offset:4384
    ds_read_b64_tr_b16 v[76:77], v13 offset:6176
    ds_read_b64_tr_b16 v[78:79], v13 offset:6432
    ds_read_b64_tr_b16 v[80:81], v13 offset:8224
    ds_read_b64_tr_b16 v[82:83], v13 offset:8480
    ds_read_b64_tr_b16 v[84:85], v13 offset:10272
    ds_read_b64_tr_b16 v[86:87], v13 offset:10528
    s_waitcnt lgkmcnt(0)
    s_barrier
    s_mov_b32 s39, s61
    s_mov_b32 m0, s39
    s_add_u32 s43, s39, 4096
    buffer_load_dwordx4 v4, s[56:59], s38 offen lds
    buffer_load_dwordx4 v5, s[56:59], s38 offen offset:1024 lds
    buffer_load_dwordx4 v6, s[56:59], s38 offen offset:2048 lds
    buffer_load_dwordx4 v7, s[56:59], s38 offen offset:3072 lds
    s_mov_b32 m0, s43
    s_nop 0
    buffer_load_dwordx4 v8, s[56:59], s38 offen lds
    buffer_load_dwordx4 v9, s[56:59], s38 offen offset:1024 lds
    s_mov_b64 exec, 0xffff
    buffer_load_dwordx4 v10, s[56:59], s38 offen offset:2048 lds
    s_mov_b64 exec, -1
    s_add_u32 s38, s38, 196608
    s_add_u32 s39, s39, 6400
    s_mov_b32 m0, s39
    s_add_u32 s43, s39, 4096
    buffer_load_dwordx4 v4, s[56:59], s38 offen lds
    buffer_load_dwordx4 v5, s[56:59], s38 offen offset:1024 lds
    buffer_load_dwordx4 v6, s[56:59], s38 offen offset:2048 lds
    buffer_load_dwordx4 v7, s[56:59], s38 offen offset:3072 lds
    s_mov_b32 m0, s43
    s_nop 0
    buffer_load_dwordx4 v8, s[56:59], s38 offen lds
    buffer_load_dwordx4 v9, s[56:59], s38 offen offset:1024 lds
    s_mov_b64 exec, 0xffff
    buffer_load_dwordx4 v10, s[56:59], s38 offen offset:2048 lds
    s_mov_b64 exec, -1
    s_add_u32 s38, s38, 196608
    s_add_u32 s39, s39, 6400
    s_mov_b32 m0, s39
    s_add_u32 s43, s39, 4096
    buffer_load_dwordx4 v4, s[56:59], s38 offen lds
    buffer_load_dwordx4 v5, s[56:59], s38 offen offset:1024 lds
    buffer_load_dwordx4 v6, s[56:59], s38 offen offset:2048 lds
    buffer_load_dwordx4 v7, s[56:59], s38 offen offset:3072 lds
    s_mov_b32 m0, s43
    s_nop 0
    buffer_load_dwordx4 v8, s[56:59], s38 offen lds
    buffer_load_dwordx4 v9, s[56:59], s38 offen offset:1024 lds
    s_mov_b64 exec, 0xffff
    buffer_load_dwordx4 v10, s[56:59], s38 offen offset:2048 lds
    s_mov_b64 exec, -1
    s_add_u32 s38, s38, 196608
    s_add_u32 s39, s39, 6400
    s_mov_b32 s39, s61
    s_add_u32 s55, s61, 19200
    s_mov_b32 s54, 3
    s_branch C_swAgo
C_swAsub:
    s_waitcnt vmcnt(14)
    v_add_u32 v12, s39, v14
    ds_read_b128 v[16:19], v12 offset:0
    ds_read_b128 v[20:23], v12 offset:64
    ds_read_b128 v[24:27], v12 offset:128
    ds_read_b128 v[28:31], v12 offset:192
    ds_read_b128 v[32:35], v12 offset:256
    ds_read_b128 v[36:39], v12 offset:320
    s_cmp_ge_u32 s54, 40
    s_cselect_b32 s43, 196608, 0
    s_sub_u32 s38, s38, s43
    s_add_u32 s54, s54, 1
    s_waitcnt lgkmcnt(0)
    s_mov_b32 m0, s39
    s_add_u32 s43, s39, 4096
    buffer_load_dwordx4 v4, s[56:59], s38 offen lds
    buffer_load_dwordx4 v5, s[56:59], s38 offen offset:1024 lds
    buffer_load_dwordx4 v6, s[56:59], s38 offen offset:2048 lds
    buffer_load_dwordx4 v7, s[56:59], s38 offen offset:3072 lds
    s_mov_b32 m0, s43
    s_nop 0
    buffer_load_dwordx4 v8, s[56:59], s38 offen lds
    buffer_load_dwordx4 v9, s[56:59], s38 offen offset:1024 lds
    s_mov_b64 exec, 0xffff
    buffer_load_dwordx4 v10, s[56:59], s38 offen offset:2048 lds
    s_mov_b64 exec, -1
    s_add_u32 s38, s38, 196608
    s_add_u32 s39, s39, 6400
    s_cmp_ge_u32 s39, s55
    s_cselect_b32 s39, s61, s39
    v_mfma_f32_16x16x32_bf16 v[88:91], v[16:19], v[40:43], 0
    v_mfma_f32_16x16x32_bf16 v[92:95], v[16:19], v[64:67], 0
    v_mfma_f32_16x16x32_bf16 v[88:91], v[20:23], v[44:47], v[88:91]
    v_mfma_f32_16x16x32_bf16 v[92:95], v[20:23], v[68:71], v[92:95]
    v_mfma_f32_16x16x32_bf16 v[88:91], v[24:27], v[48:51], v[88:91]
    v_mfma_f32_16x16x32_bf16 v[92:95], v[24:27], v[72:75], v[92:95]
    v_mfma_f32_16x16x32_bf16 v[88:91], v[28:31], v[52:55], v[88:91]
    v_mfma_f32_16x16x32_bf16 v[92:95], v[28:31], v[76:79], v[92:95]
    v_mfma_f32_16x16x32_bf16 v[88:91], v[32:35], v[56:59], v[88:91]
    v_mfma_f32_16x16x32_bf16 v[92:95], v[32:35], v[80:83], v[92:95]
    v_mfma_f32_16x16x32_bf16 v[88:91], v[36:39], v[60:63], v[88:91]
    v_mfma_f32_16x16x32_bf16 v[92:95], v[36:39], v[84:87], v[92:95]
    s_waitcnt vmcnt(14)
    v_add_u32 v12, s39, v14
    ds_read_b128 v[16:19], v12 offset:0
    ds_read_b128 v[20:23], v12 offset:64
    ds_read_b128 v[24:27], v12 offset:128
    ds_read_b128 v[28:31], v12 offset:192
    ds_read_b128 v[32:35], v12 offset:256
    ds_read_b128 v[36:39], v12 offset:320
    s_cmp_ge_u32 s54, 40
    s_cselect_b32 s43, 196608, 0
    s_sub_u32 s38, s38, s43
    s_add_u32 s54, s54, 1
    s_waitcnt lgkmcnt(0)
    s_mov_b32 m0, s39
    s_add_u32 s43, s39, 4096
    buffer_load_dwordx4 v4, s[56:59], s38 offen lds
    buffer_load_dwordx4 v5, s[56:59], s38 offen offset:1024 lds
    buffer_load_dwordx4 v6, s[56:59], s38 offen offset:2048 lds
    buffer_load_dwordx4 v7, s[56:59], s38 offen offset:3072 lds
    s_mov_b32 m0, s43
    s_nop 0
    buffer_load_dwordx4 v8, s[56:59], s38 offen lds
    buffer_load_dwordx4 v9, s[56:59], s38 offen offset:1024 lds
    s_mov_b64 exec, 0xffff
    buffer_load_dwordx4 v10, s[56:59], s38 offen offset:2048 lds
    s_mov_b64 exec, -1
    s_add_u32 s38, s38, 196608
    s_add_u32 s39, s39, 6400
    s_cmp_ge_u32 s39, s55
    s_cselect_b32 s39, s61, s39
    v_mfma_f32_16x16x32_bf16 v[96:99], v[16:19], v[40:43], 0
    v_mfma_f32_16x16x32_bf16 v[100:103], v[16:19], v[64:67], 0
    v_mfma_f32_16x16x32_bf16 v[96:99], v[20:23], v[44:47], v[96:99]
    v_mfma_f32_16x16x32_bf16 v[100:103], v[20:23], v[68:71], v[100:103]
    v_mfma_f32_16x16x32_bf16 v[96:99], v[24:27], v[48:51], v[96:99]
    v_mfma_f32_16x16x32_bf16 v[100:103], v[24:27], v[72:75], v[100:103]
    v_mfma_f32_16x16x32_bf16 v[96:99], v[28:31], v[52:55], v[96:99]
    v_mfma_f32_16x16x32_bf16 v[100:103], v[28:31], v[76:79], v[100:103]
    v_mfma_f32_16x16x32_bf16 v[96:99], v[32:35], v[56:59], v[96:99]
    v_mfma_f32_16x16x32_bf16 v[100:103], v[32:35], v[80:83], v[100:103]
    v_mfma_f32_16x16x32_bf16 v[96:99], v[36:39], v[60:63], v[96:99]
    v_mfma_f32_16x16x32_bf16 v[100:103], v[36:39], v[84:87], v[100:103]
    s_nop 7
    v_cvt_pk_bf16_f32 v104, v88, v89
    v_cvt_pk_bf16_f32 v105, v90, v91
    v_cvt_pk_bf16_f32 v106, v96, v97
    v_cvt_pk_bf16_f32 v107, v98, v99
    v_cvt_pk_bf16_f32 v108, v92, v93
    v_cvt_pk_bf16_f32 v109, v94, v95
    v_cvt_pk_bf16_f32 v110, v100, v101
    v_cvt_pk_bf16_f32 v111, v102, v103
    s_setpc_b64 s[70:71]
C_swAgo:
    s_call_b64 s[70:71], C_swAsub
    v_accvgpr_write_b32 a160, v104
    v_accvgpr_write_b32 a161, v105
    v_accvgpr_write_b32 a162, v106
    v_accvgpr_write_b32 a163, v107
    v_accvgpr_write_b32 a240, v108
    v_accvgpr_write_b32 a241, v109
    v_accvgpr_write_b32 a242, v110
    v_accvgpr_write_b32 a243, v111
    s_call_b64 s[70:71], C_swAsub
    v_accvgpr_write_b32 a164, v104
    v_accvgpr_write_b32 a165, v105
    v_accvgpr_write_b32 a166, v106
    v_accvgpr_write_b32 a167, v107
    v_accvgpr_write_b32 a244, v108
    v_accvgpr_write_b32 a245, v109
    v_accvgpr_write_b32 a246, v110
    v_accvgpr_write_b32 a247, v111
    s_call_b64 s[70:71], C_swAsub
    v_accvgpr_write_b32 a168, v104
    v_accvgpr_write_b32 a169, v105
    v_accvgpr_write_b32 a170, v106
    v_accvgpr_write_b32 a171, v107
    v_accvgpr_write_b32 a248, v108
    v_accvgpr_write_b32 a249, v109
    v_accvgpr_write_b32 a250, v110
    v_accvgpr_write_b32 a251, v111
    s_call_b64 s[70:71], C_swAsub
    v_accvgpr_write_b32 a172, v104
    v_accvgpr_write_b32 a173, v105
    v_accvgpr_write_b32 a174, v106
    v_accvgpr_write_b32 a175, v107
    v_accvgpr_write_b32 a252, v108
    v_accvgpr_write_b32 a253, v109
    v_accvgpr_write_b32 a254, v110
    v_accvgpr_write_b32 a255, v111
    s_call_b64 s[70:71], C_swAsub
    v_accvgpr_write_b32 a176, v104
    v_accvgpr_write_b32 a177, v105
    v_accvgpr_write_b32 a178, v106
    v_accvgpr_write_b32 a179, v107
    v_mov_b32 v192, v108
    v_mov_b32 v193, v109
    v_mov_b32 v194, v110
    v_mov_b32 v195, v111
    s_barrier
    v_and_b32 v11, 15, v1
    v_lshrrev_b32 v12, 2, v11
    v_lshlrev_b32 v15, 7, v12
    v_and_b32 v11, 3, v1
    v_lshlrev_b32 v11, 3, v11
    v_add_u32 v15, v15, v11
    s_lshl_b32 s40, s9, 5
    v_add_u32 v15, s40, v15
    v_lshrrev_b32 v11, 4, v1
    v_lshlrev_b32 v11, 9, v11
    v_add_u32 v15, v15, v11
    v_add_u32 v12, 76800, v15
    ds_read_b64_tr_b16 a[0:1], v12 offset:0
    ds_read_b64_tr_b16 a[2:3], v12 offset:2048
    ds_read_b64_tr_b16 a[4:5], v12 offset:4096
    ds_read_b64_tr_b16 a[6:7], v12 offset:6144
    ds_read_b64_tr_b16 a[8:9], v12 offset:8192
    ds_read_b64_tr_b16 a[10:11], v12 offset:10240
    ds_read_b64_tr_b16 a[12:13], v12 offset:12288
    ds_read_b64_tr_b16 a[14:15], v12 offset:14336
    s_waitcnt lgkmcnt(0)
    ds_read_b64_tr_b16 a[16:17], v12 offset:16384
    ds_read_b64_tr_b16 a[18:19], v12 offset:18432
    ds_read_b64_tr_b16 a[20:21], v12 offset:20480
    ds_read_b64_tr_b16 a[22:23], v12 offset:22528
    ds_read_b64_tr_b16 a[24:25], v12 offset:24576
    ds_read_b64_tr_b16 a[26:27], v12 offset:26624
    ds_read_b64_tr_b16 a[28:29], v12 offset:28672
    ds_read_b64_tr_b16 a[30:31], v12 offset:30720
    s_waitcnt lgkmcnt(0)
    v_add_u32 v12, 109568, v15
    ds_read_b64_tr_b16 a[32:33], v12 offset:0
    ds_read_b64_tr_b16 a[34:35], v12 offset:2048
    ds_read_b64_tr_b16 a[36:37], v12 offset:4096
    ds_read_b64_tr_b16 a[38:39], v12 offset:6144
    ds_read_b64_tr_b16 a[40:41], v12 offset:8192
    ds_read_b64_tr_b16 a[42:43], v12 offset:10240
    ds_read_b64_tr_b16 a[44:45], v12 offset:12288
    ds_read_b64_tr_b16 a[46:47], v12 offset:14336
    s_waitcnt lgkmcnt(0)
    ds_read_b64_tr_b16 a[48:49], v12 offset:16384
    ds_read_b64_tr_b16 a[50:51], v12 offset:18432
    ds_read_b64_tr_b16 a[52:53], v12 offset:20480
    ds_read_b64_tr_b16 a[54:55], v12 offset:22528
    ds_read_b64_tr_b16 a[56:57], v12 offset:24576
    ds_read_b64_tr_b16 a[58:59], v12 offset:26624
    ds_read_b64_tr_b16 a[60:61], v12 offset:28672
    ds_read_b64_tr_b16 a[62:63], v12 offset:30720
    s_waitcnt lgkmcnt(0)
    v_add_u32 v12, 142336, v15
    ds_read_b64_tr_b16 a[64:65], v12 offset:0
    ds_read_b64_tr_b16 a[66:67], v12 offset:2048
    ds_read_b64_tr_b16 a[68:69], v12 offset:4096
    ds_read_b64_tr_b16 a[70:71], v12 offset:6144
    ds_read_b64_tr_b16 a[72:73], v12 offset:8192
    ds_read_b64_tr_b16 a[74:75], v12 offset:10240
    ds_read_b64_tr_b16 a[76:77], v12 offset:12288
    ds_read_b64_tr_b16 a[78:79], v12 offset:14336
    s_waitcnt lgkmcnt(0)
    s_barrier
    s_load_dwordx2 s[64:65], s[0:1], 24
    s_waitcnt lgkmcnt(0)
    s_and_b32 s65, s65, 0xffff
    s_mov_b32 s66, 0x780000
    s_mov_b32 s67, 0x00020000
    v_lshrrev_b32 v11, 3, v1
    s_lshl_b32 s40, s9, 3
    v_add_u32 v11, s40, v11
    s_mov_b32 s41, 12288
    v_mul_lo_u32 v11, v11, s41
    v_and_b32 v12, 7, v1
    v_lshlrev_b32 v12, 4, v12
    v_add_u32 v11, v11, v12
    s_mul_i32 s42, s25, 384
    s_lshl_b32 s43, s24, 7
    s_add_u32 s42, s42, s43
    s_lshl_b32 s41, s9, 10
    s_add_u32 s43, s41, 76800
    s_mov_b32 m0, s43
    s_add_u32 s40, s42, 0
    buffer_load_dwordx4 v11, s[64:67], s40 offen lds
    s_add_u32 s43, s41, 80896
    s_mov_b32 m0, s43
    s_add_u32 s40, s42, 393216
    buffer_load_dwordx4 v11, s[64:67], s40 offen lds
    s_add_u32 s43, s41, 84992
    s_mov_b32 m0, s43
    s_add_u32 s40, s42, 786432
    buffer_load_dwordx4 v11, s[64:67], s40 offen lds
    s_add_u32 s43, s41, 89088
    s_mov_b32 m0, s43
    s_add_u32 s40, s42, 1179648
    buffer_load_dwordx4 v11, s[64:67], s40 offen lds
    s_add_u32 s43, s41, 93184
    s_mov_b32 m0, s43
    s_add_u32 s40, s42, 1572864
    buffer_load_dwordx4 v11, s[64:67], s40 offen lds
    s_add_u32 s43, s41, 97280
    s_mov_b32 m0, s43
    s_add_u32 s40, s42, 1966080
    buffer_load_dwordx4 v11, s[64:67], s40 offen lds
    s_add_u32 s43, s41, 101376
    s_mov_b32 m0, s43
    s_add_u32 s40, s42, 2359296
    buffer_load_dwordx4 v11, s[64:67], s40 offen lds
    s_add_u32 s43, s41, 105472
    s_mov_b32 m0, s43
    s_add_u32 s40, s42, 2752512
    buffer_load_dwordx4 v11, s[64:67], s40 offen lds
    s_add_u32 s43, s41, 109568
    s_mov_b32 m0, s43
    s_add_u32 s40, s42, 3145728
    buffer_load_dwordx4 v11, s[64:67], s40 offen lds
    s_add_u32 s43, s41, 113664
    s_mov_b32 m0, s43
    s_add_u32 s40, s42, 3538944
    buffer_load_dwordx4 v11, s[64:67], s40 offen lds
    s_add_u32 s43, s41, 117760
    s_mov_b32 m0, s43
    s_add_u32 s40, s42, 3932160
    buffer_load_dwordx4 v11, s[64:67], s40 offen lds
    s_add_u32 s43, s41, 121856
    s_mov_b32 m0, s43
    s_add_u32 s40, s42, 4325376
    buffer_load_dwordx4 v11, s[64:67], s40 offen lds
    s_add_u32 s43, s41, 125952
    s_mov_b32 m0, s43
    s_add_u32 s40, s42, 4718592
    buffer_load_dwordx4 v11, s[64:67], s40 offen lds
    s_add_u32 s43, s41, 130048
    s_mov_b32 m0, s43
    s_add_u32 s40, s42, 5111808
    buffer_load_dwordx4 v11, s[64:67], s40 offen lds
    s_add_u32 s43, s41, 134144
    s_mov_b32 m0, s43
    s_add_u32 s40, s42, 5505024
    buffer_load_dwordx4 v11, s[64:67], s40 offen lds
    s_add_u32 s43, s41, 138240
    s_mov_b32 m0, s43
    s_add_u32 s40, s42, 5898240
    buffer_load_dwordx4 v11, s[64:67], s40 offen lds
    s_add_u32 s43, s41, 142336
    s_mov_b32 m0, s43
    s_add_u32 s40, s42, 6291456
    buffer_load_dwordx4 v11, s[64:67], s40 offen lds
    s_add_u32 s43, s41, 146432
    s_mov_b32 m0, s43
    s_add_u32 s40, s42, 6684672
    buffer_load_dwordx4 v11, s[64:67], s40 offen lds
    s_add_u32 s43, s41, 150528
    s_mov_b32 m0, s43
    s_add_u32 s40, s42, 7077888
    buffer_load_dwordx4 v11, s[64:67], s40 offen lds
    s_add_u32 s43, s41, 154624
    s_mov_b32 m0, s43
    s_add_u32 s40, s42, 7471104
    buffer_load_dwordx4 v11, s[64:67], s40 offen lds
    s_call_b64 s[70:71], C_swAsub
    v_accvgpr_write_b32 a180, v104
    v_accvgpr_write_b32 a181, v105
    v_accvgpr_write_b32 a182, v106
    v_accvgpr_write_b32 a183, v107
    v_mov_b32 v196, v108
    v_mov_b32 v197, v109
    v_mov_b32 v198, v110
    v_mov_b32 v199, v111
    s_call_b64 s[70:71], C_swAsub
    v_accvgpr_write_b32 a184, v104
    v_accvgpr_write_b32 a185, v105
    v_accvgpr_write_b32 a186, v106
    v_accvgpr_write_b32 a187, v107
    v_mov_b32 v200, v108
    v_mov_b32 v201, v109
    v_mov_b32 v202, v110
    v_mov_b32 v203, v111
    s_call_b64 s[70:71], C_swAsub
    v_accvgpr_write_b32 a188, v104
    v_accvgpr_write_b32 a189, v105
    v_accvgpr_write_b32 a190, v106
    v_accvgpr_write_b32 a191, v107
    v_mov_b32 v204, v108
    v_mov_b32 v205, v109
    v_mov_b32 v206, v110
    v_mov_b32 v207, v111
    s_call_b64 s[70:71], C_swAsub
    v_accvgpr_write_b32 a192, v104
    v_accvgpr_write_b32 a193, v105
    v_accvgpr_write_b32 a194, v106
    v_accvgpr_write_b32 a195, v107
    v_mov_b32 v208, v108
    v_mov_b32 v209, v109
    v_mov_b32 v210, v110
    v_mov_b32 v211, v111
    s_call_b64 s[70:71], C_swAsub
    v_accvgpr_write_b32 a196, v104
    v_accvgpr_write_b32 a197, v105
    v_accvgpr_write_b32 a198, v106
    v_accvgpr_write_b32 a199, v107
    v_mov_b32 v212, v108
    v_mov_b32 v213, v109
    v_mov_b32 v214, v110
    v_mov_b32 v215, v111
    s_call_b64 s[70:71], C_swAsub
    v_accvgpr_write_b32 a200, v104
    v_accvgpr_write_b32 a201, v105
    v_accvgpr_write_b32 a202, v106
    v_accvgpr_write_b32 a203, v107
    v_mov_b32 v216, v108
    v_mov_b32 v217, v109
    v_mov_b32 v218, v110
    v_mov_b32 v219, v111
    s_call_b64 s[70:71], C_swAsub
    v_accvgpr_write_b32 a204, v104
    v_accvgpr_write_b32 a205, v105
    v_accvgpr_write_b32 a206, v106
    v_accvgpr_write_b32 a207, v107
    v_mov_b32 v220, v108
    v_mov_b32 v221, v109
    v_mov_b32 v222, v110
    v_mov_b32 v223, v111
    s_call_b64 s[70:71], C_swAsub
    v_accvgpr_write_b32 a208, v104
    v_accvgpr_write_b32 a209, v105
    v_accvgpr_write_b32 a210, v106
    v_accvgpr_write_b32 a211, v107
    v_mov_b32 v224, v108
    v_mov_b32 v225, v109
    v_mov_b32 v226, v110
    v_mov_b32 v227, v111
    s_barrier
    v_and_b32 v11, 15, v1
    v_lshrrev_b32 v12, 2, v11
    v_lshlrev_b32 v15, 7, v12
    v_and_b32 v11, 3, v1
    v_lshlrev_b32 v11, 3, v11
    v_add_u32 v15, v15, v11
    s_lshl_b32 s40, s9, 5
    v_add_u32 v15, s40, v15
    v_lshrrev_b32 v11, 4, v1
    v_lshlrev_b32 v11, 9, v11
    v_add_u32 v15, v15, v11
    v_add_u32 v12, 76800, v15
    ds_read_b64_tr_b16 a[80:81], v12 offset:0
    ds_read_b64_tr_b16 a[82:83], v12 offset:2048
    ds_read_b64_tr_b16 a[84:85], v12 offset:4096
    ds_read_b64_tr_b16 a[86:87], v12 offset:6144
    ds_read_b64_tr_b16 a[88:89], v12 offset:8192
    ds_read_b64_tr_b16 a[90:91], v12 offset:10240
    ds_read_b64_tr_b16 a[92:93], v12 offset:12288
    ds_read_b64_tr_b16 a[94:95], v12 offset:14336
    s_waitcnt lgkmcnt(0)
    ds_read_b64_tr_b16 a[96:97], v12 offset:16384
    ds_read_b64_tr_b16 a[98:99], v12 offset:18432
    ds_read_b64_tr_b16 a[100:101], v12 offset:20480
    ds_read_b64_tr_b16 a[102:103], v12 offset:22528
    ds_read_b64_tr_b16 a[104:105], v12 offset:24576
    ds_read_b64_tr_b16 a[106:107], v12 offset:26624
    ds_read_b64_tr_b16 a[108:109], v12 offset:28672
    ds_read_b64_tr_b16 a[110:111], v12 offset:30720
    s_waitcnt lgkmcnt(0)
    v_add_u32 v12, 109568, v15
    ds_read_b64_tr_b16 a[112:113], v12 offset:0
    ds_read_b64_tr_b16 a[114:115], v12 offset:2048
    ds_read_b64_tr_b16 a[116:117], v12 offset:4096
    ds_read_b64_tr_b16 a[118:119], v12 offset:6144
    ds_read_b64_tr_b16 a[120:121], v12 offset:8192
    ds_read_b64_tr_b16 a[122:123], v12 offset:10240
    ds_read_b64_tr_b16 a[124:125], v12 offset:12288
    ds_read_b64_tr_b16 a[126:127], v12 offset:14336
    s_waitcnt lgkmcnt(0)
    ds_read_b64_tr_b16 a[128:129], v12 offset:16384
    ds_read_b64_tr_b16 a[130:131], v12 offset:18432
    ds_read_b64_tr_b16 a[132:133], v12 offset:20480
    ds_read_b64_tr_b16 a[134:135], v12 offset:22528
    ds_read_b64_tr_b16 a[136:137], v12 offset:24576
    ds_read_b64_tr_b16 a[138:139], v12 offset:26624
    ds_read_b64_tr_b16 a[140:141], v12 offset:28672
    ds_read_b64_tr_b16 a[142:143], v12 offset:30720
    s_waitcnt lgkmcnt(0)
    v_add_u32 v12, 142336, v15
    ds_read_b64_tr_b16 a[144:145], v12 offset:0
    ds_read_b64_tr_b16 a[146:147], v12 offset:2048
    ds_read_b64_tr_b16 a[148:149], v12 offset:4096
    ds_read_b64_tr_b16 a[150:151], v12 offset:6144
    ds_read_b64_tr_b16 a[152:153], v12 offset:8192
    ds_read_b64_tr_b16 a[154:155], v12 offset:10240
    ds_read_b64_tr_b16 a[156:157], v12 offset:12288
    ds_read_b64_tr_b16 a[158:159], v12 offset:14336
    s_waitcnt lgkmcnt(0)
    s_call_b64 s[70:71], C_swAsub
    v_accvgpr_write_b32 a212, v104
    v_accvgpr_write_b32 a213, v105
    v_accvgpr_write_b32 a214, v106
    v_accvgpr_write_b32 a215, v107
    v_mov_b32 v228, v108
    v_mov_b32 v229, v109
    v_mov_b32 v230, v110
    v_mov_b32 v231, v111
    s_call_b64 s[70:71], C_swAsub
    v_accvgpr_write_b32 a216, v104
    v_accvgpr_write_b32 a217, v105
    v_accvgpr_write_b32 a218, v106
    v_accvgpr_write_b32 a219, v107
    v_mov_b32 v232, v108
    v_mov_b32 v233, v109
    v_mov_b32 v234, v110
    v_mov_b32 v235, v111
    s_call_b64 s[70:71], C_swAsub
    v_accvgpr_write_b32 a220, v104
    v_accvgpr_write_b32 a221, v105
    v_accvgpr_write_b32 a222, v106
    v_accvgpr_write_b32 a223, v107
    v_mov_b32 v236, v108
    v_mov_b32 v237, v109
    v_mov_b32 v238, v110
    v_mov_b32 v239, v111
    s_call_b64 s[70:71], C_swAsub
    v_accvgpr_write_b32 a224, v104
    v_accvgpr_write_b32 a225, v105
    v_accvgpr_write_b32 a226, v106
    v_accvgpr_write_b32 a227, v107
    v_mov_b32 v240, v108
    v_mov_b32 v241, v109
    v_mov_b32 v242, v110
    v_mov_b32 v243, v111
    s_call_b64 s[70:71], C_swAsub
    v_accvgpr_write_b32 a228, v104
    v_accvgpr_write_b32 a229, v105
    v_accvgpr_write_b32 a230, v106
    v_accvgpr_write_b32 a231, v107
    v_mov_b32 v244, v108
    v_mov_b32 v245, v109
    v_mov_b32 v246, v110
    v_mov_b32 v247, v111
    s_call_b64 s[70:71], C_swAsub
    v_accvgpr_write_b32 a232, v104
    v_accvgpr_write_b32 a233, v105
    v_accvgpr_write_b32 a234, v106
    v_accvgpr_write_b32 a235, v107
    v_mov_b32 v248, v108
    v_mov_b32 v249, v109
    v_mov_b32 v250, v110
    v_mov_b32 v251, v111
    s_call_b64 s[70:71], C_swAsub
    v_accvgpr_write_b32 a236, v104
    v_accvgpr_write_b32 a237, v105
    v_accvgpr_write_b32 a238, v106
    v_accvgpr_write_b32 a239, v107
    v_mov_b32 v252, v108
    v_mov_b32 v253, v109
    v_mov_b32 v254, v110
    v_mov_b32 v255, v111
    s_waitcnt vmcnt(0)
    s_branch C_swJ
C_swB:
    s_load_dwordx2 s[16:17], s[0:1], 40
    s_load_dwordx2 s[56:57], s[0:1], 32
    s_waitcnt lgkmcnt(0)
    s_and_b32 s17, s17, 0xffff
    s_mov_b32 s18, 0x780000
    s_mov_b32 s19, 0x00020000
    s_and_b32 s57, s57, 0xffff
    s_mov_b32 s58, 0x780000
    s_mov_b32 s59, 0x00020000
    v_lshrrev_b32 v2, 3, v1
    v_mul_u32_u24 v2, 1280, v2
    v_and_b32 v3, 7, v1
    v_lshl_add_u32 v2, v3, 4, v2
    s_mul_i32 s40, s52, 245760
    s_lshl_b32 s41, s28, 5
    s_add_u32 s40, s40, s41
    s_mul_i32 s42, s9, 24576
    s_mov_b32 s43, s42
    s_mov_b32 m0, s43
    s_add_u32 s43, s43, 1024
    buffer_load_dwordx4 v2, s[16:19], s40 offen lds
    s_add_u32 s40, s40, 10240
    s_mov_b32 m0, s43
    s_add_u32 s43, s43, 1024
    buffer_load_dwordx4 v2, s[16:19], s40 offen lds
    s_add_u32 s40, s40, 10240
    s_mov_b32 m0, s43
    s_add_u32 s43, s43, 1024
    buffer_load_dwordx4 v2, s[16:19], s40 offen lds
    s_add_u32 s40, s40, 10240
    s_mov_b32 m0, s43
    s_add_u32 s43, s43, 1024
    buffer_load_dwordx4 v2, s[16:19], s40 offen lds
    s_add_u32 s40, s40, 10240
    s_mov_b32 m0, s43
    s_add_u32 s43, s43, 1024
    buffer_load_dwordx4 v2, s[16:19], s40 offen lds
    s_add_u32 s40, s40, 10240
    s_mov_b32 m0, s43
    s_add_u32 s43, s43, 1024
    buffer_load_dwordx4 v2, s[16:19], s40 offen lds
    s_add_u32 s40, s40, 10240
    s_mov_b32 m0, s43
    s_add_u32 s43, s43, 1024
    buffer_load_dwordx4 v2, s[16:19], s40 offen lds
    s_add_u32 s40, s40, 10240
    s_mov_b32 m0, s43
    s_add_u32 s43, s43, 1024
    buffer_load_dwordx4 v2, s[16:19], s40 offen lds
    s_add_u32 s40, s40, 10240
    s_mov_b32 m0, s43
    s_add_u32 s43, s43, 1024
    buffer_load_dwordx4 v2, s[16:19], s40 offen lds
    s_add_u32 s40, s40, 10240
    s_mov_b32 m0, s43
    s_add_u32 s43, s43, 1024
    buffer_load_dwordx4 v2, s[16:19], s40 offen lds
    s_add_u32 s40, s40, 10240
    s_mov_b32 m0, s43
    s_add_u32 s43, s43, 1024
    buffer_load_dwordx4 v2, s[16:19], s40 offen lds
    s_add_u32 s40, s40, 10240
    s_mov_b32 m0, s43
    s_add_u32 s43, s43, 1024
    buffer_load_dwordx4 v2, s[16:19], s40 offen lds
    s_add_u32 s40, s40, 10240
    s_mov_b32 m0, s43
    s_add_u32 s43, s43, 1024
    buffer_load_dwordx4 v2, s[16:19], s40 offen lds
    s_add_u32 s40, s40, 10240
    s_mov_b32 m0, s43
    s_add_u32 s43, s43, 1024
    buffer_load_dwordx4 v2, s[16:19], s40 offen lds
    s_add_u32 s40, s40, 10240
    s_mov_b32 m0, s43
    s_add_u32 s43, s43, 1024
    buffer_load_dwordx4 v2, s[16:19], s40 offen lds
    s_add_u32 s40, s40, 10240
    s_mov_b32 m0, s43
    s_add_u32 s43, s43, 1024
    buffer_load_dwordx4 v2, s[16:19], s40 offen lds
    s_add_u32 s40, s40, 10240
    s_mov_b32 m0, s43
    s_add_u32 s43, s43, 1024
    buffer_load_dwordx4 v2, s[16:19], s40 offen lds
    s_add_u32 s40, s40, 10240
    s_mov_b32 m0, s43
    s_add_u32 s43, s43, 1024
    buffer_load_dwordx4 v2, s[16:19], s40 offen lds
    s_add_u32 s40, s40, 10240
    s_mov_b32 m0, s43
    s_add_u32 s43, s43, 1024
    buffer_load_dwordx4 v2, s[16:19], s40 offen lds
    s_add_u32 s40, s40, 10240
    s_mov_b32 m0, s43
    s_add_u32 s43, s43, 1024
    buffer_load_dwordx4 v2, s[16:19], s40 offen lds
    s_add_u32 s40, s40, 10240
    s_mov_b32 m0, s43
    s_add_u32 s43, s43, 1024
    buffer_load_dwordx4 v2, s[16:19], s40 offen lds
    s_add_u32 s40, s40, 10240
    s_mov_b32 m0, s43
    s_add_u32 s43, s43, 1024
    buffer_load_dwordx4 v2, s[16:19], s40 offen lds
    s_add_u32 s40, s40, 10240
    s_mov_b32 m0, s43
    s_add_u32 s43, s43, 1024
    buffer_load_dwordx4 v2, s[16:19], s40 offen lds
    s_add_u32 s40, s40, 10240
    s_mov_b32 m0, s43
    s_add_u32 s43, s43, 1024
    buffer_load_dwordx4 v2, s[16:19], s40 offen lds
    s_add_u32 s40, s40, 10240
    s_mov_b32 s60, s42
    s_sub_u32 s56, s56, 4096
    s_subb_u32 s57, s57, 0
    s_add_u32 s58, s58, 4096
    v_add_u32 v11, 0, v1
    v_mul_u32_u24 v12, 2622, v11
    v_lshrrev_b32 v12, 16, v12
    v_mul_u32_u24 v13, 25, v12
    v_sub_u32 v13, v11, v13
    v_min_u32 v13, 23, v13
    v_min_u32 v12, 15, v12
    s_mov_b32 s40, 12288
    v_mul_lo_u32 v12, v12, s40
    v_lshl_add_u32 v12, v13, 4, v12
    v_add_u32 v4, 4096, v12
    v_add_u32 v11, 64, v1
    v_mul_u32_u24 v12, 2622, v11
    v_lshrrev_b32 v12, 16, v12
    v_mul_u32_u24 v13, 25, v12
    v_sub_u32 v13, v11, v13
    v_min_u32 v13, 23, v13
    v_min_u32 v12, 15, v12
    s_mov_b32 s40, 12288
    v_mul_lo_u32 v12, v12, s40
    v_lshl_add_u32 v12, v13, 4, v12
    v_add_u32 v5, 3072, v12
    v_add_u32 v11, 128, v1
    v_mul_u32_u24 v12, 2622, v11
    v_lshrrev_b32 v12, 16, v12
    v_mul_u32_u24 v13, 25, v12
    v_sub_u32 v13, v11, v13
    v_min_u32 v13, 23, v13
    v_min_u32 v12, 15, v12
    s_mov_b32 s40, 12288
    v_mul_lo_u32 v12, v12, s40
    v_lshl_add_u32 v12, v13, 4, v12
    v_add_u32 v6, 2048, v12
    v_add_u32 v11, 192, v1
    v_mul_u32_u24 v12, 2622, v11
    v_lshrrev_b32 v12, 16, v12
    v_mul_u32_u24 v13, 25, v12
    v_sub_u32 v13, v11, v13
    v_min_u32 v13, 23, v13
    v_min_u32 v12, 15, v12
    s_mov_b32 s40, 12288
    v_mul_lo_u32 v12, v12, s40
    v_lshl_add_u32 v12, v13, 4, v12
    v_add_u32 v7, 1024, v12
    v_add_u32 v11, 256, v1
    v_mul_u32_u24 v12, 2622, v11
    v_lshrrev_b32 v12, 16, v12
    v_mul_u32_u24 v13, 25, v12
    v_sub_u32 v13, v11, v13
    v_min_u32 v13, 23, v13
    v_min_u32 v12, 15, v12
    s_mov_b32 s40, 12288
    v_mul_lo_u32 v12, v12, s40
    v_lshl_add_u32 v12, v13, 4, v12
    v_add_u32 v8, 4096, v12
    v_add_u32 v11, 320, v1
    v_mul_u32_u24 v12, 2622, v11
    v_lshrrev_b32 v12, 16, v12
    v_mul_u32_u24 v13, 25, v12
    v_sub_u32 v13, v11, v13
    v_min_u32 v13, 23, v13
    v_min_u32 v12, 15, v12
    s_mov_b32 s40, 12288
    v_mul_lo_u32 v12, v12, s40
    v_lshl_add_u32 v12, v13, 4, v12
    v_add_u32 v9, 3072, v12
    v_add_u32 v11, 384, v1
    v_mul_u32_u24 v12, 2622, v11
    v_lshrrev_b32 v12, 16, v12
    v_mul_u32_u24 v13, 25, v12
    v_sub_u32 v13, v11, v13
    v_min_u32 v13, 23, v13
    v_min_u32 v12, 15, v12
    s_mov_b32 s40, 12288
    v_mul_lo_u32 v12, v12, s40
    v_lshl_add_u32 v12, v13, 4, v12
    v_add_u32 v10, 2048, v12
    v_and_b32 v11, 15, v1
    v_lshrrev_b32 v12, 4, v1
    v_lshrrev_b32 v13, 2, v11
    v_lshl_add_u32 v13, v12, 3, v13
    v_mul_u32_u24 v13, 128, v13
    v_and_b32 v14, 3, v1
    v_lshl_add_u32 v13, v14, 3, v13
    v_add_u32 v13, s60, v13
    v_mul_u32_u24 v14, 400, v11
    v_lshl_add_u32 v14, v12, 4, v14
    s_mul_i32 s61, s9, 25600
    s_mul_i32 s38, s52, 384
    s_waitcnt vmcnt(0)
    ds_read_b64_tr_b16 v[40:41], v13 offset:0
    ds_read_b64_tr_b16 v[42:43], v13 offset:512
    ds_read_b64_tr_b16 v[44:45], v13 offset:4096
    ds_read_b64_tr_b16 v[46:47], v13 offset:4608
    ds_read_b64_tr_b16 v[48:49], v13 offset:8192
    ds_read_b64_tr_b16 v[50:51], v13 offset:8704
    ds_read_b64_tr_b16 v[52:53], v13 offset:12288
    ds_read_b64_tr_b16 v[54:55], v13 offset:12800
    ds_read_b64_tr_b16 v[56:57], v13 offset:16384
    ds_read_b64_tr_b16 v[58:59], v13 offset:16896
    ds_read_b64_tr_b16 v[60:61], v13 offset:20480
    ds_read_b64_tr_b16 v[62:63], v13 offset:20992
    s_waitcnt lgkmcnt(0)
    ds_read_b64_tr_b16 v[64:65], v13 offset:32
    ds_read_b64_tr_b16 v[66:67], v13 offset:544
    ds_read_b64_tr_b16 v[68:69], v13 offset:4128
    ds_read_b64_tr_b16 v[70:71], v13 offset:4640
    ds_read_b64_tr_b16 v[72:73], v13 offset:8224
    ds_read_b64_tr_b16 v[74:75], v13 offset:8736
    ds_read_b64_tr_b16 v[76:77], v13 offset:12320
    ds_read_b64_tr_b16 v[78:79], v13 offset:12832
    ds_read_b64_tr_b16 v[80:81], v13 offset:16416
    ds_read_b64_tr_b16 v[82:83], v13 offset:16928
    ds_read_b64_tr_b16 v[84:85], v13 offset:20512
    ds_read_b64_tr_b16 v[86:87], v13 offset:21024
    s_waitcnt lgkmcnt(0)
    ds_read_b64_tr_b16 v[88:89], v13 offset:64
    ds_read_b64_tr_b16 v[90:91], v13 offset:576
    ds_read_b64_tr_b16 v[92:93], v13 offset:4160
    ds_read_b64_tr_b16 v[94:95], v13 offset:4672
    ds_read_b64_tr_b16 v[96:97], v13 offset:8256
    ds_read_b64_tr_b16 v[98:99], v13 offset:8768
    ds_read_b64_tr_b16 v[100:101], v13 offset:12352
    ds_read_b64_tr_b16 v[102:103], v13 offset:12864
    ds_read_b64_tr_b16 v[104:105], v13 offset:16448
    ds_read_b64_tr_b16 v[106:107], v13 offset:16960
    ds_read_b64_tr_b16 v[108:109], v13 offset:20544
    ds_read_b64_tr_b16 v[110:111], v13 offset:21056
    s_waitcnt lgkmcnt(0)
    ds_read_b64_tr_b16 v[112:113], v13 offset:96
    ds_read_b64_tr_b16 v[114:115], v13 offset:608
    ds_read_b64_tr_b16 v[116:117], v13 offset:4192
    ds_read_b64_tr_b16 v[118:119], v13 offset:4704
    ds_read_b64_tr_b16 v[120:121], v13 offset:8288
    ds_read_b64_tr_b16 v[122:123], v13 offset:8800
    ds_read_b64_tr_b16 v[124:125], v13 offset:12384
    ds_read_b64_tr_b16 v[126:127], v13 offset:12896
    ds_read_b64_tr_b16 v[128:129], v13 offset:16480
    ds_read_b64_tr_b16 v[130:131], v13 offset:16992
    ds_read_b64_tr_b16 v[132:133], v13 offset:20576
    ds_read_b64_tr_b16 v[134:135], v13 offset:21088
    s_waitcnt lgkmcnt(0)
    s_barrier
    s_mov_b32 s39, s61
    s_mov_b32 m0, s39
    s_add_u32 s43, s39, 4096
    buffer_load_dwordx4 v4, s[56:59], s38 offen lds
    buffer_load_dwordx4 v5, s[56:59], s38 offen offset:1024 lds
    buffer_load_dwordx4 v6, s[56:59], s38 offen offset:2048 lds
    buffer_load_dwordx4 v7, s[56:59], s38 offen offset:3072 lds
    s_mov_b32 m0, s43
    s_nop 0
    buffer_load_dwordx4 v8, s[56:59], s38 offen lds
    buffer_load_dwordx4 v9, s[56:59], s38 offen offset:1024 lds
    s_mov_b64 exec, 0xffff
    buffer_load_dwordx4 v10, s[56:59], s38 offen offset:2048 lds
    s_mov_b64 exec, -1
    s_add_u32 s38, s38, 196608
    s_add_u32 s39, s39, 6400
    s_mov_b32 m0, s39
    s_add_u32 s43, s39, 4096
    buffer_load_dwordx4 v4, s[56:59], s38 offen lds
    buffer_load_dwordx4 v5, s[56:59], s38 offen offset:1024 lds
    buffer_load_dwordx4 v6, s[56:59], s38 offen offset:2048 lds
    buffer_load_dwordx4 v7, s[56:59], s38 offen offset:3072 lds
    s_mov_b32 m0, s43
    s_nop 0
    buffer_load_dwordx4 v8, s[56:59], s38 offen lds
    buffer_load_dwordx4 v9, s[56:59], s38 offen offset:1024 lds
    s_mov_b64 exec, 0xffff
    buffer_load_dwordx4 v10, s[56:59], s38 offen offset:2048 lds
    s_mov_b64 exec, -1
    s_add_u32 s38, s38, 196608
    s_add_u32 s39, s39, 6400
    s_mov_b32 m0, s39
    s_add_u32 s43, s39, 4096
    buffer_load_dwordx4 v4, s[56:59], s38 offen lds
    buffer_load_dwordx4 v5, s[56:59], s38 offen offset:1024 lds
    buffer_load_dwordx4 v6, s[56:59], s38 offen offset:2048 lds
    buffer_load_dwordx4 v7, s[56:59], s38 offen offset:3072 lds
    s_mov_b32 m0, s43
    s_nop 0
    buffer_load_dwordx4 v8, s[56:59], s38 offen lds
    buffer_load_dwordx4 v9, s[56:59], s38 offen offset:1024 lds
    s_mov_b64 exec, 0xffff
    buffer_load_dwordx4 v10, s[56:59], s38 offen offset:2048 lds
    s_mov_b64 exec, -1
    s_add_u32 s38, s38, 196608
    s_add_u32 s39, s39, 6400
    s_mov_b32 m0, s39
    s_add_u32 s43, s39, 4096
    buffer_load_dwordx4 v4, s[56:59], s38 offen lds
    buffer_load_dwordx4 v5, s[56:59], s38 offen offset:1024 lds
    buffer_load_dwordx4 v6, s[56:59], s38 offen offset:2048 lds
    buffer_load_dwordx4 v7, s[56:59], s38 offen offset:3072 lds
    s_mov_b32 m0, s43
    s_nop 0
    buffer_load_dwordx4 v8, s[56:59], s38 offen lds
    buffer_load_dwordx4 v9, s[56:59], s38 offen offset:1024 lds
    s_mov_b64 exec, 0xffff
    buffer_load_dwordx4 v10, s[56:59], s38 offen offset:2048 lds
    s_mov_b64 exec, -1
    s_add_u32 s38, s38, 196608
    s_add_u32 s39, s39, 6400
    s_mov_b32 s39, s61
    s_add_u32 s55, s61, 25600
    s_mov_b32 s54, 4
    s_branch C_swBgo
C_swBsub:
    s_waitcnt vmcnt(21)
    v_add_u32 v12, s39, v14
    ds_read_b128 v[16:19], v12 offset:0
    ds_read_b128 v[20:23], v12 offset:64
    ds_read_b128 v[24:27], v12 offset:128
    ds_read_b128 v[28:31], v12 offset:192
    ds_read_b128 v[32:35], v12 offset:256
    ds_read_b128 v[36:39], v12 offset:320
    s_cmp_ge_u32 s54, 40
    s_cselect_b32 s43, 196608, 0
    s_sub_u32 s38, s38, s43
    s_add_u32 s54, s54, 1
    s_waitcnt lgkmcnt(0)
    s_mov_b32 m0, s39
    s_add_u32 s43, s39, 4096
    buffer_load_dwordx4 v4, s[56:59], s38 offen lds
    buffer_load_dwordx4 v5, s[56:59], s38 offen offset:1024 lds
    buffer_load_dwordx4 v6, s[56:59], s38 offen offset:2048 lds
    buffer_load_dwordx4 v7, s[56:59], s38 offen offset:3072 lds
    s_mov_b32 m0, s43
    s_nop 0
    buffer_load_dwordx4 v8, s[56:59], s38 offen lds
    buffer_load_dwordx4 v9, s[56:59], s38 offen offset:1024 lds
    s_mov_b64 exec, 0xffff
    buffer_load_dwordx4 v10, s[56:59], s38 offen offset:2048 lds
    s_mov_b64 exec, -1
    s_add_u32 s38, s38, 196608
    s_add_u32 s39, s39, 6400
    s_cmp_ge_u32 s39, s55
    s_cselect_b32 s39, s61, s39
    v_mfma_f32_16x16x32_bf16 v[136:139], v[16:19], v[40:43], 0
    v_mfma_f32_16x16x32_bf16 v[140:143], v[16:19], v[64:67], 0
    v_mfma_f32_16x16x32_bf16 v[144:147], v[16:19], v[88:91], 0
    v_mfma_f32_16x16x32_bf16 v[148:151], v[16:19], v[112:115], 0
    v_mfma_f32_16x16x32_bf16 v[136:139], v[20:23], v[44:47], v[136:139]
    v_mfma_f32_16x16x32_bf16 v[140:143], v[20:23], v[68:71], v[140:143]
    v_mfma_f32_16x16x32_bf16 v[144:147], v[20:23], v[92:95], v[144:147]
    v_mfma_f32_16x16x32_bf16 v[148:151], v[20:23], v[116:119], v[148:151]
    v_mfma_f32_16x16x32_bf16 v[136:139], v[24:27], v[48:51], v[136:139]
    v_mfma_f32_16x16x32_bf16 v[140:143], v[24:27], v[72:75], v[140:143]
    v_mfma_f32_16x16x32_bf16 v[144:147], v[24:27], v[96:99], v[144:147]
    v_mfma_f32_16x16x32_bf16 v[148:151], v[24:27], v[120:123], v[148:151]
    v_mfma_f32_16x16x32_bf16 v[136:139], v[28:31], v[52:55], v[136:139]
    v_mfma_f32_16x16x32_bf16 v[140:143], v[28:31], v[76:79], v[140:143]
    v_mfma_f32_16x16x32_bf16 v[144:147], v[28:31], v[100:103], v[144:147]
    v_mfma_f32_16x16x32_bf16 v[148:151], v[28:31], v[124:127], v[148:151]
    v_mfma_f32_16x16x32_bf16 v[136:139], v[32:35], v[56:59], v[136:139]
    v_mfma_f32_16x16x32_bf16 v[140:143], v[32:35], v[80:83], v[140:143]
    v_mfma_f32_16x16x32_bf16 v[144:147], v[32:35], v[104:107], v[144:147]
    v_mfma_f32_16x16x32_bf16 v[148:151], v[32:35], v[128:131], v[148:151]
    v_mfma_f32_16x16x32_bf16 v[136:139], v[36:39], v[60:63], v[136:139]
    v_mfma_f32_16x16x32_bf16 v[140:143], v[36:39], v[84:87], v[140:143]
    v_mfma_f32_16x16x32_bf16 v[144:147], v[36:39], v[108:111], v[144:147]
    v_mfma_f32_16x16x32_bf16 v[148:151], v[36:39], v[132:135], v[148:151]
    s_waitcnt vmcnt(21)
    v_add_u32 v12, s39, v14
    ds_read_b128 v[16:19], v12 offset:0
    ds_read_b128 v[20:23], v12 offset:64
    ds_read_b128 v[24:27], v12 offset:128
    ds_read_b128 v[28:31], v12 offset:192
    ds_read_b128 v[32:35], v12 offset:256
    ds_read_b128 v[36:39], v12 offset:320
    s_cmp_ge_u32 s54, 40
    s_cselect_b32 s43, 196608, 0
    s_sub_u32 s38, s38, s43
    s_add_u32 s54, s54, 1
    s_waitcnt lgkmcnt(0)
    s_mov_b32 m0, s39
    s_add_u32 s43, s39, 4096
    buffer_load_dwordx4 v4, s[56:59], s38 offen lds
    buffer_load_dwordx4 v5, s[56:59], s38 offen offset:1024 lds
    buffer_load_dwordx4 v6, s[56:59], s38 offen offset:2048 lds
    buffer_load_dwordx4 v7, s[56:59], s38 offen offset:3072 lds
    s_mov_b32 m0, s43
    s_nop 0
    buffer_load_dwordx4 v8, s[56:59], s38 offen lds
    buffer_load_dwordx4 v9, s[56:59], s38 offen offset:1024 lds
    s_mov_b64 exec, 0xffff
    buffer_load_dwordx4 v10, s[56:59], s38 offen offset:2048 lds
    s_mov_b64 exec, -1
    s_add_u32 s38, s38, 196608
    s_add_u32 s39, s39, 6400
    s_cmp_ge_u32 s39, s55
    s_cselect_b32 s39, s61, s39
    v_mfma_f32_16x16x32_bf16 v[152:155], v[16:19], v[40:43], 0
    v_mfma_f32_16x16x32_bf16 v[156:159], v[16:19], v[64:67], 0
    v_mfma_f32_16x16x32_bf16 v[160:163], v[16:19], v[88:91], 0
    v_mfma_f32_16x16x32_bf16 v[164:167], v[16:19], v[112:115], 0
    v_mfma_f32_16x16x32_bf16 v[152:155], v[20:23], v[44:47], v[152:155]
    v_mfma_f32_16x16x32_bf16 v[156:159], v[20:23], v[68:71], v[156:159]
    v_mfma_f32_16x16x32_bf16 v[160:163], v[20:23], v[92:95], v[160:163]
    v_mfma_f32_16x16x32_bf16 v[164:167], v[20:23], v[116:119], v[164:167]
    v_mfma_f32_16x16x32_bf16 v[152:155], v[24:27], v[48:51], v[152:155]
    v_mfma_f32_16x16x32_bf16 v[156:159], v[24:27], v[72:75], v[156:159]
    v_mfma_f32_16x16x32_bf16 v[160:163], v[24:27], v[96:99], v[160:163]
    v_mfma_f32_16x16x32_bf16 v[164:167], v[24:27], v[120:123], v[164:167]
    v_mfma_f32_16x16x32_bf16 v[152:155], v[28:31], v[52:55], v[152:155]
    v_mfma_f32_16x16x32_bf16 v[156:159], v[28:31], v[76:79], v[156:159]
    v_mfma_f32_16x16x32_bf16 v[160:163], v[28:31], v[100:103], v[160:163]
    v_mfma_f32_16x16x32_bf16 v[164:167], v[28:31], v[124:127], v[164:167]
    v_mfma_f32_16x16x32_bf16 v[152:155], v[32:35], v[56:59], v[152:155]
    v_mfma_f32_16x16x32_bf16 v[156:159], v[32:35], v[80:83], v[156:159]
    v_mfma_f32_16x16x32_bf16 v[160:163], v[32:35], v[104:107], v[160:163]
    v_mfma_f32_16x16x32_bf16 v[164:167], v[32:35], v[128:131], v[164:167]
    v_mfma_f32_16x16x32_bf16 v[152:155], v[36:39], v[60:63], v[152:155]
    v_mfma_f32_16x16x32_bf16 v[156:159], v[36:39], v[84:87], v[156:159]
    v_mfma_f32_16x16x32_bf16 v[160:163], v[36:39], v[108:111], v[160:163]
    v_mfma_f32_16x16x32_bf16 v[164:167], v[36:39], v[132:135], v[164:167]
    s_nop 7
    v_cvt_pk_bf16_f32 v168, v136, v137
    v_cvt_pk_bf16_f32 v169, v138, v139
    v_cvt_pk_bf16_f32 v170, v152, v153
    v_cvt_pk_bf16_f32 v171, v154, v155
    v_cvt_pk_bf16_f32 v172, v140, v141
    v_cvt_pk_bf16_f32 v173, v142, v143
    v_cvt_pk_bf16_f32 v174, v156, v157
    v_cvt_pk_bf16_f32 v175, v158, v159
    v_cvt_pk_bf16_f32 v176, v144, v145
    v_cvt_pk_bf16_f32 v177, v146, v147
    v_cvt_pk_bf16_f32 v178, v160, v161
    v_cvt_pk_bf16_f32 v179, v162, v163
    v_cvt_pk_bf16_f32 v180, v148, v149
    v_cvt_pk_bf16_f32 v181, v150, v151
    v_cvt_pk_bf16_f32 v182, v164, v165
    v_cvt_pk_bf16_f32 v183, v166, v167
    s_setpc_b64 s[70:71]
C_swBgo:
    s_call_b64 s[70:71], C_swBsub
    v_accvgpr_write_b32 a0, v168
    v_accvgpr_write_b32 a1, v169
    v_accvgpr_write_b32 a2, v170
    v_accvgpr_write_b32 a3, v171
    v_accvgpr_write_b32 a80, v172
    v_accvgpr_write_b32 a81, v173
    v_accvgpr_write_b32 a82, v174
    v_accvgpr_write_b32 a83, v175
    v_accvgpr_write_b32 a160, v176
    v_accvgpr_write_b32 a161, v177
    v_accvgpr_write_b32 a162, v178
    v_accvgpr_write_b32 a163, v179
    v_accvgpr_write_b32 a240, v180
    v_accvgpr_write_b32 a241, v181
    v_accvgpr_write_b32 a242, v182
    v_accvgpr_write_b32 a243, v183
    s_call_b64 s[70:71], C_swBsub
    v_accvgpr_write_b32 a4, v168
    v_accvgpr_write_b32 a5, v169
    v_accvgpr_write_b32 a6, v170
    v_accvgpr_write_b32 a7, v171
    v_accvgpr_write_b32 a84, v172
    v_accvgpr_write_b32 a85, v173
    v_accvgpr_write_b32 a86, v174
    v_accvgpr_write_b32 a87, v175
    v_accvgpr_write_b32 a164, v176
    v_accvgpr_write_b32 a165, v177
    v_accvgpr_write_b32 a166, v178
    v_accvgpr_write_b32 a167, v179
    v_accvgpr_write_b32 a244, v180
    v_accvgpr_write_b32 a245, v181
    v_accvgpr_write_b32 a246, v182
    v_accvgpr_write_b32 a247, v183
    s_call_b64 s[70:71], C_swBsub
    v_accvgpr_write_b32 a8, v168
    v_accvgpr_write_b32 a9, v169
    v_accvgpr_write_b32 a10, v170
    v_accvgpr_write_b32 a11, v171
    v_accvgpr_write_b32 a88, v172
    v_accvgpr_write_b32 a89, v173
    v_accvgpr_write_b32 a90, v174
    v_accvgpr_write_b32 a91, v175
    v_accvgpr_write_b32 a168, v176
    v_accvgpr_write_b32 a169, v177
    v_accvgpr_write_b32 a170, v178
    v_accvgpr_write_b32 a171, v179
    v_accvgpr_write_b32 a248, v180
    v_accvgpr_write_b32 a249, v181
    v_accvgpr_write_b32 a250, v182
    v_accvgpr_write_b32 a251, v183
    s_call_b64 s[70:71], C_swBsub
    v_accvgpr_write_b32 a12, v168
    v_accvgpr_write_b32 a13, v169
    v_accvgpr_write_b32 a14, v170
    v_accvgpr_write_b32 a15, v171
    v_accvgpr_write_b32 a92, v172
    v_accvgpr_write_b32 a93, v173
    v_accvgpr_write_b32 a94, v174
    v_accvgpr_write_b32 a95, v175
    v_accvgpr_write_b32 a172, v176
    v_accvgpr_write_b32 a173, v177
    v_accvgpr_write_b32 a174, v178
    v_accvgpr_write_b32 a175, v179
    v_accvgpr_write_b32 a252, v180
    v_accvgpr_write_b32 a253, v181
    v_accvgpr_write_b32 a254, v182
    v_accvgpr_write_b32 a255, v183
    s_call_b64 s[70:71], C_swBsub
    v_accvgpr_write_b32 a16, v168
    v_accvgpr_write_b32 a17, v169
    v_accvgpr_write_b32 a18, v170
    v_accvgpr_write_b32 a19, v171
    v_accvgpr_write_b32 a96, v172
    v_accvgpr_write_b32 a97, v173
    v_accvgpr_write_b32 a98, v174
    v_accvgpr_write_b32 a99, v175
    v_accvgpr_write_b32 a176, v176
    v_accvgpr_write_b32 a177, v177
    v_accvgpr_write_b32 a178, v178
    v_accvgpr_write_b32 a179, v179
    v_mov_b32 v192, v180
    v_mov_b32 v193, v181
    v_mov_b32 v194, v182
    v_mov_b32 v195, v183
    s_call_b64 s[70:71], C_swBsub
    v_accvgpr_write_b32 a20, v168
    v_accvgpr_write_b32 a21, v169
    v_accvgpr_write_b32 a22, v170
    v_accvgpr_write_b32 a23, v171
    v_accvgpr_write_b32 a100, v172
    v_accvgpr_write_b32 a101, v173
    v_accvgpr_write_b32 a102, v174
    v_accvgpr_write_b32 a103, v175
    v_accvgpr_write_b32 a180, v176
    v_accvgpr_write_b32 a181, v177
    v_accvgpr_write_b32 a182, v178
    v_accvgpr_write_b32 a183, v179
    v_mov_b32 v196, v180
    v_mov_b32 v197, v181
    v_mov_b32 v198, v182
    v_mov_b32 v199, v183
    s_call_b64 s[70:71], C_swBsub
    v_accvgpr_write_b32 a24, v168
    v_accvgpr_write_b32 a25, v169
    v_accvgpr_write_b32 a26, v170
    v_accvgpr_write_b32 a27, v171
    v_accvgpr_write_b32 a104, v172
    v_accvgpr_write_b32 a105, v173
    v_accvgpr_write_b32 a106, v174
    v_accvgpr_write_b32 a107, v175
    v_accvgpr_write_b32 a184, v176
    v_accvgpr_write_b32 a185, v177
    v_accvgpr_write_b32 a186, v178
    v_accvgpr_write_b32 a187, v179
    v_mov_b32 v200, v180
    v_mov_b32 v201, v181
    v_mov_b32 v202, v182
    v_mov_b32 v203, v183
    s_call_b64 s[70:71], C_swBsub
    v_accvgpr_write_b32 a28, v168
    v_accvgpr_write_b32 a29, v169
    v_accvgpr_write_b32 a30, v170
    v_accvgpr_write_b32 a31, v171
    v_accvgpr_write_b32 a108, v172
    v_accvgpr_write_b32 a109, v173
    v_accvgpr_write_b32 a110, v174
    v_accvgpr_write_b32 a111, v175
    v_accvgpr_write_b32 a188, v176
    v_accvgpr_write_b32 a189, v177
    v_accvgpr_write_b32 a190, v178
    v_accvgpr_write_b32 a191, v179
    v_mov_b32 v204, v180
    v_mov_b32 v205, v181
    v_mov_b32 v206, v182
    v_mov_b32 v207, v183
    s_call_b64 s[70:71], C_swBsub
    v_accvgpr_write_b32 a32, v168
    v_accvgpr_write_b32 a33, v169
    v_accvgpr_write_b32 a34, v170
    v_accvgpr_write_b32 a35, v171
    v_accvgpr_write_b32 a112, v172
    v_accvgpr_write_b32 a113, v173
    v_accvgpr_write_b32 a114, v174
    v_accvgpr_write_b32 a115, v175
    v_accvgpr_write_b32 a192, v176
    v_accvgpr_write_b32 a193, v177
    v_accvgpr_write_b32 a194, v178
    v_accvgpr_write_b32 a195, v179
    v_mov_b32 v208, v180
    v_mov_b32 v209, v181
    v_mov_b32 v210, v182
    v_mov_b32 v211, v183
    s_call_b64 s[70:71], C_swBsub
    v_accvgpr_write_b32 a36, v168
    v_accvgpr_write_b32 a37, v169
    v_accvgpr_write_b32 a38, v170
    v_accvgpr_write_b32 a39, v171
    v_accvgpr_write_b32 a116, v172
    v_accvgpr_write_b32 a117, v173
    v_accvgpr_write_b32 a118, v174
    v_accvgpr_write_b32 a119, v175
    v_accvgpr_write_b32 a196, v176
    v_accvgpr_write_b32 a197, v177
    v_accvgpr_write_b32 a198, v178
    v_accvgpr_write_b32 a199, v179
    v_mov_b32 v212, v180
    v_mov_b32 v213, v181
    v_mov_b32 v214, v182
    v_mov_b32 v215, v183
    s_call_b64 s[70:71], C_swBsub
    v_accvgpr_write_b32 a40, v168
    v_accvgpr_write_b32 a41, v169
    v_accvgpr_write_b32 a42, v170
    v_accvgpr_write_b32 a43, v171
    v_accvgpr_write_b32 a120, v172
    v_accvgpr_write_b32 a121, v173
    v_accvgpr_write_b32 a122, v174
    v_accvgpr_write_b32 a123, v175
    v_accvgpr_write_b32 a200, v176
    v_accvgpr_write_b32 a201, v177
    v_accvgpr_write_b32 a202, v178
    v_accvgpr_write_b32 a203, v179
    v_mov_b32 v216, v180
    v_mov_b32 v217, v181
    v_mov_b32 v218, v182
    v_mov_b32 v219, v183
    s_call_b64 s[70:71], C_swBsub
    v_accvgpr_write_b32 a44, v168
    v_accvgpr_write_b32 a45, v169
    v_accvgpr_write_b32 a46, v170
    v_accvgpr_write_b32 a47, v171
    v_accvgpr_write_b32 a124, v172
    v_accvgpr_write_b32 a125, v173
    v_accvgpr_write_b32 a126, v174
    v_accvgpr_write_b32 a127, v175
    v_accvgpr_write_b32 a204, v176
    v_accvgpr_write_b32 a205, v177
    v_accvgpr_write_b32 a206, v178
    v_accvgpr_write_b32 a207, v179
    v_mov_b32 v220, v180
    v_mov_b32 v221, v181
    v_mov_b32 v222, v182
    v_mov_b32 v223, v183
    s_call_b64 s[70:71], C_swBsub
    v_accvgpr_write_b32 a48, v168
    v_accvgpr_write_b32 a49, v169
    v_accvgpr_write_b32 a50, v170
    v_accvgpr_write_b32 a51, v171
    v_accvgpr_write_b32 a128, v172
    v_accvgpr_write_b32 a129, v173
    v_accvgpr_write_b32 a130, v174
    v_accvgpr_write_b32 a131, v175
    v_accvgpr_write_b32 a208, v176
    v_accvgpr_write_b32 a209, v177
    v_accvgpr_write_b32 a210, v178
    v_accvgpr_write_b32 a211, v179
    v_mov_b32 v224, v180
    v_mov_b32 v225, v181
    v_mov_b32 v226, v182
    v_mov_b32 v227, v183
    s_call_b64 s[70:71], C_swBsub
    v_accvgpr_write_b32 a52, v168
    v_accvgpr_write_b32 a53, v169
    v_accvgpr_write_b32 a54, v170
    v_accvgpr_write_b32 a55, v171
    v_accvgpr_write_b32 a132, v172
    v_accvgpr_write_b32 a133, v173
    v_accvgpr_write_b32 a134, v174
    v_accvgpr_write_b32 a135, v175
    v_accvgpr_write_b32 a212, v176
    v_accvgpr_write_b32 a213, v177
    v_accvgpr_write_b32 a214, v178
    v_accvgpr_write_b32 a215, v179
    v_mov_b32 v228, v180
    v_mov_b32 v229, v181
    v_mov_b32 v230, v182
    v_mov_b32 v231, v183
    s_call_b64 s[70:71], C_swBsub
    v_accvgpr_write_b32 a56, v168
    v_accvgpr_write_b32 a57, v169
    v_accvgpr_write_b32 a58, v170
    v_accvgpr_write_b32 a59, v171
    v_accvgpr_write_b32 a136, v172
    v_accvgpr_write_b32 a137, v173
    v_accvgpr_write_b32 a138, v174
    v_accvgpr_write_b32 a139, v175
    v_accvgpr_write_b32 a216, v176
    v_accvgpr_write_b32 a217, v177
    v_accvgpr_write_b32 a218, v178
    v_accvgpr_write_b32 a219, v179
    v_mov_b32 v232, v180
    v_mov_b32 v233, v181
    v_mov_b32 v234, v182
    v_mov_b32 v235, v183
    s_call_b64 s[70:71], C_swBsub
    v_accvgpr_write_b32 a60, v168
    v_accvgpr_write_b32 a61, v169
    v_accvgpr_write_b32 a62, v170
    v_accvgpr_write_b32 a63, v171
    v_accvgpr_write_b32 a140, v172
    v_accvgpr_write_b32 a141, v173
    v_accvgpr_write_b32 a142, v174
    v_accvgpr_write_b32 a143, v175
    v_accvgpr_write_b32 a220, v176
    v_accvgpr_write_b32 a221, v177
    v_accvgpr_write_b32 a222, v178
    v_accvgpr_write_b32 a223, v179
    v_mov_b32 v236, v180
    v_mov_b32 v237, v181
    v_mov_b32 v238, v182
    v_mov_b32 v239, v183
    s_call_b64 s[70:71], C_swBsub
    v_accvgpr_write_b32 a64, v168
    v_accvgpr_write_b32 a65, v169
    v_accvgpr_write_b32 a66, v170
    v_accvgpr_write_b32 a67, v171
    v_accvgpr_write_b32 a144, v172
    v_accvgpr_write_b32 a145, v173
    v_accvgpr_write_b32 a146, v174
    v_accvgpr_write_b32 a147, v175
    v_accvgpr_write_b32 a224, v176
    v_accvgpr_write_b32 a225, v177
    v_accvgpr_write_b32 a226, v178
    v_accvgpr_write_b32 a227, v179
    v_mov_b32 v240, v180
    v_mov_b32 v241, v181
    v_mov_b32 v242, v182
    v_mov_b32 v243, v183
    s_call_b64 s[70:71], C_swBsub
    v_accvgpr_write_b32 a68, v168
    v_accvgpr_write_b32 a69, v169
    v_accvgpr_write_b32 a70, v170
    v_accvgpr_write_b32 a71, v171
    v_accvgpr_write_b32 a148, v172
    v_accvgpr_write_b32 a149, v173
    v_accvgpr_write_b32 a150, v174
    v_accvgpr_write_b32 a151, v175
    v_accvgpr_write_b32 a228, v176
    v_accvgpr_write_b32 a229, v177
    v_accvgpr_write_b32 a230, v178
    v_accvgpr_write_b32 a231, v179
    v_mov_b32 v244, v180
    v_mov_b32 v245, v181
    v_mov_b32 v246, v182
    v_mov_b32 v247, v183
    s_call_b64 s[70:71], C_swBsub
    v_accvgpr_write_b32 a72, v168
    v_accvgpr_write_b32 a73, v169
    v_accvgpr_write_b32 a74, v170
    v_accvgpr_write_b32 a75, v171
    v_accvgpr_write_b32 a152, v172
    v_accvgpr_write_b32 a153, v173
    v_accvgpr_write_b32 a154, v174
    v_accvgpr_write_b32 a155, v175
    v_accvgpr_write_b32 a232, v176
    v_accvgpr_write_b32 a233, v177
    v_accvgpr_write_b32 a234, v178
    v_accvgpr_write_b32 a235, v179
    v_mov_b32 v248, v180
    v_mov_b32 v249, v181
    v_mov_b32 v250, v182
    v_mov_b32 v251, v183
    s_call_b64 s[70:71], C_swBsub
    v_accvgpr_write_b32 a76, v168
    v_accvgpr_write_b32 a77, v169
    v_accvgpr_write_b32 a78, v170
    v_accvgpr_write_b32 a79, v171
    v_accvgpr_write_b32 a156, v172
    v_accvgpr_write_b32 a157, v173
    v_accvgpr_write_b32 a158, v174
    v_accvgpr_write_b32 a159, v175
    v_accvgpr_write_b32 a236, v176
    v_accvgpr_write_b32 a237, v177
    v_accvgpr_write_b32 a238, v178
    v_accvgpr_write_b32 a239, v179
    v_mov_b32 v252, v180
    v_mov_b32 v253, v181
    v_mov_b32 v254, v182
    v_mov_b32 v255, v183
    s_waitcnt vmcnt(0)
C_swJ:
    s_barrier
    s_cmp_lg_u32 s9, 0
    s_cbranch_scc1 dw_1b
    v_mov_b32 v20, 160
    s_mov_b32 s58, 0
dw_1:
    buffer_load_dword v21, v20, s[20:23], 0 offen sc1
    s_waitcnt vmcnt(0)
    v_readfirstlane_b32 s59, v21
    s_nop 3
    s_cmp_ge_u32 s59, 12
    s_cbranch_scc1 dw_1b
    s_sleep 16
    s_add_u32 s58, s58, 1
    s_cmp_lt_u32 s58, 0x80000
    s_cbranch_scc1 dw_1
dw_1b:
    s_barrier
    s_waitcnt vmcnt(0)
    s_add_u32 s40, s49, 1982464
    v_mov_b32 v20, s40
C_hs:
    buffer_load_dword v21, v20, s[12:15], 0 offen sc1
    s_waitcnt vmcnt(0)
    v_readfirstlane_b32 s40, v21
    s_nop 3
    s_cmp_lg_u32 s40, 0
    s_cbranch_scc1 C_hsd
    s_mov_b32 s50, 0
    s_add_u32 s50, s50, 1
    s_cmp_lt_u32 s50, 0x200000
    s_cbranch_scc1 C_hs
    s_branch C_abort
C_hsd:
    s_cmp_eq_u32 s40, 2
    s_cselect_b32 s29, 8192, 0
    v_and_b32 v20, 15, v1
    v_lshrrev_b32 v21, 4, v1
    v_and_b32 v22, 7, v1
    v_bfe_u32 v23, v1, 3, 1
    s_mul_i32 s40, s9, 160
    v_add_u32 v2, s40, v1
    v_lshlrev_b32 v2, 4, v2
    v_add_u32 v3, 128, v1
    v_min_u32 v3, 159, v3
    v_add_u32 v3, s40, v3
    v_lshlrev_b32 v3, 4, v3
    v_lshlrev_b32 v4, 7, v21
    v_lshl_add_u32 v4, v22, 4, v4
    s_mul_i32 s40, s9, 3072
    v_lshlrev_b32 v24, 4, v1
    v_add_u32 v15, s40, v24
    v_add_u32 v15, 10240, v15
    s_lshl_b32 s40, s9, 10
    v_add_u32 v16, s40, v24
    v_add_u32 v18, 22528, v16
    v_add_u32 v16, 10240, v16
    s_lshl_b32 s40, s9, 12
    v_add_u32 v17, s40, v24
    v_add_u32 v17, 22528, v17
    s_mul_i32 s40, s25, 3
    s_add_u32 s40, s40, s24
    s_mul_i32 s40, s40, 1536
    s_lshl_b32 s41, s9, 9
    s_add_u32 s40, s40, s41
    s_add_u32 s40, s40, 368640
    v_add_u32 v5, s40, v4
    s_mul_i32 s40, s52, 4608
    s_add_u32 s40, s40, 368640
    v_lshlrev_b32 v6, 9, v23
    v_add_u32 v6, v6, v4
    v_add_u32 v6, s40, v6
    v_add_u32 v6, 512, v6
    v_and_b32 v24, 1, v21
    v_lshlrev_b32 v7, 7, v24
    v_lshl_add_u32 v7, v22, 4, v7
    v_lshrrev_b32 v24, 1, v21
    v_lshl_add_u32 v24, v24, 1, v23
    v_lshl_add_u32 v7, v24, 2, v7
    v_add_u32 v7, s40, v7
    s_add_u32 s41, s28, s9
    s_lshr_b32 s40, s41, 1
    s_lshl_b32 s40, s40, 14
    s_and_b32 s41, s41, 1
    s_lshl_b32 s41, s41, 9
    s_add_u32 s40, s40, s41
    s_lshl_b32 s41, s8, 1
    s_add_u32 s41, s41, s27
    s_lshl_b32 s41, s41, 10
    s_add_u32 s40, s40, s41
    s_add_u32 s40, s40, s29
    v_add_u32 v8, s40, v4
    s_lshl_b32 s40, s10, 14
    s_add_u32 s40, s40, s29
    v_lshlrev_b32 v9, 4, v1
    v_add_u32 v9, s40, v9
    v_bfe_u32 v24, v1, 3, 2
    v_lshlrev_b32 v10, 7, v24
    v_lshl_add_u32 v10, v22, 4, v10
    v_lshrrev_b32 v24, 5, v1
    v_lshl_add_u32 v10, v24, 3, v10
    s_mul_i32 s40, s8, 10240
    s_lshl_b32 s41, s10, 9
    s_add_u32 s40, s40, s41
    s_add_u32 s40, s40, 327680
    v_add_u32 v10, s40, v10
    s_mul_i32 s40, s25, 12288
    s_lshl_b32 s41, s26, 10
    s_add_u32 s41, s41, s40
    s_add_u32 s41, s41, 4194304
    v_lshlrev_b32 v11, 5, v20
    v_and_b32 v24, 1, v21
    v_lshl_add_u32 v11, v24, 4, v11
    v_lshrrev_b32 v24, 1, v21
    v_lshl_add_u32 v11, v24, 3, v11
    v_add_u32 v11, s41, v11
    s_lshl_b32 s41, s9, 10
    v_subrev_u32 v11, s41, v11
    s_add_u32 s41, s9, 1
    s_and_b32 s41, s41, 1
    s_lshl_b32 s41, s41, 9
    v_add_u32 v11, s41, v11
    v_lshlrev_b32 v16, 4, v1
    v_add_u32 v16, 10240, v16
    s_lshr_b32 s41, s9, 1
    s_lshl_b32 s41, s41, 10
    s_and_b32 s42, s9, 1
    s_lshl_b32 s42, s42, 3
    s_add_u32 s41, s41, s42
    v_add_u32 v15, s41, v16
    s_mul_i32 s40, s52, 40
    s_add_u32 s40, s40, s28
    s_lshl_b32 s41, s40, 10
    s_add_u32 s41, s41, 96468992
    v_lshlrev_b32 v12, 4, v1
    v_add_u32 v12, s41, v12
    s_lshl_b32 s41, s40, 8
    s_add_u32 s41, s41, 180355072
    v_lshlrev_b32 v14, 7, v21
    v_lshl_add_u32 v14, v20, 3, v14
    v_add_u32 v14, s41, v14
    s_mul_i32 s40, s25, 3072
    s_lshl_b32 s41, s26, 8
    s_add_u32 s40, s40, s41
    v_lshlrev_b32 v13, 5, v22
    v_and_b32 v24, 1, v21
    v_lshl_add_u32 v13, v24, 4, v13
    v_lshrrev_b32 v24, 1, v21
    v_lshl_add_u32 v13, v24, 3, v13
    s_add_u32 s41, s40, 89128960
    v_add_u32 v13, s41, v13
    v_mov_b32 v24, -1
    v_mov_b32 v25, -1
    v_mov_b32 v26, -1
    v_mov_b32 v27, -1
    s_mov_b32 s44, 0x00ff00ff
    s_mov_b32 s45, 0x00ff00ff
    s_mov_b32 s46, 0x3dd53b95
    s_mul_i32 s47, s8, 10240
    s_add_u32 s47, s47, 327680
    s_mov_b32 s30, 0
    s_mov_b32 s31, s49
    s_add_u32 s33, s49, 655360
    s_add_u32 s32, s49, 1310720
    s_mov_b32 s34, 0
    s_mov_b32 s35, 0
    s_mov_b32 s36, 0
    s_mov_b32 s37, 0
    s_mov_b32 s54, 173015040
    s_mov_b32 s55, 81788928
    s_mov_b32 s50, 0
    s_mul_i32 s40, s25, 3
    s_add_u32 s40, s40, s24
    s_add_u32 s40, s40, 96
    s_lshl_b32 s40, s40, 7
    s_add_u32 s40, s40, 1986560
    s_mul_i32 s41, s28, 26
    s_lshr_b32 s41, s41, 8
    s_lshl_b32 s42, s52, 2
    s_add_u32 s41, s41, s42
    s_lshl_b32 s41, s41, 7
    s_add_u32 s41, s41, 2031616
    s_add_u32 s43, s28, 3
    s_min_u32 s43, s43, 39
    s_mul_i32 s43, s43, 26
    s_lshr_b32 s43, s43, 8
    s_add_u32 s43, s43, s42
    s_lshl_b32 s43, s43, 7
    s_add_u32 s43, s43, 2031616
    s_cmp_ge_u32 s10, 24
    s_cselect_b32 s40, s41, s40
    v_mov_b32 v19, s43
    v_mov_b32 v24, s41
    v_cmp_eq_u32 vcc, 1, v1
    s_nop 1
    v_cndmask_b32 v19, v19, v24, vcc
    v_mov_b32 v24, s40
    v_cmp_eq_u32 vcc, 0, v1
    s_nop 1
    v_cndmask_b32 v19, v19, v24, vcc
    v_add_u32 v19, s49, v19
    v_mov_b32 v24, -1
    v_and_b32 v20, 7, v1
    v_lshlrev_b32 v20, 4, v20
    v_bfe_u32 v21, v1, 3, 1
    v_lshl_add_u32 v20, v21, 3, v20
    v_lshrrev_b32 v22, 4, v1
    v_lshl_add_u32 v20, v22, 8, v20
    v_mov_b32 v106, 0x4444
    v_mov_b32 v22, 0xeeee
    v_cmp_eq_u32 vcc, 1, v21
    s_nop 1
    v_cndmask_b32 v106, v106, v22, vcc
    v_mov_b32 v0, v20
    v_and_b32 v20, 7, v1
    v_bfe_u32 v21, v1, 4, 1
    v_lshlrev_b32 v21, 2, v21
    v_sub_u32 v20, v20, v21
    v_mov_b32 v188, 0
    v_mov_b32 v189, 0
    v_mov_b32 v21, 0x3f80
    v_mov_b32 v22, 0x3f800000
    v_cmp_eq_u32 vcc, 0, v20
    s_nop 1
    v_cndmask_b32 v188, v188, v21, vcc
    v_cmp_eq_u32 vcc, 1, v20
    s_nop 1
    v_cndmask_b32 v188, v188, v22, vcc
    v_cmp_eq_u32 vcc, 2, v20
    s_nop 1
    v_cndmask_b32 v189, v189, v21, vcc
    v_cmp_eq_u32 vcc, 3, v20
    s_nop 1
    v_cndmask_b32 v189, v189, v22, vcc
    s_cmp_ge_u32 s10, 20
    s_cbranch_scc1 C_nomem0
    s_cmp_lg_u32 s9, 0
    s_cbranch_scc1 C_nomem0
    s_load_dwordx2 s[16:17], s[0:1], 8
    s_waitcnt lgkmcnt(0)
    s_and_b32 s17, s17, 0xffff
    s_mov_b32 s18, 10240
    s_mov_b32 s19, 0x00020000
    v_and_b32 v20, 7, v1
    v_mul_u32_u24 v20, 1280, v20
    v_bfe_u32 v21, v1, 3, 2
    v_lshl_add_u32 v20, v21, 3, v20
    v_lshrrev_b32 v21, 5, v1
    v_lshl_add_u32 v20, v21, 5, v20
    s_lshl_b32 s40, s10, 6
    v_add_u32 v20, s40, v20
    buffer_load_dwordx2 v[28:29], v20, s[16:19], 0 offen
    s_waitcnt vmcnt(0)
    v_permlane32_swap_b32 v28, v29
    buffer_store_dwordx2 v[28:29], v10, s[12:15], s31 offen
C_nomem0:
C_f0:
    buffer_load_dword v107, v19, s[12:15], 0 offen sc1
    s_waitcnt vmcnt(0)
    v_cmp_gt_u32 vcc, 1, v107
    s_cbranch_vccz C_f0d
    s_sleep 8
    s_add_u32 s50, s50, 1
    s_cmp_lt_u32 s50, 0x200000
    s_cbranch_scc1 C_f0
    s_branch C_abort
C_f0d:
    buffer_load_dwordx2 v[88:89], v11, s[12:15], s34 offen offset:0 sc1
    buffer_load_dwordx2 v[90:91], v11, s[12:15], s34 offen offset:1024 sc1
    buffer_load_dwordx2 v[100:101], v11, s[12:15], s34 offen offset:2048 sc1
    buffer_load_dwordx2 v[102:103], v11, s[12:15], s34 offen offset:3072 sc1
    s_cmp_ge_u32 s10, 24
    s_cbranch_scc1 C_y0B
    buffer_load_dwordx4 v[60:63], v12, s[12:15], s36 offen sc1
    buffer_load_dwordx4 v[64:67], v12, s[12:15], s36 offen offset:1024 sc1
    s_branch C_y0J
C_y0B:
    buffer_load_dwordx4 v[84:87], v12, s[12:15], s36 offen offset:0 sc1
    buffer_load_dwordx4 v[88:91], v12, s[12:15], s36 offen offset:1024 sc1
    buffer_load_dwordx4 v[92:95], v12, s[12:15], s36 offen offset:2048 sc1
    buffer_load_dwordx4 v[96:99], v12, s[12:15], s36 offen offset:3072 sc1
C_y0J:
    s_waitcnt vmcnt(0)
    s_cmp_ge_u32 s10, 24
    s_cbranch_scc1 C_Bstep
C_Astep:
    s_add_u32 s40, s31, s47
    buffer_load_dwordx4 v[28:31], v2, s[12:15], s40 offen offset:0 sc1
    buffer_load_dwordx4 v[32:35], v2, s[12:15], s40 offen offset:1024 sc1
    buffer_load_dwordx4 v[36:39], v3, s[12:15], s40 offen offset:0 sc1
    v_mov_b32 v68, 0
    v_mov_b32 v69, 0
    v_mov_b32 v70, 0
    v_mov_b32 v71, 0
    v_mov_b32 v72, 0
    v_mov_b32 v73, 0
    v_mov_b32 v74, 0
    v_mov_b32 v75, 0
    v_mov_b32 v92, 0
    v_mov_b32 v93, 0
    v_mov_b32 v94, 0
    v_mov_b32 v95, 0
    v_mov_b32 v96, 0
    v_mov_b32 v97, 0
    v_mov_b32 v98, 0
    v_mov_b32 v99, 0
    buffer_load_dwordx4 v[40:43], v2, s[12:15], s40 offen offset:0 sc1
    buffer_load_dwordx4 v[44:47], v2, s[12:15], s40 offen offset:1024 sc1
    buffer_load_dwordx4 v[48:51], v3, s[12:15], s40 offen offset:0 sc1
C_Ap0:
    s_waitcnt vmcnt(3)
    v_max3_u32 v20, v28, v29, v30
    v_max3_u32 v21, v31, v32, v33
    v_max3_u32 v20, v20, v34, v35
    v_max3_u32 v21, v21, v36, v37
    v_max3_u32 v20, v20, v38, v39
    v_max_u32 v20, v20, v21
    v_cmp_eq_u32 vcc, -1, v20
    s_cbranch_vccz C_Ap0A
    buffer_load_dwordx4 v[28:31], v2, s[12:15], s40 offen offset:0 sc1
    buffer_load_dwordx4 v[32:35], v2, s[12:15], s40 offen offset:1024 sc1
    buffer_load_dwordx4 v[36:39], v3, s[12:15], s40 offen offset:0 sc1
    s_waitcnt vmcnt(3)
    v_max3_u32 v20, v40, v41, v42
    v_max3_u32 v21, v43, v44, v45
    v_max3_u32 v20, v20, v46, v47
    v_max3_u32 v21, v21, v48, v49
    v_max3_u32 v20, v20, v50, v51
    v_max_u32 v20, v20, v21
    v_cmp_eq_u32 vcc, -1, v20
    s_cbranch_vccz C_Ap0B
    buffer_load_dwordx4 v[40:43], v2, s[12:15], s40 offen offset:0 sc1
    buffer_load_dwordx4 v[44:47], v2, s[12:15], s40 offen offset:1024 sc1
    buffer_load_dwordx4 v[48:51], v3, s[12:15], s40 offen offset:0 sc1
    s_add_u32 s50, s50, 1
    s_cmp_lt_u32 s50, 0x200000
    s_cbranch_scc1 C_Ap0
    s_branch C_abort
C_Ap0B:
    ds_write_b128 v2, v[40:43] offset:0
    ds_write_b128 v2, v[44:47] offset:1024
    ds_write_b128 v3, v[48:51] offset:0
    s_branch C_Ap0J
C_Ap0A:
    ds_write_b128 v2, v[28:31] offset:0
    ds_write_b128 v2, v[32:35] offset:1024
    ds_write_b128 v3, v[36:39] offset:0
C_Ap0J:
    v_add_u32 v20, 2048, v0
    v_add_u32 v21, 4096, v0
    v_add_u32 v22, 6144, v0
    v_add_u32 v23, 8192, v0
    s_waitcnt lgkmcnt(0)
    s_barrier
    ds_read2_b64 v[112:115], v0 offset0:0 offset1:16
    ds_read2_b64 v[116:119], v0 offset0:128 offset1:144
    ds_read2_b64 v[120:123], v20 offset0:0 offset1:16
    s_waitcnt lgkmcnt(2)
    v_smfmac_f32_16x16x64_bf16 v[92:95], v[112:115], a[0:7], v106
    ds_read2_b64 v[124:127], v20 offset0:128 offset1:144
    v_smfmac_f32_16x16x64_bf16 v[96:99], v[112:115], a[80:87], v106
    v_mov_b32 v52, v60
    v_mov_b32 v53, v61
    s_waitcnt lgkmcnt(2)
    v_smfmac_f32_16x16x64_bf16 v[92:95], v[116:119], a[8:15], v106
    ds_read2_b64 v[128:131], v21 offset0:0 offset1:16
    v_smfmac_f32_16x16x64_bf16 v[96:99], v[116:119], a[88:95], v106
    v_mov_b32 v54, v62
    v_mov_b32 v55, v63
    s_waitcnt lgkmcnt(2)
    v_smfmac_f32_16x16x64_bf16 v[92:95], v[120:123], a[16:23], v106
    ds_read2_b64 v[132:135], v21 offset0:128 offset1:144
    v_smfmac_f32_16x16x64_bf16 v[96:99], v[120:123], a[96:103], v106
    v_mov_b32 v56, v64
    v_mov_b32 v57, v65
    s_waitcnt lgkmcnt(2)
    v_smfmac_f32_16x16x64_bf16 v[92:95], v[124:127], a[24:31], v106
    ds_read2_b64 v[136:139], v22 offset0:0 offset1:16
    v_smfmac_f32_16x16x64_bf16 v[96:99], v[124:127], a[104:111], v106
    v_mov_b32 v58, v66
    v_mov_b32 v59, v67
    s_waitcnt lgkmcnt(2)
    v_smfmac_f32_16x16x64_bf16 v[92:95], v[128:131], a[32:39], v106
    ds_read2_b64 v[140:143], v22 offset0:128 offset1:144
    v_smfmac_f32_16x16x64_bf16 v[96:99], v[128:131], a[112:119], v106
    v_mov_b32 v76, v88
    v_mov_b32 v77, v89
    s_waitcnt lgkmcnt(2)
    v_smfmac_f32_16x16x64_bf16 v[92:95], v[132:135], a[40:47], v106
    ds_read2_b64 v[144:147], v23 offset0:0 offset1:16
    v_smfmac_f32_16x16x64_bf16 v[96:99], v[132:135], a[120:127], v106
    v_mov_b32 v78, v90
    v_mov_b32 v79, v91
    s_waitcnt lgkmcnt(2)
    v_smfmac_f32_16x16x64_bf16 v[92:95], v[136:139], a[48:55], v106
    ds_read2_b64 v[148:151], v23 offset0:128 offset1:144
    v_smfmac_f32_16x16x64_bf16 v[96:99], v[136:139], a[128:135], v106
    v_mov_b32 v80, v100
    v_mov_b32 v81, v101
    s_waitcnt lgkmcnt(2)
    v_smfmac_f32_16x16x64_bf16 v[92:95], v[140:143], a[56:63], v106
    v_smfmac_f32_16x16x64_bf16 v[96:99], v[140:143], a[136:143], v106
    v_mov_b32 v82, v102
    v_mov_b32 v83, v103
    s_waitcnt lgkmcnt(1)
    v_smfmac_f32_16x16x64_bf16 v[92:95], v[144:147], a[64:71], v106
    v_smfmac_f32_16x16x64_bf16 v[96:99], v[144:147], a[144:151], v106
    s_add_u32 s38, s36, 1310720
    s_add_u32 s39, s34, 393216
    s_cmp_eq_u32 s30, 63
    s_cselect_b32 s38, s36, s38
    s_cselect_b32 s39, s34, s39
    s_waitcnt lgkmcnt(0)
    v_smfmac_f32_16x16x64_bf16 v[92:95], v[148:151], a[72:79], v106
    v_smfmac_f32_16x16x64_bf16 v[96:99], v[148:151], a[152:159], v106
    s_add_u32 s53, s30, 2
    s_min_u32 s53, s53, 64
    v_cmp_gt_u32 vcc, s53, v107
    s_cbranch_vccz C_Apfok
C_Apfw:
    buffer_load_dword v107, v19, s[12:15], 0 offen sc1
    s_waitcnt vmcnt(0)
    v_cmp_gt_u32 vcc, s53, v107
    s_cbranch_vccz C_Apfwd
    s_sleep 8
    s_add_u32 s50, s50, 1
    s_cmp_lt_u32 s50, 0x200000
    s_cbranch_scc1 C_Apfw
    s_branch C_abort
C_Apfwd:
C_Apfok:
    s_add_u32 s53, s53, 2
    s_min_u32 s53, s53, 64
    v_cmp_gt_u32 vcc, s53, v107
    s_mov_b64 s[56:57], vcc
    s_cmp_ge_u32 s9, 2
    s_cbranch_scc1 C_Anxr
    s_mov_b64 exec, s[44:45]
    buffer_store_dwordx4 v[24:27], v8, s[12:15], s33 offen sc1
    s_mov_b64 exec, -1
C_Anxr:
    s_nop 1
    s_nop 4
    v_cvt_pk_bf16_f32 v152, v92, v93
    v_cvt_pk_bf16_f32 v153, v94, v95
    v_cvt_pk_bf16_f32 v154, v96, v97
    v_cvt_pk_bf16_f32 v155, v98, v99
    v_mfma_f32_16x16x16_bf16 v[156:159], v[152:153], v[188:189], 0
    s_nop 0
    v_mfma_f32_16x16x16_bf16 v[160:163], v[154:155], v[188:189], 0
    s_nop 1
    s_nop 3
    v_cvt_pk_bf16_f32 v84, v156, v157
    v_cvt_pk_bf16_f32 v85, v158, v159
    v_cvt_pk_bf16_f32 v86, v160, v161
    v_cvt_pk_bf16_f32 v87, v162, v163
    ds_write_b64 v15, v[84:85]
    ds_write_b64 v15, v[86:87] offset:2048
    v_smfmac_f32_16x16x64_bf16 v[68:71], v[112:115], a[160:167], v106
    v_smfmac_f32_16x16x64_bf16 v[72:75], v[112:115], a[240:247], v106
    v_smfmac_f32_16x16x64_bf16 v[68:71], v[116:119], a[168:175], v106
    s_waitcnt lgkmcnt(0)
    s_barrier
    s_cmp_eq_u32 s9, 3
    s_cbranch_scc1 C_Anored
    ds_read_b128 v[152:155], v16
    ds_read_b128 v[156:159], v16 offset:1024
    s_cmp_lg_u32 s9, 0
    s_cbranch_scc1 C_Ascx
    ds_read_b128 v[160:163], v16 offset:2048
    ds_read_b128 v[164:167], v16 offset:3072
    s_waitcnt lgkmcnt(1)
    v_mfma_f32_16x16x32_bf16 v[168:171], v[160:163], v[152:155], 0
    s_waitcnt lgkmcnt(0)
    v_mfma_f32_16x16x32_bf16 v[168:171], v[164:167], v[156:159], v[168:171]
    s_branch C_Ascj
C_Ascx:
    s_waitcnt lgkmcnt(1)
    v_mfma_f32_16x16x32_bf16 v[168:171], v[76:79], v[152:155], 0
    s_waitcnt lgkmcnt(0)
    v_mfma_f32_16x16x32_bf16 v[168:171], v[80:83], v[156:159], v[168:171]
C_Ascj:
    v_smfmac_f32_16x16x64_bf16 v[72:75], v[116:119], a[248:255], v106
    v_smfmac_f32_16x16x64_bf16 v[68:71], v[120:123], a[176:183], v106
    s_nop 5
    s_mov_b64 exec, s[44:45]
    buffer_store_dwordx4 v[168:171], v5, s[12:15], s31 offen
    s_mov_b64 exec, -1
    s_branch C_Aredj
C_Anored:
    v_smfmac_f32_16x16x64_bf16 v[72:75], v[116:119], a[248:255], v106
    v_smfmac_f32_16x16x64_bf16 v[68:71], v[120:123], a[176:183], v106
C_Aredj:
    v_smfmac_f32_16x16x64_bf16 v[72:75], v[120:123], v[192:199], v106
    v_smfmac_f32_16x16x64_bf16 v[68:71], v[124:127], a[184:191], v106
    v_smfmac_f32_16x16x64_bf16 v[72:75], v[124:127], v[200:207], v106
    v_smfmac_f32_16x16x64_bf16 v[68:71], v[128:131], a[192:199], v106
    v_smfmac_f32_16x16x64_bf16 v[72:75], v[128:131], v[208:215], v106
    v_smfmac_f32_16x16x64_bf16 v[68:71], v[132:135], a[200:207], v106
    v_smfmac_f32_16x16x64_bf16 v[72:75], v[132:135], v[216:223], v106
    v_smfmac_f32_16x16x64_bf16 v[68:71], v[136:139], a[208:215], v106
    v_smfmac_f32_16x16x64_bf16 v[72:75], v[136:139], v[224:231], v106
    v_smfmac_f32_16x16x64_bf16 v[68:71], v[140:143], a[216:223], v106
    v_smfmac_f32_16x16x64_bf16 v[72:75], v[140:143], v[232:239], v106
    v_smfmac_f32_16x16x64_bf16 v[68:71], v[144:147], a[224:231], v106
    buffer_load_dwordx4 v[28:31], v6, s[12:15], s31 offen offset:0 sc1
    buffer_load_dword v40, v7, s[12:15], s31 offen offset:0 sc1
    buffer_load_dwordx4 v[32:35], v6, s[12:15], s31 offen offset:1536 sc1
    buffer_load_dword v41, v7, s[12:15], s31 offen offset:1536 sc1
    buffer_load_dwordx4 v[36:39], v6, s[12:15], s31 offen offset:3072 sc1
    buffer_load_dword v42, v7, s[12:15], s31 offen offset:3072 sc1
    v_smfmac_f32_16x16x64_bf16 v[72:75], v[144:147], v[240:247], v106
    v_smfmac_f32_16x16x64_bf16 v[68:71], v[148:151], a[232:239], v106
    v_smfmac_f32_16x16x64_bf16 v[72:75], v[148:151], v[248:255], v106
    s_nop 7
    v_cvt_pk_bf16_f32 v152, v68, v69
    v_cvt_pk_bf16_f32 v153, v70, v71
    v_cvt_pk_bf16_f32 v154, v72, v73
    v_cvt_pk_bf16_f32 v155, v74, v75
    s_nop 1
    v_mfma_f32_16x16x16_bf16 v[160:163], v[188:189], v[152:153], 0
    v_mfma_f32_16x16x16_bf16 v[164:167], v[188:189], v[154:155], 0
    s_nop 7
    v_cvt_pk_bf16_f32 v84, v160, v161
    v_cvt_pk_bf16_f32 v85, v162, v163
    v_cvt_pk_bf16_f32 v104, v164, v165
    v_cvt_pk_bf16_f32 v105, v166, v167
    s_mov_b32 exec_hi, 0
    v_mov_b32 v112, v84
    v_mov_b32 v114, v104
    s_mov_b32 exec_lo, 0
    s_mov_b32 exec_hi, -1
    v_mov_b32 v112, v85
    v_mov_b32 v114, v105
    s_mov_b32 exec_lo, -1
    v_mov_b32 v113, 0
    v_mov_b32 v115, 0
    s_cmp_eq_u32 s30, 63
    s_cbranch_scc1 C_Alast
    s_waitcnt vmcnt(0)
    v_pk_add_f32 v[120:121], v[28:29], v[32:33]
    v_pk_add_f32 v[122:123], v[30:31], v[34:35]
    v_add_f32 v124, v40, v41
    v_pk_add_f32 v[120:121], v[120:121], v[36:37]
    v_pk_add_f32 v[122:123], v[122:123], v[38:39]
    v_add_f32 v124, v124, v42
    v_add_f32 v21, v120, v121
    v_max3_f32 v20, v120, v121, v122
    v_add_f32 v22, v122, v123
    v_max3_f32 v20, v20, v123, v124
    v_add_f32 v21, v21, v124
    v_add_f32 v21, v21, v22
    v_max_f32_dpp v20, v20, v20 row_ror:8 row_mask:0xf bank_mask:0xf
    v_cmp_u_f32 vcc, v21, v21
    s_cbranch_vccz C_Ap3d
C_Ap3poll:
    buffer_load_dwordx4 v[28:31], v6, s[12:15], s31 offen offset:0 sc1
    buffer_load_dword v40, v7, s[12:15], s31 offen offset:0 sc1
    buffer_load_dwordx4 v[32:35], v6, s[12:15], s31 offen offset:1536 sc1
    buffer_load_dword v41, v7, s[12:15], s31 offen offset:1536 sc1
    buffer_load_dwordx4 v[36:39], v6, s[12:15], s31 offen offset:3072 sc1
    buffer_load_dword v42, v7, s[12:15], s31 offen offset:3072 sc1
    s_waitcnt vmcnt(0)
    v_pk_add_f32 v[120:121], v[28:29], v[32:33]
    v_pk_add_f32 v[122:123], v[30:31], v[34:35]
    v_add_f32 v124, v40, v41
    v_pk_add_f32 v[120:121], v[120:121], v[36:37]
    v_pk_add_f32 v[122:123], v[122:123], v[38:39]
    v_add_f32 v124, v124, v42
    v_add_f32 v21, v120, v121
    v_max3_f32 v20, v120, v121, v122
    v_add_f32 v22, v122, v123
    v_max3_f32 v20, v20, v123, v124
    v_add_f32 v21, v21, v124
    v_add_f32 v21, v21, v22
    v_max_f32_dpp v20, v20, v20 row_ror:8 row_mask:0xf bank_mask:0xf
    v_cmp_u_f32 vcc, v21, v21
    s_cbranch_vccz C_Ap3d
    s_add_u32 s50, s50, 1
    s_cmp_lt_u32 s50, 0x200000
    s_cbranch_scc1 C_Ap3poll
    s_branch C_abort
C_Ap3d:
    v_mov_b32 v21, v20
    buffer_load_dwordx4 v[60:63], v12, s[12:15], s38 offen sc1
    buffer_load_dwordx4 v[64:67], v12, s[12:15], s38 offen offset:1024 sc1
    v_permlane16_swap_b32 v20, v21
    v_max_f32 v20, v20, v21
    v_mov_b32 v21, v20
    buffer_load_dwordx2 v[88:89], v11, s[12:15], s39 offen offset:0 sc1
    buffer_load_dwordx2 v[90:91], v11, s[12:15], s39 offen offset:1024 sc1
    v_permlane32_swap_b32 v20, v21
    v_max_f32 v20, v20, v21
    v_mul_f32 v20, s46, v20
    v_fma_f32 v120, v120, s46, -v20
    v_fma_f32 v121, v121, s46, -v20
    v_fma_f32 v122, v122, s46, -v20
    v_fma_f32 v123, v123, s46, -v20
    v_fma_f32 v124, v124, s46, -v20
    v_exp_f32 v120, v120
    v_exp_f32 v121, v121
    v_exp_f32 v122, v122
    v_exp_f32 v123, v123
    v_exp_f32 v124, v124
    s_nop 0
    v_cvt_pk_bf16_f32 v108, v120, v121
    v_cvt_pk_bf16_f32 v109, v122, v123
    v_mov_b32_dpp v23, v124 row_ror:8 row_mask:0xf bank_mask:0xf
    v_add_f32 v22, v120, v121
    v_mov_b32_dpp v110, v108 row_ror:8 row_mask:0xf bank_mask:0xf
    v_mov_b32_dpp v111, v109 row_ror:8 row_mask:0xf bank_mask:0xf
    v_cvt_pk_bf16_f32 v126, v124, v23
    v_mov_b32 v127, 0
    v_add_f32 v23, v122, v123
    v_add_f32 v22, v22, v124
    v_mfma_f32_16x16x32_bf16 v[128:131], v[52:55], v[108:111], 0
    v_add_f32 v22, v22, v23
    s_nop 0
    v_mfma_f32_16x16x32_bf16 v[132:135], v[56:59], v[108:111], 0
    v_add_f32_dpp v22, v22, v22 row_ror:8 row_mask:0xf bank_mask:0xf
    v_mov_b32 v23, v22
    s_nop 1
    v_permlane16_swap_b32 v22, v23
    v_mfma_f32_16x16x16_bf16 v[128:131], v[112:113], v[126:127], v[128:131]
    v_add_f32 v22, v22, v23
    v_mov_b32 v23, v22
    v_mfma_f32_16x16x16_bf16 v[132:135], v[114:115], v[126:127], v[132:135]
    s_nop 1
    v_permlane32_swap_b32 v22, v23
    v_add_f32 v22, v22, v23
    v_rcp_f32 v22, v22
    s_nop 1
    v_pk_mul_f32 v[128:129], v[128:129], v[22:23] op_sel_hi:[1,0]
    v_pk_mul_f32 v[130:131], v[130:131], v[22:23] op_sel_hi:[1,0]
    ds_write_b128 v17, v[128:131] offset:0
    v_pk_mul_f32 v[132:133], v[132:133], v[22:23] op_sel_hi:[1,0]
    v_pk_mul_f32 v[134:135], v[134:135], v[22:23] op_sel_hi:[1,0]
    ds_write_b128 v17, v[132:135] offset:1024
    buffer_load_dwordx2 v[100:101], v11, s[12:15], s39 offen offset:2048 sc1
    buffer_load_dwordx2 v[102:103], v11, s[12:15], s39 offen offset:3072 sc1
    s_cmp_eq_u64 s[56:57], 0
    s_cbranch_scc1 C_Anfl
    buffer_load_dword v107, v19, s[12:15], 0 offen sc1
C_Anfl:
    s_mov_b64 exec, s[44:45]
    buffer_store_dwordx2 v[86:87], v13, s[12:15], s35 offen sc1
    s_mov_b64 exec, -1
    s_mov_b32 exec_hi, 0
    buffer_store_dwordx2 v[84:85], v14, s[12:15], s37 offen offset:0 sc1
    s_mov_b32 exec_hi, -1
    s_mov_b32 exec_hi, 0
    buffer_store_dwordx2 v[104:105], v14, s[12:15], s37 offen offset:256 sc1
    s_mov_b32 exec_hi, -1
    s_waitcnt lgkmcnt(0)
    s_barrier
    s_cmp_ge_u32 s9, 2
    s_cbranch_scc1 C_Anopub
    ds_read_b128 v[144:147], v18
    ds_read_b128 v[148:151], v18 offset:4096
    ds_read_b128 v[128:131], v18 offset:8192
    ds_read_b128 v[132:135], v18 offset:12288
    s_waitcnt lgkmcnt(2)
    v_pk_add_f32 v[144:145], v[144:145], v[148:149]
    v_pk_add_f32 v[146:147], v[146:147], v[150:151]
    s_waitcnt lgkmcnt(0)
    v_pk_add_f32 v[128:129], v[128:129], v[132:133]
    v_pk_add_f32 v[130:131], v[130:131], v[134:135]
    v_pk_add_f32 v[144:145], v[144:145], v[128:129]
    v_pk_add_f32 v[146:147], v[146:147], v[130:131]
    s_mov_b64 exec, s[44:45]
    buffer_store_dwordx4 v[144:147], v8, s[12:15], s31 offen sc1
    s_mov_b64 exec, -1
C_Anopub:
    s_cmp_eq_u32 s9, 3
    s_cbranch_scc1 C_Anors
    s_mov_b64 exec, s[44:45]
    buffer_store_dwordx4 v[24:27], v5, s[12:15], s32 offen
    s_mov_b64 exec, -1
C_Anors:
    s_cmp_lg_u32 s9, 3
    s_cbranch_scc1 C_Asg
    s_lshl_b32 s40, s8, 5
    s_add_u32 s40, s40, s10
    s_lshl_b32 s40, s40, 7
    s_add_u32 s40, s40, s49
    s_add_u32 s40, s40, 2048000
    v_mov_b32 v20, s40
    v_mov_b32 v21, s30
    s_mov_b64 exec, 1
    buffer_store_dword v21, v20, s[12:15], 0 offen sc1
    s_mov_b64 exec, -1
C_Asg:
    s_cmp_ge_u32 s10, 20
    s_cbranch_scc1 C_Anextw
    s_cmp_lg_u32 s9, 2
    s_cbranch_scc1 C_Ap5done
    v_add_u32 v23, 4096, v9
    buffer_store_dwordx2 v[24:25], v10, s[12:15], s32 offen
    s_sleep 11
C_Ap5:
    buffer_load_dwordx4 v[152:155], v9, s[12:15], s31 offen offset:0 sc1
    buffer_load_dwordx4 v[156:159], v9, s[12:15], s31 offen offset:1024 sc1
    buffer_load_dwordx4 v[160:163], v9, s[12:15], s31 offen offset:2048 sc1
    buffer_load_dwordx4 v[164:167], v9, s[12:15], s31 offen offset:3072 sc1
    buffer_load_dwordx4 v[168:171], v23, s[12:15], s31 offen offset:0 sc1
    buffer_load_dwordx4 v[172:175], v23, s[12:15], s31 offen offset:1024 sc1
    buffer_load_dwordx4 v[176:179], v23, s[12:15], s31 offen offset:2048 sc1
    buffer_load_dwordx4 v[180:183], v23, s[12:15], s31 offen offset:3072 sc1
    s_waitcnt vmcnt(6)
    v_pk_add_f32 v[152:153], v[152:153], v[156:157]
    v_pk_add_f32 v[154:155], v[154:155], v[158:159]
    s_waitcnt vmcnt(4)
    v_pk_add_f32 v[160:161], v[160:161], v[164:165]
    v_pk_add_f32 v[162:163], v[162:163], v[166:167]
    v_pk_add_f32 v[152:153], v[152:153], v[160:161]
    v_pk_add_f32 v[154:155], v[154:155], v[162:163]
    s_waitcnt vmcnt(2)
    v_pk_add_f32 v[168:169], v[168:169], v[172:173]
    v_pk_add_f32 v[170:171], v[170:171], v[174:175]
    v_pk_add_f32 v[152:153], v[152:153], v[168:169]
    v_pk_add_f32 v[154:155], v[154:155], v[170:171]
    s_waitcnt vmcnt(0)
    v_pk_add_f32 v[176:177], v[176:177], v[180:181]
    v_pk_add_f32 v[178:179], v[178:179], v[182:183]
    v_pk_add_f32 v[152:153], v[152:153], v[176:177]
    v_pk_add_f32 v[154:155], v[154:155], v[178:179]
    v_cvt_pk_bf16_f32 v20, v152, v153
    v_cvt_pk_bf16_f32 v21, v154, v155
    v_add_f32 v22, v152, v153
    v_add_f32 v156, v154, v155
    v_add_f32 v22, v22, v156
    v_cmp_u_f32 vcc, v22, v22
    s_cbranch_vccz C_Ap5d
    s_add_u32 s50, s50, 1
    s_cmp_lt_u32 s50, 0x200000
    s_cbranch_scc1 C_Ap5
    s_branch C_abort
C_Ap5d:
    v_permlane32_swap_b32 v20, v21
    buffer_store_dwordx2 v[20:21], v10, s[12:15], s33 offen
C_Ap5done:
    s_barrier
    s_branch C_Anext
C_Anextw:
C_Anext:
    s_add_u32 s30, s30, 1
    s_mov_b32 s40, s31
    s_mov_b32 s31, s33
    s_mov_b32 s33, s32
    s_mov_b32 s32, s40
    s_mov_b32 s54, s35
    s_mov_b32 s55, s37
    s_add_u32 s34, s34, 393216
    s_add_u32 s35, s35, 98304
    s_add_u32 s36, s36, 1310720
    s_add_u32 s37, s37, 327680
    s_branch C_Astep
C_Alast:
    s_cmp_lg_u32 s9, 3
    s_cbranch_scc1 C_Asgl
    s_lshl_b32 s40, s8, 5
    s_add_u32 s40, s40, s10
    s_lshl_b32 s40, s40, 7
    s_add_u32 s40, s40, s49
    s_add_u32 s40, s40, 2048000
    v_mov_b32 v20, s40
    v_mov_b32 v21, s30
    s_mov_b64 exec, 1
    buffer_store_dword v21, v20, s[12:15], 0 offen sc1
    s_mov_b64 exec, -1
C_Asgl:
    s_mov_b64 exec, s[44:45]
    buffer_store_dwordx2 v[86:87], v13, s[12:15], s35 offen sc1
    s_mov_b32 exec_lo, -1
    s_mov_b32 exec_hi, 0
    buffer_store_dwordx2 v[84:85], v14, s[12:15], s37 offen offset:0 sc1
    buffer_store_dwordx2 v[104:105], v14, s[12:15], s37 offen offset:256 sc1
    s_mov_b64 exec, -1
    s_branch C_done
C_Bstep:
    s_add_u32 s40, s31, s47
    buffer_load_dwordx4 v[28:31], v2, s[12:15], s40 offen offset:0 sc1
    buffer_load_dwordx4 v[32:35], v2, s[12:15], s40 offen offset:1024 sc1
    buffer_load_dwordx4 v[36:39], v3, s[12:15], s40 offen offset:0 sc1
    v_mov_b32 v68, 0
    v_mov_b32 v69, 0
    v_mov_b32 v70, 0
    v_mov_b32 v71, 0
    v_mov_b32 v72, 0
    v_mov_b32 v73, 0
    v_mov_b32 v74, 0
    v_mov_b32 v75, 0
    v_mov_b32 v76, 0
    v_mov_b32 v77, 0
    v_mov_b32 v78, 0
    v_mov_b32 v79, 0
    v_mov_b32 v80, 0
    v_mov_b32 v81, 0
    v_mov_b32 v82, 0
    v_mov_b32 v83, 0
    buffer_load_dwordx4 v[40:43], v2, s[12:15], s40 offen offset:0 sc1
    buffer_load_dwordx4 v[44:47], v2, s[12:15], s40 offen offset:1024 sc1
    buffer_load_dwordx4 v[48:51], v3, s[12:15], s40 offen offset:0 sc1
C_Bp0:
    s_waitcnt vmcnt(3)
    v_max3_u32 v20, v28, v29, v30
    v_max3_u32 v21, v31, v32, v33
    v_max3_u32 v20, v20, v34, v35
    v_max3_u32 v21, v21, v36, v37
    v_max3_u32 v20, v20, v38, v39
    v_max_u32 v20, v20, v21
    v_cmp_eq_u32 vcc, -1, v20
    s_cbranch_vccz C_Bp0A
    buffer_load_dwordx4 v[28:31], v2, s[12:15], s40 offen offset:0 sc1
    buffer_load_dwordx4 v[32:35], v2, s[12:15], s40 offen offset:1024 sc1
    buffer_load_dwordx4 v[36:39], v3, s[12:15], s40 offen offset:0 sc1
    s_waitcnt vmcnt(3)
    v_max3_u32 v20, v40, v41, v42
    v_max3_u32 v21, v43, v44, v45
    v_max3_u32 v20, v20, v46, v47
    v_max3_u32 v21, v21, v48, v49
    v_max3_u32 v20, v20, v50, v51
    v_max_u32 v20, v20, v21
    v_cmp_eq_u32 vcc, -1, v20
    s_cbranch_vccz C_Bp0B
    buffer_load_dwordx4 v[40:43], v2, s[12:15], s40 offen offset:0 sc1
    buffer_load_dwordx4 v[44:47], v2, s[12:15], s40 offen offset:1024 sc1
    buffer_load_dwordx4 v[48:51], v3, s[12:15], s40 offen offset:0 sc1
    s_add_u32 s50, s50, 1
    s_cmp_lt_u32 s50, 0x200000
    s_cbranch_scc1 C_Bp0
    s_branch C_abort
C_Bp0B:
    ds_write_b128 v2, v[40:43] offset:0
    ds_write_b128 v2, v[44:47] offset:1024
    ds_write_b128 v3, v[48:51] offset:0
    s_branch C_Bp0J
C_Bp0A:
    ds_write_b128 v2, v[28:31] offset:0
    ds_write_b128 v2, v[32:35] offset:1024
    ds_write_b128 v3, v[36:39] offset:0
C_Bp0J:
    v_add_u32 v20, 2048, v0
    v_add_u32 v21, 4096, v0
    v_add_u32 v22, 6144, v0
    v_add_u32 v23, 8192, v0
    s_waitcnt lgkmcnt(0)
    s_barrier
    ds_read2_b64 v[112:115], v0 offset0:0 offset1:16
    ds_read2_b64 v[116:119], v0 offset0:128 offset1:144
    ds_read2_b64 v[120:123], v20 offset0:0 offset1:16
    s_waitcnt lgkmcnt(2)
    v_smfmac_f32_16x16x64_bf16 v[68:71], v[112:115], a[0:7], v106
    ds_read2_b64 v[124:127], v20 offset0:128 offset1:144
    v_smfmac_f32_16x16x64_bf16 v[72:75], v[112:115], a[80:87], v106
    v_mov_b32 v52, v84
    v_mov_b32 v53, v85
    v_smfmac_f32_16x16x64_bf16 v[76:79], v[112:115], a[160:167], v106
    v_mov_b32 v54, v86
    v_mov_b32 v55, v87
    v_smfmac_f32_16x16x64_bf16 v[80:83], v[112:115], a[240:247], v106
    s_waitcnt lgkmcnt(2)
    v_smfmac_f32_16x16x64_bf16 v[68:71], v[116:119], a[8:15], v106
    ds_read2_b64 v[128:131], v21 offset0:0 offset1:16
    v_smfmac_f32_16x16x64_bf16 v[72:75], v[116:119], a[88:95], v106
    v_mov_b32 v56, v88
    v_mov_b32 v57, v89
    v_smfmac_f32_16x16x64_bf16 v[76:79], v[116:119], a[168:175], v106
    v_mov_b32 v58, v90
    v_mov_b32 v59, v91
    v_smfmac_f32_16x16x64_bf16 v[80:83], v[116:119], a[248:255], v106
    s_waitcnt lgkmcnt(2)
    v_smfmac_f32_16x16x64_bf16 v[68:71], v[120:123], a[16:23], v106
    ds_read2_b64 v[132:135], v21 offset0:128 offset1:144
    v_smfmac_f32_16x16x64_bf16 v[72:75], v[120:123], a[96:103], v106
    v_mov_b32 v60, v92
    v_mov_b32 v61, v93
    v_smfmac_f32_16x16x64_bf16 v[76:79], v[120:123], a[176:183], v106
    v_mov_b32 v62, v94
    v_mov_b32 v63, v95
    v_smfmac_f32_16x16x64_bf16 v[80:83], v[120:123], v[192:199], v106
    s_waitcnt lgkmcnt(2)
    v_smfmac_f32_16x16x64_bf16 v[68:71], v[124:127], a[24:31], v106
    ds_read2_b64 v[136:139], v22 offset0:0 offset1:16
    v_smfmac_f32_16x16x64_bf16 v[72:75], v[124:127], a[104:111], v106
    v_mov_b32 v64, v96
    v_mov_b32 v65, v97
    v_smfmac_f32_16x16x64_bf16 v[76:79], v[124:127], a[184:191], v106
    v_mov_b32 v66, v98
    v_mov_b32 v67, v99
    v_smfmac_f32_16x16x64_bf16 v[80:83], v[124:127], v[200:207], v106
    s_waitcnt lgkmcnt(2)
    v_smfmac_f32_16x16x64_bf16 v[68:71], v[128:131], a[32:39], v106
    ds_read2_b64 v[140:143], v22 offset0:128 offset1:144
    v_smfmac_f32_16x16x64_bf16 v[72:75], v[128:131], a[112:119], v106
    s_add_u32 s38, s36, 1310720
    s_add_u32 s39, s34, 393216
    s_cmp_eq_u32 s30, 63
    s_cselect_b32 s38, s36, s38
    s_cselect_b32 s39, s34, s39
    v_smfmac_f32_16x16x64_bf16 v[76:79], v[128:131], a[192:199], v106
    s_add_u32 s53, s30, 2
    s_min_u32 s53, s53, 64
    v_cmp_gt_u32 vcc, s53, v107
    s_cbranch_vccz C_Bpfok
C_Bpfw:
    buffer_load_dword v107, v19, s[12:15], 0 offen sc1
    s_waitcnt vmcnt(0)
    v_cmp_gt_u32 vcc, s53, v107
    s_cbranch_vccz C_Bpfwd
    s_sleep 8
    s_add_u32 s50, s50, 1
    s_cmp_lt_u32 s50, 0x200000
    s_cbranch_scc1 C_Bpfw
    s_branch C_abort
C_Bpfwd:
C_Bpfok:
    s_add_u32 s53, s53, 2
    s_min_u32 s53, s53, 64
    v_cmp_gt_u32 vcc, s53, v107
    s_mov_b64 s[56:57], vcc
    v_smfmac_f32_16x16x64_bf16 v[80:83], v[128:131], v[208:215], v106
    s_waitcnt lgkmcnt(2)
    v_smfmac_f32_16x16x64_bf16 v[68:71], v[132:135], a[40:47], v106
    ds_read2_b64 v[144:147], v23 offset0:0 offset1:16
    v_smfmac_f32_16x16x64_bf16 v[72:75], v[132:135], a[120:127], v106
    s_cmp_ge_u32 s9, 4
    s_cbranch_scc1 C_Bnxr
    s_mov_b64 exec, s[44:45]
    buffer_store_dwordx4 v[24:27], v8, s[12:15], s33 offen sc1
    s_mov_b64 exec, -1
C_Bnxr:
    v_smfmac_f32_16x16x64_bf16 v[76:79], v[132:135], a[200:207], v106
    v_smfmac_f32_16x16x64_bf16 v[80:83], v[132:135], v[216:223], v106
    s_waitcnt lgkmcnt(2)
    v_smfmac_f32_16x16x64_bf16 v[68:71], v[136:139], a[48:55], v106
    ds_read2_b64 v[148:151], v23 offset0:128 offset1:144
    v_smfmac_f32_16x16x64_bf16 v[72:75], v[136:139], a[128:135], v106
    v_smfmac_f32_16x16x64_bf16 v[76:79], v[136:139], a[208:215], v106
    v_smfmac_f32_16x16x64_bf16 v[80:83], v[136:139], v[224:231], v106
    s_waitcnt lgkmcnt(2)
    v_smfmac_f32_16x16x64_bf16 v[68:71], v[140:143], a[56:63], v106
    v_smfmac_f32_16x16x64_bf16 v[72:75], v[140:143], a[136:143], v106
    v_smfmac_f32_16x16x64_bf16 v[76:79], v[140:143], a[216:223], v106
    v_smfmac_f32_16x16x64_bf16 v[80:83], v[140:143], v[232:239], v106
    s_waitcnt lgkmcnt(1)
    v_smfmac_f32_16x16x64_bf16 v[68:71], v[144:147], a[64:71], v106
    v_smfmac_f32_16x16x64_bf16 v[72:75], v[144:147], a[144:151], v106
    v_smfmac_f32_16x16x64_bf16 v[76:79], v[144:147], a[224:231], v106
    v_smfmac_f32_16x16x64_bf16 v[80:83], v[144:147], v[240:247], v106
    s_waitcnt lgkmcnt(0)
    v_smfmac_f32_16x16x64_bf16 v[68:71], v[148:151], a[72:79], v106
    v_smfmac_f32_16x16x64_bf16 v[72:75], v[148:151], a[152:159], v106
    v_smfmac_f32_16x16x64_bf16 v[76:79], v[148:151], a[232:239], v106
    v_smfmac_f32_16x16x64_bf16 v[80:83], v[148:151], v[248:255], v106
    s_nop 7
    v_cvt_pk_bf16_f32 v152, v68, v69
    v_cvt_pk_bf16_f32 v153, v70, v71
    v_cvt_pk_bf16_f32 v154, v72, v73
    v_cvt_pk_bf16_f32 v155, v74, v75
    v_cvt_pk_bf16_f32 v156, v76, v77
    v_cvt_pk_bf16_f32 v157, v78, v79
    v_cvt_pk_bf16_f32 v158, v80, v81
    v_cvt_pk_bf16_f32 v159, v82, v83
    s_nop 1
    v_mfma_f32_16x16x16_bf16 v[160:163], v[188:189], v[152:153], 0
    v_mfma_f32_16x16x16_bf16 v[164:167], v[188:189], v[154:155], 0
    v_mfma_f32_16x16x16_bf16 v[168:171], v[188:189], v[156:157], 0
    v_mfma_f32_16x16x16_bf16 v[172:175], v[188:189], v[158:159], 0
    s_sleep 4
    buffer_load_dwordx4 v[28:31], v6, s[12:15], s31 offen offset:0 sc1
    buffer_load_dword v40, v7, s[12:15], s31 offen offset:0 sc1
    buffer_load_dwordx4 v[32:35], v6, s[12:15], s31 offen offset:1536 sc1
    buffer_load_dword v41, v7, s[12:15], s31 offen offset:1536 sc1
    buffer_load_dwordx4 v[36:39], v6, s[12:15], s31 offen offset:3072 sc1
    buffer_load_dword v42, v7, s[12:15], s31 offen offset:3072 sc1
    s_nop 1
    v_cvt_pk_bf16_f32 v100, v160, v161
    v_cvt_pk_bf16_f32 v101, v162, v163
    v_cvt_pk_bf16_f32 v102, v164, v165
    v_cvt_pk_bf16_f32 v103, v166, v167
    v_cvt_pk_bf16_f32 v104, v168, v169
    v_cvt_pk_bf16_f32 v105, v170, v171
    v_cvt_pk_bf16_f32 v10, v172, v173
    v_cvt_pk_bf16_f32 v11, v174, v175
    s_mov_b32 exec_hi, 0
    v_mov_b32 v112, v100
    v_mov_b32 v114, v102
    v_mov_b32 v116, v104
    v_mov_b32 v118, v10
    s_mov_b32 exec_lo, 0
    s_mov_b32 exec_hi, -1
    v_mov_b32 v112, v101
    v_mov_b32 v114, v103
    v_mov_b32 v116, v105
    v_mov_b32 v118, v11
    s_mov_b32 exec_lo, -1
    v_mov_b32 v113, 0
    v_mov_b32 v115, 0
    v_mov_b32 v117, 0
    v_mov_b32 v119, 0
    s_cmp_eq_u32 s30, 63
    s_cbranch_scc1 C_Blast
    s_waitcnt vmcnt(0)
    v_pk_add_f32 v[120:121], v[28:29], v[32:33]
    v_pk_add_f32 v[122:123], v[30:31], v[34:35]
    v_add_f32 v124, v40, v41
    v_pk_add_f32 v[120:121], v[120:121], v[36:37]
    v_pk_add_f32 v[122:123], v[122:123], v[38:39]
    v_add_f32 v124, v124, v42
    v_add_f32 v21, v120, v121
    v_max3_f32 v20, v120, v121, v122
    v_add_f32 v22, v122, v123
    v_max3_f32 v20, v20, v123, v124
    v_add_f32 v21, v21, v124
    v_add_f32 v21, v21, v22
    v_max_f32_dpp v20, v20, v20 row_ror:8 row_mask:0xf bank_mask:0xf
    v_cmp_u_f32 vcc, v21, v21
    s_cbranch_vccz C_Bp3d
C_Bp3poll:
    buffer_load_dwordx4 v[28:31], v6, s[12:15], s31 offen offset:0 sc1
    buffer_load_dword v40, v7, s[12:15], s31 offen offset:0 sc1
    buffer_load_dwordx4 v[32:35], v6, s[12:15], s31 offen offset:1536 sc1
    buffer_load_dword v41, v7, s[12:15], s31 offen offset:1536 sc1
    buffer_load_dwordx4 v[36:39], v6, s[12:15], s31 offen offset:3072 sc1
    buffer_load_dword v42, v7, s[12:15], s31 offen offset:3072 sc1
    s_waitcnt vmcnt(0)
    v_pk_add_f32 v[120:121], v[28:29], v[32:33]
    v_pk_add_f32 v[122:123], v[30:31], v[34:35]
    v_add_f32 v124, v40, v41
    v_pk_add_f32 v[120:121], v[120:121], v[36:37]
    v_pk_add_f32 v[122:123], v[122:123], v[38:39]
    v_add_f32 v124, v124, v42
    v_add_f32 v21, v120, v121
    v_max3_f32 v20, v120, v121, v122
    v_add_f32 v22, v122, v123
    v_max3_f32 v20, v20, v123, v124
    v_add_f32 v21, v21, v124
    v_add_f32 v21, v21, v22
    v_max_f32_dpp v20, v20, v20 row_ror:8 row_mask:0xf bank_mask:0xf
    v_cmp_u_f32 vcc, v21, v21
    s_cbranch_vccz C_Bp3d
    s_add_u32 s50, s50, 1
    s_cmp_lt_u32 s50, 0x200000
    s_cbranch_scc1 C_Bp3poll
    s_branch C_abort
C_Bp3d:
    v_mov_b32 v21, v20
    buffer_load_dwordx4 v[84:87], v12, s[12:15], s38 offen offset:0 sc1
    buffer_load_dwordx4 v[88:91], v12, s[12:15], s38 offen offset:1024 sc1
    v_permlane16_swap_b32 v20, v21
    v_max_f32 v20, v20, v21
    v_mov_b32 v21, v20
    buffer_load_dwordx4 v[92:95], v12, s[12:15], s38 offen offset:2048 sc1
    buffer_load_dwordx4 v[96:99], v12, s[12:15], s38 offen offset:3072 sc1
    v_permlane32_swap_b32 v20, v21
    v_max_f32 v20, v20, v21
    v_mul_f32 v20, s46, v20
    v_fma_f32 v120, v120, s46, -v20
    v_fma_f32 v121, v121, s46, -v20
    v_fma_f32 v122, v122, s46, -v20
    v_fma_f32 v123, v123, s46, -v20
    v_fma_f32 v124, v124, s46, -v20
    v_exp_f32 v120, v120
    v_exp_f32 v121, v121
    v_exp_f32 v122, v122
    v_exp_f32 v123, v123
    v_exp_f32 v124, v124
    s_nop 0
    v_cvt_pk_bf16_f32 v108, v120, v121
    v_cvt_pk_bf16_f32 v109, v122, v123
    v_mov_b32_dpp v23, v124 row_ror:8 row_mask:0xf bank_mask:0xf
    v_add_f32 v22, v120, v121
    v_mov_b32_dpp v110, v108 row_ror:8 row_mask:0xf bank_mask:0xf
    v_mov_b32_dpp v111, v109 row_ror:8 row_mask:0xf bank_mask:0xf
    v_cvt_pk_bf16_f32 v126, v124, v23
    v_mov_b32 v127, 0
    v_add_f32 v23, v122, v123
    v_add_f32 v22, v22, v124
    v_mfma_f32_16x16x32_bf16 v[128:131], v[52:55], v[108:111], 0
    v_add_f32 v22, v22, v23
    s_nop 0
    v_mfma_f32_16x16x32_bf16 v[132:135], v[56:59], v[108:111], 0
    v_add_f32_dpp v22, v22, v22 row_ror:8 row_mask:0xf bank_mask:0xf
    v_mov_b32 v23, v22
    v_mfma_f32_16x16x32_bf16 v[136:139], v[60:63], v[108:111], 0
    v_mfma_f32_16x16x32_bf16 v[140:143], v[64:67], v[108:111], 0
    s_nop 1
    v_permlane16_swap_b32 v22, v23
    v_mfma_f32_16x16x16_bf16 v[128:131], v[112:113], v[126:127], v[128:131]
    v_add_f32 v22, v22, v23
    v_mov_b32 v23, v22
    v_mfma_f32_16x16x16_bf16 v[132:135], v[114:115], v[126:127], v[132:135]
    v_mfma_f32_16x16x16_bf16 v[136:139], v[116:117], v[126:127], v[136:139]
    v_mfma_f32_16x16x16_bf16 v[140:143], v[118:119], v[126:127], v[140:143]
    s_nop 1
    v_permlane32_swap_b32 v22, v23
    v_add_f32 v22, v22, v23
    v_rcp_f32 v22, v22
    s_nop 1
    v_pk_mul_f32 v[128:129], v[128:129], v[22:23] op_sel_hi:[1,0]
    v_pk_mul_f32 v[130:131], v[130:131], v[22:23] op_sel_hi:[1,0]
    ds_write_b128 v17, v[128:131] offset:0
    v_pk_mul_f32 v[132:133], v[132:133], v[22:23] op_sel_hi:[1,0]
    v_pk_mul_f32 v[134:135], v[134:135], v[22:23] op_sel_hi:[1,0]
    ds_write_b128 v17, v[132:135] offset:1024
    v_pk_mul_f32 v[136:137], v[136:137], v[22:23] op_sel_hi:[1,0]
    v_pk_mul_f32 v[138:139], v[138:139], v[22:23] op_sel_hi:[1,0]
    ds_write_b128 v17, v[136:139] offset:2048
    v_pk_mul_f32 v[140:141], v[140:141], v[22:23] op_sel_hi:[1,0]
    v_pk_mul_f32 v[142:143], v[142:143], v[22:23] op_sel_hi:[1,0]
    ds_write_b128 v17, v[140:143] offset:3072
    s_cmp_eq_u64 s[56:57], 0
    s_cbranch_scc1 C_Bnfl
    buffer_load_dword v107, v19, s[12:15], 0 offen sc1
C_Bnfl:
    s_mov_b32 exec_hi, 0
    buffer_store_dwordx2 v[100:101], v14, s[12:15], s37 offen offset:0 sc1
    s_mov_b32 exec_hi, -1
    s_mov_b32 exec_hi, 0
    buffer_store_dwordx2 v[102:103], v14, s[12:15], s37 offen offset:256 sc1
    s_mov_b32 exec_hi, -1
    s_mov_b32 exec_hi, 0
    buffer_store_dwordx2 v[104:105], v14, s[12:15], s37 offen offset:512 sc1
    s_mov_b32 exec_hi, -1
    s_mov_b32 exec_hi, 0
    buffer_store_dwordx2 v[10:11], v14, s[12:15], s37 offen offset:768 sc1
    s_mov_b32 exec_hi, -1
    s_waitcnt lgkmcnt(0)
    s_barrier
    s_cmp_ge_u32 s9, 4
    s_cbranch_scc1 C_Bnopub
    ds_read_b128 v[144:147], v18
    ds_read_b128 v[148:151], v18 offset:4096
    ds_read_b128 v[128:131], v18 offset:8192
    ds_read_b128 v[132:135], v18 offset:12288
    s_waitcnt lgkmcnt(2)
    v_pk_add_f32 v[144:145], v[144:145], v[148:149]
    v_pk_add_f32 v[146:147], v[146:147], v[150:151]
    s_waitcnt lgkmcnt(0)
    v_pk_add_f32 v[128:129], v[128:129], v[132:133]
    v_pk_add_f32 v[130:131], v[130:131], v[134:135]
    v_pk_add_f32 v[144:145], v[144:145], v[128:129]
    v_pk_add_f32 v[146:147], v[146:147], v[130:131]
    s_mov_b64 exec, s[44:45]
    buffer_store_dwordx4 v[144:147], v8, s[12:15], s31 offen sc1
    s_mov_b64 exec, -1
C_Bnopub:
    s_cmp_lg_u32 s9, 3
    s_cbranch_scc1 C_Bsg
    s_lshl_b32 s40, s8, 5
    s_add_u32 s40, s40, s10
    s_lshl_b32 s40, s40, 7
    s_add_u32 s40, s40, s49
    s_add_u32 s40, s40, 2048000
    v_mov_b32 v20, s40
    v_mov_b32 v21, s30
    s_mov_b64 exec, 1
    buffer_store_dword v21, v20, s[12:15], 0 offen sc1
    s_mov_b64 exec, -1
C_Bsg:
C_Bnextw:
C_Bnext:
    s_add_u32 s30, s30, 1
    s_mov_b32 s40, s31
    s_mov_b32 s31, s33
    s_mov_b32 s33, s32
    s_mov_b32 s32, s40
    s_mov_b32 s54, s35
    s_mov_b32 s55, s37
    s_add_u32 s34, s34, 393216
    s_add_u32 s35, s35, 98304
    s_add_u32 s36, s36, 1310720
    s_add_u32 s37, s37, 327680
    s_branch C_Bstep
C_Blast:
    s_cmp_lg_u32 s9, 3
    s_cbranch_scc1 C_Bsgl
    s_lshl_b32 s40, s8, 5
    s_add_u32 s40, s40, s10
    s_lshl_b32 s40, s40, 7
    s_add_u32 s40, s40, s49
    s_add_u32 s40, s40, 2048000
    v_mov_b32 v20, s40
    v_mov_b32 v21, s30
    s_mov_b64 exec, 1
    buffer_store_dword v21, v20, s[12:15], 0 offen sc1
    s_mov_b64 exec, -1
C_Bsgl:
    s_mov_b32 exec_lo, -1
    s_mov_b32 exec_hi, 0
    buffer_store_dwordx2 v[100:101], v14, s[12:15], s37 offen offset:0 sc1
    buffer_store_dwordx2 v[102:103], v14, s[12:15], s37 offen offset:256 sc1
    buffer_store_dwordx2 v[104:105], v14, s[12:15], s37 offen offset:512 sc1
    buffer_store_dwordx2 v[10:11], v14, s[12:15], s37 offen offset:768 sc1
    s_mov_b64 exec, -1
    s_branch C_done
C_abort:
    v_mov_b32 v20, 128
    v_mov_b32 v21, 0xdead
    buffer_store_dword v21, v20, s[20:23], 0 offen
C_done:
    s_waitcnt vmcnt(0)
    s_barrier
    s_cmp_lg_u32 s9, 3
    s_cbranch_scc1 C_sgC
    s_lshl_b32 s40, s8, 5
    s_add_u32 s40, s40, s10
    s_lshl_b32 s40, s40, 7
    s_add_u32 s40, s40, s49
    s_add_u32 s40, s40, 2048000
    v_mov_b32 v20, s40
    v_mov_b32 v21, 64
    s_mov_b64 exec, 1
    buffer_store_dword v21, v20, s[12:15], 0 offen sc1
    s_mov_b64 exec, -1
C_sgC:
    s_waitcnt vmcnt(0)
    s_branch M_post
M_hi:
    s_cmp_ge_u32 s10, 21
    s_cbranch_scc1 M_y
    s_sub_u32 s11, s8, 4
    s_mul_i32 s11, s11, 21
    s_add_u32 s11, s11, s10
    s_cmp_lt_u32 s11, 24
    s_cbranch_scc1 G1_lnq
    s_cmp_lt_u32 s11, 72
    s_cbranch_scc1 G1_lnskip
    s_sub_u32 s30, s11, 48
    s_branch G1_lngo
G1_lnq:
    s_mov_b32 s30, s11
G1_lngo:
    s_load_dwordx2 s[4:5], s[0:1], 0
    s_waitcnt lgkmcnt(0)
    s_mov_b32 s16, s4
    s_and_b32 s17, s5, 0xffff
    s_mov_b32 s18, 0x280000
    s_mov_b32 s19, 0x00020000
    v_and_b32 v2, 31, v1
    v_lshrrev_b32 v3, 5, v1
    v_mul_u32_u24 v4, 1280, v2
    v_lshl_add_u32 v4, v3, 4, v4
    s_mul_i32 s20, s30, 40960
    s_mul_i32 s21, s9, 320
    s_add_u32 s20, s20, s21
    buffer_load_dwordx4 v[24:27], v4, s[16:19], s20 offen offset:0
    buffer_load_dwordx4 v[28:31], v4, s[16:19], s20 offen offset:32
    buffer_load_dwordx4 v[32:35], v4, s[16:19], s20 offen offset:64
    buffer_load_dwordx4 v[36:39], v4, s[16:19], s20 offen offset:96
    buffer_load_dwordx4 v[40:43], v4, s[16:19], s20 offen offset:128
    buffer_load_dwordx4 v[44:47], v4, s[16:19], s20 offen offset:160
    buffer_load_dwordx4 v[48:51], v4, s[16:19], s20 offen offset:192
    buffer_load_dwordx4 v[52:55], v4, s[16:19], s20 offen offset:224
    buffer_load_dwordx4 v[56:59], v4, s[16:19], s20 offen offset:256
    buffer_load_dwordx4 v[60:63], v4, s[16:19], s20 offen offset:288
    s_waitcnt vmcnt(0)
    v_lshlrev_b32 v64, 16, v24
    v_and_b32 v65, 0xffff0000, v24
    v_lshlrev_b32 v66, 16, v25
    v_and_b32 v67, 0xffff0000, v25
    v_lshlrev_b32 v68, 16, v26
    v_and_b32 v69, 0xffff0000, v26
    v_lshlrev_b32 v70, 16, v27
    v_and_b32 v71, 0xffff0000, v27
    v_lshlrev_b32 v72, 16, v28
    v_and_b32 v73, 0xffff0000, v28
    v_lshlrev_b32 v74, 16, v29
    v_and_b32 v75, 0xffff0000, v29
    v_lshlrev_b32 v76, 16, v30
    v_and_b32 v77, 0xffff0000, v30
    v_lshlrev_b32 v78, 16, v31
    v_and_b32 v79, 0xffff0000, v31
    v_lshlrev_b32 v80, 16, v32
    v_and_b32 v81, 0xffff0000, v32
    v_lshlrev_b32 v82, 16, v33
    v_and_b32 v83, 0xffff0000, v33
    v_lshlrev_b32 v84, 16, v34
    v_and_b32 v85, 0xffff0000, v34
    v_lshlrev_b32 v86, 16, v35
    v_and_b32 v87, 0xffff0000, v35
    v_lshlrev_b32 v88, 16, v36
    v_and_b32 v89, 0xffff0000, v36
    v_lshlrev_b32 v90, 16, v37
    v_and_b32 v91, 0xffff0000, v37
    v_lshlrev_b32 v92, 16, v38
    v_and_b32 v93, 0xffff0000, v38
    v_lshlrev_b32 v94, 16, v39
    v_and_b32 v95, 0xffff0000, v39
    v_lshlrev_b32 v96, 16, v40
    v_and_b32 v97, 0xffff0000, v40
    v_lshlrev_b32 v98, 16, v41
    v_and_b32 v99, 0xffff0000, v41
    v_lshlrev_b32 v100, 16, v42
    v_and_b32 v101, 0xffff0000, v42
    v_lshlrev_b32 v102, 16, v43
    v_and_b32 v103, 0xffff0000, v43
    v_lshlrev_b32 v104, 16, v44
    v_and_b32 v105, 0xffff0000, v44
    v_lshlrev_b32 v106, 16, v45
    v_and_b32 v107, 0xffff0000, v45
    v_lshlrev_b32 v108, 16, v46
    v_and_b32 v109, 0xffff0000, v46
    v_lshlrev_b32 v110, 16, v47
    v_and_b32 v111, 0xffff0000, v47
    v_lshlrev_b32 v112, 16, v48
    v_and_b32 v113, 0xffff0000, v48
    v_lshlrev_b32 v114, 16, v49
    v_and_b32 v115, 0xffff0000, v49
    v_lshlrev_b32 v116, 16, v50
    v_and_b32 v117, 0xffff0000, v50
    v_lshlrev_b32 v118, 16, v51
    v_and_b32 v119, 0xffff0000, v51
    v_lshlrev_b32 v120, 16, v52
    v_and_b32 v121, 0xffff0000, v52
    v_lshlrev_b32 v122, 16, v53
    v_and_b32 v123, 0xffff0000, v53
    v_lshlrev_b32 v124, 16, v54
    v_and_b32 v125, 0xffff0000, v54
    v_lshlrev_b32 v126, 16, v55
    v_and_b32 v127, 0xffff0000, v55
    v_lshlrev_b32 v128, 16, v56
    v_and_b32 v129, 0xffff0000, v56
    v_lshlrev_b32 v130, 16, v57
    v_and_b32 v131, 0xffff0000, v57
    v_lshlrev_b32 v132, 16, v58
    v_and_b32 v133, 0xffff0000, v58
    v_lshlrev_b32 v134, 16, v59
    v_and_b32 v135, 0xffff0000, v59
    v_lshlrev_b32 v136, 16, v60
    v_and_b32 v137, 0xffff0000, v60
    v_lshlrev_b32 v138, 16, v61
    v_and_b32 v139, 0xffff0000, v61
    v_lshlrev_b32 v140, 16, v62
    v_and_b32 v141, 0xffff0000, v62
    v_lshlrev_b32 v142, 16, v63
    v_and_b32 v143, 0xffff0000, v63
    v_mov_b32 v5, 0
    v_mov_b32 v6, 0
    v_mov_b32 v7, 0
    v_mov_b32 v14, 0
    v_add_f32 v5, v5, v64
    v_add_f32 v6, v6, v65
    v_add_f32 v7, v7, v66
    v_add_f32 v14, v14, v67
    v_add_f32 v5, v5, v68
    v_add_f32 v6, v6, v69
    v_add_f32 v7, v7, v70
    v_add_f32 v14, v14, v71
    v_add_f32 v5, v5, v72
    v_add_f32 v6, v6, v73
    v_add_f32 v7, v7, v74
    v_add_f32 v14, v14, v75
    v_add_f32 v5, v5, v76
    v_add_f32 v6, v6, v77
    v_add_f32 v7, v7, v78
    v_add_f32 v14, v14, v79
    v_add_f32 v5, v5, v80
    v_add_f32 v6, v6, v81
    v_add_f32 v7, v7, v82
    v_add_f32 v14, v14, v83
    v_add_f32 v5, v5, v84
    v_add_f32 v6, v6, v85
    v_add_f32 v7, v7, v86
    v_add_f32 v14, v14, v87
    v_add_f32 v5, v5, v88
    v_add_f32 v6, v6, v89
    v_add_f32 v7, v7, v90
    v_add_f32 v14, v14, v91
    v_add_f32 v5, v5, v92
    v_add_f32 v6, v6, v93
    v_add_f32 v7, v7, v94
    v_add_f32 v14, v14, v95
    v_add_f32 v5, v5, v96
    v_add_f32 v6, v6, v97
    v_add_f32 v7, v7, v98
    v_add_f32 v14, v14, v99
    v_add_f32 v5, v5, v100
    v_add_f32 v6, v6, v101
    v_add_f32 v7, v7, v102
    v_add_f32 v14, v14, v103
    v_add_f32 v5, v5, v104
    v_add_f32 v6, v6, v105
    v_add_f32 v7, v7, v106
    v_add_f32 v14, v14, v107
    v_add_f32 v5, v5, v108
    v_add_f32 v6, v6, v109
    v_add_f32 v7, v7, v110
    v_add_f32 v14, v14, v111
    v_add_f32 v5, v5, v112
    v_add_f32 v6, v6, v113
    v_add_f32 v7, v7, v114
    v_add_f32 v14, v14, v115
    v_add_f32 v5, v5, v116
    v_add_f32 v6, v6, v117
    v_add_f32 v7, v7, v118
    v_add_f32 v14, v14, v119
    v_add_f32 v5, v5, v120
    v_add_f32 v6, v6, v121
    v_add_f32 v7, v7, v122
    v_add_f32 v14, v14, v123
    v_add_f32 v5, v5, v124
    v_add_f32 v6, v6, v125
    v_add_f32 v7, v7, v126
    v_add_f32 v14, v14, v127
    v_add_f32 v5, v5, v128
    v_add_f32 v6, v6, v129
    v_add_f32 v7, v7, v130
    v_add_f32 v14, v14, v131
    v_add_f32 v5, v5, v132
    v_add_f32 v6, v6, v133
    v_add_f32 v7, v7, v134
    v_add_f32 v14, v14, v135
    v_add_f32 v5, v5, v136
    v_add_f32 v6, v6, v137
    v_add_f32 v7, v7, v138
    v_add_f32 v14, v14, v139
    v_add_f32 v5, v5, v140
    v_add_f32 v6, v6, v141
    v_add_f32 v7, v7, v142
    v_add_f32 v14, v14, v143
    v_add_f32 v5, v5, v6
    v_add_f32 v7, v7, v14
    v_add_f32 v5, v5, v7
    v_mov_b32 v9, v5
    s_nop 1
    v_permlane32_swap_b32 v5, v9
    v_add_f32 v5, v5, v9
    v_lshlrev_b32 v10, 2, v2
    s_lshl_b32 s22, s9, 7
    v_add_u32 v10, s22, v10
    v_add_u32 v10, 0, v10
    ds_write_b32 v10, v5 offset:0
    s_waitcnt lgkmcnt(0)
    s_barrier
    v_lshlrev_b32 v10, 2, v2
    v_add_u32 v10, 0, v10
    ds_read_b32 v8, v10 offset:0
    ds_read_b32 v11, v10 offset:128
    ds_read_b32 v12, v10 offset:256
    ds_read_b32 v13, v10 offset:384
    s_waitcnt lgkmcnt(0)
    v_add_f32 v8, v8, v11
    v_add_f32 v12, v12, v13
    v_add_f32 v8, v8, v12
    v_mul_f32 v15, 0x3acccccd, v8
    v_mov_b32 v5, 0
    v_mov_b32 v6, 0
    v_mov_b32 v7, 0
    v_mov_b32 v14, 0
    v_sub_f32 v16, v64, v15
    v_fmac_f32 v5, v16, v16
    v_sub_f32 v16, v65, v15
    v_fmac_f32 v6, v16, v16
    v_sub_f32 v16, v66, v15
    v_fmac_f32 v7, v16, v16
    v_sub_f32 v16, v67, v15
    v_fmac_f32 v14, v16, v16
    v_sub_f32 v16, v68, v15
    v_fmac_f32 v5, v16, v16
    v_sub_f32 v16, v69, v15
    v_fmac_f32 v6, v16, v16
    v_sub_f32 v16, v70, v15
    v_fmac_f32 v7, v16, v16
    v_sub_f32 v16, v71, v15
    v_fmac_f32 v14, v16, v16
    v_sub_f32 v16, v72, v15
    v_fmac_f32 v5, v16, v16
    v_sub_f32 v16, v73, v15
    v_fmac_f32 v6, v16, v16
    v_sub_f32 v16, v74, v15
    v_fmac_f32 v7, v16, v16
    v_sub_f32 v16, v75, v15
    v_fmac_f32 v14, v16, v16
    v_sub_f32 v16, v76, v15
    v_fmac_f32 v5, v16, v16
    v_sub_f32 v16, v77, v15
    v_fmac_f32 v6, v16, v16
    v_sub_f32 v16, v78, v15
    v_fmac_f32 v7, v16, v16
    v_sub_f32 v16, v79, v15
    v_fmac_f32 v14, v16, v16
    v_sub_f32 v16, v80, v15
    v_fmac_f32 v5, v16, v16
    v_sub_f32 v16, v81, v15
    v_fmac_f32 v6, v16, v16
    v_sub_f32 v16, v82, v15
    v_fmac_f32 v7, v16, v16
    v_sub_f32 v16, v83, v15
    v_fmac_f32 v14, v16, v16
    v_sub_f32 v16, v84, v15
    v_fmac_f32 v5, v16, v16
    v_sub_f32 v16, v85, v15
    v_fmac_f32 v6, v16, v16
    v_sub_f32 v16, v86, v15
    v_fmac_f32 v7, v16, v16
    v_sub_f32 v16, v87, v15
    v_fmac_f32 v14, v16, v16
    v_sub_f32 v16, v88, v15
    v_fmac_f32 v5, v16, v16
    v_sub_f32 v16, v89, v15
    v_fmac_f32 v6, v16, v16
    v_sub_f32 v16, v90, v15
    v_fmac_f32 v7, v16, v16
    v_sub_f32 v16, v91, v15
    v_fmac_f32 v14, v16, v16
    v_sub_f32 v16, v92, v15
    v_fmac_f32 v5, v16, v16
    v_sub_f32 v16, v93, v15
    v_fmac_f32 v6, v16, v16
    v_sub_f32 v16, v94, v15
    v_fmac_f32 v7, v16, v16
    v_sub_f32 v16, v95, v15
    v_fmac_f32 v14, v16, v16
    v_sub_f32 v16, v96, v15
    v_fmac_f32 v5, v16, v16
    v_sub_f32 v16, v97, v15
    v_fmac_f32 v6, v16, v16
    v_sub_f32 v16, v98, v15
    v_fmac_f32 v7, v16, v16
    v_sub_f32 v16, v99, v15
    v_fmac_f32 v14, v16, v16
    v_sub_f32 v16, v100, v15
    v_fmac_f32 v5, v16, v16
    v_sub_f32 v16, v101, v15
    v_fmac_f32 v6, v16, v16
    v_sub_f32 v16, v102, v15
    v_fmac_f32 v7, v16, v16
    v_sub_f32 v16, v103, v15
    v_fmac_f32 v14, v16, v16
    v_sub_f32 v16, v104, v15
    v_fmac_f32 v5, v16, v16
    v_sub_f32 v16, v105, v15
    v_fmac_f32 v6, v16, v16
    v_sub_f32 v16, v106, v15
    v_fmac_f32 v7, v16, v16
    v_sub_f32 v16, v107, v15
    v_fmac_f32 v14, v16, v16
    v_sub_f32 v16, v108, v15
    v_fmac_f32 v5, v16, v16
    v_sub_f32 v16, v109, v15
    v_fmac_f32 v6, v16, v16
    v_sub_f32 v16, v110, v15
    v_fmac_f32 v7, v16, v16
    v_sub_f32 v16, v111, v15
    v_fmac_f32 v14, v16, v16
    v_sub_f32 v16, v112, v15
    v_fmac_f32 v5, v16, v16
    v_sub_f32 v16, v113, v15
    v_fmac_f32 v6, v16, v16
    v_sub_f32 v16, v114, v15
    v_fmac_f32 v7, v16, v16
    v_sub_f32 v16, v115, v15
    v_fmac_f32 v14, v16, v16
    v_sub_f32 v16, v116, v15
    v_fmac_f32 v5, v16, v16
    v_sub_f32 v16, v117, v15
    v_fmac_f32 v6, v16, v16
    v_sub_f32 v16, v118, v15
    v_fmac_f32 v7, v16, v16
    v_sub_f32 v16, v119, v15
    v_fmac_f32 v14, v16, v16
    v_sub_f32 v16, v120, v15
    v_fmac_f32 v5, v16, v16
    v_sub_f32 v16, v121, v15
    v_fmac_f32 v6, v16, v16
    v_sub_f32 v16, v122, v15
    v_fmac_f32 v7, v16, v16
    v_sub_f32 v16, v123, v15
    v_fmac_f32 v14, v16, v16
    v_sub_f32 v16, v124, v15
    v_fmac_f32 v5, v16, v16
    v_sub_f32 v16, v125, v15
    v_fmac_f32 v6, v16, v16
    v_sub_f32 v16, v126, v15
    v_fmac_f32 v7, v16, v16
    v_sub_f32 v16, v127, v15
    v_fmac_f32 v14, v16, v16
    v_sub_f32 v16, v128, v15
    v_fmac_f32 v5, v16, v16
    v_sub_f32 v16, v129, v15
    v_fmac_f32 v6, v16, v16
    v_sub_f32 v16, v130, v15
    v_fmac_f32 v7, v16, v16
    v_sub_f32 v16, v131, v15
    v_fmac_f32 v14, v16, v16
    v_sub_f32 v16, v132, v15
    v_fmac_f32 v5, v16, v16
    v_sub_f32 v16, v133, v15
    v_fmac_f32 v6, v16, v16
    v_sub_f32 v16, v134, v15
    v_fmac_f32 v7, v16, v16
    v_sub_f32 v16, v135, v15
    v_fmac_f32 v14, v16, v16
    v_sub_f32 v16, v136, v15
    v_fmac_f32 v5, v16, v16
    v_sub_f32 v16, v137, v15
    v_fmac_f32 v6, v16, v16
    v_sub_f32 v16, v138, v15
    v_fmac_f32 v7, v16, v16
    v_sub_f32 v16, v139, v15
    v_fmac_f32 v14, v16, v16
    v_sub_f32 v16, v140, v15
    v_fmac_f32 v5, v16, v16
    v_sub_f32 v16, v141, v15
    v_fmac_f32 v6, v16, v16
    v_sub_f32 v16, v142, v15
    v_fmac_f32 v7, v16, v16
    v_sub_f32 v16, v143, v15
    v_fmac_f32 v14, v16, v16
    v_add_f32 v5, v5, v6
    v_add_f32 v7, v7, v14
    v_add_f32 v5, v5, v7
    v_mov_b32 v9, v5
    s_nop 1
    v_permlane32_swap_b32 v5, v9
    v_add_f32 v5, v5, v9
    v_lshlrev_b32 v10, 2, v2
    s_lshl_b32 s22, s9, 7
    v_add_u32 v10, s22, v10
    v_add_u32 v10, 0, v10
    ds_write_b32 v10, v5 offset:512
    s_waitcnt lgkmcnt(0)
    s_barrier
    v_lshlrev_b32 v10, 2, v2
    v_add_u32 v10, 0, v10
    ds_read_b32 v8, v10 offset:512
    ds_read_b32 v11, v10 offset:640
    ds_read_b32 v12, v10 offset:768
    ds_read_b32 v13, v10 offset:896
    s_waitcnt lgkmcnt(0)
    v_add_f32 v8, v8, v11
    v_add_f32 v12, v12, v13
    v_add_f32 v8, v8, v12
    v_mul_f32 v8, 0x3acccccd, v8
    v_cvt_pk_bf16_f32 v8, v8, v8
    v_lshlrev_b32 v8, 16, v8
    v_add_f32 v8, 0x3727c5ac, v8
    v_cvt_pk_bf16_f32 v8, v8, v8
    v_lshlrev_b32 v8, 16, v8
    v_sqrt_f32 v8, v8
    s_nop 0
    v_cvt_pk_bf16_f32 v8, v8, v8
    v_lshlrev_b32 v8, 16, v8
    v_rcp_f32 v9, v8
    v_cvt_pk_bf16_f32 v15, v15, v15
    v_lshlrev_b32 v15, 16, v15
    v_sub_f32 v64, v64, v15
    v_sub_f32 v65, v65, v15
    v_cvt_pk_bf16_f32 v16, v64, v65
    v_lshlrev_b32 v64, 16, v16
    v_and_b32 v65, 0xffff0000, v16
    v_mul_f32 v16, v64, v9
    v_mul_f32 v17, v65, v9
    v_fma_f32 v18, -v16, v8, v64
    v_fma_f32 v19, -v17, v8, v65
    v_fmac_f32 v16, v18, v9
    v_fmac_f32 v17, v19, v9
    v_cvt_pk_bf16_f32 v24, v16, v17
    v_sub_f32 v66, v66, v15
    v_sub_f32 v67, v67, v15
    v_cvt_pk_bf16_f32 v16, v66, v67
    v_lshlrev_b32 v66, 16, v16
    v_and_b32 v67, 0xffff0000, v16
    v_mul_f32 v16, v66, v9
    v_mul_f32 v17, v67, v9
    v_fma_f32 v18, -v16, v8, v66
    v_fma_f32 v19, -v17, v8, v67
    v_fmac_f32 v16, v18, v9
    v_fmac_f32 v17, v19, v9
    v_cvt_pk_bf16_f32 v25, v16, v17
    v_sub_f32 v68, v68, v15
    v_sub_f32 v69, v69, v15
    v_cvt_pk_bf16_f32 v16, v68, v69
    v_lshlrev_b32 v68, 16, v16
    v_and_b32 v69, 0xffff0000, v16
    v_mul_f32 v16, v68, v9
    v_mul_f32 v17, v69, v9
    v_fma_f32 v18, -v16, v8, v68
    v_fma_f32 v19, -v17, v8, v69
    v_fmac_f32 v16, v18, v9
    v_fmac_f32 v17, v19, v9
    v_cvt_pk_bf16_f32 v26, v16, v17
    v_sub_f32 v70, v70, v15
    v_sub_f32 v71, v71, v15
    v_cvt_pk_bf16_f32 v16, v70, v71
    v_lshlrev_b32 v70, 16, v16
    v_and_b32 v71, 0xffff0000, v16
    v_mul_f32 v16, v70, v9
    v_mul_f32 v17, v71, v9
    v_fma_f32 v18, -v16, v8, v70
    v_fma_f32 v19, -v17, v8, v71
    v_fmac_f32 v16, v18, v9
    v_fmac_f32 v17, v19, v9
    v_cvt_pk_bf16_f32 v27, v16, v17
    v_sub_f32 v72, v72, v15
    v_sub_f32 v73, v73, v15
    v_cvt_pk_bf16_f32 v16, v72, v73
    v_lshlrev_b32 v72, 16, v16
    v_and_b32 v73, 0xffff0000, v16
    v_mul_f32 v16, v72, v9
    v_mul_f32 v17, v73, v9
    v_fma_f32 v18, -v16, v8, v72
    v_fma_f32 v19, -v17, v8, v73
    v_fmac_f32 v16, v18, v9
    v_fmac_f32 v17, v19, v9
    v_cvt_pk_bf16_f32 v28, v16, v17
    v_sub_f32 v74, v74, v15
    v_sub_f32 v75, v75, v15
    v_cvt_pk_bf16_f32 v16, v74, v75
    v_lshlrev_b32 v74, 16, v16
    v_and_b32 v75, 0xffff0000, v16
    v_mul_f32 v16, v74, v9
    v_mul_f32 v17, v75, v9
    v_fma_f32 v18, -v16, v8, v74
    v_fma_f32 v19, -v17, v8, v75
    v_fmac_f32 v16, v18, v9
    v_fmac_f32 v17, v19, v9
    v_cvt_pk_bf16_f32 v29, v16, v17
    v_sub_f32 v76, v76, v15
    v_sub_f32 v77, v77, v15
    v_cvt_pk_bf16_f32 v16, v76, v77
    v_lshlrev_b32 v76, 16, v16
    v_and_b32 v77, 0xffff0000, v16
    v_mul_f32 v16, v76, v9
    v_mul_f32 v17, v77, v9
    v_fma_f32 v18, -v16, v8, v76
    v_fma_f32 v19, -v17, v8, v77
    v_fmac_f32 v16, v18, v9
    v_fmac_f32 v17, v19, v9
    v_cvt_pk_bf16_f32 v30, v16, v17
    v_sub_f32 v78, v78, v15
    v_sub_f32 v79, v79, v15
    v_cvt_pk_bf16_f32 v16, v78, v79
    v_lshlrev_b32 v78, 16, v16
    v_and_b32 v79, 0xffff0000, v16
    v_mul_f32 v16, v78, v9
    v_mul_f32 v17, v79, v9
    v_fma_f32 v18, -v16, v8, v78
    v_fma_f32 v19, -v17, v8, v79
    v_fmac_f32 v16, v18, v9
    v_fmac_f32 v17, v19, v9
    v_cvt_pk_bf16_f32 v31, v16, v17
    v_sub_f32 v80, v80, v15
    v_sub_f32 v81, v81, v15
    v_cvt_pk_bf16_f32 v16, v80, v81
    v_lshlrev_b32 v80, 16, v16
    v_and_b32 v81, 0xffff0000, v16
    v_mul_f32 v16, v80, v9
    v_mul_f32 v17, v81, v9
    v_fma_f32 v18, -v16, v8, v80
    v_fma_f32 v19, -v17, v8, v81
    v_fmac_f32 v16, v18, v9
    v_fmac_f32 v17, v19, v9
    v_cvt_pk_bf16_f32 v32, v16, v17
    v_sub_f32 v82, v82, v15
    v_sub_f32 v83, v83, v15
    v_cvt_pk_bf16_f32 v16, v82, v83
    v_lshlrev_b32 v82, 16, v16
    v_and_b32 v83, 0xffff0000, v16
    v_mul_f32 v16, v82, v9
    v_mul_f32 v17, v83, v9
    v_fma_f32 v18, -v16, v8, v82
    v_fma_f32 v19, -v17, v8, v83
    v_fmac_f32 v16, v18, v9
    v_fmac_f32 v17, v19, v9
    v_cvt_pk_bf16_f32 v33, v16, v17
    v_sub_f32 v84, v84, v15
    v_sub_f32 v85, v85, v15
    v_cvt_pk_bf16_f32 v16, v84, v85
    v_lshlrev_b32 v84, 16, v16
    v_and_b32 v85, 0xffff0000, v16
    v_mul_f32 v16, v84, v9
    v_mul_f32 v17, v85, v9
    v_fma_f32 v18, -v16, v8, v84
    v_fma_f32 v19, -v17, v8, v85
    v_fmac_f32 v16, v18, v9
    v_fmac_f32 v17, v19, v9
    v_cvt_pk_bf16_f32 v34, v16, v17
    v_sub_f32 v86, v86, v15
    v_sub_f32 v87, v87, v15
    v_cvt_pk_bf16_f32 v16, v86, v87
    v_lshlrev_b32 v86, 16, v16
    v_and_b32 v87, 0xffff0000, v16
    v_mul_f32 v16, v86, v9
    v_mul_f32 v17, v87, v9
    v_fma_f32 v18, -v16, v8, v86
    v_fma_f32 v19, -v17, v8, v87
    v_fmac_f32 v16, v18, v9
    v_fmac_f32 v17, v19, v9
    v_cvt_pk_bf16_f32 v35, v16, v17
    v_sub_f32 v88, v88, v15
    v_sub_f32 v89, v89, v15
    v_cvt_pk_bf16_f32 v16, v88, v89
    v_lshlrev_b32 v88, 16, v16
    v_and_b32 v89, 0xffff0000, v16
    v_mul_f32 v16, v88, v9
    v_mul_f32 v17, v89, v9
    v_fma_f32 v18, -v16, v8, v88
    v_fma_f32 v19, -v17, v8, v89
    v_fmac_f32 v16, v18, v9
    v_fmac_f32 v17, v19, v9
    v_cvt_pk_bf16_f32 v36, v16, v17
    v_sub_f32 v90, v90, v15
    v_sub_f32 v91, v91, v15
    v_cvt_pk_bf16_f32 v16, v90, v91
    v_lshlrev_b32 v90, 16, v16
    v_and_b32 v91, 0xffff0000, v16
    v_mul_f32 v16, v90, v9
    v_mul_f32 v17, v91, v9
    v_fma_f32 v18, -v16, v8, v90
    v_fma_f32 v19, -v17, v8, v91
    v_fmac_f32 v16, v18, v9
    v_fmac_f32 v17, v19, v9
    v_cvt_pk_bf16_f32 v37, v16, v17
    v_sub_f32 v92, v92, v15
    v_sub_f32 v93, v93, v15
    v_cvt_pk_bf16_f32 v16, v92, v93
    v_lshlrev_b32 v92, 16, v16
    v_and_b32 v93, 0xffff0000, v16
    v_mul_f32 v16, v92, v9
    v_mul_f32 v17, v93, v9
    v_fma_f32 v18, -v16, v8, v92
    v_fma_f32 v19, -v17, v8, v93
    v_fmac_f32 v16, v18, v9
    v_fmac_f32 v17, v19, v9
    v_cvt_pk_bf16_f32 v38, v16, v17
    v_sub_f32 v94, v94, v15
    v_sub_f32 v95, v95, v15
    v_cvt_pk_bf16_f32 v16, v94, v95
    v_lshlrev_b32 v94, 16, v16
    v_and_b32 v95, 0xffff0000, v16
    v_mul_f32 v16, v94, v9
    v_mul_f32 v17, v95, v9
    v_fma_f32 v18, -v16, v8, v94
    v_fma_f32 v19, -v17, v8, v95
    v_fmac_f32 v16, v18, v9
    v_fmac_f32 v17, v19, v9
    v_cvt_pk_bf16_f32 v39, v16, v17
    v_sub_f32 v96, v96, v15
    v_sub_f32 v97, v97, v15
    v_cvt_pk_bf16_f32 v16, v96, v97
    v_lshlrev_b32 v96, 16, v16
    v_and_b32 v97, 0xffff0000, v16
    v_mul_f32 v16, v96, v9
    v_mul_f32 v17, v97, v9
    v_fma_f32 v18, -v16, v8, v96
    v_fma_f32 v19, -v17, v8, v97
    v_fmac_f32 v16, v18, v9
    v_fmac_f32 v17, v19, v9
    v_cvt_pk_bf16_f32 v40, v16, v17
    v_sub_f32 v98, v98, v15
    v_sub_f32 v99, v99, v15
    v_cvt_pk_bf16_f32 v16, v98, v99
    v_lshlrev_b32 v98, 16, v16
    v_and_b32 v99, 0xffff0000, v16
    v_mul_f32 v16, v98, v9
    v_mul_f32 v17, v99, v9
    v_fma_f32 v18, -v16, v8, v98
    v_fma_f32 v19, -v17, v8, v99
    v_fmac_f32 v16, v18, v9
    v_fmac_f32 v17, v19, v9
    v_cvt_pk_bf16_f32 v41, v16, v17
    v_sub_f32 v100, v100, v15
    v_sub_f32 v101, v101, v15
    v_cvt_pk_bf16_f32 v16, v100, v101
    v_lshlrev_b32 v100, 16, v16
    v_and_b32 v101, 0xffff0000, v16
    v_mul_f32 v16, v100, v9
    v_mul_f32 v17, v101, v9
    v_fma_f32 v18, -v16, v8, v100
    v_fma_f32 v19, -v17, v8, v101
    v_fmac_f32 v16, v18, v9
    v_fmac_f32 v17, v19, v9
    v_cvt_pk_bf16_f32 v42, v16, v17
    v_sub_f32 v102, v102, v15
    v_sub_f32 v103, v103, v15
    v_cvt_pk_bf16_f32 v16, v102, v103
    v_lshlrev_b32 v102, 16, v16
    v_and_b32 v103, 0xffff0000, v16
    v_mul_f32 v16, v102, v9
    v_mul_f32 v17, v103, v9
    v_fma_f32 v18, -v16, v8, v102
    v_fma_f32 v19, -v17, v8, v103
    v_fmac_f32 v16, v18, v9
    v_fmac_f32 v17, v19, v9
    v_cvt_pk_bf16_f32 v43, v16, v17
    v_sub_f32 v104, v104, v15
    v_sub_f32 v105, v105, v15
    v_cvt_pk_bf16_f32 v16, v104, v105
    v_lshlrev_b32 v104, 16, v16
    v_and_b32 v105, 0xffff0000, v16
    v_mul_f32 v16, v104, v9
    v_mul_f32 v17, v105, v9
    v_fma_f32 v18, -v16, v8, v104
    v_fma_f32 v19, -v17, v8, v105
    v_fmac_f32 v16, v18, v9
    v_fmac_f32 v17, v19, v9
    v_cvt_pk_bf16_f32 v44, v16, v17
    v_sub_f32 v106, v106, v15
    v_sub_f32 v107, v107, v15
    v_cvt_pk_bf16_f32 v16, v106, v107
    v_lshlrev_b32 v106, 16, v16
    v_and_b32 v107, 0xffff0000, v16
    v_mul_f32 v16, v106, v9
    v_mul_f32 v17, v107, v9
    v_fma_f32 v18, -v16, v8, v106
    v_fma_f32 v19, -v17, v8, v107
    v_fmac_f32 v16, v18, v9
    v_fmac_f32 v17, v19, v9
    v_cvt_pk_bf16_f32 v45, v16, v17
    v_sub_f32 v108, v108, v15
    v_sub_f32 v109, v109, v15
    v_cvt_pk_bf16_f32 v16, v108, v109
    v_lshlrev_b32 v108, 16, v16
    v_and_b32 v109, 0xffff0000, v16
    v_mul_f32 v16, v108, v9
    v_mul_f32 v17, v109, v9
    v_fma_f32 v18, -v16, v8, v108
    v_fma_f32 v19, -v17, v8, v109
    v_fmac_f32 v16, v18, v9
    v_fmac_f32 v17, v19, v9
    v_cvt_pk_bf16_f32 v46, v16, v17
    v_sub_f32 v110, v110, v15
    v_sub_f32 v111, v111, v15
    v_cvt_pk_bf16_f32 v16, v110, v111
    v_lshlrev_b32 v110, 16, v16
    v_and_b32 v111, 0xffff0000, v16
    v_mul_f32 v16, v110, v9
    v_mul_f32 v17, v111, v9
    v_fma_f32 v18, -v16, v8, v110
    v_fma_f32 v19, -v17, v8, v111
    v_fmac_f32 v16, v18, v9
    v_fmac_f32 v17, v19, v9
    v_cvt_pk_bf16_f32 v47, v16, v17
    v_sub_f32 v112, v112, v15
    v_sub_f32 v113, v113, v15
    v_cvt_pk_bf16_f32 v16, v112, v113
    v_lshlrev_b32 v112, 16, v16
    v_and_b32 v113, 0xffff0000, v16
    v_mul_f32 v16, v112, v9
    v_mul_f32 v17, v113, v9
    v_fma_f32 v18, -v16, v8, v112
    v_fma_f32 v19, -v17, v8, v113
    v_fmac_f32 v16, v18, v9
    v_fmac_f32 v17, v19, v9
    v_cvt_pk_bf16_f32 v48, v16, v17
    v_sub_f32 v114, v114, v15
    v_sub_f32 v115, v115, v15
    v_cvt_pk_bf16_f32 v16, v114, v115
    v_lshlrev_b32 v114, 16, v16
    v_and_b32 v115, 0xffff0000, v16
    v_mul_f32 v16, v114, v9
    v_mul_f32 v17, v115, v9
    v_fma_f32 v18, -v16, v8, v114
    v_fma_f32 v19, -v17, v8, v115
    v_fmac_f32 v16, v18, v9
    v_fmac_f32 v17, v19, v9
    v_cvt_pk_bf16_f32 v49, v16, v17
    v_sub_f32 v116, v116, v15
    v_sub_f32 v117, v117, v15
    v_cvt_pk_bf16_f32 v16, v116, v117
    v_lshlrev_b32 v116, 16, v16
    v_and_b32 v117, 0xffff0000, v16
    v_mul_f32 v16, v116, v9
    v_mul_f32 v17, v117, v9
    v_fma_f32 v18, -v16, v8, v116
    v_fma_f32 v19, -v17, v8, v117
    v_fmac_f32 v16, v18, v9
    v_fmac_f32 v17, v19, v9
    v_cvt_pk_bf16_f32 v50, v16, v17
    v_sub_f32 v118, v118, v15
    v_sub_f32 v119, v119, v15
    v_cvt_pk_bf16_f32 v16, v118, v119
    v_lshlrev_b32 v118, 16, v16
    v_and_b32 v119, 0xffff0000, v16
    v_mul_f32 v16, v118, v9
    v_mul_f32 v17, v119, v9
    v_fma_f32 v18, -v16, v8, v118
    v_fma_f32 v19, -v17, v8, v119
    v_fmac_f32 v16, v18, v9
    v_fmac_f32 v17, v19, v9
    v_cvt_pk_bf16_f32 v51, v16, v17
    v_sub_f32 v120, v120, v15
    v_sub_f32 v121, v121, v15
    v_cvt_pk_bf16_f32 v16, v120, v121
    v_lshlrev_b32 v120, 16, v16
    v_and_b32 v121, 0xffff0000, v16
    v_mul_f32 v16, v120, v9
    v_mul_f32 v17, v121, v9
    v_fma_f32 v18, -v16, v8, v120
    v_fma_f32 v19, -v17, v8, v121
    v_fmac_f32 v16, v18, v9
    v_fmac_f32 v17, v19, v9
    v_cvt_pk_bf16_f32 v52, v16, v17
    v_sub_f32 v122, v122, v15
    v_sub_f32 v123, v123, v15
    v_cvt_pk_bf16_f32 v16, v122, v123
    v_lshlrev_b32 v122, 16, v16
    v_and_b32 v123, 0xffff0000, v16
    v_mul_f32 v16, v122, v9
    v_mul_f32 v17, v123, v9
    v_fma_f32 v18, -v16, v8, v122
    v_fma_f32 v19, -v17, v8, v123
    v_fmac_f32 v16, v18, v9
    v_fmac_f32 v17, v19, v9
    v_cvt_pk_bf16_f32 v53, v16, v17
    v_sub_f32 v124, v124, v15
    v_sub_f32 v125, v125, v15
    v_cvt_pk_bf16_f32 v16, v124, v125
    v_lshlrev_b32 v124, 16, v16
    v_and_b32 v125, 0xffff0000, v16
    v_mul_f32 v16, v124, v9
    v_mul_f32 v17, v125, v9
    v_fma_f32 v18, -v16, v8, v124
    v_fma_f32 v19, -v17, v8, v125
    v_fmac_f32 v16, v18, v9
    v_fmac_f32 v17, v19, v9
    v_cvt_pk_bf16_f32 v54, v16, v17
    v_sub_f32 v126, v126, v15
    v_sub_f32 v127, v127, v15
    v_cvt_pk_bf16_f32 v16, v126, v127
    v_lshlrev_b32 v126, 16, v16
    v_and_b32 v127, 0xffff0000, v16
    v_mul_f32 v16, v126, v9
    v_mul_f32 v17, v127, v9
    v_fma_f32 v18, -v16, v8, v126
    v_fma_f32 v19, -v17, v8, v127
    v_fmac_f32 v16, v18, v9
    v_fmac_f32 v17, v19, v9
    v_cvt_pk_bf16_f32 v55, v16, v17
    v_sub_f32 v128, v128, v15
    v_sub_f32 v129, v129, v15
    v_cvt_pk_bf16_f32 v16, v128, v129
    v_lshlrev_b32 v128, 16, v16
    v_and_b32 v129, 0xffff0000, v16
    v_mul_f32 v16, v128, v9
    v_mul_f32 v17, v129, v9
    v_fma_f32 v18, -v16, v8, v128
    v_fma_f32 v19, -v17, v8, v129
    v_fmac_f32 v16, v18, v9
    v_fmac_f32 v17, v19, v9
    v_cvt_pk_bf16_f32 v56, v16, v17
    v_sub_f32 v130, v130, v15
    v_sub_f32 v131, v131, v15
    v_cvt_pk_bf16_f32 v16, v130, v131
    v_lshlrev_b32 v130, 16, v16
    v_and_b32 v131, 0xffff0000, v16
    v_mul_f32 v16, v130, v9
    v_mul_f32 v17, v131, v9
    v_fma_f32 v18, -v16, v8, v130
    v_fma_f32 v19, -v17, v8, v131
    v_fmac_f32 v16, v18, v9
    v_fmac_f32 v17, v19, v9
    v_cvt_pk_bf16_f32 v57, v16, v17
    v_sub_f32 v132, v132, v15
    v_sub_f32 v133, v133, v15
    v_cvt_pk_bf16_f32 v16, v132, v133
    v_lshlrev_b32 v132, 16, v16
    v_and_b32 v133, 0xffff0000, v16
    v_mul_f32 v16, v132, v9
    v_mul_f32 v17, v133, v9
    v_fma_f32 v18, -v16, v8, v132
    v_fma_f32 v19, -v17, v8, v133
    v_fmac_f32 v16, v18, v9
    v_fmac_f32 v17, v19, v9
    v_cvt_pk_bf16_f32 v58, v16, v17
    v_sub_f32 v134, v134, v15
    v_sub_f32 v135, v135, v15
    v_cvt_pk_bf16_f32 v16, v134, v135
    v_lshlrev_b32 v134, 16, v16
    v_and_b32 v135, 0xffff0000, v16
    v_mul_f32 v16, v134, v9
    v_mul_f32 v17, v135, v9
    v_fma_f32 v18, -v16, v8, v134
    v_fma_f32 v19, -v17, v8, v135
    v_fmac_f32 v16, v18, v9
    v_fmac_f32 v17, v19, v9
    v_cvt_pk_bf16_f32 v59, v16, v17
    v_sub_f32 v136, v136, v15
    v_sub_f32 v137, v137, v15
    v_cvt_pk_bf16_f32 v16, v136, v137
    v_lshlrev_b32 v136, 16, v16
    v_and_b32 v137, 0xffff0000, v16
    v_mul_f32 v16, v136, v9
    v_mul_f32 v17, v137, v9
    v_fma_f32 v18, -v16, v8, v136
    v_fma_f32 v19, -v17, v8, v137
    v_fmac_f32 v16, v18, v9
    v_fmac_f32 v17, v19, v9
    v_cvt_pk_bf16_f32 v60, v16, v17
    v_sub_f32 v138, v138, v15
    v_sub_f32 v139, v139, v15
    v_cvt_pk_bf16_f32 v16, v138, v139
    v_lshlrev_b32 v138, 16, v16
    v_and_b32 v139, 0xffff0000, v16
    v_mul_f32 v16, v138, v9
    v_mul_f32 v17, v139, v9
    v_fma_f32 v18, -v16, v8, v138
    v_fma_f32 v19, -v17, v8, v139
    v_fmac_f32 v16, v18, v9
    v_fmac_f32 v17, v19, v9
    v_cvt_pk_bf16_f32 v61, v16, v17
    v_sub_f32 v140, v140, v15
    v_sub_f32 v141, v141, v15
    v_cvt_pk_bf16_f32 v16, v140, v141
    v_lshlrev_b32 v140, 16, v16
    v_and_b32 v141, 0xffff0000, v16
    v_mul_f32 v16, v140, v9
    v_mul_f32 v17, v141, v9
    v_fma_f32 v18, -v16, v8, v140
    v_fma_f32 v19, -v17, v8, v141
    v_fmac_f32 v16, v18, v9
    v_fmac_f32 v17, v19, v9
    v_cvt_pk_bf16_f32 v62, v16, v17
    v_sub_f32 v142, v142, v15
    v_sub_f32 v143, v143, v15
    v_cvt_pk_bf16_f32 v16, v142, v143
    v_lshlrev_b32 v142, 16, v16
    v_and_b32 v143, 0xffff0000, v16
    v_mul_f32 v16, v142, v9
    v_mul_f32 v17, v143, v9
    v_fma_f32 v18, -v16, v8, v142
    v_fma_f32 v19, -v17, v8, v143
    v_fmac_f32 v16, v18, v9
    v_fmac_f32 v17, v19, v9
    v_cvt_pk_bf16_f32 v63, v16, v17
    v_lshlrev_b32 v4, 4, v1
    s_mul_i32 s20, s30, 40960
    s_mul_i32 s21, s9, 10240
    s_add_u32 s20, s20, s21
    s_add_u32 s20, s20, 85983232
    buffer_store_dwordx4 v[24:27], v4, s[12:15], s20 offen offset:0 sc1
    buffer_store_dwordx4 v[28:31], v4, s[12:15], s20 offen offset:1024 sc1
    buffer_store_dwordx4 v[32:35], v4, s[12:15], s20 offen offset:2048 sc1
    buffer_store_dwordx4 v[36:39], v4, s[12:15], s20 offen offset:3072 sc1
    s_add_u32 s20, s20, 4096
    buffer_store_dwordx4 v[40:43], v4, s[12:15], s20 offen offset:0 sc1
    buffer_store_dwordx4 v[44:47], v4, s[12:15], s20 offen offset:1024 sc1
    buffer_store_dwordx4 v[48:51], v4, s[12:15], s20 offen offset:2048 sc1
    buffer_store_dwordx4 v[52:55], v4, s[12:15], s20 offen offset:3072 sc1
    s_add_u32 s20, s20, 4096
    buffer_store_dwordx4 v[56:59], v4, s[12:15], s20 offen offset:0 sc1
    buffer_store_dwordx4 v[60:63], v4, s[12:15], s20 offen offset:1024 sc1
    s_waitcnt vmcnt(0)
    s_barrier
    s_load_dwordx2 s[4:5], s[0:1], 96
    s_waitcnt lgkmcnt(0)
    s_mov_b32 s20, s4
    s_and_b32 s21, s5, 0xffff
    s_mov_b32 s22, 0x100
    s_mov_b32 s23, 0x00020000
    s_cmp_lg_u32 s9, 0
    s_cbranch_scc1 dw_2b
    v_mov_b32 v20, 224
    s_mov_b32 s58, 0
dw_2:
    buffer_load_dword v21, v20, s[20:23], 0 offen sc1
    s_waitcnt vmcnt(0)
    v_readfirstlane_b32 s59, v21
    s_nop 3
    s_cmp_ge_u32 s59, 1
    s_cbranch_scc1 dw_2b
    s_sleep 16
    s_add_u32 s58, s58, 1
    s_cmp_lt_u32 s58, 0x80000
    s_cbranch_scc1 dw_2
dw_2b:
    s_barrier
    s_cmp_lg_u32 s9, 0
    s_cbranch_scc1 fs_3
    s_lshl_b32 s59, s30, 7
    s_add_u32 s59, s59, s62
    s_add_u32 s59, s59, 2080768
    v_mov_b32 v20, s59
    v_mov_b32 v21, 1
    s_mov_b64 exec, 1
    buffer_store_dword v21, v20, s[12:15], 0 offen sc1
    s_mov_b64 exec, -1
fs_3:
    s_cmp_lt_u32 s11, 24
    s_cbranch_scc1 G1_lnq2
    s_cmp_ge_u32 s11, 76
    s_cbranch_scc1 G1_lnskip
    s_sub_u32 s30, s11, 36
    s_branch G1_lngo2
G1_lnq2:
    s_add_u32 s30, s11, 40
G1_lngo2:
    s_load_dwordx2 s[4:5], s[0:1], 0
    s_waitcnt lgkmcnt(0)
    s_mov_b32 s16, s4
    s_and_b32 s17, s5, 0xffff
    s_mov_b32 s18, 0x280000
    s_mov_b32 s19, 0x00020000
    v_and_b32 v2, 31, v1
    v_lshrrev_b32 v3, 5, v1
    v_mul_u32_u24 v4, 1280, v2
    v_lshl_add_u32 v4, v3, 4, v4
    s_mul_i32 s20, s30, 40960
    s_mul_i32 s21, s9, 320
    s_add_u32 s20, s20, s21
    buffer_load_dwordx4 v[24:27], v4, s[16:19], s20 offen offset:0
    buffer_load_dwordx4 v[28:31], v4, s[16:19], s20 offen offset:32
    buffer_load_dwordx4 v[32:35], v4, s[16:19], s20 offen offset:64
    buffer_load_dwordx4 v[36:39], v4, s[16:19], s20 offen offset:96
    buffer_load_dwordx4 v[40:43], v4, s[16:19], s20 offen offset:128
    buffer_load_dwordx4 v[44:47], v4, s[16:19], s20 offen offset:160
    buffer_load_dwordx4 v[48:51], v4, s[16:19], s20 offen offset:192
    buffer_load_dwordx4 v[52:55], v4, s[16:19], s20 offen offset:224
    buffer_load_dwordx4 v[56:59], v4, s[16:19], s20 offen offset:256
    buffer_load_dwordx4 v[60:63], v4, s[16:19], s20 offen offset:288
    s_waitcnt vmcnt(0)
    v_lshlrev_b32 v64, 16, v24
    v_and_b32 v65, 0xffff0000, v24
    v_lshlrev_b32 v66, 16, v25
    v_and_b32 v67, 0xffff0000, v25
    v_lshlrev_b32 v68, 16, v26
    v_and_b32 v69, 0xffff0000, v26
    v_lshlrev_b32 v70, 16, v27
    v_and_b32 v71, 0xffff0000, v27
    v_lshlrev_b32 v72, 16, v28
    v_and_b32 v73, 0xffff0000, v28
    v_lshlrev_b32 v74, 16, v29
    v_and_b32 v75, 0xffff0000, v29
    v_lshlrev_b32 v76, 16, v30
    v_and_b32 v77, 0xffff0000, v30
    v_lshlrev_b32 v78, 16, v31
    v_and_b32 v79, 0xffff0000, v31
    v_lshlrev_b32 v80, 16, v32
    v_and_b32 v81, 0xffff0000, v32
    v_lshlrev_b32 v82, 16, v33
    v_and_b32 v83, 0xffff0000, v33
    v_lshlrev_b32 v84, 16, v34
    v_and_b32 v85, 0xffff0000, v34
    v_lshlrev_b32 v86, 16, v35
    v_and_b32 v87, 0xffff0000, v35
    v_lshlrev_b32 v88, 16, v36
    v_and_b32 v89, 0xffff0000, v36
    v_lshlrev_b32 v90, 16, v37
    v_and_b32 v91, 0xffff0000, v37
    v_lshlrev_b32 v92, 16, v38
    v_and_b32 v93, 0xffff0000, v38
    v_lshlrev_b32 v94, 16, v39
    v_and_b32 v95, 0xffff0000, v39
    v_lshlrev_b32 v96, 16, v40
    v_and_b32 v97, 0xffff0000, v40
    v_lshlrev_b32 v98, 16, v41
    v_and_b32 v99, 0xffff0000, v41
    v_lshlrev_b32 v100, 16, v42
    v_and_b32 v101, 0xffff0000, v42
    v_lshlrev_b32 v102, 16, v43
    v_and_b32 v103, 0xffff0000, v43
    v_lshlrev_b32 v104, 16, v44
    v_and_b32 v105, 0xffff0000, v44
    v_lshlrev_b32 v106, 16, v45
    v_and_b32 v107, 0xffff0000, v45
    v_lshlrev_b32 v108, 16, v46
    v_and_b32 v109, 0xffff0000, v46
    v_lshlrev_b32 v110, 16, v47
    v_and_b32 v111, 0xffff0000, v47
    v_lshlrev_b32 v112, 16, v48
    v_and_b32 v113, 0xffff0000, v48
    v_lshlrev_b32 v114, 16, v49
    v_and_b32 v115, 0xffff0000, v49
    v_lshlrev_b32 v116, 16, v50
    v_and_b32 v117, 0xffff0000, v50
    v_lshlrev_b32 v118, 16, v51
    v_and_b32 v119, 0xffff0000, v51
    v_lshlrev_b32 v120, 16, v52
    v_and_b32 v121, 0xffff0000, v52
    v_lshlrev_b32 v122, 16, v53
    v_and_b32 v123, 0xffff0000, v53
    v_lshlrev_b32 v124, 16, v54
    v_and_b32 v125, 0xffff0000, v54
    v_lshlrev_b32 v126, 16, v55
    v_and_b32 v127, 0xffff0000, v55
    v_lshlrev_b32 v128, 16, v56
    v_and_b32 v129, 0xffff0000, v56
    v_lshlrev_b32 v130, 16, v57
    v_and_b32 v131, 0xffff0000, v57
    v_lshlrev_b32 v132, 16, v58
    v_and_b32 v133, 0xffff0000, v58
    v_lshlrev_b32 v134, 16, v59
    v_and_b32 v135, 0xffff0000, v59
    v_lshlrev_b32 v136, 16, v60
    v_and_b32 v137, 0xffff0000, v60
    v_lshlrev_b32 v138, 16, v61
    v_and_b32 v139, 0xffff0000, v61
    v_lshlrev_b32 v140, 16, v62
    v_and_b32 v141, 0xffff0000, v62
    v_lshlrev_b32 v142, 16, v63
    v_and_b32 v143, 0xffff0000, v63
    v_mov_b32 v5, 0
    v_mov_b32 v6, 0
    v_mov_b32 v7, 0
    v_mov_b32 v14, 0
    v_add_f32 v5, v5, v64
    v_add_f32 v6, v6, v65
    v_add_f32 v7, v7, v66
    v_add_f32 v14, v14, v67
    v_add_f32 v5, v5, v68
    v_add_f32 v6, v6, v69
    v_add_f32 v7, v7, v70
    v_add_f32 v14, v14, v71
    v_add_f32 v5, v5, v72
    v_add_f32 v6, v6, v73
    v_add_f32 v7, v7, v74
    v_add_f32 v14, v14, v75
    v_add_f32 v5, v5, v76
    v_add_f32 v6, v6, v77
    v_add_f32 v7, v7, v78
    v_add_f32 v14, v14, v79
    v_add_f32 v5, v5, v80
    v_add_f32 v6, v6, v81
    v_add_f32 v7, v7, v82
    v_add_f32 v14, v14, v83
    v_add_f32 v5, v5, v84
    v_add_f32 v6, v6, v85
    v_add_f32 v7, v7, v86
    v_add_f32 v14, v14, v87
    v_add_f32 v5, v5, v88
    v_add_f32 v6, v6, v89
    v_add_f32 v7, v7, v90
    v_add_f32 v14, v14, v91
    v_add_f32 v5, v5, v92
    v_add_f32 v6, v6, v93
    v_add_f32 v7, v7, v94
    v_add_f32 v14, v14, v95
    v_add_f32 v5, v5, v96
    v_add_f32 v6, v6, v97
    v_add_f32 v7, v7, v98
    v_add_f32 v14, v14, v99
    v_add_f32 v5, v5, v100
    v_add_f32 v6, v6, v101
    v_add_f32 v7, v7, v102
    v_add_f32 v14, v14, v103
    v_add_f32 v5, v5, v104
    v_add_f32 v6, v6, v105
    v_add_f32 v7, v7, v106
    v_add_f32 v14, v14, v107
    v_add_f32 v5, v5, v108
    v_add_f32 v6, v6, v109
    v_add_f32 v7, v7, v110
    v_add_f32 v14, v14, v111
    v_add_f32 v5, v5, v112
    v_add_f32 v6, v6, v113
    v_add_f32 v7, v7, v114
    v_add_f32 v14, v14, v115
    v_add_f32 v5, v5, v116
    v_add_f32 v6, v6, v117
    v_add_f32 v7, v7, v118
    v_add_f32 v14, v14, v119
    v_add_f32 v5, v5, v120
    v_add_f32 v6, v6, v121
    v_add_f32 v7, v7, v122
    v_add_f32 v14, v14, v123
    v_add_f32 v5, v5, v124
    v_add_f32 v6, v6, v125
    v_add_f32 v7, v7, v126
    v_add_f32 v14, v14, v127
    v_add_f32 v5, v5, v128
    v_add_f32 v6, v6, v129
    v_add_f32 v7, v7, v130
    v_add_f32 v14, v14, v131
    v_add_f32 v5, v5, v132
    v_add_f32 v6, v6, v133
    v_add_f32 v7, v7, v134
    v_add_f32 v14, v14, v135
    v_add_f32 v5, v5, v136
    v_add_f32 v6, v6, v137
    v_add_f32 v7, v7, v138
    v_add_f32 v14, v14, v139
    v_add_f32 v5, v5, v140
    v_add_f32 v6, v6, v141
    v_add_f32 v7, v7, v142
    v_add_f32 v14, v14, v143
    v_add_f32 v5, v5, v6
    v_add_f32 v7, v7, v14
    v_add_f32 v5, v5, v7
    v_mov_b32 v9, v5
    s_nop 1
    v_permlane32_swap_b32 v5, v9
    v_add_f32 v5, v5, v9
    v_lshlrev_b32 v10, 2, v2
    s_lshl_b32 s22, s9, 7
    v_add_u32 v10, s22, v10
    v_add_u32 v10, 0, v10
    ds_write_b32 v10, v5 offset:0
    s_waitcnt lgkmcnt(0)
    s_barrier
    v_lshlrev_b32 v10, 2, v2
    v_add_u32 v10, 0, v10
    ds_read_b32 v8, v10 offset:0
    ds_read_b32 v11, v10 offset:128
    ds_read_b32 v12, v10 offset:256
    ds_read_b32 v13, v10 offset:384
    s_waitcnt lgkmcnt(0)
    v_add_f32 v8, v8, v11
    v_add_f32 v12, v12, v13
    v_add_f32 v8, v8, v12
    v_mul_f32 v15, 0x3acccccd, v8
    v_mov_b32 v5, 0
    v_mov_b32 v6, 0
    v_mov_b32 v7, 0
    v_mov_b32 v14, 0
    v_sub_f32 v16, v64, v15
    v_fmac_f32 v5, v16, v16
    v_sub_f32 v16, v65, v15
    v_fmac_f32 v6, v16, v16
    v_sub_f32 v16, v66, v15
    v_fmac_f32 v7, v16, v16
    v_sub_f32 v16, v67, v15
    v_fmac_f32 v14, v16, v16
    v_sub_f32 v16, v68, v15
    v_fmac_f32 v5, v16, v16
    v_sub_f32 v16, v69, v15
    v_fmac_f32 v6, v16, v16
    v_sub_f32 v16, v70, v15
    v_fmac_f32 v7, v16, v16
    v_sub_f32 v16, v71, v15
    v_fmac_f32 v14, v16, v16
    v_sub_f32 v16, v72, v15
    v_fmac_f32 v5, v16, v16
    v_sub_f32 v16, v73, v15
    v_fmac_f32 v6, v16, v16
    v_sub_f32 v16, v74, v15
    v_fmac_f32 v7, v16, v16
    v_sub_f32 v16, v75, v15
    v_fmac_f32 v14, v16, v16
    v_sub_f32 v16, v76, v15
    v_fmac_f32 v5, v16, v16
    v_sub_f32 v16, v77, v15
    v_fmac_f32 v6, v16, v16
    v_sub_f32 v16, v78, v15
    v_fmac_f32 v7, v16, v16
    v_sub_f32 v16, v79, v15
    v_fmac_f32 v14, v16, v16
    v_sub_f32 v16, v80, v15
    v_fmac_f32 v5, v16, v16
    v_sub_f32 v16, v81, v15
    v_fmac_f32 v6, v16, v16
    v_sub_f32 v16, v82, v15
    v_fmac_f32 v7, v16, v16
    v_sub_f32 v16, v83, v15
    v_fmac_f32 v14, v16, v16
    v_sub_f32 v16, v84, v15
    v_fmac_f32 v5, v16, v16
    v_sub_f32 v16, v85, v15
    v_fmac_f32 v6, v16, v16
    v_sub_f32 v16, v86, v15
    v_fmac_f32 v7, v16, v16
    v_sub_f32 v16, v87, v15
    v_fmac_f32 v14, v16, v16
    v_sub_f32 v16, v88, v15
    v_fmac_f32 v5, v16, v16
    v_sub_f32 v16, v89, v15
    v_fmac_f32 v6, v16, v16
    v_sub_f32 v16, v90, v15
    v_fmac_f32 v7, v16, v16
    v_sub_f32 v16, v91, v15
    v_fmac_f32 v14, v16, v16
    v_sub_f32 v16, v92, v15
    v_fmac_f32 v5, v16, v16
    v_sub_f32 v16, v93, v15
    v_fmac_f32 v6, v16, v16
    v_sub_f32 v16, v94, v15
    v_fmac_f32 v7, v16, v16
    v_sub_f32 v16, v95, v15
    v_fmac_f32 v14, v16, v16
    v_sub_f32 v16, v96, v15
    v_fmac_f32 v5, v16, v16
    v_sub_f32 v16, v97, v15
    v_fmac_f32 v6, v16, v16
    v_sub_f32 v16, v98, v15
    v_fmac_f32 v7, v16, v16
    v_sub_f32 v16, v99, v15
    v_fmac_f32 v14, v16, v16
    v_sub_f32 v16, v100, v15
    v_fmac_f32 v5, v16, v16
    v_sub_f32 v16, v101, v15
    v_fmac_f32 v6, v16, v16
    v_sub_f32 v16, v102, v15
    v_fmac_f32 v7, v16, v16
    v_sub_f32 v16, v103, v15
    v_fmac_f32 v14, v16, v16
    v_sub_f32 v16, v104, v15
    v_fmac_f32 v5, v16, v16
    v_sub_f32 v16, v105, v15
    v_fmac_f32 v6, v16, v16
    v_sub_f32 v16, v106, v15
    v_fmac_f32 v7, v16, v16
    v_sub_f32 v16, v107, v15
    v_fmac_f32 v14, v16, v16
    v_sub_f32 v16, v108, v15
    v_fmac_f32 v5, v16, v16
    v_sub_f32 v16, v109, v15
    v_fmac_f32 v6, v16, v16
    v_sub_f32 v16, v110, v15
    v_fmac_f32 v7, v16, v16
    v_sub_f32 v16, v111, v15
    v_fmac_f32 v14, v16, v16
    v_sub_f32 v16, v112, v15
    v_fmac_f32 v5, v16, v16
    v_sub_f32 v16, v113, v15
    v_fmac_f32 v6, v16, v16
    v_sub_f32 v16, v114, v15
    v_fmac_f32 v7, v16, v16
    v_sub_f32 v16, v115, v15
    v_fmac_f32 v14, v16, v16
    v_sub_f32 v16, v116, v15
    v_fmac_f32 v5, v16, v16
    v_sub_f32 v16, v117, v15
    v_fmac_f32 v6, v16, v16
    v_sub_f32 v16, v118, v15
    v_fmac_f32 v7, v16, v16
    v_sub_f32 v16, v119, v15
    v_fmac_f32 v14, v16, v16
    v_sub_f32 v16, v120, v15
    v_fmac_f32 v5, v16, v16
    v_sub_f32 v16, v121, v15
    v_fmac_f32 v6, v16, v16
    v_sub_f32 v16, v122, v15
    v_fmac_f32 v7, v16, v16
    v_sub_f32 v16, v123, v15
    v_fmac_f32 v14, v16, v16
    v_sub_f32 v16, v124, v15
    v_fmac_f32 v5, v16, v16
    v_sub_f32 v16, v125, v15
    v_fmac_f32 v6, v16, v16
    v_sub_f32 v16, v126, v15
    v_fmac_f32 v7, v16, v16
    v_sub_f32 v16, v127, v15
    v_fmac_f32 v14, v16, v16
    v_sub_f32 v16, v128, v15
    v_fmac_f32 v5, v16, v16
    v_sub_f32 v16, v129, v15
    v_fmac_f32 v6, v16, v16
    v_sub_f32 v16, v130, v15
    v_fmac_f32 v7, v16, v16
    v_sub_f32 v16, v131, v15
    v_fmac_f32 v14, v16, v16
    v_sub_f32 v16, v132, v15
    v_fmac_f32 v5, v16, v16
    v_sub_f32 v16, v133, v15
    v_fmac_f32 v6, v16, v16
    v_sub_f32 v16, v134, v15
    v_fmac_f32 v7, v16, v16
    v_sub_f32 v16, v135, v15
    v_fmac_f32 v14, v16, v16
    v_sub_f32 v16, v136, v15
    v_fmac_f32 v5, v16, v16
    v_sub_f32 v16, v137, v15
    v_fmac_f32 v6, v16, v16
    v_sub_f32 v16, v138, v15
    v_fmac_f32 v7, v16, v16
    v_sub_f32 v16, v139, v15
    v_fmac_f32 v14, v16, v16
    v_sub_f32 v16, v140, v15
    v_fmac_f32 v5, v16, v16
    v_sub_f32 v16, v141, v15
    v_fmac_f32 v6, v16, v16
    v_sub_f32 v16, v142, v15
    v_fmac_f32 v7, v16, v16
    v_sub_f32 v16, v143, v15
    v_fmac_f32 v14, v16, v16
    v_add_f32 v5, v5, v6
    v_add_f32 v7, v7, v14
    v_add_f32 v5, v5, v7
    v_mov_b32 v9, v5
    s_nop 1
    v_permlane32_swap_b32 v5, v9
    v_add_f32 v5, v5, v9
    v_lshlrev_b32 v10, 2, v2
    s_lshl_b32 s22, s9, 7
    v_add_u32 v10, s22, v10
    v_add_u32 v10, 0, v10
    ds_write_b32 v10, v5 offset:512
    s_waitcnt lgkmcnt(0)
    s_barrier
    v_lshlrev_b32 v10, 2, v2
    v_add_u32 v10, 0, v10
    ds_read_b32 v8, v10 offset:512
    ds_read_b32 v11, v10 offset:640
    ds_read_b32 v12, v10 offset:768
    ds_read_b32 v13, v10 offset:896
    s_waitcnt lgkmcnt(0)
    v_add_f32 v8, v8, v11
    v_add_f32 v12, v12, v13
    v_add_f32 v8, v8, v12
    v_mul_f32 v8, 0x3acccccd, v8
    v_cvt_pk_bf16_f32 v8, v8, v8
    v_lshlrev_b32 v8, 16, v8
    v_add_f32 v8, 0x3727c5ac, v8
    v_cvt_pk_bf16_f32 v8, v8, v8
    v_lshlrev_b32 v8, 16, v8
    v_sqrt_f32 v8, v8
    s_nop 0
    v_cvt_pk_bf16_f32 v8, v8, v8
    v_lshlrev_b32 v8, 16, v8
    v_rcp_f32 v9, v8
    v_cvt_pk_bf16_f32 v15, v15, v15
    v_lshlrev_b32 v15, 16, v15
    v_sub_f32 v64, v64, v15
    v_sub_f32 v65, v65, v15
    v_cvt_pk_bf16_f32 v16, v64, v65
    v_lshlrev_b32 v64, 16, v16
    v_and_b32 v65, 0xffff0000, v16
    v_mul_f32 v16, v64, v9
    v_mul_f32 v17, v65, v9
    v_fma_f32 v18, -v16, v8, v64
    v_fma_f32 v19, -v17, v8, v65
    v_fmac_f32 v16, v18, v9
    v_fmac_f32 v17, v19, v9
    v_cvt_pk_bf16_f32 v24, v16, v17
    v_sub_f32 v66, v66, v15
    v_sub_f32 v67, v67, v15
    v_cvt_pk_bf16_f32 v16, v66, v67
    v_lshlrev_b32 v66, 16, v16
    v_and_b32 v67, 0xffff0000, v16
    v_mul_f32 v16, v66, v9
    v_mul_f32 v17, v67, v9
    v_fma_f32 v18, -v16, v8, v66
    v_fma_f32 v19, -v17, v8, v67
    v_fmac_f32 v16, v18, v9
    v_fmac_f32 v17, v19, v9
    v_cvt_pk_bf16_f32 v25, v16, v17
    v_sub_f32 v68, v68, v15
    v_sub_f32 v69, v69, v15
    v_cvt_pk_bf16_f32 v16, v68, v69
    v_lshlrev_b32 v68, 16, v16
    v_and_b32 v69, 0xffff0000, v16
    v_mul_f32 v16, v68, v9
    v_mul_f32 v17, v69, v9
    v_fma_f32 v18, -v16, v8, v68
    v_fma_f32 v19, -v17, v8, v69
    v_fmac_f32 v16, v18, v9
    v_fmac_f32 v17, v19, v9
    v_cvt_pk_bf16_f32 v26, v16, v17
    v_sub_f32 v70, v70, v15
    v_sub_f32 v71, v71, v15
    v_cvt_pk_bf16_f32 v16, v70, v71
    v_lshlrev_b32 v70, 16, v16
    v_and_b32 v71, 0xffff0000, v16
    v_mul_f32 v16, v70, v9
    v_mul_f32 v17, v71, v9
    v_fma_f32 v18, -v16, v8, v70
    v_fma_f32 v19, -v17, v8, v71
    v_fmac_f32 v16, v18, v9
    v_fmac_f32 v17, v19, v9
    v_cvt_pk_bf16_f32 v27, v16, v17
    v_sub_f32 v72, v72, v15
    v_sub_f32 v73, v73, v15
    v_cvt_pk_bf16_f32 v16, v72, v73
    v_lshlrev_b32 v72, 16, v16
    v_and_b32 v73, 0xffff0000, v16
    v_mul_f32 v16, v72, v9
    v_mul_f32 v17, v73, v9
    v_fma_f32 v18, -v16, v8, v72
    v_fma_f32 v19, -v17, v8, v73
    v_fmac_f32 v16, v18, v9
    v_fmac_f32 v17, v19, v9
    v_cvt_pk_bf16_f32 v28, v16, v17
    v_sub_f32 v74, v74, v15
    v_sub_f32 v75, v75, v15
    v_cvt_pk_bf16_f32 v16, v74, v75
    v_lshlrev_b32 v74, 16, v16
    v_and_b32 v75, 0xffff0000, v16
    v_mul_f32 v16, v74, v9
    v_mul_f32 v17, v75, v9
    v_fma_f32 v18, -v16, v8, v74
    v_fma_f32 v19, -v17, v8, v75
    v_fmac_f32 v16, v18, v9
    v_fmac_f32 v17, v19, v9
    v_cvt_pk_bf16_f32 v29, v16, v17
    v_sub_f32 v76, v76, v15
    v_sub_f32 v77, v77, v15
    v_cvt_pk_bf16_f32 v16, v76, v77
    v_lshlrev_b32 v76, 16, v16
    v_and_b32 v77, 0xffff0000, v16
    v_mul_f32 v16, v76, v9
    v_mul_f32 v17, v77, v9
    v_fma_f32 v18, -v16, v8, v76
    v_fma_f32 v19, -v17, v8, v77
    v_fmac_f32 v16, v18, v9
    v_fmac_f32 v17, v19, v9
    v_cvt_pk_bf16_f32 v30, v16, v17
    v_sub_f32 v78, v78, v15
    v_sub_f32 v79, v79, v15
    v_cvt_pk_bf16_f32 v16, v78, v79
    v_lshlrev_b32 v78, 16, v16
    v_and_b32 v79, 0xffff0000, v16
    v_mul_f32 v16, v78, v9
    v_mul_f32 v17, v79, v9
    v_fma_f32 v18, -v16, v8, v78
    v_fma_f32 v19, -v17, v8, v79
    v_fmac_f32 v16, v18, v9
    v_fmac_f32 v17, v19, v9
    v_cvt_pk_bf16_f32 v31, v16, v17
    v_sub_f32 v80, v80, v15
    v_sub_f32 v81, v81, v15
    v_cvt_pk_bf16_f32 v16, v80, v81
    v_lshlrev_b32 v80, 16, v16
    v_and_b32 v81, 0xffff0000, v16
    v_mul_f32 v16, v80, v9
    v_mul_f32 v17, v81, v9
    v_fma_f32 v18, -v16, v8, v80
    v_fma_f32 v19, -v17, v8, v81
    v_fmac_f32 v16, v18, v9
    v_fmac_f32 v17, v19, v9
    v_cvt_pk_bf16_f32 v32, v16, v17
    v_sub_f32 v82, v82, v15
    v_sub_f32 v83, v83, v15
    v_cvt_pk_bf16_f32 v16, v82, v83
    v_lshlrev_b32 v82, 16, v16
    v_and_b32 v83, 0xffff0000, v16
    v_mul_f32 v16, v82, v9
    v_mul_f32 v17, v83, v9
    v_fma_f32 v18, -v16, v8, v82
    v_fma_f32 v19, -v17, v8, v83
    v_fmac_f32 v16, v18, v9
    v_fmac_f32 v17, v19, v9
    v_cvt_pk_bf16_f32 v33, v16, v17
    v_sub_f32 v84, v84, v15
    v_sub_f32 v85, v85, v15
    v_cvt_pk_bf16_f32 v16, v84, v85
    v_lshlrev_b32 v84, 16, v16
    v_and_b32 v85, 0xffff0000, v16
    v_mul_f32 v16, v84, v9
    v_mul_f32 v17, v85, v9
    v_fma_f32 v18, -v16, v8, v84
    v_fma_f32 v19, -v17, v8, v85
    v_fmac_f32 v16, v18, v9
    v_fmac_f32 v17, v19, v9
    v_cvt_pk_bf16_f32 v34, v16, v17
    v_sub_f32 v86, v86, v15
    v_sub_f32 v87, v87, v15
    v_cvt_pk_bf16_f32 v16, v86, v87
    v_lshlrev_b32 v86, 16, v16
    v_and_b32 v87, 0xffff0000, v16
    v_mul_f32 v16, v86, v9
    v_mul_f32 v17, v87, v9
    v_fma_f32 v18, -v16, v8, v86
    v_fma_f32 v19, -v17, v8, v87
    v_fmac_f32 v16, v18, v9
    v_fmac_f32 v17, v19, v9
    v_cvt_pk_bf16_f32 v35, v16, v17
    v_sub_f32 v88, v88, v15
    v_sub_f32 v89, v89, v15
    v_cvt_pk_bf16_f32 v16, v88, v89
    v_lshlrev_b32 v88, 16, v16
    v_and_b32 v89, 0xffff0000, v16
    v_mul_f32 v16, v88, v9
    v_mul_f32 v17, v89, v9
    v_fma_f32 v18, -v16, v8, v88
    v_fma_f32 v19, -v17, v8, v89
    v_fmac_f32 v16, v18, v9
    v_fmac_f32 v17, v19, v9
    v_cvt_pk_bf16_f32 v36, v16, v17
    v_sub_f32 v90, v90, v15
    v_sub_f32 v91, v91, v15
    v_cvt_pk_bf16_f32 v16, v90, v91
    v_lshlrev_b32 v90, 16, v16
    v_and_b32 v91, 0xffff0000, v16
    v_mul_f32 v16, v90, v9
    v_mul_f32 v17, v91, v9
    v_fma_f32 v18, -v16, v8, v90
    v_fma_f32 v19, -v17, v8, v91
    v_fmac_f32 v16, v18, v9
    v_fmac_f32 v17, v19, v9
    v_cvt_pk_bf16_f32 v37, v16, v17
    v_sub_f32 v92, v92, v15
    v_sub_f32 v93, v93, v15
    v_cvt_pk_bf16_f32 v16, v92, v93
    v_lshlrev_b32 v92, 16, v16
    v_and_b32 v93, 0xffff0000, v16
    v_mul_f32 v16, v92, v9
    v_mul_f32 v17, v93, v9
    v_fma_f32 v18, -v16, v8, v92
    v_fma_f32 v19, -v17, v8, v93
    v_fmac_f32 v16, v18, v9
    v_fmac_f32 v17, v19, v9
    v_cvt_pk_bf16_f32 v38, v16, v17
    v_sub_f32 v94, v94, v15
    v_sub_f32 v95, v95, v15
    v_cvt_pk_bf16_f32 v16, v94, v95
    v_lshlrev_b32 v94, 16, v16
    v_and_b32 v95, 0xffff0000, v16
    v_mul_f32 v16, v94, v9
    v_mul_f32 v17, v95, v9
    v_fma_f32 v18, -v16, v8, v94
    v_fma_f32 v19, -v17, v8, v95
    v_fmac_f32 v16, v18, v9
    v_fmac_f32 v17, v19, v9
    v_cvt_pk_bf16_f32 v39, v16, v17
    v_sub_f32 v96, v96, v15
    v_sub_f32 v97, v97, v15
    v_cvt_pk_bf16_f32 v16, v96, v97
    v_lshlrev_b32 v96, 16, v16
    v_and_b32 v97, 0xffff0000, v16
    v_mul_f32 v16, v96, v9
    v_mul_f32 v17, v97, v9
    v_fma_f32 v18, -v16, v8, v96
    v_fma_f32 v19, -v17, v8, v97
    v_fmac_f32 v16, v18, v9
    v_fmac_f32 v17, v19, v9
    v_cvt_pk_bf16_f32 v40, v16, v17
    v_sub_f32 v98, v98, v15
    v_sub_f32 v99, v99, v15
    v_cvt_pk_bf16_f32 v16, v98, v99
    v_lshlrev_b32 v98, 16, v16
    v_and_b32 v99, 0xffff0000, v16
    v_mul_f32 v16, v98, v9
    v_mul_f32 v17, v99, v9
    v_fma_f32 v18, -v16, v8, v98
    v_fma_f32 v19, -v17, v8, v99
    v_fmac_f32 v16, v18, v9
    v_fmac_f32 v17, v19, v9
    v_cvt_pk_bf16_f32 v41, v16, v17
    v_sub_f32 v100, v100, v15
    v_sub_f32 v101, v101, v15
    v_cvt_pk_bf16_f32 v16, v100, v101
    v_lshlrev_b32 v100, 16, v16
    v_and_b32 v101, 0xffff0000, v16
    v_mul_f32 v16, v100, v9
    v_mul_f32 v17, v101, v9
    v_fma_f32 v18, -v16, v8, v100
    v_fma_f32 v19, -v17, v8, v101
    v_fmac_f32 v16, v18, v9
    v_fmac_f32 v17, v19, v9
    v_cvt_pk_bf16_f32 v42, v16, v17
    v_sub_f32 v102, v102, v15
    v_sub_f32 v103, v103, v15
    v_cvt_pk_bf16_f32 v16, v102, v103
    v_lshlrev_b32 v102, 16, v16
    v_and_b32 v103, 0xffff0000, v16
    v_mul_f32 v16, v102, v9
    v_mul_f32 v17, v103, v9
    v_fma_f32 v18, -v16, v8, v102
    v_fma_f32 v19, -v17, v8, v103
    v_fmac_f32 v16, v18, v9
    v_fmac_f32 v17, v19, v9
    v_cvt_pk_bf16_f32 v43, v16, v17
    v_sub_f32 v104, v104, v15
    v_sub_f32 v105, v105, v15
    v_cvt_pk_bf16_f32 v16, v104, v105
    v_lshlrev_b32 v104, 16, v16
    v_and_b32 v105, 0xffff0000, v16
    v_mul_f32 v16, v104, v9
    v_mul_f32 v17, v105, v9
    v_fma_f32 v18, -v16, v8, v104
    v_fma_f32 v19, -v17, v8, v105
    v_fmac_f32 v16, v18, v9
    v_fmac_f32 v17, v19, v9
    v_cvt_pk_bf16_f32 v44, v16, v17
    v_sub_f32 v106, v106, v15
    v_sub_f32 v107, v107, v15
    v_cvt_pk_bf16_f32 v16, v106, v107
    v_lshlrev_b32 v106, 16, v16
    v_and_b32 v107, 0xffff0000, v16
    v_mul_f32 v16, v106, v9
    v_mul_f32 v17, v107, v9
    v_fma_f32 v18, -v16, v8, v106
    v_fma_f32 v19, -v17, v8, v107
    v_fmac_f32 v16, v18, v9
    v_fmac_f32 v17, v19, v9
    v_cvt_pk_bf16_f32 v45, v16, v17
    v_sub_f32 v108, v108, v15
    v_sub_f32 v109, v109, v15
    v_cvt_pk_bf16_f32 v16, v108, v109
    v_lshlrev_b32 v108, 16, v16
    v_and_b32 v109, 0xffff0000, v16
    v_mul_f32 v16, v108, v9
    v_mul_f32 v17, v109, v9
    v_fma_f32 v18, -v16, v8, v108
    v_fma_f32 v19, -v17, v8, v109
    v_fmac_f32 v16, v18, v9
    v_fmac_f32 v17, v19, v9
    v_cvt_pk_bf16_f32 v46, v16, v17
    v_sub_f32 v110, v110, v15
    v_sub_f32 v111, v111, v15
    v_cvt_pk_bf16_f32 v16, v110, v111
    v_lshlrev_b32 v110, 16, v16
    v_and_b32 v111, 0xffff0000, v16
    v_mul_f32 v16, v110, v9
    v_mul_f32 v17, v111, v9
    v_fma_f32 v18, -v16, v8, v110
    v_fma_f32 v19, -v17, v8, v111
    v_fmac_f32 v16, v18, v9
    v_fmac_f32 v17, v19, v9
    v_cvt_pk_bf16_f32 v47, v16, v17
    v_sub_f32 v112, v112, v15
    v_sub_f32 v113, v113, v15
    v_cvt_pk_bf16_f32 v16, v112, v113
    v_lshlrev_b32 v112, 16, v16
    v_and_b32 v113, 0xffff0000, v16
    v_mul_f32 v16, v112, v9
    v_mul_f32 v17, v113, v9
    v_fma_f32 v18, -v16, v8, v112
    v_fma_f32 v19, -v17, v8, v113
    v_fmac_f32 v16, v18, v9
    v_fmac_f32 v17, v19, v9
    v_cvt_pk_bf16_f32 v48, v16, v17
    v_sub_f32 v114, v114, v15
    v_sub_f32 v115, v115, v15
    v_cvt_pk_bf16_f32 v16, v114, v115
    v_lshlrev_b32 v114, 16, v16
    v_and_b32 v115, 0xffff0000, v16
    v_mul_f32 v16, v114, v9
    v_mul_f32 v17, v115, v9
    v_fma_f32 v18, -v16, v8, v114
    v_fma_f32 v19, -v17, v8, v115
    v_fmac_f32 v16, v18, v9
    v_fmac_f32 v17, v19, v9
    v_cvt_pk_bf16_f32 v49, v16, v17
    v_sub_f32 v116, v116, v15
    v_sub_f32 v117, v117, v15
    v_cvt_pk_bf16_f32 v16, v116, v117
    v_lshlrev_b32 v116, 16, v16
    v_and_b32 v117, 0xffff0000, v16
    v_mul_f32 v16, v116, v9
    v_mul_f32 v17, v117, v9
    v_fma_f32 v18, -v16, v8, v116
    v_fma_f32 v19, -v17, v8, v117
    v_fmac_f32 v16, v18, v9
    v_fmac_f32 v17, v19, v9
    v_cvt_pk_bf16_f32 v50, v16, v17
    v_sub_f32 v118, v118, v15
    v_sub_f32 v119, v119, v15
    v_cvt_pk_bf16_f32 v16, v118, v119
    v_lshlrev_b32 v118, 16, v16
    v_and_b32 v119, 0xffff0000, v16
    v_mul_f32 v16, v118, v9
    v_mul_f32 v17, v119, v9
    v_fma_f32 v18, -v16, v8, v118
    v_fma_f32 v19, -v17, v8, v119
    v_fmac_f32 v16, v18, v9
    v_fmac_f32 v17, v19, v9
    v_cvt_pk_bf16_f32 v51, v16, v17
    v_sub_f32 v120, v120, v15
    v_sub_f32 v121, v121, v15
    v_cvt_pk_bf16_f32 v16, v120, v121
    v_lshlrev_b32 v120, 16, v16
    v_and_b32 v121, 0xffff0000, v16
    v_mul_f32 v16, v120, v9
    v_mul_f32 v17, v121, v9
    v_fma_f32 v18, -v16, v8, v120
    v_fma_f32 v19, -v17, v8, v121
    v_fmac_f32 v16, v18, v9
    v_fmac_f32 v17, v19, v9
    v_cvt_pk_bf16_f32 v52, v16, v17
    v_sub_f32 v122, v122, v15
    v_sub_f32 v123, v123, v15
    v_cvt_pk_bf16_f32 v16, v122, v123
    v_lshlrev_b32 v122, 16, v16
    v_and_b32 v123, 0xffff0000, v16
    v_mul_f32 v16, v122, v9
    v_mul_f32 v17, v123, v9
    v_fma_f32 v18, -v16, v8, v122
    v_fma_f32 v19, -v17, v8, v123
    v_fmac_f32 v16, v18, v9
    v_fmac_f32 v17, v19, v9
    v_cvt_pk_bf16_f32 v53, v16, v17
    v_sub_f32 v124, v124, v15
    v_sub_f32 v125, v125, v15
    v_cvt_pk_bf16_f32 v16, v124, v125
    v_lshlrev_b32 v124, 16, v16
    v_and_b32 v125, 0xffff0000, v16
    v_mul_f32 v16, v124, v9
    v_mul_f32 v17, v125, v9
    v_fma_f32 v18, -v16, v8, v124
    v_fma_f32 v19, -v17, v8, v125
    v_fmac_f32 v16, v18, v9
    v_fmac_f32 v17, v19, v9
    v_cvt_pk_bf16_f32 v54, v16, v17
    v_sub_f32 v126, v126, v15
    v_sub_f32 v127, v127, v15
    v_cvt_pk_bf16_f32 v16, v126, v127
    v_lshlrev_b32 v126, 16, v16
    v_and_b32 v127, 0xffff0000, v16
    v_mul_f32 v16, v126, v9
    v_mul_f32 v17, v127, v9
    v_fma_f32 v18, -v16, v8, v126
    v_fma_f32 v19, -v17, v8, v127
    v_fmac_f32 v16, v18, v9
    v_fmac_f32 v17, v19, v9
    v_cvt_pk_bf16_f32 v55, v16, v17
    v_sub_f32 v128, v128, v15
    v_sub_f32 v129, v129, v15
    v_cvt_pk_bf16_f32 v16, v128, v129
    v_lshlrev_b32 v128, 16, v16
    v_and_b32 v129, 0xffff0000, v16
    v_mul_f32 v16, v128, v9
    v_mul_f32 v17, v129, v9
    v_fma_f32 v18, -v16, v8, v128
    v_fma_f32 v19, -v17, v8, v129
    v_fmac_f32 v16, v18, v9
    v_fmac_f32 v17, v19, v9
    v_cvt_pk_bf16_f32 v56, v16, v17
    v_sub_f32 v130, v130, v15
    v_sub_f32 v131, v131, v15
    v_cvt_pk_bf16_f32 v16, v130, v131
    v_lshlrev_b32 v130, 16, v16
    v_and_b32 v131, 0xffff0000, v16
    v_mul_f32 v16, v130, v9
    v_mul_f32 v17, v131, v9
    v_fma_f32 v18, -v16, v8, v130
    v_fma_f32 v19, -v17, v8, v131
    v_fmac_f32 v16, v18, v9
    v_fmac_f32 v17, v19, v9
    v_cvt_pk_bf16_f32 v57, v16, v17
    v_sub_f32 v132, v132, v15
    v_sub_f32 v133, v133, v15
    v_cvt_pk_bf16_f32 v16, v132, v133
    v_lshlrev_b32 v132, 16, v16
    v_and_b32 v133, 0xffff0000, v16
    v_mul_f32 v16, v132, v9
    v_mul_f32 v17, v133, v9
    v_fma_f32 v18, -v16, v8, v132
    v_fma_f32 v19, -v17, v8, v133
    v_fmac_f32 v16, v18, v9
    v_fmac_f32 v17, v19, v9
    v_cvt_pk_bf16_f32 v58, v16, v17
    v_sub_f32 v134, v134, v15
    v_sub_f32 v135, v135, v15
    v_cvt_pk_bf16_f32 v16, v134, v135
    v_lshlrev_b32 v134, 16, v16
    v_and_b32 v135, 0xffff0000, v16
    v_mul_f32 v16, v134, v9
    v_mul_f32 v17, v135, v9
    v_fma_f32 v18, -v16, v8, v134
    v_fma_f32 v19, -v17, v8, v135
    v_fmac_f32 v16, v18, v9
    v_fmac_f32 v17, v19, v9
    v_cvt_pk_bf16_f32 v59, v16, v17
    v_sub_f32 v136, v136, v15
    v_sub_f32 v137, v137, v15
    v_cvt_pk_bf16_f32 v16, v136, v137
    v_lshlrev_b32 v136, 16, v16
    v_and_b32 v137, 0xffff0000, v16
    v_mul_f32 v16, v136, v9
    v_mul_f32 v17, v137, v9
    v_fma_f32 v18, -v16, v8, v136
    v_fma_f32 v19, -v17, v8, v137
    v_fmac_f32 v16, v18, v9
    v_fmac_f32 v17, v19, v9
    v_cvt_pk_bf16_f32 v60, v16, v17
    v_sub_f32 v138, v138, v15
    v_sub_f32 v139, v139, v15
    v_cvt_pk_bf16_f32 v16, v138, v139
    v_lshlrev_b32 v138, 16, v16
    v_and_b32 v139, 0xffff0000, v16
    v_mul_f32 v16, v138, v9
    v_mul_f32 v17, v139, v9
    v_fma_f32 v18, -v16, v8, v138
    v_fma_f32 v19, -v17, v8, v139
    v_fmac_f32 v16, v18, v9
    v_fmac_f32 v17, v19, v9
    v_cvt_pk_bf16_f32 v61, v16, v17
    v_sub_f32 v140, v140, v15
    v_sub_f32 v141, v141, v15
    v_cvt_pk_bf16_f32 v16, v140, v141
    v_lshlrev_b32 v140, 16, v16
    v_and_b32 v141, 0xffff0000, v16
    v_mul_f32 v16, v140, v9
    v_mul_f32 v17, v141, v9
    v_fma_f32 v18, -v16, v8, v140
    v_fma_f32 v19, -v17, v8, v141
    v_fmac_f32 v16, v18, v9
    v_fmac_f32 v17, v19, v9
    v_cvt_pk_bf16_f32 v62, v16, v17
    v_sub_f32 v142, v142, v15
    v_sub_f32 v143, v143, v15
    v_cvt_pk_bf16_f32 v16, v142, v143
    v_lshlrev_b32 v142, 16, v16
    v_and_b32 v143, 0xffff0000, v16
    v_mul_f32 v16, v142, v9
    v_mul_f32 v17, v143, v9
    v_fma_f32 v18, -v16, v8, v142
    v_fma_f32 v19, -v17, v8, v143
    v_fmac_f32 v16, v18, v9
    v_fmac_f32 v17, v19, v9
    v_cvt_pk_bf16_f32 v63, v16, v17
    v_lshlrev_b32 v4, 4, v1
    s_mul_i32 s20, s30, 40960
    s_mul_i32 s21, s9, 10240
    s_add_u32 s20, s20, s21
    s_add_u32 s20, s20, 85983232
    buffer_store_dwordx4 v[24:27], v4, s[12:15], s20 offen offset:0 sc1
    buffer_store_dwordx4 v[28:31], v4, s[12:15], s20 offen offset:1024 sc1
    buffer_store_dwordx4 v[32:35], v4, s[12:15], s20 offen offset:2048 sc1
    buffer_store_dwordx4 v[36:39], v4, s[12:15], s20 offen offset:3072 sc1
    s_add_u32 s20, s20, 4096
    buffer_store_dwordx4 v[40:43], v4, s[12:15], s20 offen offset:0 sc1
    buffer_store_dwordx4 v[44:47], v4, s[12:15], s20 offen offset:1024 sc1
    buffer_store_dwordx4 v[48:51], v4, s[12:15], s20 offen offset:2048 sc1
    buffer_store_dwordx4 v[52:55], v4, s[12:15], s20 offen offset:3072 sc1
    s_add_u32 s20, s20, 4096
    buffer_store_dwordx4 v[56:59], v4, s[12:15], s20 offen offset:0 sc1
    buffer_store_dwordx4 v[60:63], v4, s[12:15], s20 offen offset:1024 sc1
    s_waitcnt vmcnt(0)
    s_barrier
    s_cmp_lg_u32 s9, 0
    s_cbranch_scc1 fs_4
    s_lshl_b32 s59, s30, 7
    s_add_u32 s59, s59, s62
    s_add_u32 s59, s59, 2080768
    v_mov_b32 v20, s59
    v_mov_b32 v21, 1
    s_mov_b64 exec, 1
    buffer_store_dword v21, v20, s[12:15], 0 offen sc1
    s_mov_b64 exec, -1
fs_4:
G1_lnskip:
    s_sub_u32 s11, s8, 4
    s_mul_i32 s11, s11, 21
    s_add_u32 s11, s11, s10
    s_lshl_b32 s60, s11, 2
    s_add_u32 s60, s60, s9
    s_lshl_b32 s60, s60, 7
    s_add_u32 s60, s60, s49
    s_add_u32 s60, s60, 1986560
    v_mov_b32 v8, s60
    s_mov_b32 s30, 0
    s_mov_b32 s31, 64
    s_mul_i32 s24, s11, 171
    s_lshr_b32 s24, s24, 12
    s_mul_i32 s25, s24, 24
    s_sub_u32 s25, s11, s25
    s_cmp_eq_u32 s24, 3
    s_cbranch_scc1 G1_wgu
    s_lshl_b32 s26, s24, 3
    s_add_u32 s26, s26, 16
    s_load_dwordx2 s[16:17], s[0:1], s26
    s_waitcnt lgkmcnt(0)
    s_and_b32 s17, s17, 0xffff
    s_mov_b32 s18, 0x780000
    s_mov_b32 s19, 0x00020000
    v_lshrrev_b32 v20, 5, v1
    s_lshl_b32 s26, s9, 1
    v_add_u32 v20, s26, v20
    s_mov_b32 s26, 12288
    v_mul_lo_u32 v20, v20, s26
    v_and_b32 v21, 31, v1
    v_lshl_add_u32 v20, v21, 4, v20
    s_lshl_b32 s27, s25, 9
    v_and_b32 v21, 15, v1
    v_lshrrev_b32 v22, 2, v21
    v_lshrrev_b32 v23, 5, v1
    v_lshl_add_u32 v22, v23, 3, v22
    v_lshlrev_b32 v22, 9, v22
    v_and_b32 v21, 3, v1
    v_lshl_add_u32 v22, v21, 3, v22
    v_bfe_u32 v21, v1, 4, 1
    v_lshl_add_u32 v22, v21, 5, v22
    s_lshl_b32 s26, s9, 7
    v_add_u32 v22, s26, v22
    s_lshl_b32 s28, s9, 10
    s_add_u32 s28, s28, 0
    s_mov_b32 m0, s28
    s_add_u32 s28, s28, 4096
    buffer_load_dwordx4 v20, s[16:19], s27 offen lds
    s_add_u32 s27, s27, 98304
    s_mov_b32 m0, s28
    s_add_u32 s28, s28, 4096
    buffer_load_dwordx4 v20, s[16:19], s27 offen lds
    s_add_u32 s27, s27, 98304
    s_mov_b32 m0, s28
    s_add_u32 s28, s28, 4096
    buffer_load_dwordx4 v20, s[16:19], s27 offen lds
    s_add_u32 s27, s27, 98304
    s_mov_b32 m0, s28
    s_add_u32 s28, s28, 4096
    buffer_load_dwordx4 v20, s[16:19], s27 offen lds
    s_add_u32 s27, s27, 98304
    s_mov_b32 m0, s28
    s_add_u32 s28, s28, 4096
    buffer_load_dwordx4 v20, s[16:19], s27 offen lds
    s_add_u32 s27, s27, 98304
    s_mov_b32 m0, s28
    s_add_u32 s28, s28, 4096
    buffer_load_dwordx4 v20, s[16:19], s27 offen lds
    s_add_u32 s27, s27, 98304
    s_mov_b32 m0, s28
    s_add_u32 s28, s28, 4096
    buffer_load_dwordx4 v20, s[16:19], s27 offen lds
    s_add_u32 s27, s27, 98304
    s_mov_b32 m0, s28
    s_add_u32 s28, s28, 4096
    buffer_load_dwordx4 v20, s[16:19], s27 offen lds
    s_add_u32 s27, s27, 98304
    s_mov_b32 m0, s28
    s_add_u32 s28, s28, 4096
    buffer_load_dwordx4 v20, s[16:19], s27 offen lds
    s_add_u32 s27, s27, 98304
    s_mov_b32 m0, s28
    s_add_u32 s28, s28, 4096
    buffer_load_dwordx4 v20, s[16:19], s27 offen lds
    s_add_u32 s27, s27, 98304
    s_lshl_b32 s28, s9, 10
    s_add_u32 s28, s28, 40960
    s_mov_b32 m0, s28
    s_add_u32 s28, s28, 4096
    buffer_load_dwordx4 v20, s[16:19], s27 offen lds
    s_add_u32 s27, s27, 98304
    s_mov_b32 m0, s28
    s_add_u32 s28, s28, 4096
    buffer_load_dwordx4 v20, s[16:19], s27 offen lds
    s_add_u32 s27, s27, 98304
    s_mov_b32 m0, s28
    s_add_u32 s28, s28, 4096
    buffer_load_dwordx4 v20, s[16:19], s27 offen lds
    s_add_u32 s27, s27, 98304
    s_mov_b32 m0, s28
    s_add_u32 s28, s28, 4096
    buffer_load_dwordx4 v20, s[16:19], s27 offen lds
    s_add_u32 s27, s27, 98304
    s_mov_b32 m0, s28
    s_add_u32 s28, s28, 4096
    buffer_load_dwordx4 v20, s[16:19], s27 offen lds
    s_add_u32 s27, s27, 98304
    s_mov_b32 m0, s28
    s_add_u32 s28, s28, 4096
    buffer_load_dwordx4 v20, s[16:19], s27 offen lds
    s_add_u32 s27, s27, 98304
    s_mov_b32 m0, s28
    s_add_u32 s28, s28, 4096
    buffer_load_dwordx4 v20, s[16:19], s27 offen lds
    s_add_u32 s27, s27, 98304
    s_mov_b32 m0, s28
    s_add_u32 s28, s28, 4096
    buffer_load_dwordx4 v20, s[16:19], s27 offen lds
    s_add_u32 s27, s27, 98304
    s_mov_b32 m0, s28
    s_add_u32 s28, s28, 4096
    buffer_load_dwordx4 v20, s[16:19], s27 offen lds
    s_add_u32 s27, s27, 98304
    s_mov_b32 m0, s28
    s_add_u32 s28, s28, 4096
    buffer_load_dwordx4 v20, s[16:19], s27 offen lds
    s_add_u32 s27, s27, 98304
    s_lshl_b32 s28, s9, 10
    s_add_u32 s28, s28, 81920
    s_mov_b32 m0, s28
    s_add_u32 s28, s28, 4096
    buffer_load_dwordx4 v20, s[16:19], s27 offen lds
    s_add_u32 s27, s27, 98304
    s_mov_b32 m0, s28
    s_add_u32 s28, s28, 4096
    buffer_load_dwordx4 v20, s[16:19], s27 offen lds
    s_add_u32 s27, s27, 98304
    s_mov_b32 m0, s28
    s_add_u32 s28, s28, 4096
    buffer_load_dwordx4 v20, s[16:19], s27 offen lds
    s_add_u32 s27, s27, 98304
    s_mov_b32 m0, s28
    s_add_u32 s28, s28, 4096
    buffer_load_dwordx4 v20, s[16:19], s27 offen lds
    s_add_u32 s27, s27, 98304
    s_mov_b32 m0, s28
    s_add_u32 s28, s28, 4096
    buffer_load_dwordx4 v20, s[16:19], s27 offen lds
    s_add_u32 s27, s27, 98304
    s_mov_b32 m0, s28
    s_add_u32 s28, s28, 4096
    buffer_load_dwordx4 v20, s[16:19], s27 offen lds
    s_add_u32 s27, s27, 98304
    s_mov_b32 m0, s28
    s_add_u32 s28, s28, 4096
    buffer_load_dwordx4 v20, s[16:19], s27 offen lds
    s_add_u32 s27, s27, 98304
    s_mov_b32 m0, s28
    s_add_u32 s28, s28, 4096
    buffer_load_dwordx4 v20, s[16:19], s27 offen lds
    s_add_u32 s27, s27, 98304
    s_mov_b32 m0, s28
    s_add_u32 s28, s28, 4096
    buffer_load_dwordx4 v20, s[16:19], s27 offen lds
    s_add_u32 s27, s27, 98304
    s_mov_b32 m0, s28
    s_add_u32 s28, s28, 4096
    buffer_load_dwordx4 v20, s[16:19], s27 offen lds
    s_add_u32 s27, s27, 98304
    s_waitcnt vmcnt(20)
    s_barrier
    v_add_u32 v23, 0, v22
    ds_read_b64_tr_b16 a[0:1], v23 offset:0
    ds_read_b64_tr_b16 a[2:3], v23 offset:2048
    ds_read_b64_tr_b16 a[160:161], v23 offset:64
    ds_read_b64_tr_b16 a[162:163], v23 offset:2112
    ds_read_b64_tr_b16 a[4:5], v23 offset:8192
    ds_read_b64_tr_b16 a[6:7], v23 offset:10240
    ds_read_b64_tr_b16 a[164:165], v23 offset:8256
    ds_read_b64_tr_b16 a[166:167], v23 offset:10304
    ds_read_b64_tr_b16 a[8:9], v23 offset:16384
    ds_read_b64_tr_b16 a[10:11], v23 offset:18432
    ds_read_b64_tr_b16 a[168:169], v23 offset:16448
    ds_read_b64_tr_b16 a[170:171], v23 offset:18496
    s_waitcnt lgkmcnt(0)
    ds_read_b64_tr_b16 a[12:13], v23 offset:24576
    ds_read_b64_tr_b16 a[14:15], v23 offset:26624
    ds_read_b64_tr_b16 a[172:173], v23 offset:24640
    ds_read_b64_tr_b16 a[174:175], v23 offset:26688
    ds_read_b64_tr_b16 a[16:17], v23 offset:32768
    ds_read_b64_tr_b16 a[18:19], v23 offset:34816
    ds_read_b64_tr_b16 a[176:177], v23 offset:32832
    ds_read_b64_tr_b16 a[178:179], v23 offset:34880
    s_waitcnt lgkmcnt(0)
    s_barrier
    s_lshl_b32 s28, s9, 10
    s_add_u32 s28, s28, 0
    s_mov_b32 m0, s28
    s_add_u32 s28, s28, 4096
    buffer_load_dwordx4 v20, s[16:19], s27 offen lds
    s_add_u32 s27, s27, 98304
    s_mov_b32 m0, s28
    s_add_u32 s28, s28, 4096
    buffer_load_dwordx4 v20, s[16:19], s27 offen lds
    s_add_u32 s27, s27, 98304
    s_mov_b32 m0, s28
    s_add_u32 s28, s28, 4096
    buffer_load_dwordx4 v20, s[16:19], s27 offen lds
    s_add_u32 s27, s27, 98304
    s_mov_b32 m0, s28
    s_add_u32 s28, s28, 4096
    buffer_load_dwordx4 v20, s[16:19], s27 offen lds
    s_add_u32 s27, s27, 98304
    s_mov_b32 m0, s28
    s_add_u32 s28, s28, 4096
    buffer_load_dwordx4 v20, s[16:19], s27 offen lds
    s_add_u32 s27, s27, 98304
    s_mov_b32 m0, s28
    s_add_u32 s28, s28, 4096
    buffer_load_dwordx4 v20, s[16:19], s27 offen lds
    s_add_u32 s27, s27, 98304
    s_mov_b32 m0, s28
    s_add_u32 s28, s28, 4096
    buffer_load_dwordx4 v20, s[16:19], s27 offen lds
    s_add_u32 s27, s27, 98304
    s_mov_b32 m0, s28
    s_add_u32 s28, s28, 4096
    buffer_load_dwordx4 v20, s[16:19], s27 offen lds
    s_add_u32 s27, s27, 98304
    s_mov_b32 m0, s28
    s_add_u32 s28, s28, 4096
    buffer_load_dwordx4 v20, s[16:19], s27 offen lds
    s_add_u32 s27, s27, 98304
    s_mov_b32 m0, s28
    s_add_u32 s28, s28, 4096
    buffer_load_dwordx4 v20, s[16:19], s27 offen lds
    s_add_u32 s27, s27, 98304
    s_waitcnt vmcnt(20)
    s_barrier
    v_add_u32 v23, 40960, v22
    ds_read_b64_tr_b16 a[20:21], v23 offset:0
    ds_read_b64_tr_b16 a[22:23], v23 offset:2048
    ds_read_b64_tr_b16 a[180:181], v23 offset:64
    ds_read_b64_tr_b16 a[182:183], v23 offset:2112
    ds_read_b64_tr_b16 a[24:25], v23 offset:8192
    ds_read_b64_tr_b16 a[26:27], v23 offset:10240
    ds_read_b64_tr_b16 a[184:185], v23 offset:8256
    ds_read_b64_tr_b16 a[186:187], v23 offset:10304
    ds_read_b64_tr_b16 a[28:29], v23 offset:16384
    ds_read_b64_tr_b16 a[30:31], v23 offset:18432
    ds_read_b64_tr_b16 a[188:189], v23 offset:16448
    ds_read_b64_tr_b16 a[190:191], v23 offset:18496
    s_waitcnt lgkmcnt(0)
    ds_read_b64_tr_b16 a[32:33], v23 offset:24576
    ds_read_b64_tr_b16 a[34:35], v23 offset:26624
    ds_read_b64_tr_b16 a[192:193], v23 offset:24640
    ds_read_b64_tr_b16 a[194:195], v23 offset:26688
    ds_read_b64_tr_b16 a[36:37], v23 offset:32768
    ds_read_b64_tr_b16 a[38:39], v23 offset:34816
    ds_read_b64_tr_b16 a[196:197], v23 offset:32832
    ds_read_b64_tr_b16 a[198:199], v23 offset:34880
    s_waitcnt lgkmcnt(0)
    s_barrier
    s_lshl_b32 s28, s9, 10
    s_add_u32 s28, s28, 40960
    s_mov_b32 m0, s28
    s_add_u32 s28, s28, 4096
    buffer_load_dwordx4 v20, s[16:19], s27 offen lds
    s_add_u32 s27, s27, 98304
    s_mov_b32 m0, s28
    s_add_u32 s28, s28, 4096
    buffer_load_dwordx4 v20, s[16:19], s27 offen lds
    s_add_u32 s27, s27, 98304
    s_mov_b32 m0, s28
    s_add_u32 s28, s28, 4096
    buffer_load_dwordx4 v20, s[16:19], s27 offen lds
    s_add_u32 s27, s27, 98304
    s_mov_b32 m0, s28
    s_add_u32 s28, s28, 4096
    buffer_load_dwordx4 v20, s[16:19], s27 offen lds
    s_add_u32 s27, s27, 98304
    s_mov_b32 m0, s28
    s_add_u32 s28, s28, 4096
    buffer_load_dwordx4 v20, s[16:19], s27 offen lds
    s_add_u32 s27, s27, 98304
    s_mov_b32 m0, s28
    s_add_u32 s28, s28, 4096
    buffer_load_dwordx4 v20, s[16:19], s27 offen lds
    s_add_u32 s27, s27, 98304
    s_mov_b32 m0, s28
    s_add_u32 s28, s28, 4096
    buffer_load_dwordx4 v20, s[16:19], s27 offen lds
    s_add_u32 s27, s27, 98304
    s_mov_b32 m0, s28
    s_add_u32 s28, s28, 4096
    buffer_load_dwordx4 v20, s[16:19], s27 offen lds
    s_add_u32 s27, s27, 98304
    s_mov_b32 m0, s28
    s_add_u32 s28, s28, 4096
    buffer_load_dwordx4 v20, s[16:19], s27 offen lds
    s_add_u32 s27, s27, 98304
    s_mov_b32 m0, s28
    s_add_u32 s28, s28, 4096
    buffer_load_dwordx4 v20, s[16:19], s27 offen lds
    s_add_u32 s27, s27, 98304
    s_waitcnt vmcnt(20)
    s_barrier
    v_add_u32 v23, 81920, v22
    ds_read_b64_tr_b16 a[40:41], v23 offset:0
    ds_read_b64_tr_b16 a[42:43], v23 offset:2048
    ds_read_b64_tr_b16 a[200:201], v23 offset:64
    ds_read_b64_tr_b16 a[202:203], v23 offset:2112
    ds_read_b64_tr_b16 a[44:45], v23 offset:8192
    ds_read_b64_tr_b16 a[46:47], v23 offset:10240
    ds_read_b64_tr_b16 a[204:205], v23 offset:8256
    ds_read_b64_tr_b16 a[206:207], v23 offset:10304
    ds_read_b64_tr_b16 a[48:49], v23 offset:16384
    ds_read_b64_tr_b16 a[50:51], v23 offset:18432
    ds_read_b64_tr_b16 a[208:209], v23 offset:16448
    ds_read_b64_tr_b16 a[210:211], v23 offset:18496
    s_waitcnt lgkmcnt(0)
    ds_read_b64_tr_b16 a[52:53], v23 offset:24576
    ds_read_b64_tr_b16 a[54:55], v23 offset:26624
    ds_read_b64_tr_b16 a[212:213], v23 offset:24640
    ds_read_b64_tr_b16 a[214:215], v23 offset:26688
    ds_read_b64_tr_b16 a[56:57], v23 offset:32768
    ds_read_b64_tr_b16 a[58:59], v23 offset:34816
    ds_read_b64_tr_b16 a[216:217], v23 offset:32832
    ds_read_b64_tr_b16 a[218:219], v23 offset:34880
    s_waitcnt lgkmcnt(0)
    s_barrier
    s_lshl_b32 s28, s9, 10
    s_add_u32 s28, s28, 81920
    s_mov_b32 m0, s28
    s_add_u32 s28, s28, 4096
    buffer_load_dwordx4 v20, s[16:19], s27 offen lds
    s_add_u32 s27, s27, 98304
    s_mov_b32 m0, s28
    s_add_u32 s28, s28, 4096
    buffer_load_dwordx4 v20, s[16:19], s27 offen lds
    s_add_u32 s27, s27, 98304
    s_mov_b32 m0, s28
    s_add_u32 s28, s28, 4096
    buffer_load_dwordx4 v20, s[16:19], s27 offen lds
    s_add_u32 s27, s27, 98304
    s_mov_b32 m0, s28
    s_add_u32 s28, s28, 4096
    buffer_load_dwordx4 v20, s[16:19], s27 offen lds
    s_add_u32 s27, s27, 98304
    s_mov_b32 m0, s28
    s_add_u32 s28, s28, 4096
    buffer_load_dwordx4 v20, s[16:19], s27 offen lds
    s_add_u32 s27, s27, 98304
    s_mov_b32 m0, s28
    s_add_u32 s28, s28, 4096
    buffer_load_dwordx4 v20, s[16:19], s27 offen lds
    s_add_u32 s27, s27, 98304
    s_mov_b32 m0, s28
    s_add_u32 s28, s28, 4096
    buffer_load_dwordx4 v20, s[16:19], s27 offen lds
    s_add_u32 s27, s27, 98304
    s_mov_b32 m0, s28
    s_add_u32 s28, s28, 4096
    buffer_load_dwordx4 v20, s[16:19], s27 offen lds
    s_add_u32 s27, s27, 98304
    s_mov_b32 m0, s28
    s_add_u32 s28, s28, 4096
    buffer_load_dwordx4 v20, s[16:19], s27 offen lds
    s_add_u32 s27, s27, 98304
    s_mov_b32 m0, s28
    s_add_u32 s28, s28, 4096
    buffer_load_dwordx4 v20, s[16:19], s27 offen lds
    s_add_u32 s27, s27, 98304
    s_waitcnt vmcnt(20)
    s_barrier
    v_add_u32 v23, 0, v22
    ds_read_b64_tr_b16 a[60:61], v23 offset:0
    ds_read_b64_tr_b16 a[62:63], v23 offset:2048
    ds_read_b64_tr_b16 a[220:221], v23 offset:64
    ds_read_b64_tr_b16 a[222:223], v23 offset:2112
    ds_read_b64_tr_b16 a[64:65], v23 offset:8192
    ds_read_b64_tr_b16 a[66:67], v23 offset:10240
    ds_read_b64_tr_b16 a[224:225], v23 offset:8256
    ds_read_b64_tr_b16 a[226:227], v23 offset:10304
    ds_read_b64_tr_b16 a[68:69], v23 offset:16384
    ds_read_b64_tr_b16 a[70:71], v23 offset:18432
    ds_read_b64_tr_b16 a[228:229], v23 offset:16448
    ds_read_b64_tr_b16 a[230:231], v23 offset:18496
    s_waitcnt lgkmcnt(0)
    ds_read_b64_tr_b16 a[72:73], v23 offset:24576
    ds_read_b64_tr_b16 a[74:75], v23 offset:26624
    ds_read_b64_tr_b16 a[232:233], v23 offset:24640
    ds_read_b64_tr_b16 a[234:235], v23 offset:26688
    ds_read_b64_tr_b16 a[76:77], v23 offset:32768
    ds_read_b64_tr_b16 a[78:79], v23 offset:34816
    ds_read_b64_tr_b16 a[236:237], v23 offset:32832
    ds_read_b64_tr_b16 a[238:239], v23 offset:34880
    s_waitcnt lgkmcnt(0)
    s_barrier
    s_lshl_b32 s28, s9, 10
    s_add_u32 s28, s28, 0
    s_mov_b32 m0, s28
    s_add_u32 s28, s28, 4096
    buffer_load_dwordx4 v20, s[16:19], s27 offen lds
    s_add_u32 s27, s27, 98304
    s_mov_b32 m0, s28
    s_add_u32 s28, s28, 4096
    buffer_load_dwordx4 v20, s[16:19], s27 offen lds
    s_add_u32 s27, s27, 98304
    s_mov_b32 m0, s28
    s_add_u32 s28, s28, 4096
    buffer_load_dwordx4 v20, s[16:19], s27 offen lds
    s_add_u32 s27, s27, 98304
    s_mov_b32 m0, s28
    s_add_u32 s28, s28, 4096
    buffer_load_dwordx4 v20, s[16:19], s27 offen lds
    s_add_u32 s27, s27, 98304
    s_mov_b32 m0, s28
    s_add_u32 s28, s28, 4096
    buffer_load_dwordx4 v20, s[16:19], s27 offen lds
    s_add_u32 s27, s27, 98304
    s_mov_b32 m0, s28
    s_add_u32 s28, s28, 4096
    buffer_load_dwordx4 v20, s[16:19], s27 offen lds
    s_add_u32 s27, s27, 98304
    s_mov_b32 m0, s28
    s_add_u32 s28, s28, 4096
    buffer_load_dwordx4 v20, s[16:19], s27 offen lds
    s_add_u32 s27, s27, 98304
    s_mov_b32 m0, s28
    s_add_u32 s28, s28, 4096
    buffer_load_dwordx4 v20, s[16:19], s27 offen lds
    s_add_u32 s27, s27, 98304
    s_mov_b32 m0, s28
    s_add_u32 s28, s28, 4096
    buffer_load_dwordx4 v20, s[16:19], s27 offen lds
    s_add_u32 s27, s27, 98304
    s_mov_b32 m0, s28
    s_add_u32 s28, s28, 4096
    buffer_load_dwordx4 v20, s[16:19], s27 offen lds
    s_add_u32 s27, s27, 98304
    s_waitcnt vmcnt(20)
    s_barrier
    v_add_u32 v23, 40960, v22
    ds_read_b64_tr_b16 a[80:81], v23 offset:0
    ds_read_b64_tr_b16 a[82:83], v23 offset:2048
    ds_read_b64_tr_b16 a[240:241], v23 offset:64
    ds_read_b64_tr_b16 a[242:243], v23 offset:2112
    ds_read_b64_tr_b16 a[84:85], v23 offset:8192
    ds_read_b64_tr_b16 a[86:87], v23 offset:10240
    ds_read_b64_tr_b16 a[244:245], v23 offset:8256
    ds_read_b64_tr_b16 a[246:247], v23 offset:10304
    ds_read_b64_tr_b16 a[88:89], v23 offset:16384
    ds_read_b64_tr_b16 a[90:91], v23 offset:18432
    ds_read_b64_tr_b16 a[248:249], v23 offset:16448
    ds_read_b64_tr_b16 a[250:251], v23 offset:18496
    s_waitcnt lgkmcnt(0)
    ds_read_b64_tr_b16 a[92:93], v23 offset:24576
    ds_read_b64_tr_b16 a[94:95], v23 offset:26624
    ds_read_b64_tr_b16 a[252:253], v23 offset:24640
    ds_read_b64_tr_b16 a[254:255], v23 offset:26688
    ds_read_b64_tr_b16 a[96:97], v23 offset:32768
    ds_read_b64_tr_b16 a[98:99], v23 offset:34816
    ds_read_b64_tr_b16 v[192:193], v23 offset:32832
    ds_read_b64_tr_b16 v[194:195], v23 offset:34880
    s_waitcnt lgkmcnt(0)
    s_barrier
    s_lshl_b32 s28, s9, 10
    s_add_u32 s28, s28, 40960
    s_mov_b32 m0, s28
    s_add_u32 s28, s28, 4096
    buffer_load_dwordx4 v20, s[16:19], s27 offen lds
    s_add_u32 s27, s27, 98304
    s_mov_b32 m0, s28
    s_add_u32 s28, s28, 4096
    buffer_load_dwordx4 v20, s[16:19], s27 offen lds
    s_add_u32 s27, s27, 98304
    s_mov_b32 m0, s28
    s_add_u32 s28, s28, 4096
    buffer_load_dwordx4 v20, s[16:19], s27 offen lds
    s_add_u32 s27, s27, 98304
    s_mov_b32 m0, s28
    s_add_u32 s28, s28, 4096
    buffer_load_dwordx4 v20, s[16:19], s27 offen lds
    s_add_u32 s27, s27, 98304
    s_mov_b32 m0, s28
    s_add_u32 s28, s28, 4096
    buffer_load_dwordx4 v20, s[16:19], s27 offen lds
    s_add_u32 s27, s27, 98304
    s_mov_b32 m0, s28
    s_add_u32 s28, s28, 4096
    buffer_load_dwordx4 v20, s[16:19], s27 offen lds
    s_add_u32 s27, s27, 98304
    s_mov_b32 m0, s28
    s_add_u32 s28, s28, 4096
    buffer_load_dwordx4 v20, s[16:19], s27 offen lds
    s_add_u32 s27, s27, 98304
    s_mov_b32 m0, s28
    s_add_u32 s28, s28, 4096
    buffer_load_dwordx4 v20, s[16:19], s27 offen lds
    s_add_u32 s27, s27, 98304
    s_mov_b32 m0, s28
    s_add_u32 s28, s28, 4096
    buffer_load_dwordx4 v20, s[16:19], s27 offen lds
    s_add_u32 s27, s27, 98304
    s_mov_b32 m0, s28
    s_add_u32 s28, s28, 4096
    buffer_load_dwordx4 v20, s[16:19], s27 offen lds
    s_add_u32 s27, s27, 98304
    s_waitcnt vmcnt(20)
    s_barrier
    v_add_u32 v23, 81920, v22
    ds_read_b64_tr_b16 a[100:101], v23 offset:0
    ds_read_b64_tr_b16 a[102:103], v23 offset:2048
    ds_read_b64_tr_b16 v[196:197], v23 offset:64
    ds_read_b64_tr_b16 v[198:199], v23 offset:2112
    ds_read_b64_tr_b16 a[104:105], v23 offset:8192
    ds_read_b64_tr_b16 a[106:107], v23 offset:10240
    ds_read_b64_tr_b16 v[200:201], v23 offset:8256
    ds_read_b64_tr_b16 v[202:203], v23 offset:10304
    ds_read_b64_tr_b16 a[108:109], v23 offset:16384
    ds_read_b64_tr_b16 a[110:111], v23 offset:18432
    ds_read_b64_tr_b16 v[204:205], v23 offset:16448
    ds_read_b64_tr_b16 v[206:207], v23 offset:18496
    s_waitcnt lgkmcnt(0)
    ds_read_b64_tr_b16 a[112:113], v23 offset:24576
    ds_read_b64_tr_b16 a[114:115], v23 offset:26624
    ds_read_b64_tr_b16 v[208:209], v23 offset:24640
    ds_read_b64_tr_b16 v[210:211], v23 offset:26688
    ds_read_b64_tr_b16 a[116:117], v23 offset:32768
    ds_read_b64_tr_b16 a[118:119], v23 offset:34816
    ds_read_b64_tr_b16 v[212:213], v23 offset:32832
    ds_read_b64_tr_b16 v[214:215], v23 offset:34880
    s_waitcnt lgkmcnt(0)
    s_barrier
    s_waitcnt vmcnt(10)
    s_barrier
    v_add_u32 v23, 0, v22
    ds_read_b64_tr_b16 a[120:121], v23 offset:0
    ds_read_b64_tr_b16 a[122:123], v23 offset:2048
    ds_read_b64_tr_b16 v[216:217], v23 offset:64
    ds_read_b64_tr_b16 v[218:219], v23 offset:2112
    ds_read_b64_tr_b16 a[124:125], v23 offset:8192
    ds_read_b64_tr_b16 a[126:127], v23 offset:10240
    ds_read_b64_tr_b16 v[220:221], v23 offset:8256
    ds_read_b64_tr_b16 v[222:223], v23 offset:10304
    ds_read_b64_tr_b16 a[128:129], v23 offset:16384
    ds_read_b64_tr_b16 a[130:131], v23 offset:18432
    ds_read_b64_tr_b16 v[224:225], v23 offset:16448
    ds_read_b64_tr_b16 v[226:227], v23 offset:18496
    s_waitcnt lgkmcnt(0)
    ds_read_b64_tr_b16 a[132:133], v23 offset:24576
    ds_read_b64_tr_b16 a[134:135], v23 offset:26624
    ds_read_b64_tr_b16 v[228:229], v23 offset:24640
    ds_read_b64_tr_b16 v[230:231], v23 offset:26688
    ds_read_b64_tr_b16 a[136:137], v23 offset:32768
    ds_read_b64_tr_b16 a[138:139], v23 offset:34816
    ds_read_b64_tr_b16 v[232:233], v23 offset:32832
    ds_read_b64_tr_b16 v[234:235], v23 offset:34880
    s_waitcnt lgkmcnt(0)
    s_barrier
    s_waitcnt vmcnt(0)
    s_barrier
    v_add_u32 v23, 40960, v22
    ds_read_b64_tr_b16 a[140:141], v23 offset:0
    ds_read_b64_tr_b16 a[142:143], v23 offset:2048
    ds_read_b64_tr_b16 v[236:237], v23 offset:64
    ds_read_b64_tr_b16 v[238:239], v23 offset:2112
    ds_read_b64_tr_b16 a[144:145], v23 offset:8192
    ds_read_b64_tr_b16 a[146:147], v23 offset:10240
    ds_read_b64_tr_b16 v[240:241], v23 offset:8256
    ds_read_b64_tr_b16 v[242:243], v23 offset:10304
    ds_read_b64_tr_b16 a[148:149], v23 offset:16384
    ds_read_b64_tr_b16 a[150:151], v23 offset:18432
    ds_read_b64_tr_b16 v[244:245], v23 offset:16448
    ds_read_b64_tr_b16 v[246:247], v23 offset:18496
    s_waitcnt lgkmcnt(0)
    ds_read_b64_tr_b16 a[152:153], v23 offset:24576
    ds_read_b64_tr_b16 a[154:155], v23 offset:26624
    ds_read_b64_tr_b16 v[248:249], v23 offset:24640
    ds_read_b64_tr_b16 v[250:251], v23 offset:26688
    ds_read_b64_tr_b16 a[156:157], v23 offset:32768
    ds_read_b64_tr_b16 a[158:159], v23 offset:34816
    ds_read_b64_tr_b16 v[252:253], v23 offset:32832
    ds_read_b64_tr_b16 v[254:255], v23 offset:34880
    s_waitcnt lgkmcnt(0)
    s_barrier
    s_branch G1_wdone
G1_wgu:
    s_load_dwordx2 s[16:17], s[0:1], 64
    s_load_dwordx2 s[20:21], s[0:1], 72
    s_waitcnt lgkmcnt(0)
    s_and_b32 s17, s17, 0xffff
    s_mov_b32 s18, 0x1e0000
    s_mov_b32 s19, 0x00020000
    s_and_b32 s21, s21, 0xffff
    s_mov_b32 s22, 0x1e0000
    s_mov_b32 s23, 0x00020000
    v_lshrrev_b32 v20, 4, v1
    s_lshl_b32 s26, s9, 2
    v_add_u32 v20, s26, v20
    v_mul_u32_u24 v20, 3072, v20
    v_and_b32 v21, 15, v1
    v_lshl_add_u32 v20, v21, 4, v20
    s_lshl_b32 s27, s25, 8
    v_and_b32 v21, 15, v1
    v_lshrrev_b32 v22, 2, v21
    v_lshrrev_b32 v23, 5, v1
    v_lshl_add_u32 v22, v23, 3, v22
    v_lshlrev_b32 v22, 8, v22
    v_and_b32 v21, 3, v1
    v_lshl_add_u32 v22, v21, 3, v22
    v_bfe_u32 v21, v1, 4, 1
    v_lshl_add_u32 v22, v21, 5, v22
    s_lshl_b32 s26, s9, 6
    v_add_u32 v22, s26, v22
    v_add_u32 v23, 40960, v22
    s_lshl_b32 s28, s9, 10
    s_mov_b32 m0, s28
    s_add_u32 s29, s28, 40960
    buffer_load_dwordx4 v20, s[16:19], s27 offen lds
    s_mov_b32 m0, s29
    s_add_u32 s28, s28, 4096
    buffer_load_dwordx4 v20, s[20:23], s27 offen lds
    s_add_u32 s27, s27, 49152
    s_mov_b32 m0, s28
    s_add_u32 s29, s28, 40960
    buffer_load_dwordx4 v20, s[16:19], s27 offen lds
    s_mov_b32 m0, s29
    s_add_u32 s28, s28, 4096
    buffer_load_dwordx4 v20, s[20:23], s27 offen lds
    s_add_u32 s27, s27, 49152
    s_mov_b32 m0, s28
    s_add_u32 s29, s28, 40960
    buffer_load_dwordx4 v20, s[16:19], s27 offen lds
    s_mov_b32 m0, s29
    s_add_u32 s28, s28, 4096
    buffer_load_dwordx4 v20, s[20:23], s27 offen lds
    s_add_u32 s27, s27, 49152
    s_mov_b32 m0, s28
    s_add_u32 s29, s28, 40960
    buffer_load_dwordx4 v20, s[16:19], s27 offen lds
    s_mov_b32 m0, s29
    s_add_u32 s28, s28, 4096
    buffer_load_dwordx4 v20, s[20:23], s27 offen lds
    s_add_u32 s27, s27, 49152
    s_mov_b32 m0, s28
    s_add_u32 s29, s28, 40960
    buffer_load_dwordx4 v20, s[16:19], s27 offen lds
    s_mov_b32 m0, s29
    s_add_u32 s28, s28, 4096
    buffer_load_dwordx4 v20, s[20:23], s27 offen lds
    s_add_u32 s27, s27, 49152
    s_mov_b32 m0, s28
    s_add_u32 s29, s28, 40960
    buffer_load_dwordx4 v20, s[16:19], s27 offen lds
    s_mov_b32 m0, s29
    s_add_u32 s28, s28, 4096
    buffer_load_dwordx4 v20, s[20:23], s27 offen lds
    s_add_u32 s27, s27, 49152
    s_mov_b32 m0, s28
    s_add_u32 s29, s28, 40960
    buffer_load_dwordx4 v20, s[16:19], s27 offen lds
    s_mov_b32 m0, s29
    s_add_u32 s28, s28, 4096
    buffer_load_dwordx4 v20, s[20:23], s27 offen lds
    s_add_u32 s27, s27, 49152
    s_mov_b32 m0, s28
    s_add_u32 s29, s28, 40960
    buffer_load_dwordx4 v20, s[16:19], s27 offen lds
    s_mov_b32 m0, s29
    s_add_u32 s28, s28, 4096
    buffer_load_dwordx4 v20, s[20:23], s27 offen lds
    s_add_u32 s27, s27, 49152
    s_mov_b32 m0, s28
    s_add_u32 s29, s28, 40960
    buffer_load_dwordx4 v20, s[16:19], s27 offen lds
    s_mov_b32 m0, s29
    s_add_u32 s28, s28, 4096
    buffer_load_dwordx4 v20, s[20:23], s27 offen lds
    s_add_u32 s27, s27, 49152
    s_mov_b32 m0, s28
    s_add_u32 s29, s28, 40960
    buffer_load_dwordx4 v20, s[16:19], s27 offen lds
    s_mov_b32 m0, s29
    s_add_u32 s28, s28, 4096
    buffer_load_dwordx4 v20, s[20:23], s27 offen lds
    s_add_u32 s27, s27, 49152
    s_waitcnt vmcnt(0)
    s_barrier
    ds_read_b64_tr_b16 a[0:1], v22 offset:0
    ds_read_b64_tr_b16 a[2:3], v22 offset:1024
    ds_read_b64_tr_b16 a[160:161], v23 offset:0
    ds_read_b64_tr_b16 a[162:163], v23 offset:1024
    ds_read_b64_tr_b16 a[4:5], v22 offset:4096
    ds_read_b64_tr_b16 a[6:7], v22 offset:5120
    ds_read_b64_tr_b16 a[164:165], v23 offset:4096
    ds_read_b64_tr_b16 a[166:167], v23 offset:5120
    ds_read_b64_tr_b16 a[8:9], v22 offset:8192
    ds_read_b64_tr_b16 a[10:11], v22 offset:9216
    ds_read_b64_tr_b16 a[168:169], v23 offset:8192
    ds_read_b64_tr_b16 a[170:171], v23 offset:9216
    s_waitcnt lgkmcnt(0)
    ds_read_b64_tr_b16 a[12:13], v22 offset:12288
    ds_read_b64_tr_b16 a[14:15], v22 offset:13312
    ds_read_b64_tr_b16 a[172:173], v23 offset:12288
    ds_read_b64_tr_b16 a[174:175], v23 offset:13312
    ds_read_b64_tr_b16 a[16:17], v22 offset:16384
    ds_read_b64_tr_b16 a[18:19], v22 offset:17408
    ds_read_b64_tr_b16 a[176:177], v23 offset:16384
    ds_read_b64_tr_b16 a[178:179], v23 offset:17408
    ds_read_b64_tr_b16 a[20:21], v22 offset:20480
    ds_read_b64_tr_b16 a[22:23], v22 offset:21504
    ds_read_b64_tr_b16 a[180:181], v23 offset:20480
    ds_read_b64_tr_b16 a[182:183], v23 offset:21504
    s_waitcnt lgkmcnt(0)
    ds_read_b64_tr_b16 a[24:25], v22 offset:24576
    ds_read_b64_tr_b16 a[26:27], v22 offset:25600
    ds_read_b64_tr_b16 a[184:185], v23 offset:24576
    ds_read_b64_tr_b16 a[186:187], v23 offset:25600
    ds_read_b64_tr_b16 a[28:29], v22 offset:28672
    ds_read_b64_tr_b16 a[30:31], v22 offset:29696
    ds_read_b64_tr_b16 a[188:189], v23 offset:28672
    ds_read_b64_tr_b16 a[190:191], v23 offset:29696
    ds_read_b64_tr_b16 a[32:33], v22 offset:32768
    ds_read_b64_tr_b16 a[34:35], v22 offset:33792
    ds_read_b64_tr_b16 a[192:193], v23 offset:32768
    ds_read_b64_tr_b16 a[194:195], v23 offset:33792
    s_waitcnt lgkmcnt(0)
    ds_read_b64_tr_b16 a[36:37], v22 offset:36864
    ds_read_b64_tr_b16 a[38:39], v22 offset:37888
    ds_read_b64_tr_b16 a[196:197], v23 offset:36864
    ds_read_b64_tr_b16 a[198:199], v23 offset:37888
    s_waitcnt lgkmcnt(0)
    s_barrier
    s_lshl_b32 s28, s9, 10
    s_mov_b32 m0, s28
    s_add_u32 s29, s28, 40960
    buffer_load_dwordx4 v20, s[16:19], s27 offen lds
    s_mov_b32 m0, s29
    s_add_u32 s28, s28, 4096
    buffer_load_dwordx4 v20, s[20:23], s27 offen lds
    s_add_u32 s27, s27, 49152
    s_mov_b32 m0, s28
    s_add_u32 s29, s28, 40960
    buffer_load_dwordx4 v20, s[16:19], s27 offen lds
    s_mov_b32 m0, s29
    s_add_u32 s28, s28, 4096
    buffer_load_dwordx4 v20, s[20:23], s27 offen lds
    s_add_u32 s27, s27, 49152
    s_mov_b32 m0, s28
    s_add_u32 s29, s28, 40960
    buffer_load_dwordx4 v20, s[16:19], s27 offen lds
    s_mov_b32 m0, s29
    s_add_u32 s28, s28, 4096
    buffer_load_dwordx4 v20, s[20:23], s27 offen lds
    s_add_u32 s27, s27, 49152
    s_mov_b32 m0, s28
    s_add_u32 s29, s28, 40960
    buffer_load_dwordx4 v20, s[16:19], s27 offen lds
    s_mov_b32 m0, s29
    s_add_u32 s28, s28, 4096
    buffer_load_dwordx4 v20, s[20:23], s27 offen lds
    s_add_u32 s27, s27, 49152
    s_mov_b32 m0, s28
    s_add_u32 s29, s28, 40960
    buffer_load_dwordx4 v20, s[16:19], s27 offen lds
    s_mov_b32 m0, s29
    s_add_u32 s28, s28, 4096
    buffer_load_dwordx4 v20, s[20:23], s27 offen lds
    s_add_u32 s27, s27, 49152
    s_mov_b32 m0, s28
    s_add_u32 s29, s28, 40960
    buffer_load_dwordx4 v20, s[16:19], s27 offen lds
    s_mov_b32 m0, s29
    s_add_u32 s28, s28, 4096
    buffer_load_dwordx4 v20, s[20:23], s27 offen lds
    s_add_u32 s27, s27, 49152
    s_mov_b32 m0, s28
    s_add_u32 s29, s28, 40960
    buffer_load_dwordx4 v20, s[16:19], s27 offen lds
    s_mov_b32 m0, s29
    s_add_u32 s28, s28, 4096
    buffer_load_dwordx4 v20, s[20:23], s27 offen lds
    s_add_u32 s27, s27, 49152
    s_mov_b32 m0, s28
    s_add_u32 s29, s28, 40960
    buffer_load_dwordx4 v20, s[16:19], s27 offen lds
    s_mov_b32 m0, s29
    s_add_u32 s28, s28, 4096
    buffer_load_dwordx4 v20, s[20:23], s27 offen lds
    s_add_u32 s27, s27, 49152
    s_mov_b32 m0, s28
    s_add_u32 s29, s28, 40960
    buffer_load_dwordx4 v20, s[16:19], s27 offen lds
    s_mov_b32 m0, s29
    s_add_u32 s28, s28, 4096
    buffer_load_dwordx4 v20, s[20:23], s27 offen lds
    s_add_u32 s27, s27, 49152
    s_mov_b32 m0, s28
    s_add_u32 s29, s28, 40960
    buffer_load_dwordx4 v20, s[16:19], s27 offen lds
    s_mov_b32 m0, s29
    s_add_u32 s28, s28, 4096
    buffer_load_dwordx4 v20, s[20:23], s27 offen lds
    s_add_u32 s27, s27, 49152
    s_waitcnt vmcnt(0)
    s_barrier
    ds_read_b64_tr_b16 a[40:41], v22 offset:0
    ds_read_b64_tr_b16 a[42:43], v22 offset:1024
    ds_read_b64_tr_b16 a[200:201], v23 offset:0
    ds_read_b64_tr_b16 a[202:203], v23 offset:1024
    ds_read_b64_tr_b16 a[44:45], v22 offset:4096
    ds_read_b64_tr_b16 a[46:47], v22 offset:5120
    ds_read_b64_tr_b16 a[204:205], v23 offset:4096
    ds_read_b64_tr_b16 a[206:207], v23 offset:5120
    ds_read_b64_tr_b16 a[48:49], v22 offset:8192
    ds_read_b64_tr_b16 a[50:51], v22 offset:9216
    ds_read_b64_tr_b16 a[208:209], v23 offset:8192
    ds_read_b64_tr_b16 a[210:211], v23 offset:9216
    s_waitcnt lgkmcnt(0)
    ds_read_b64_tr_b16 a[52:53], v22 offset:12288
    ds_read_b64_tr_b16 a[54:55], v22 offset:13312
    ds_read_b64_tr_b16 a[212:213], v23 offset:12288
    ds_read_b64_tr_b16 a[214:215], v23 offset:13312
    ds_read_b64_tr_b16 a[56:57], v22 offset:16384
    ds_read_b64_tr_b16 a[58:59], v22 offset:17408
    ds_read_b64_tr_b16 a[216:217], v23 offset:16384
    ds_read_b64_tr_b16 a[218:219], v23 offset:17408
    ds_read_b64_tr_b16 a[60:61], v22 offset:20480
    ds_read_b64_tr_b16 a[62:63], v22 offset:21504
    ds_read_b64_tr_b16 a[220:221], v23 offset:20480
    ds_read_b64_tr_b16 a[222:223], v23 offset:21504
    s_waitcnt lgkmcnt(0)
    ds_read_b64_tr_b16 a[64:65], v22 offset:24576
    ds_read_b64_tr_b16 a[66:67], v22 offset:25600
    ds_read_b64_tr_b16 a[224:225], v23 offset:24576
    ds_read_b64_tr_b16 a[226:227], v23 offset:25600
    ds_read_b64_tr_b16 a[68:69], v22 offset:28672
    ds_read_b64_tr_b16 a[70:71], v22 offset:29696
    ds_read_b64_tr_b16 a[228:229], v23 offset:28672
    ds_read_b64_tr_b16 a[230:231], v23 offset:29696
    ds_read_b64_tr_b16 a[72:73], v22 offset:32768
    ds_read_b64_tr_b16 a[74:75], v22 offset:33792
    ds_read_b64_tr_b16 a[232:233], v23 offset:32768
    ds_read_b64_tr_b16 a[234:235], v23 offset:33792
    s_waitcnt lgkmcnt(0)
    ds_read_b64_tr_b16 a[76:77], v22 offset:36864
    ds_read_b64_tr_b16 a[78:79], v22 offset:37888
    ds_read_b64_tr_b16 a[236:237], v23 offset:36864
    ds_read_b64_tr_b16 a[238:239], v23 offset:37888
    s_waitcnt lgkmcnt(0)
    s_barrier
    s_lshl_b32 s28, s9, 10
    s_mov_b32 m0, s28
    s_add_u32 s29, s28, 40960
    buffer_load_dwordx4 v20, s[16:19], s27 offen lds
    s_mov_b32 m0, s29
    s_add_u32 s28, s28, 4096
    buffer_load_dwordx4 v20, s[20:23], s27 offen lds
    s_add_u32 s27, s27, 49152
    s_mov_b32 m0, s28
    s_add_u32 s29, s28, 40960
    buffer_load_dwordx4 v20, s[16:19], s27 offen lds
    s_mov_b32 m0, s29
    s_add_u32 s28, s28, 4096
    buffer_load_dwordx4 v20, s[20:23], s27 offen lds
    s_add_u32 s27, s27, 49152
    s_mov_b32 m0, s28
    s_add_u32 s29, s28, 40960
    buffer_load_dwordx4 v20, s[16:19], s27 offen lds
    s_mov_b32 m0, s29
    s_add_u32 s28, s28, 4096
    buffer_load_dwordx4 v20, s[20:23], s27 offen lds
    s_add_u32 s27, s27, 49152
    s_mov_b32 m0, s28
    s_add_u32 s29, s28, 40960
    buffer_load_dwordx4 v20, s[16:19], s27 offen lds
    s_mov_b32 m0, s29
    s_add_u32 s28, s28, 4096
    buffer_load_dwordx4 v20, s[20:23], s27 offen lds
    s_add_u32 s27, s27, 49152
    s_mov_b32 m0, s28
    s_add_u32 s29, s28, 40960
    buffer_load_dwordx4 v20, s[16:19], s27 offen lds
    s_mov_b32 m0, s29
    s_add_u32 s28, s28, 4096
    buffer_load_dwordx4 v20, s[20:23], s27 offen lds
    s_add_u32 s27, s27, 49152
    s_mov_b32 m0, s28
    s_add_u32 s29, s28, 40960
    buffer_load_dwordx4 v20, s[16:19], s27 offen lds
    s_mov_b32 m0, s29
    s_add_u32 s28, s28, 4096
    buffer_load_dwordx4 v20, s[20:23], s27 offen lds
    s_add_u32 s27, s27, 49152
    s_mov_b32 m0, s28
    s_add_u32 s29, s28, 40960
    buffer_load_dwordx4 v20, s[16:19], s27 offen lds
    s_mov_b32 m0, s29
    s_add_u32 s28, s28, 4096
    buffer_load_dwordx4 v20, s[20:23], s27 offen lds
    s_add_u32 s27, s27, 49152
    s_mov_b32 m0, s28
    s_add_u32 s29, s28, 40960
    buffer_load_dwordx4 v20, s[16:19], s27 offen lds
    s_mov_b32 m0, s29
    s_add_u32 s28, s28, 4096
    buffer_load_dwordx4 v20, s[20:23], s27 offen lds
    s_add_u32 s27, s27, 49152
    s_mov_b32 m0, s28
    s_add_u32 s29, s28, 40960
    buffer_load_dwordx4 v20, s[16:19], s27 offen lds
    s_mov_b32 m0, s29
    s_add_u32 s28, s28, 4096
    buffer_load_dwordx4 v20, s[20:23], s27 offen lds
    s_add_u32 s27, s27, 49152
    s_mov_b32 m0, s28
    s_add_u32 s29, s28, 40960
    buffer_load_dwordx4 v20, s[16:19], s27 offen lds
    s_mov_b32 m0, s29
    s_add_u32 s28, s28, 4096
    buffer_load_dwordx4 v20, s[20:23], s27 offen lds
    s_add_u32 s27, s27, 49152
    s_waitcnt vmcnt(0)
    s_barrier
    ds_read_b64_tr_b16 a[80:81], v22 offset:0
    ds_read_b64_tr_b16 a[82:83], v22 offset:1024
    ds_read_b64_tr_b16 a[240:241], v23 offset:0
    ds_read_b64_tr_b16 a[242:243], v23 offset:1024
    ds_read_b64_tr_b16 a[84:85], v22 offset:4096
    ds_read_b64_tr_b16 a[86:87], v22 offset:5120
    ds_read_b64_tr_b16 a[244:245], v23 offset:4096
    ds_read_b64_tr_b16 a[246:247], v23 offset:5120
    ds_read_b64_tr_b16 a[88:89], v22 offset:8192
    ds_read_b64_tr_b16 a[90:91], v22 offset:9216
    ds_read_b64_tr_b16 a[248:249], v23 offset:8192
    ds_read_b64_tr_b16 a[250:251], v23 offset:9216
    s_waitcnt lgkmcnt(0)
    ds_read_b64_tr_b16 a[92:93], v22 offset:12288
    ds_read_b64_tr_b16 a[94:95], v22 offset:13312
    ds_read_b64_tr_b16 a[252:253], v23 offset:12288
    ds_read_b64_tr_b16 a[254:255], v23 offset:13312
    ds_read_b64_tr_b16 a[96:97], v22 offset:16384
    ds_read_b64_tr_b16 a[98:99], v22 offset:17408
    ds_read_b64_tr_b16 v[192:193], v23 offset:16384
    ds_read_b64_tr_b16 v[194:195], v23 offset:17408
    ds_read_b64_tr_b16 a[100:101], v22 offset:20480
    ds_read_b64_tr_b16 a[102:103], v22 offset:21504
    ds_read_b64_tr_b16 v[196:197], v23 offset:20480
    ds_read_b64_tr_b16 v[198:199], v23 offset:21504
    s_waitcnt lgkmcnt(0)
    ds_read_b64_tr_b16 a[104:105], v22 offset:24576
    ds_read_b64_tr_b16 a[106:107], v22 offset:25600
    ds_read_b64_tr_b16 v[200:201], v23 offset:24576
    ds_read_b64_tr_b16 v[202:203], v23 offset:25600
    ds_read_b64_tr_b16 a[108:109], v22 offset:28672
    ds_read_b64_tr_b16 a[110:111], v22 offset:29696
    ds_read_b64_tr_b16 v[204:205], v23 offset:28672
    ds_read_b64_tr_b16 v[206:207], v23 offset:29696
    ds_read_b64_tr_b16 a[112:113], v22 offset:32768
    ds_read_b64_tr_b16 a[114:115], v22 offset:33792
    ds_read_b64_tr_b16 v[208:209], v23 offset:32768
    ds_read_b64_tr_b16 v[210:211], v23 offset:33792
    s_waitcnt lgkmcnt(0)
    ds_read_b64_tr_b16 a[116:117], v22 offset:36864
    ds_read_b64_tr_b16 a[118:119], v22 offset:37888
    ds_read_b64_tr_b16 v[212:213], v23 offset:36864
    ds_read_b64_tr_b16 v[214:215], v23 offset:37888
    s_waitcnt lgkmcnt(0)
    s_barrier
    s_lshl_b32 s28, s9, 10
    s_mov_b32 m0, s28
    s_add_u32 s29, s28, 40960
    buffer_load_dwordx4 v20, s[16:19], s27 offen lds
    s_mov_b32 m0, s29
    s_add_u32 s28, s28, 4096
    buffer_load_dwordx4 v20, s[20:23], s27 offen lds
    s_add_u32 s27, s27, 49152
    s_mov_b32 m0, s28
    s_add_u32 s29, s28, 40960
    buffer_load_dwordx4 v20, s[16:19], s27 offen lds
    s_mov_b32 m0, s29
    s_add_u32 s28, s28, 4096
    buffer_load_dwordx4 v20, s[20:23], s27 offen lds
    s_add_u32 s27, s27, 49152
    s_mov_b32 m0, s28
    s_add_u32 s29, s28, 40960
    buffer_load_dwordx4 v20, s[16:19], s27 offen lds
    s_mov_b32 m0, s29
    s_add_u32 s28, s28, 4096
    buffer_load_dwordx4 v20, s[20:23], s27 offen lds
    s_add_u32 s27, s27, 49152
    s_mov_b32 m0, s28
    s_add_u32 s29, s28, 40960
    buffer_load_dwordx4 v20, s[16:19], s27 offen lds
    s_mov_b32 m0, s29
    s_add_u32 s28, s28, 4096
    buffer_load_dwordx4 v20, s[20:23], s27 offen lds
    s_add_u32 s27, s27, 49152
    s_mov_b32 m0, s28
    s_add_u32 s29, s28, 40960
    buffer_load_dwordx4 v20, s[16:19], s27 offen lds
    s_mov_b32 m0, s29
    s_add_u32 s28, s28, 4096
    buffer_load_dwordx4 v20, s[20:23], s27 offen lds
    s_add_u32 s27, s27, 49152
    s_mov_b32 m0, s28
    s_add_u32 s29, s28, 40960
    buffer_load_dwordx4 v20, s[16:19], s27 offen lds
    s_mov_b32 m0, s29
    s_add_u32 s28, s28, 4096
    buffer_load_dwordx4 v20, s[20:23], s27 offen lds
    s_add_u32 s27, s27, 49152
    s_mov_b32 m0, s28
    s_add_u32 s29, s28, 40960
    buffer_load_dwordx4 v20, s[16:19], s27 offen lds
    s_mov_b32 m0, s29
    s_add_u32 s28, s28, 4096
    buffer_load_dwordx4 v20, s[20:23], s27 offen lds
    s_add_u32 s27, s27, 49152
    s_mov_b32 m0, s28
    s_add_u32 s29, s28, 40960
    buffer_load_dwordx4 v20, s[16:19], s27 offen lds
    s_mov_b32 m0, s29
    s_add_u32 s28, s28, 4096
    buffer_load_dwordx4 v20, s[20:23], s27 offen lds
    s_add_u32 s27, s27, 49152
    s_mov_b32 m0, s28
    s_add_u32 s29, s28, 40960
    buffer_load_dwordx4 v20, s[16:19], s27 offen lds
    s_mov_b32 m0, s29
    s_add_u32 s28, s28, 4096
    buffer_load_dwordx4 v20, s[20:23], s27 offen lds
    s_add_u32 s27, s27, 49152
    s_mov_b32 m0, s28
    s_add_u32 s29, s28, 40960
    buffer_load_dwordx4 v20, s[16:19], s27 offen lds
    s_mov_b32 m0, s29
    s_add_u32 s28, s28, 4096
    buffer_load_dwordx4 v20, s[20:23], s27 offen lds
    s_add_u32 s27, s27, 49152
    s_waitcnt vmcnt(0)
    s_barrier
    ds_read_b64_tr_b16 a[120:121], v22 offset:0
    ds_read_b64_tr_b16 a[122:123], v22 offset:1024
    ds_read_b64_tr_b16 v[216:217], v23 offset:0
    ds_read_b64_tr_b16 v[218:219], v23 offset:1024
    ds_read_b64_tr_b16 a[124:125], v22 offset:4096
    ds_read_b64_tr_b16 a[126:127], v22 offset:5120
    ds_read_b64_tr_b16 v[220:221], v23 offset:4096
    ds_read_b64_tr_b16 v[222:223], v23 offset:5120
    ds_read_b64_tr_b16 a[128:129], v22 offset:8192
    ds_read_b64_tr_b16 a[130:131], v22 offset:9216
    ds_read_b64_tr_b16 v[224:225], v23 offset:8192
    ds_read_b64_tr_b16 v[226:227], v23 offset:9216
    s_waitcnt lgkmcnt(0)
    ds_read_b64_tr_b16 a[132:133], v22 offset:12288
    ds_read_b64_tr_b16 a[134:135], v22 offset:13312
    ds_read_b64_tr_b16 v[228:229], v23 offset:12288
    ds_read_b64_tr_b16 v[230:231], v23 offset:13312
    ds_read_b64_tr_b16 a[136:137], v22 offset:16384
    ds_read_b64_tr_b16 a[138:139], v22 offset:17408
    ds_read_b64_tr_b16 v[232:233], v23 offset:16384
    ds_read_b64_tr_b16 v[234:235], v23 offset:17408
    ds_read_b64_tr_b16 a[140:141], v22 offset:20480
    ds_read_b64_tr_b16 a[142:143], v22 offset:21504
    ds_read_b64_tr_b16 v[236:237], v23 offset:20480
    ds_read_b64_tr_b16 v[238:239], v23 offset:21504
    s_waitcnt lgkmcnt(0)
    ds_read_b64_tr_b16 a[144:145], v22 offset:24576
    ds_read_b64_tr_b16 a[146:147], v22 offset:25600
    ds_read_b64_tr_b16 v[240:241], v23 offset:24576
    ds_read_b64_tr_b16 v[242:243], v23 offset:25600
    ds_read_b64_tr_b16 a[148:149], v22 offset:28672
    ds_read_b64_tr_b16 a[150:151], v22 offset:29696
    ds_read_b64_tr_b16 v[244:245], v23 offset:28672
    ds_read_b64_tr_b16 v[246:247], v23 offset:29696
    ds_read_b64_tr_b16 a[152:153], v22 offset:32768
    ds_read_b64_tr_b16 a[154:155], v22 offset:33792
    ds_read_b64_tr_b16 v[248:249], v23 offset:32768
    ds_read_b64_tr_b16 v[250:251], v23 offset:33792
    s_waitcnt lgkmcnt(0)
    ds_read_b64_tr_b16 a[156:157], v22 offset:36864
    ds_read_b64_tr_b16 a[158:159], v22 offset:37888
    ds_read_b64_tr_b16 v[252:253], v23 offset:36864
    ds_read_b64_tr_b16 v[254:255], v23 offset:37888
    s_waitcnt lgkmcnt(0)
    s_barrier
G1_wdone:
    v_lshlrev_b32 v3, 4, v1
    s_mul_i32 s26, s9, 10240
    v_add_u32 v2, s26, v3
    v_and_b32 v20, 31, v1
    v_lshrrev_b32 v21, 5, v1
    v_lshlrev_b32 v4, 5, v20
    v_lshl_add_u32 v4, v21, 4, v4
    v_bfe_u32 v22, v1, 4, 1
    v_lshlrev_b32 v5, 10, v22
    v_lshl_add_u32 v5, v21, 8, v5
    v_and_b32 v22, 15, v1
    v_lshl_add_u32 v5, v22, 4, v5
    s_lshl_b32 s26, s25, 2
    s_add_u32 s26, s26, s9
    s_lshl_b32 s36, s26, 12
    s_mov_b32 s27, 54525952
    s_cmp_eq_u32 s24, 1
    s_cselect_b32 s27, 4194304, s27
    s_cmp_eq_u32 s24, 2
    s_cselect_b32 s27, 29360128, s27
    s_add_u32 s36, s36, s27
    s_mov_b32 s37, 393216
    s_cmp_lg_u32 s24, 3
    s_cbranch_scc1 G1_ob
    s_lshl_b32 s36, s25, 13
    s_lshl_b32 s27, s9, 11
    s_add_u32 s36, s36, s27
    s_add_u32 s36, s36, 79691776
    s_mov_b32 s37, 98304
G1_ob:
    s_mul_i32 s26, s30, s37
    s_add_u32 s36, s36, s26
    s_mov_b32 s38, 262144000
    s_mul_i32 s39, s30, 40960
    s_add_u32 s39, s39, 85983232
    s_mul_i32 s40, s9, 10240
    s_mov_b32 s44, 0xc0135761
    s_mov_b32 s45, 0xbdd2d3e8
    s_mov_b32 s49, s30
    s_load_dwordx2 s[4:5], s[0:1], 96
    s_waitcnt lgkmcnt(0)
    s_mov_b32 s20, s4
    s_and_b32 s21, s5, 0xffff
    s_mov_b32 s22, 0x100
    s_mov_b32 s23, 0x00020000
    s_cmp_lg_u32 s9, 0
    s_cbranch_scc1 dw_5b
    v_mov_b32 v20, 224
    s_mov_b32 s58, 0
dw_5:
    buffer_load_dword v21, v20, s[20:23], 0 offen sc1
    s_waitcnt vmcnt(0)
    v_readfirstlane_b32 s59, v21
    s_nop 3
    s_cmp_ge_u32 s59, 1
    s_cbranch_scc1 dw_5b
    s_sleep 16
    s_add_u32 s58, s58, 1
    s_cmp_lt_u32 s58, 0x80000
    s_cbranch_scc1 dw_5
dw_5b:
    s_barrier
    s_cmp_lg_u32 s9, 0
    s_cbranch_scc1 fw_6b
    v_add_u32 v20, 0, v1
    v_min_u32 v20, 7, v20
    v_lshlrev_b32 v20, 7, v20
    s_add_u32 s59, s62, 2080768
    v_add_u32 v20, s59, v20
    s_mov_b32 s58, 0
fw_6:
    buffer_load_dword v22, v20, s[12:15], 0 offen sc1
    s_waitcnt vmcnt(0)
    v_cmp_eq_u32 vcc, 0, v22
    s_cbranch_vccz fw_6b
    s_sleep 8
    s_add_u32 s58, s58, 1
    s_cmp_lt_u32 s58, 0x100000
    s_cbranch_scc1 fw_6
fw_6b:
    s_barrier
    s_mov_b32 s48, 0
    s_add_u32 s41, s48, s40
    s_add_u32 s41, s41, 0
    s_add_u32 s42, s39, 0
    s_mov_b32 m0, s41
    s_nop 0
    buffer_load_dwordx4 v2, s[12:15], s42 offen offset:0 lds
    buffer_load_dwordx4 v2, s[12:15], s42 offen offset:1024 lds
    buffer_load_dwordx4 v2, s[12:15], s42 offen offset:2048 lds
    buffer_load_dwordx4 v2, s[12:15], s42 offen offset:3072 lds
    s_add_u32 s41, s48, s40
    s_add_u32 s41, s41, 4096
    s_add_u32 s42, s39, 4096
    s_mov_b32 m0, s41
    s_nop 0
    buffer_load_dwordx4 v2, s[12:15], s42 offen offset:0 lds
    buffer_load_dwordx4 v2, s[12:15], s42 offen offset:1024 lds
    buffer_load_dwordx4 v2, s[12:15], s42 offen offset:2048 lds
    buffer_load_dwordx4 v2, s[12:15], s42 offen offset:3072 lds
    s_add_u32 s41, s48, s40
    s_add_u32 s41, s41, 8192
    s_add_u32 s42, s39, 8192
    s_mov_b32 m0, s41
    s_nop 0
    buffer_load_dwordx4 v2, s[12:15], s42 offen offset:0 lds
    buffer_load_dwordx4 v2, s[12:15], s42 offen offset:1024 lds
    s_add_u32 s49, s49, 1
    s_cmp_lt_u32 s49, s31
    s_cselect_b32 s27, 40960, 0
    s_add_u32 s39, s39, s27
    s_mov_b32 s48, 40960
    s_add_u32 s41, s48, s40
    s_add_u32 s41, s41, 0
    s_add_u32 s42, s39, 0
    s_mov_b32 m0, s41
    s_nop 0
    buffer_load_dwordx4 v2, s[12:15], s42 offen offset:0 lds
    buffer_load_dwordx4 v2, s[12:15], s42 offen offset:1024 lds
    buffer_load_dwordx4 v2, s[12:15], s42 offen offset:2048 lds
    buffer_load_dwordx4 v2, s[12:15], s42 offen offset:3072 lds
    s_add_u32 s41, s48, s40
    s_add_u32 s41, s41, 4096
    s_add_u32 s42, s39, 4096
    s_mov_b32 m0, s41
    s_nop 0
    buffer_load_dwordx4 v2, s[12:15], s42 offen offset:0 lds
    buffer_load_dwordx4 v2, s[12:15], s42 offen offset:1024 lds
    buffer_load_dwordx4 v2, s[12:15], s42 offen offset:2048 lds
    buffer_load_dwordx4 v2, s[12:15], s42 offen offset:3072 lds
    s_add_u32 s41, s48, s40
    s_add_u32 s41, s41, 8192
    s_add_u32 s42, s39, 8192
    s_mov_b32 m0, s41
    s_nop 0
    buffer_load_dwordx4 v2, s[12:15], s42 offen offset:0 lds
    buffer_load_dwordx4 v2, s[12:15], s42 offen offset:1024 lds
    s_mov_b32 s46, 0
    s_mov_b32 s47, 40960
    s_mov_b32 s48, 81920
    s_waitcnt vmcnt(10)
    s_barrier
    v_mov_b32 v6, v3
    v_add_u32 v7, s47, v3
    ds_read_b128 v[128:131], v6 offset:0
    ds_read_b128 v[132:135], v6 offset:1024
    ds_read_b128 v[136:139], v6 offset:2048
    s_cmp_eq_u32 s24, 3
    s_cbranch_scc1 G1_gu
G1_qk:
    s_waitcnt lgkmcnt(2)
    v_mfma_f32_32x32x16_bf16 v[64:79], a[0:3], v[128:131], 0
    ds_read_b128 v[140:143], v6 offset:3072
    v_mfma_f32_32x32x16_bf16 v[80:95], a[160:163], v[128:131], 0
    s_waitcnt lgkmcnt(2)
    v_mfma_f32_32x32x16_bf16 v[64:79], a[4:7], v[132:135], v[64:79]
    ds_read_b128 v[144:147], v6 offset:4096
    v_mfma_f32_32x32x16_bf16 v[80:95], a[164:167], v[132:135], v[80:95]
    s_waitcnt lgkmcnt(2)
    v_mfma_f32_32x32x16_bf16 v[64:79], a[8:11], v[136:139], v[64:79]
    ds_read_b128 v[148:151], v6 offset:5120
    v_mfma_f32_32x32x16_bf16 v[80:95], a[168:171], v[136:139], v[80:95]
    s_waitcnt lgkmcnt(2)
    v_mfma_f32_32x32x16_bf16 v[64:79], a[12:15], v[140:143], v[64:79]
    ds_read_b128 v[152:155], v6 offset:6144
    v_cvt_pk_bf16_f32 v160, v96, v97
    v_mfma_f32_32x32x16_bf16 v[80:95], a[172:175], v[140:143], v[80:95]
    s_waitcnt lgkmcnt(2)
    v_mfma_f32_32x32x16_bf16 v[64:79], a[16:19], v[144:147], v[64:79]
    ds_read_b128 v[156:159], v6 offset:7168
    v_cvt_pk_bf16_f32 v161, v98, v99
    v_mfma_f32_32x32x16_bf16 v[80:95], a[176:179], v[144:147], v[80:95]
    s_waitcnt lgkmcnt(2)
    v_mfma_f32_32x32x16_bf16 v[64:79], a[20:23], v[148:151], v[64:79]
    ds_read_b128 v[128:131], v6 offset:8192
    v_cvt_pk_bf16_f32 v162, v100, v101
    v_mfma_f32_32x32x16_bf16 v[80:95], a[180:183], v[148:151], v[80:95]
    s_waitcnt lgkmcnt(2)
    v_mfma_f32_32x32x16_bf16 v[64:79], a[24:27], v[152:155], v[64:79]
    ds_read_b128 v[132:135], v6 offset:9216
    v_cvt_pk_bf16_f32 v163, v102, v103
    v_mfma_f32_32x32x16_bf16 v[80:95], a[184:187], v[152:155], v[80:95]
    s_waitcnt lgkmcnt(2)
    v_mfma_f32_32x32x16_bf16 v[64:79], a[28:31], v[156:159], v[64:79]
    ds_read_b128 v[136:139], v6 offset:10240
    buffer_store_dwordx4 v[160:163], v4, s[12:15], s38 offen offset:0 sc1
    v_mfma_f32_32x32x16_bf16 v[80:95], a[188:191], v[156:159], v[80:95]
    s_waitcnt lgkmcnt(2)
    v_mfma_f32_32x32x16_bf16 v[64:79], a[32:35], v[128:131], v[64:79]
    ds_read_b128 v[140:143], v6 offset:11264
    v_cvt_pk_bf16_f32 v164, v104, v105
    v_mfma_f32_32x32x16_bf16 v[80:95], a[192:195], v[128:131], v[80:95]
    s_waitcnt lgkmcnt(2)
    v_mfma_f32_32x32x16_bf16 v[64:79], a[36:39], v[132:135], v[64:79]
    ds_read_b128 v[144:147], v6 offset:12288
    v_cvt_pk_bf16_f32 v165, v106, v107
    v_mfma_f32_32x32x16_bf16 v[80:95], a[196:199], v[132:135], v[80:95]
    s_waitcnt lgkmcnt(2)
    v_mfma_f32_32x32x16_bf16 v[64:79], a[40:43], v[136:139], v[64:79]
    ds_read_b128 v[148:151], v6 offset:13312
    v_cvt_pk_bf16_f32 v166, v108, v109
    v_mfma_f32_32x32x16_bf16 v[80:95], a[200:203], v[136:139], v[80:95]
    s_waitcnt lgkmcnt(2)
    v_mfma_f32_32x32x16_bf16 v[64:79], a[44:47], v[140:143], v[64:79]
    ds_read_b128 v[152:155], v6 offset:14336
    v_cvt_pk_bf16_f32 v167, v110, v111
    v_mfma_f32_32x32x16_bf16 v[80:95], a[204:207], v[140:143], v[80:95]
    s_waitcnt lgkmcnt(2)
    v_mfma_f32_32x32x16_bf16 v[64:79], a[48:51], v[144:147], v[64:79]
    ds_read_b128 v[156:159], v6 offset:15360
    buffer_store_dwordx4 v[164:167], v4, s[12:15], s38 offen offset:1024 sc1
    v_mfma_f32_32x32x16_bf16 v[80:95], a[208:211], v[144:147], v[80:95]
    s_waitcnt lgkmcnt(2)
    v_mfma_f32_32x32x16_bf16 v[64:79], a[52:55], v[148:151], v[64:79]
    ds_read_b128 v[128:131], v6 offset:16384
    v_cvt_pk_bf16_f32 v168, v112, v113
    v_mfma_f32_32x32x16_bf16 v[80:95], a[212:215], v[148:151], v[80:95]
    s_waitcnt lgkmcnt(2)
    v_mfma_f32_32x32x16_bf16 v[64:79], a[56:59], v[152:155], v[64:79]
    ds_read_b128 v[132:135], v6 offset:17408
    v_cvt_pk_bf16_f32 v169, v114, v115
    v_mfma_f32_32x32x16_bf16 v[80:95], a[216:219], v[152:155], v[80:95]
    s_waitcnt lgkmcnt(2)
    v_mfma_f32_32x32x16_bf16 v[64:79], a[60:63], v[156:159], v[64:79]
    ds_read_b128 v[136:139], v6 offset:18432
    v_cvt_pk_bf16_f32 v170, v116, v117
    v_mfma_f32_32x32x16_bf16 v[80:95], a[220:223], v[156:159], v[80:95]
    s_waitcnt lgkmcnt(2)
    v_mfma_f32_32x32x16_bf16 v[64:79], a[64:67], v[128:131], v[64:79]
    ds_read_b128 v[140:143], v6 offset:19456
    v_cvt_pk_bf16_f32 v171, v118, v119
    v_mfma_f32_32x32x16_bf16 v[80:95], a[224:227], v[128:131], v[80:95]
    s_waitcnt lgkmcnt(2)
    v_mfma_f32_32x32x16_bf16 v[64:79], a[68:71], v[132:135], v[64:79]
    ds_read_b128 v[144:147], v6 offset:20480
    buffer_store_dwordx4 v[168:171], v4, s[12:15], s38 offen offset:2048 sc1
    v_mfma_f32_32x32x16_bf16 v[80:95], a[228:231], v[132:135], v[80:95]
    s_waitcnt lgkmcnt(2)
    v_mfma_f32_32x32x16_bf16 v[64:79], a[72:75], v[136:139], v[64:79]
    ds_read_b128 v[148:151], v6 offset:21504
    v_cvt_pk_bf16_f32 v172, v120, v121
    v_mfma_f32_32x32x16_bf16 v[80:95], a[232:235], v[136:139], v[80:95]
    s_waitcnt lgkmcnt(2)
    v_mfma_f32_32x32x16_bf16 v[64:79], a[76:79], v[140:143], v[64:79]
    ds_read_b128 v[152:155], v6 offset:22528
    v_cvt_pk_bf16_f32 v173, v122, v123
    v_mfma_f32_32x32x16_bf16 v[80:95], a[236:239], v[140:143], v[80:95]
    s_waitcnt lgkmcnt(2)
    v_mfma_f32_32x32x16_bf16 v[64:79], a[80:83], v[144:147], v[64:79]
    ds_read_b128 v[156:159], v6 offset:23552
    v_cvt_pk_bf16_f32 v174, v124, v125
    v_mfma_f32_32x32x16_bf16 v[80:95], a[240:243], v[144:147], v[80:95]
    s_waitcnt lgkmcnt(2)
    v_mfma_f32_32x32x16_bf16 v[64:79], a[84:87], v[148:151], v[64:79]
    ds_read_b128 v[128:131], v6 offset:24576
    v_cvt_pk_bf16_f32 v175, v126, v127
    v_mfma_f32_32x32x16_bf16 v[80:95], a[244:247], v[148:151], v[80:95]
    s_waitcnt lgkmcnt(2)
    v_mfma_f32_32x32x16_bf16 v[64:79], a[88:91], v[152:155], v[64:79]
    ds_read_b128 v[132:135], v6 offset:25600
    buffer_store_dwordx4 v[172:175], v4, s[12:15], s38 offen offset:3072 sc1
    v_mfma_f32_32x32x16_bf16 v[80:95], a[248:251], v[152:155], v[80:95]
    s_waitcnt vmcnt(4)
    s_barrier
    s_add_u32 s49, s49, 1
    s_cmp_lt_u32 s49, s31
    s_cselect_b32 s27, 40960, 0
    s_add_u32 s39, s39, s27
    s_max_u32 s61, s30, 1
    s_sub_u32 s61, s61, 1
    v_mov_b32 v9, s61
    s_mov_b64 exec, 1
    buffer_store_dword v9, v8, s[12:15], 0 offen sc1
    s_mov_b64 exec, -1
    s_cmp_lg_u32 s49, 8
    s_cbranch_scc1 G1_mw1d
    v_min_u32 v10, 35, v1
    v_lshlrev_b32 v10, 7, v10
    s_add_u32 s59, s62, 2080768
    v_add_u32 v10, s59, v10
    s_mov_b32 s58, 0
G1_mw1:
    buffer_load_dword v11, v10, s[12:15], 0 offen sc1
    s_waitcnt vmcnt(0)
    v_cmp_eq_u32 vcc, 0, v11
    s_cbranch_vccz G1_mw1d
    s_sleep 4
    s_add_u32 s58, s58, 1
    s_cmp_lt_u32 s58, 0x200000
    s_cbranch_scc1 G1_mw1
G1_mw1d:
    s_cmp_lg_u32 s49, 36
    s_cbranch_scc1 G1_mw2d
    v_min_u32 v10, 63, v1
    v_lshlrev_b32 v10, 7, v10
    s_add_u32 s59, s62, 2080768
    v_add_u32 v10, s59, v10
    s_mov_b32 s58, 0
G1_mw2:
    buffer_load_dword v11, v10, s[12:15], 0 offen sc1
    s_waitcnt vmcnt(0)
    v_cmp_eq_u32 vcc, 0, v11
    s_cbranch_vccz G1_mw2d
    s_sleep 4
    s_add_u32 s58, s58, 1
    s_cmp_lt_u32 s58, 0x200000
    s_cbranch_scc1 G1_mw2
G1_mw2d:
    s_waitcnt lgkmcnt(2)
    v_mfma_f32_32x32x16_bf16 v[64:79], a[92:95], v[156:159], v[64:79]
    ds_read_b128 v[136:139], v6 offset:26624
    v_mfma_f32_32x32x16_bf16 v[80:95], a[252:255], v[156:159], v[80:95]
    s_add_u32 s41, s48, s40
    s_add_u32 s41, s41, 0
    s_add_u32 s42, s39, 0
    s_mov_b32 m0, s41
    s_nop 0
    buffer_load_dwordx4 v2, s[12:15], s42 offen offset:0 lds
    s_waitcnt lgkmcnt(2)
    v_mfma_f32_32x32x16_bf16 v[64:79], a[96:99], v[128:131], v[64:79]
    ds_read_b128 v[140:143], v6 offset:27648
    v_mfma_f32_32x32x16_bf16 v[80:95], v[192:195], v[128:131], v[80:95]
    buffer_load_dwordx4 v2, s[12:15], s42 offen offset:1024 lds
    s_waitcnt lgkmcnt(2)
    v_mfma_f32_32x32x16_bf16 v[64:79], a[100:103], v[132:135], v[64:79]
    ds_read_b128 v[144:147], v6 offset:28672
    v_mfma_f32_32x32x16_bf16 v[80:95], v[196:199], v[132:135], v[80:95]
    buffer_load_dwordx4 v2, s[12:15], s42 offen offset:2048 lds
    s_waitcnt lgkmcnt(2)
    v_mfma_f32_32x32x16_bf16 v[64:79], a[104:107], v[136:139], v[64:79]
    ds_read_b128 v[148:151], v6 offset:29696
    v_mfma_f32_32x32x16_bf16 v[80:95], v[200:203], v[136:139], v[80:95]
    buffer_load_dwordx4 v2, s[12:15], s42 offen offset:3072 lds
    s_waitcnt lgkmcnt(2)
    v_mfma_f32_32x32x16_bf16 v[64:79], a[108:111], v[140:143], v[64:79]
    ds_read_b128 v[152:155], v6 offset:30720
    v_mfma_f32_32x32x16_bf16 v[80:95], v[204:207], v[140:143], v[80:95]
    s_add_u32 s41, s48, s40
    s_add_u32 s41, s41, 4096
    s_add_u32 s42, s39, 4096
    s_mov_b32 m0, s41
    s_nop 0
    buffer_load_dwordx4 v2, s[12:15], s42 offen offset:0 lds
    s_waitcnt lgkmcnt(2)
    v_mfma_f32_32x32x16_bf16 v[64:79], a[112:115], v[144:147], v[64:79]
    ds_read_b128 v[156:159], v6 offset:31744
    v_mfma_f32_32x32x16_bf16 v[80:95], v[208:211], v[144:147], v[80:95]
    buffer_load_dwordx4 v2, s[12:15], s42 offen offset:1024 lds
    s_waitcnt lgkmcnt(2)
    v_mfma_f32_32x32x16_bf16 v[64:79], a[116:119], v[148:151], v[64:79]
    ds_read_b128 v[128:131], v6 offset:32768
    v_mfma_f32_32x32x16_bf16 v[80:95], v[212:215], v[148:151], v[80:95]
    buffer_load_dwordx4 v2, s[12:15], s42 offen offset:2048 lds
    s_waitcnt lgkmcnt(2)
    v_mfma_f32_32x32x16_bf16 v[64:79], a[120:123], v[152:155], v[64:79]
    ds_read_b128 v[132:135], v6 offset:33792
    v_mfma_f32_32x32x16_bf16 v[80:95], v[216:219], v[152:155], v[80:95]
    buffer_load_dwordx4 v2, s[12:15], s42 offen offset:3072 lds
    s_waitcnt lgkmcnt(2)
    v_mfma_f32_32x32x16_bf16 v[64:79], a[124:127], v[156:159], v[64:79]
    ds_read_b128 v[136:139], v6 offset:34816
    v_mfma_f32_32x32x16_bf16 v[80:95], v[220:223], v[156:159], v[80:95]
    s_add_u32 s41, s48, s40
    s_add_u32 s41, s41, 8192
    s_add_u32 s42, s39, 8192
    s_mov_b32 m0, s41
    s_nop 0
    buffer_load_dwordx4 v2, s[12:15], s42 offen offset:0 lds
    s_waitcnt lgkmcnt(2)
    v_mfma_f32_32x32x16_bf16 v[64:79], a[128:131], v[128:131], v[64:79]
    ds_read_b128 v[140:143], v6 offset:35840
    v_mfma_f32_32x32x16_bf16 v[80:95], v[224:227], v[128:131], v[80:95]
    buffer_load_dwordx4 v2, s[12:15], s42 offen offset:1024 lds
    s_waitcnt lgkmcnt(2)
    v_mfma_f32_32x32x16_bf16 v[64:79], a[132:135], v[132:135], v[64:79]
    ds_read_b128 v[144:147], v6 offset:36864
    v_mfma_f32_32x32x16_bf16 v[80:95], v[228:231], v[132:135], v[80:95]
    s_waitcnt lgkmcnt(2)
    v_mfma_f32_32x32x16_bf16 v[64:79], a[136:139], v[136:139], v[64:79]
    ds_read_b128 v[148:151], v6 offset:37888
    v_mfma_f32_32x32x16_bf16 v[80:95], v[232:235], v[136:139], v[80:95]
    s_waitcnt lgkmcnt(2)
    v_mfma_f32_32x32x16_bf16 v[64:79], a[140:143], v[140:143], v[64:79]
    ds_read_b128 v[152:155], v6 offset:38912
    v_mfma_f32_32x32x16_bf16 v[80:95], v[236:239], v[140:143], v[80:95]
    s_waitcnt lgkmcnt(2)
    v_mfma_f32_32x32x16_bf16 v[64:79], a[144:147], v[144:147], v[64:79]
    ds_read_b128 v[156:159], v6 offset:39936
    v_mfma_f32_32x32x16_bf16 v[80:95], v[240:243], v[144:147], v[80:95]
    s_waitcnt lgkmcnt(2)
    v_mfma_f32_32x32x16_bf16 v[64:79], a[148:151], v[148:151], v[64:79]
    ds_read_b128 v[128:131], v7 offset:0
    v_mfma_f32_32x32x16_bf16 v[80:95], v[244:247], v[148:151], v[80:95]
    s_waitcnt lgkmcnt(2)
    v_mfma_f32_32x32x16_bf16 v[64:79], a[152:155], v[152:155], v[64:79]
    ds_read_b128 v[132:135], v7 offset:1024
    v_mfma_f32_32x32x16_bf16 v[80:95], v[248:251], v[152:155], v[80:95]
    s_waitcnt lgkmcnt(2)
    v_mfma_f32_32x32x16_bf16 v[64:79], a[156:159], v[156:159], v[64:79]
    ds_read_b128 v[136:139], v7 offset:2048
    v_mfma_f32_32x32x16_bf16 v[80:95], v[252:255], v[156:159], v[80:95]
    s_mov_b32 s38, s36
    s_add_u32 s36, s36, s37
    s_mov_b32 s27, s46
    s_mov_b32 s46, s47
    s_mov_b32 s47, s48
    s_mov_b32 s48, s27
    v_mov_b32 v6, v7
    v_add_u32 v7, s47, v3
    s_add_u32 s30, s30, 1
    s_cmp_ge_u32 s30, s31
    s_cbranch_scc1 G1_qk_f0
    s_waitcnt lgkmcnt(2)
    v_mfma_f32_32x32x16_bf16 v[96:111], a[0:3], v[128:131], 0
    ds_read_b128 v[140:143], v6 offset:3072
    v_mfma_f32_32x32x16_bf16 v[112:127], a[160:163], v[128:131], 0
    s_waitcnt lgkmcnt(2)
    v_mfma_f32_32x32x16_bf16 v[96:111], a[4:7], v[132:135], v[96:111]
    ds_read_b128 v[144:147], v6 offset:4096
    v_mfma_f32_32x32x16_bf16 v[112:127], a[164:167], v[132:135], v[112:127]
    s_waitcnt lgkmcnt(2)
    v_mfma_f32_32x32x16_bf16 v[96:111], a[8:11], v[136:139], v[96:111]
    ds_read_b128 v[148:151], v6 offset:5120
    v_mfma_f32_32x32x16_bf16 v[112:127], a[168:171], v[136:139], v[112:127]
    s_waitcnt lgkmcnt(2)
    v_mfma_f32_32x32x16_bf16 v[96:111], a[12:15], v[140:143], v[96:111]
    ds_read_b128 v[152:155], v6 offset:6144
    v_cvt_pk_bf16_f32 v160, v64, v65
    v_mfma_f32_32x32x16_bf16 v[112:127], a[172:175], v[140:143], v[112:127]
    s_waitcnt lgkmcnt(2)
    v_mfma_f32_32x32x16_bf16 v[96:111], a[16:19], v[144:147], v[96:111]
    ds_read_b128 v[156:159], v6 offset:7168
    v_cvt_pk_bf16_f32 v161, v66, v67
    v_mfma_f32_32x32x16_bf16 v[112:127], a[176:179], v[144:147], v[112:127]
    s_waitcnt lgkmcnt(2)
    v_mfma_f32_32x32x16_bf16 v[96:111], a[20:23], v[148:151], v[96:111]
    ds_read_b128 v[128:131], v6 offset:8192
    v_cvt_pk_bf16_f32 v162, v68, v69
    v_mfma_f32_32x32x16_bf16 v[112:127], a[180:183], v[148:151], v[112:127]
    s_waitcnt lgkmcnt(2)
    v_mfma_f32_32x32x16_bf16 v[96:111], a[24:27], v[152:155], v[96:111]
    ds_read_b128 v[132:135], v6 offset:9216
    v_cvt_pk_bf16_f32 v163, v70, v71
    v_mfma_f32_32x32x16_bf16 v[112:127], a[184:187], v[152:155], v[112:127]
    s_waitcnt lgkmcnt(2)
    v_mfma_f32_32x32x16_bf16 v[96:111], a[28:31], v[156:159], v[96:111]
    ds_read_b128 v[136:139], v6 offset:10240
    buffer_store_dwordx4 v[160:163], v4, s[12:15], s38 offen offset:0 sc1
    v_mfma_f32_32x32x16_bf16 v[112:127], a[188:191], v[156:159], v[112:127]
    s_waitcnt lgkmcnt(2)
    v_mfma_f32_32x32x16_bf16 v[96:111], a[32:35], v[128:131], v[96:111]
    ds_read_b128 v[140:143], v6 offset:11264
    v_cvt_pk_bf16_f32 v164, v72, v73
    v_mfma_f32_32x32x16_bf16 v[112:127], a[192:195], v[128:131], v[112:127]
    s_waitcnt lgkmcnt(2)
    v_mfma_f32_32x32x16_bf16 v[96:111], a[36:39], v[132:135], v[96:111]
    ds_read_b128 v[144:147], v6 offset:12288
    v_cvt_pk_bf16_f32 v165, v74, v75
    v_mfma_f32_32x32x16_bf16 v[112:127], a[196:199], v[132:135], v[112:127]
    s_waitcnt lgkmcnt(2)
    v_mfma_f32_32x32x16_bf16 v[96:111], a[40:43], v[136:139], v[96:111]
    ds_read_b128 v[148:151], v6 offset:13312
    v_cvt_pk_bf16_f32 v166, v76, v77
    v_mfma_f32_32x32x16_bf16 v[112:127], a[200:203], v[136:139], v[112:127]
    s_waitcnt lgkmcnt(2)
    v_mfma_f32_32x32x16_bf16 v[96:111], a[44:47], v[140:143], v[96:111]
    ds_read_b128 v[152:155], v6 offset:14336
    v_cvt_pk_bf16_f32 v167, v78, v79
    v_mfma_f32_32x32x16_bf16 v[112:127], a[204:207], v[140:143], v[112:127]
    s_waitcnt lgkmcnt(2)
    v_mfma_f32_32x32x16_bf16 v[96:111], a[48:51], v[144:147], v[96:111]
    ds_read_b128 v[156:159], v6 offset:15360
    buffer_store_dwordx4 v[164:167], v4, s[12:15], s38 offen offset:1024 sc1
    v_mfma_f32_32x32x16_bf16 v[112:127], a[208:211], v[144:147], v[112:127]
    s_waitcnt lgkmcnt(2)
    v_mfma_f32_32x32x16_bf16 v[96:111], a[52:55], v[148:151], v[96:111]
    ds_read_b128 v[128:131], v6 offset:16384
    v_cvt_pk_bf16_f32 v168, v80, v81
    v_mfma_f32_32x32x16_bf16 v[112:127], a[212:215], v[148:151], v[112:127]
    s_waitcnt lgkmcnt(2)
    v_mfma_f32_32x32x16_bf16 v[96:111], a[56:59], v[152:155], v[96:111]
    ds_read_b128 v[132:135], v6 offset:17408
    v_cvt_pk_bf16_f32 v169, v82, v83
    v_mfma_f32_32x32x16_bf16 v[112:127], a[216:219], v[152:155], v[112:127]
    s_waitcnt lgkmcnt(2)
    v_mfma_f32_32x32x16_bf16 v[96:111], a[60:63], v[156:159], v[96:111]
    ds_read_b128 v[136:139], v6 offset:18432
    v_cvt_pk_bf16_f32 v170, v84, v85
    v_mfma_f32_32x32x16_bf16 v[112:127], a[220:223], v[156:159], v[112:127]
    s_waitcnt lgkmcnt(2)
    v_mfma_f32_32x32x16_bf16 v[96:111], a[64:67], v[128:131], v[96:111]
    ds_read_b128 v[140:143], v6 offset:19456
    v_cvt_pk_bf16_f32 v171, v86, v87
    v_mfma_f32_32x32x16_bf16 v[112:127], a[224:227], v[128:131], v[112:127]
    s_waitcnt lgkmcnt(2)
    v_mfma_f32_32x32x16_bf16 v[96:111], a[68:71], v[132:135], v[96:111]
    ds_read_b128 v[144:147], v6 offset:20480
    buffer_store_dwordx4 v[168:171], v4, s[12:15], s38 offen offset:2048 sc1
    v_mfma_f32_32x32x16_bf16 v[112:127], a[228:231], v[132:135], v[112:127]
    s_waitcnt lgkmcnt(2)
    v_mfma_f32_32x32x16_bf16 v[96:111], a[72:75], v[136:139], v[96:111]
    ds_read_b128 v[148:151], v6 offset:21504
    v_cvt_pk_bf16_f32 v172, v88, v89
    v_mfma_f32_32x32x16_bf16 v[112:127], a[232:235], v[136:139], v[112:127]
    s_waitcnt lgkmcnt(2)
    v_mfma_f32_32x32x16_bf16 v[96:111], a[76:79], v[140:143], v[96:111]
    ds_read_b128 v[152:155], v6 offset:22528
    v_cvt_pk_bf16_f32 v173, v90, v91
    v_mfma_f32_32x32x16_bf16 v[112:127], a[236:239], v[140:143], v[112:127]
    s_waitcnt lgkmcnt(2)
    v_mfma_f32_32x32x16_bf16 v[96:111], a[80:83], v[144:147], v[96:111]
    ds_read_b128 v[156:159], v6 offset:23552
    v_cvt_pk_bf16_f32 v174, v92, v93
    v_mfma_f32_32x32x16_bf16 v[112:127], a[240:243], v[144:147], v[112:127]
    s_waitcnt lgkmcnt(2)
    v_mfma_f32_32x32x16_bf16 v[96:111], a[84:87], v[148:151], v[96:111]
    ds_read_b128 v[128:131], v6 offset:24576
    v_cvt_pk_bf16_f32 v175, v94, v95
    v_mfma_f32_32x32x16_bf16 v[112:127], a[244:247], v[148:151], v[112:127]
    s_waitcnt lgkmcnt(2)
    v_mfma_f32_32x32x16_bf16 v[96:111], a[88:91], v[152:155], v[96:111]
    ds_read_b128 v[132:135], v6 offset:25600
    buffer_store_dwordx4 v[172:175], v4, s[12:15], s38 offen offset:3072 sc1
    v_mfma_f32_32x32x16_bf16 v[112:127], a[248:251], v[152:155], v[112:127]
    s_waitcnt vmcnt(4)
    s_barrier
    s_add_u32 s49, s49, 1
    s_cmp_lt_u32 s49, s31
    s_cselect_b32 s27, 40960, 0
    s_add_u32 s39, s39, s27
    s_max_u32 s61, s30, 1
    s_sub_u32 s61, s61, 1
    v_mov_b32 v9, s61
    s_mov_b64 exec, 1
    buffer_store_dword v9, v8, s[12:15], 0 offen sc1
    s_mov_b64 exec, -1
    s_cmp_lg_u32 s49, 8
    s_cbranch_scc1 G1_mw3d
    v_min_u32 v10, 35, v1
    v_lshlrev_b32 v10, 7, v10
    s_add_u32 s59, s62, 2080768
    v_add_u32 v10, s59, v10
    s_mov_b32 s58, 0
G1_mw3:
    buffer_load_dword v11, v10, s[12:15], 0 offen sc1
    s_waitcnt vmcnt(0)
    v_cmp_eq_u32 vcc, 0, v11
    s_cbranch_vccz G1_mw3d
    s_sleep 4
    s_add_u32 s58, s58, 1
    s_cmp_lt_u32 s58, 0x200000
    s_cbranch_scc1 G1_mw3
G1_mw3d:
    s_cmp_lg_u32 s49, 36
    s_cbranch_scc1 G1_mw4d
    v_min_u32 v10, 63, v1
    v_lshlrev_b32 v10, 7, v10
    s_add_u32 s59, s62, 2080768
    v_add_u32 v10, s59, v10
    s_mov_b32 s58, 0
G1_mw4:
    buffer_load_dword v11, v10, s[12:15], 0 offen sc1
    s_waitcnt vmcnt(0)
    v_cmp_eq_u32 vcc, 0, v11
    s_cbranch_vccz G1_mw4d
    s_sleep 4
    s_add_u32 s58, s58, 1
    s_cmp_lt_u32 s58, 0x200000
    s_cbranch_scc1 G1_mw4
G1_mw4d:
    s_waitcnt lgkmcnt(2)
    v_mfma_f32_32x32x16_bf16 v[96:111], a[92:95], v[156:159], v[96:111]
    ds_read_b128 v[136:139], v6 offset:26624
    v_mfma_f32_32x32x16_bf16 v[112:127], a[252:255], v[156:159], v[112:127]
    s_add_u32 s41, s48, s40
    s_add_u32 s41, s41, 0
    s_add_u32 s42, s39, 0
    s_mov_b32 m0, s41
    s_nop 0
    buffer_load_dwordx4 v2, s[12:15], s42 offen offset:0 lds
    s_waitcnt lgkmcnt(2)
    v_mfma_f32_32x32x16_bf16 v[96:111], a[96:99], v[128:131], v[96:111]
    ds_read_b128 v[140:143], v6 offset:27648
    v_mfma_f32_32x32x16_bf16 v[112:127], v[192:195], v[128:131], v[112:127]
    buffer_load_dwordx4 v2, s[12:15], s42 offen offset:1024 lds
    s_waitcnt lgkmcnt(2)
    v_mfma_f32_32x32x16_bf16 v[96:111], a[100:103], v[132:135], v[96:111]
    ds_read_b128 v[144:147], v6 offset:28672
    v_mfma_f32_32x32x16_bf16 v[112:127], v[196:199], v[132:135], v[112:127]
    buffer_load_dwordx4 v2, s[12:15], s42 offen offset:2048 lds
    s_waitcnt lgkmcnt(2)
    v_mfma_f32_32x32x16_bf16 v[96:111], a[104:107], v[136:139], v[96:111]
    ds_read_b128 v[148:151], v6 offset:29696
    v_mfma_f32_32x32x16_bf16 v[112:127], v[200:203], v[136:139], v[112:127]
    buffer_load_dwordx4 v2, s[12:15], s42 offen offset:3072 lds
    s_waitcnt lgkmcnt(2)
    v_mfma_f32_32x32x16_bf16 v[96:111], a[108:111], v[140:143], v[96:111]
    ds_read_b128 v[152:155], v6 offset:30720
    v_mfma_f32_32x32x16_bf16 v[112:127], v[204:207], v[140:143], v[112:127]
    s_add_u32 s41, s48, s40
    s_add_u32 s41, s41, 4096
    s_add_u32 s42, s39, 4096
    s_mov_b32 m0, s41
    s_nop 0
    buffer_load_dwordx4 v2, s[12:15], s42 offen offset:0 lds
    s_waitcnt lgkmcnt(2)
    v_mfma_f32_32x32x16_bf16 v[96:111], a[112:115], v[144:147], v[96:111]
    ds_read_b128 v[156:159], v6 offset:31744
    v_mfma_f32_32x32x16_bf16 v[112:127], v[208:211], v[144:147], v[112:127]
    buffer_load_dwordx4 v2, s[12:15], s42 offen offset:1024 lds
    s_waitcnt lgkmcnt(2)
    v_mfma_f32_32x32x16_bf16 v[96:111], a[116:119], v[148:151], v[96:111]
    ds_read_b128 v[128:131], v6 offset:32768
    v_mfma_f32_32x32x16_bf16 v[112:127], v[212:215], v[148:151], v[112:127]
    buffer_load_dwordx4 v2, s[12:15], s42 offen offset:2048 lds
    s_waitcnt lgkmcnt(2)
    v_mfma_f32_32x32x16_bf16 v[96:111], a[120:123], v[152:155], v[96:111]
    ds_read_b128 v[132:135], v6 offset:33792
    v_mfma_f32_32x32x16_bf16 v[112:127], v[216:219], v[152:155], v[112:127]
    buffer_load_dwordx4 v2, s[12:15], s42 offen offset:3072 lds
    s_waitcnt lgkmcnt(2)
    v_mfma_f32_32x32x16_bf16 v[96:111], a[124:127], v[156:159], v[96:111]
    ds_read_b128 v[136:139], v6 offset:34816
    v_mfma_f32_32x32x16_bf16 v[112:127], v[220:223], v[156:159], v[112:127]
    s_add_u32 s41, s48, s40
    s_add_u32 s41, s41, 8192
    s_add_u32 s42, s39, 8192
    s_mov_b32 m0, s41
    s_nop 0
    buffer_load_dwordx4 v2, s[12:15], s42 offen offset:0 lds
    s_waitcnt lgkmcnt(2)
    v_mfma_f32_32x32x16_bf16 v[96:111], a[128:131], v[128:131], v[96:111]
    ds_read_b128 v[140:143], v6 offset:35840
    v_mfma_f32_32x32x16_bf16 v[112:127], v[224:227], v[128:131], v[112:127]
    buffer_load_dwordx4 v2, s[12:15], s42 offen offset:1024 lds
    s_waitcnt lgkmcnt(2)
    v_mfma_f32_32x32x16_bf16 v[96:111], a[132:135], v[132:135], v[96:111]
    ds_read_b128 v[144:147], v6 offset:36864
    v_mfma_f32_32x32x16_bf16 v[112:127], v[228:231], v[132:135], v[112:127]
    s_waitcnt lgkmcnt(2)
    v_mfma_f32_32x32x16_bf16 v[96:111], a[136:139], v[136:139], v[96:111]
    ds_read_b128 v[148:151], v6 offset:37888
    v_mfma_f32_32x32x16_bf16 v[112:127], v[232:235], v[136:139], v[112:127]
    s_waitcnt lgkmcnt(2)
    v_mfma_f32_32x32x16_bf16 v[96:111], a[140:143], v[140:143], v[96:111]
    ds_read_b128 v[152:155], v6 offset:38912
    v_mfma_f32_32x32x16_bf16 v[112:127], v[236:239], v[140:143], v[112:127]
    s_waitcnt lgkmcnt(2)
    v_mfma_f32_32x32x16_bf16 v[96:111], a[144:147], v[144:147], v[96:111]
    ds_read_b128 v[156:159], v6 offset:39936
    v_mfma_f32_32x32x16_bf16 v[112:127], v[240:243], v[144:147], v[112:127]
    s_waitcnt lgkmcnt(2)
    v_mfma_f32_32x32x16_bf16 v[96:111], a[148:151], v[148:151], v[96:111]
    ds_read_b128 v[128:131], v7 offset:0
    v_mfma_f32_32x32x16_bf16 v[112:127], v[244:247], v[148:151], v[112:127]
    s_waitcnt lgkmcnt(2)
    v_mfma_f32_32x32x16_bf16 v[96:111], a[152:155], v[152:155], v[96:111]
    ds_read_b128 v[132:135], v7 offset:1024
    v_mfma_f32_32x32x16_bf16 v[112:127], v[248:251], v[152:155], v[112:127]
    s_waitcnt lgkmcnt(2)
    v_mfma_f32_32x32x16_bf16 v[96:111], a[156:159], v[156:159], v[96:111]
    ds_read_b128 v[136:139], v7 offset:2048
    v_mfma_f32_32x32x16_bf16 v[112:127], v[252:255], v[156:159], v[112:127]
    s_mov_b32 s38, s36
    s_add_u32 s36, s36, s37
    s_mov_b32 s27, s46
    s_mov_b32 s46, s47
    s_mov_b32 s47, s48
    s_mov_b32 s48, s27
    v_mov_b32 v6, v7
    v_add_u32 v7, s47, v3
    s_add_u32 s30, s30, 1
    s_cmp_ge_u32 s30, s31
    s_cbranch_scc0 G1_qk
    s_nop 15
    v_cvt_pk_bf16_f32 v160, v96, v97
    v_cvt_pk_bf16_f32 v161, v98, v99
    v_cvt_pk_bf16_f32 v162, v100, v101
    v_cvt_pk_bf16_f32 v163, v102, v103
    buffer_store_dwordx4 v[160:163], v4, s[12:15], s38 offen offset:0 sc1
    v_cvt_pk_bf16_f32 v164, v104, v105
    v_cvt_pk_bf16_f32 v165, v106, v107
    v_cvt_pk_bf16_f32 v166, v108, v109
    v_cvt_pk_bf16_f32 v167, v110, v111
    buffer_store_dwordx4 v[164:167], v4, s[12:15], s38 offen offset:1024 sc1
    v_cvt_pk_bf16_f32 v168, v112, v113
    v_cvt_pk_bf16_f32 v169, v114, v115
    v_cvt_pk_bf16_f32 v170, v116, v117
    v_cvt_pk_bf16_f32 v171, v118, v119
    buffer_store_dwordx4 v[168:171], v4, s[12:15], s38 offen offset:2048 sc1
    v_cvt_pk_bf16_f32 v172, v120, v121
    v_cvt_pk_bf16_f32 v173, v122, v123
    v_cvt_pk_bf16_f32 v174, v124, v125
    v_cvt_pk_bf16_f32 v175, v126, v127
    buffer_store_dwordx4 v[172:175], v4, s[12:15], s38 offen offset:3072 sc1
    s_branch G1_fin
G1_qk_f0:
    s_nop 15
    v_cvt_pk_bf16_f32 v160, v64, v65
    v_cvt_pk_bf16_f32 v161, v66, v67
    v_cvt_pk_bf16_f32 v162, v68, v69
    v_cvt_pk_bf16_f32 v163, v70, v71
    buffer_store_dwordx4 v[160:163], v4, s[12:15], s38 offen offset:0 sc1
    v_cvt_pk_bf16_f32 v164, v72, v73
    v_cvt_pk_bf16_f32 v165, v74, v75
    v_cvt_pk_bf16_f32 v166, v76, v77
    v_cvt_pk_bf16_f32 v167, v78, v79
    buffer_store_dwordx4 v[164:167], v4, s[12:15], s38 offen offset:1024 sc1
    v_cvt_pk_bf16_f32 v168, v80, v81
    v_cvt_pk_bf16_f32 v169, v82, v83
    v_cvt_pk_bf16_f32 v170, v84, v85
    v_cvt_pk_bf16_f32 v171, v86, v87
    buffer_store_dwordx4 v[168:171], v4, s[12:15], s38 offen offset:2048 sc1
    v_cvt_pk_bf16_f32 v172, v88, v89
    v_cvt_pk_bf16_f32 v173, v90, v91
    v_cvt_pk_bf16_f32 v174, v92, v93
    v_cvt_pk_bf16_f32 v175, v94, v95
    buffer_store_dwordx4 v[172:175], v4, s[12:15], s38 offen offset:3072 sc1
    s_branch G1_fin
G1_gu:
    s_waitcnt lgkmcnt(2)
    v_mfma_f32_32x32x16_bf16 v[64:79], a[0:3], v[128:131], 0
    ds_read_b128 v[140:143], v6 offset:3072
    v_mfma_f32_32x32x16_bf16 v[80:95], a[160:163], v[128:131], 0
    s_waitcnt lgkmcnt(2)
    v_mfma_f32_32x32x16_bf16 v[64:79], a[4:7], v[132:135], v[64:79]
    ds_read_b128 v[144:147], v6 offset:4096
    v_mfma_f32_32x32x16_bf16 v[80:95], a[164:167], v[132:135], v[80:95]
    s_waitcnt lgkmcnt(2)
    v_mfma_f32_32x32x16_bf16 v[64:79], a[8:11], v[136:139], v[64:79]
    ds_read_b128 v[148:151], v6 offset:5120
    v_mfma_f32_32x32x16_bf16 v[80:95], a[168:171], v[136:139], v[80:95]
    s_waitcnt lgkmcnt(2)
    v_mfma_f32_32x32x16_bf16 v[64:79], a[12:15], v[140:143], v[64:79]
    ds_read_b128 v[152:155], v6 offset:6144
    v_cvt_pk_bf16_f32 v169, v96, v97
    v_cvt_pk_bf16_f32 v171, v112, v113
    v_lshlrev_b32 v96, 16, v169
    v_and_b32 v97, 0xffff0000, v169
    v_mfma_f32_32x32x16_bf16 v[80:95], a[172:175], v[140:143], v[80:95]
    v_lshlrev_b32 v112, 16, v171
    v_and_b32 v113, 0xffff0000, v171
    v_mul_f32 v168, v96, v96
    s_waitcnt lgkmcnt(2)
    v_mfma_f32_32x32x16_bf16 v[64:79], a[16:19], v[144:147], v[64:79]
    ds_read_b128 v[156:159], v6 offset:7168
    v_mul_f32 v169, v97, v97
    v_mov_b32 v170, s44
    v_mov_b32 v171, s44
    v_fmac_f32 v170, s45, v168
    v_mfma_f32_32x32x16_bf16 v[80:95], a[176:179], v[144:147], v[80:95]
    v_fmac_f32 v171, s45, v169
    v_mul_f32 v170, v170, v96
    v_mul_f32 v171, v171, v97
    s_waitcnt lgkmcnt(2)
    v_mfma_f32_32x32x16_bf16 v[64:79], a[20:23], v[148:151], v[64:79]
    ds_read_b128 v[128:131], v6 offset:8192
    v_exp_f32 v170, v170
    v_exp_f32 v171, v171
    s_nop 0
    v_add_f32 v170, 1.0, v170
    v_mfma_f32_32x32x16_bf16 v[80:95], a[180:183], v[148:151], v[80:95]
    v_add_f32 v171, 1.0, v171
    v_rcp_f32 v170, v170
    v_rcp_f32 v171, v171
    s_waitcnt lgkmcnt(2)
    v_mfma_f32_32x32x16_bf16 v[64:79], a[24:27], v[152:155], v[64:79]
    ds_read_b128 v[132:135], v6 offset:9216
    s_nop 0
    v_mul_f32 v170, v170, v96
    v_mul_f32 v171, v171, v97
    v_cvt_pk_bf16_f32 v168, v170, v171
    v_mfma_f32_32x32x16_bf16 v[80:95], a[184:187], v[152:155], v[80:95]
    v_lshlrev_b32 v170, 16, v168
    v_and_b32 v171, 0xffff0000, v168
    v_mul_f32 v170, v170, v112
    s_waitcnt lgkmcnt(2)
    v_mfma_f32_32x32x16_bf16 v[64:79], a[28:31], v[156:159], v[64:79]
    ds_read_b128 v[136:139], v6 offset:10240
    v_mul_f32 v171, v171, v113
    v_cvt_pk_bf16_f32 v160, v170, v171
    v_cvt_pk_bf16_f32 v169, v98, v99
    v_cvt_pk_bf16_f32 v171, v114, v115
    v_mfma_f32_32x32x16_bf16 v[80:95], a[188:191], v[156:159], v[80:95]
    v_lshlrev_b32 v98, 16, v169
    v_and_b32 v99, 0xffff0000, v169
    v_lshlrev_b32 v114, 16, v171
    s_waitcnt lgkmcnt(2)
    v_mfma_f32_32x32x16_bf16 v[64:79], a[32:35], v[128:131], v[64:79]
    ds_read_b128 v[140:143], v6 offset:11264
    v_and_b32 v115, 0xffff0000, v171
    v_mul_f32 v168, v98, v98
    v_mul_f32 v169, v99, v99
    v_mov_b32 v170, s44
    v_mfma_f32_32x32x16_bf16 v[80:95], a[192:195], v[128:131], v[80:95]
    v_mov_b32 v171, s44
    v_fmac_f32 v170, s45, v168
    v_fmac_f32 v171, s45, v169
    s_waitcnt lgkmcnt(2)
    v_mfma_f32_32x32x16_bf16 v[64:79], a[36:39], v[132:135], v[64:79]
    ds_read_b128 v[144:147], v6 offset:12288
    v_mul_f32 v170, v170, v98
    v_mul_f32 v171, v171, v99
    v_exp_f32 v170, v170
    v_exp_f32 v171, v171
    v_mfma_f32_32x32x16_bf16 v[80:95], a[196:199], v[132:135], v[80:95]
    s_nop 0
    v_add_f32 v170, 1.0, v170
    v_add_f32 v171, 1.0, v171
    s_waitcnt lgkmcnt(2)
    v_mfma_f32_32x32x16_bf16 v[64:79], a[40:43], v[136:139], v[64:79]
    ds_read_b128 v[148:151], v6 offset:13312
    v_rcp_f32 v170, v170
    v_rcp_f32 v171, v171
    s_nop 0
    v_mul_f32 v170, v170, v98
    v_mfma_f32_32x32x16_bf16 v[80:95], a[200:203], v[136:139], v[80:95]
    v_mul_f32 v171, v171, v99
    v_cvt_pk_bf16_f32 v168, v170, v171
    v_lshlrev_b32 v170, 16, v168
    s_waitcnt lgkmcnt(2)
    v_mfma_f32_32x32x16_bf16 v[64:79], a[44:47], v[140:143], v[64:79]
    ds_read_b128 v[152:155], v6 offset:14336
    v_and_b32 v171, 0xffff0000, v168
    v_mul_f32 v170, v170, v114
    v_mul_f32 v171, v171, v115
    v_cvt_pk_bf16_f32 v161, v170, v171
    v_mfma_f32_32x32x16_bf16 v[80:95], a[204:207], v[140:143], v[80:95]
    v_cvt_pk_bf16_f32 v169, v100, v101
    v_cvt_pk_bf16_f32 v171, v116, v117
    v_lshlrev_b32 v100, 16, v169
    s_waitcnt lgkmcnt(2)
    v_mfma_f32_32x32x16_bf16 v[64:79], a[48:51], v[144:147], v[64:79]
    ds_read_b128 v[156:159], v6 offset:15360
    v_and_b32 v101, 0xffff0000, v169
    v_lshlrev_b32 v116, 16, v171
    v_and_b32 v117, 0xffff0000, v171
    v_mul_f32 v168, v100, v100
    v_mfma_f32_32x32x16_bf16 v[80:95], a[208:211], v[144:147], v[80:95]
    v_mul_f32 v169, v101, v101
    v_mov_b32 v170, s44
    v_mov_b32 v171, s44
    s_waitcnt lgkmcnt(2)
    v_mfma_f32_32x32x16_bf16 v[64:79], a[52:55], v[148:151], v[64:79]
    ds_read_b128 v[128:131], v6 offset:16384
    v_fmac_f32 v170, s45, v168
    v_fmac_f32 v171, s45, v169
    v_mul_f32 v170, v170, v100
    v_mul_f32 v171, v171, v101
    v_mfma_f32_32x32x16_bf16 v[80:95], a[212:215], v[148:151], v[80:95]
    v_exp_f32 v170, v170
    v_exp_f32 v171, v171
    s_nop 0
    s_waitcnt lgkmcnt(2)
    v_mfma_f32_32x32x16_bf16 v[64:79], a[56:59], v[152:155], v[64:79]
    ds_read_b128 v[132:135], v6 offset:17408
    v_add_f32 v170, 1.0, v170
    v_add_f32 v171, 1.0, v171
    v_rcp_f32 v170, v170
    v_rcp_f32 v171, v171
    v_mfma_f32_32x32x16_bf16 v[80:95], a[216:219], v[152:155], v[80:95]
    s_nop 0
    v_mul_f32 v170, v170, v100
    v_mul_f32 v171, v171, v101
    s_waitcnt lgkmcnt(2)
    v_mfma_f32_32x32x16_bf16 v[64:79], a[60:63], v[156:159], v[64:79]
    ds_read_b128 v[136:139], v6 offset:18432
    v_cvt_pk_bf16_f32 v168, v170, v171
    v_lshlrev_b32 v170, 16, v168
    v_and_b32 v171, 0xffff0000, v168
    v_mul_f32 v170, v170, v116
    v_mfma_f32_32x32x16_bf16 v[80:95], a[220:223], v[156:159], v[80:95]
    v_mul_f32 v171, v171, v117
    v_cvt_pk_bf16_f32 v162, v170, v171
    v_cvt_pk_bf16_f32 v169, v102, v103
    s_waitcnt lgkmcnt(2)
    v_mfma_f32_32x32x16_bf16 v[64:79], a[64:67], v[128:131], v[64:79]
    ds_read_b128 v[140:143], v6 offset:19456
    v_cvt_pk_bf16_f32 v171, v118, v119
    v_lshlrev_b32 v102, 16, v169
    v_and_b32 v103, 0xffff0000, v169
    v_lshlrev_b32 v118, 16, v171
    v_mfma_f32_32x32x16_bf16 v[80:95], a[224:227], v[128:131], v[80:95]
    v_and_b32 v119, 0xffff0000, v171
    v_mul_f32 v168, v102, v102
    v_mul_f32 v169, v103, v103
    s_waitcnt lgkmcnt(2)
    v_mfma_f32_32x32x16_bf16 v[64:79], a[68:71], v[132:135], v[64:79]
    ds_read_b128 v[144:147], v6 offset:20480
    v_mov_b32 v170, s44
    v_mov_b32 v171, s44
    v_fmac_f32 v170, s45, v168
    v_fmac_f32 v171, s45, v169
    v_mfma_f32_32x32x16_bf16 v[80:95], a[228:231], v[132:135], v[80:95]
    v_mul_f32 v170, v170, v102
    v_mul_f32 v171, v171, v103
    v_exp_f32 v170, v170
    s_waitcnt lgkmcnt(2)
    v_mfma_f32_32x32x16_bf16 v[64:79], a[72:75], v[136:139], v[64:79]
    ds_read_b128 v[148:151], v6 offset:21504
    v_exp_f32 v171, v171
    s_nop 0
    v_add_f32 v170, 1.0, v170
    v_add_f32 v171, 1.0, v171
    v_mfma_f32_32x32x16_bf16 v[80:95], a[232:235], v[136:139], v[80:95]
    v_rcp_f32 v170, v170
    v_rcp_f32 v171, v171
    s_nop 0
    s_waitcnt lgkmcnt(2)
    v_mfma_f32_32x32x16_bf16 v[64:79], a[76:79], v[140:143], v[64:79]
    ds_read_b128 v[152:155], v6 offset:22528
    v_mul_f32 v170, v170, v102
    v_mul_f32 v171, v171, v103
    v_cvt_pk_bf16_f32 v168, v170, v171
    v_lshlrev_b32 v170, 16, v168
    v_mfma_f32_32x32x16_bf16 v[80:95], a[236:239], v[140:143], v[80:95]
    v_and_b32 v171, 0xffff0000, v168
    v_mul_f32 v170, v170, v118
    v_mul_f32 v171, v171, v119
    s_waitcnt lgkmcnt(2)
    v_mfma_f32_32x32x16_bf16 v[64:79], a[80:83], v[144:147], v[64:79]
    ds_read_b128 v[156:159], v6 offset:23552
    v_cvt_pk_bf16_f32 v163, v170, v171
    buffer_store_dwordx4 v[160:163], v4, s[12:15], s38 offen offset:0 sc1
    v_cvt_pk_bf16_f32 v169, v104, v105
    v_cvt_pk_bf16_f32 v171, v120, v121
    v_mfma_f32_32x32x16_bf16 v[80:95], a[240:243], v[144:147], v[80:95]
    v_lshlrev_b32 v104, 16, v169
    v_and_b32 v105, 0xffff0000, v169
    v_lshlrev_b32 v120, 16, v171
    s_waitcnt lgkmcnt(2)
    v_mfma_f32_32x32x16_bf16 v[64:79], a[84:87], v[148:151], v[64:79]
    ds_read_b128 v[128:131], v6 offset:24576
    v_and_b32 v121, 0xffff0000, v171
    v_mul_f32 v168, v104, v104
    v_mul_f32 v169, v105, v105
    v_mov_b32 v170, s44
    v_mfma_f32_32x32x16_bf16 v[80:95], a[244:247], v[148:151], v[80:95]
    v_mov_b32 v171, s44
    v_fmac_f32 v170, s45, v168
    v_fmac_f32 v171, s45, v169
    s_waitcnt lgkmcnt(2)
    v_mfma_f32_32x32x16_bf16 v[64:79], a[88:91], v[152:155], v[64:79]
    ds_read_b128 v[132:135], v6 offset:25600
    v_mul_f32 v170, v170, v104
    v_mul_f32 v171, v171, v105
    v_exp_f32 v170, v170
    v_exp_f32 v171, v171
    v_mfma_f32_32x32x16_bf16 v[80:95], a[248:251], v[152:155], v[80:95]
    s_nop 0
    v_add_f32 v170, 1.0, v170
    v_add_f32 v171, 1.0, v171
    s_waitcnt vmcnt(1)
    s_barrier
    s_add_u32 s49, s49, 1
    s_cmp_lt_u32 s49, s31
    s_cselect_b32 s27, 40960, 0
    s_add_u32 s39, s39, s27
    s_max_u32 s61, s30, 1
    s_sub_u32 s61, s61, 1
    v_mov_b32 v9, s61
    s_mov_b64 exec, 1
    buffer_store_dword v9, v8, s[12:15], 0 offen sc1
    s_mov_b64 exec, -1
    s_cmp_lg_u32 s49, 8
    s_cbranch_scc1 G1_mw5d
    v_min_u32 v10, 35, v1
    v_lshlrev_b32 v10, 7, v10
    s_add_u32 s59, s62, 2080768
    v_add_u32 v10, s59, v10
    s_mov_b32 s58, 0
G1_mw5:
    buffer_load_dword v11, v10, s[12:15], 0 offen sc1
    s_waitcnt vmcnt(0)
    v_cmp_eq_u32 vcc, 0, v11
    s_cbranch_vccz G1_mw5d
    s_sleep 4
    s_add_u32 s58, s58, 1
    s_cmp_lt_u32 s58, 0x200000
    s_cbranch_scc1 G1_mw5
G1_mw5d:
    s_cmp_lg_u32 s49, 36
    s_cbranch_scc1 G1_mw6d
    v_min_u32 v10, 63, v1
    v_lshlrev_b32 v10, 7, v10
    s_add_u32 s59, s62, 2080768
    v_add_u32 v10, s59, v10
    s_mov_b32 s58, 0
G1_mw6:
    buffer_load_dword v11, v10, s[12:15], 0 offen sc1
    s_waitcnt vmcnt(0)
    v_cmp_eq_u32 vcc, 0, v11
    s_cbranch_vccz G1_mw6d
    s_sleep 4
    s_add_u32 s58, s58, 1
    s_cmp_lt_u32 s58, 0x200000
    s_cbranch_scc1 G1_mw6
G1_mw6d:
    s_waitcnt lgkmcnt(2)
    v_mfma_f32_32x32x16_bf16 v[64:79], a[92:95], v[156:159], v[64:79]
    ds_read_b128 v[136:139], v6 offset:26624
    v_rcp_f32 v170, v170
    v_rcp_f32 v171, v171
    s_nop 0
    v_mul_f32 v170, v170, v104
    v_mfma_f32_32x32x16_bf16 v[80:95], a[252:255], v[156:159], v[80:95]
    v_mul_f32 v171, v171, v105
    v_cvt_pk_bf16_f32 v168, v170, v171
    v_lshlrev_b32 v170, 16, v168
    s_add_u32 s41, s48, s40
    s_add_u32 s41, s41, 0
    s_add_u32 s42, s39, 0
    s_mov_b32 m0, s41
    s_nop 0
    buffer_load_dwordx4 v2, s[12:15], s42 offen offset:0 lds
    s_waitcnt lgkmcnt(2)
    v_mfma_f32_32x32x16_bf16 v[64:79], a[96:99], v[128:131], v[64:79]
    ds_read_b128 v[140:143], v6 offset:27648
    v_and_b32 v171, 0xffff0000, v168
    v_mul_f32 v170, v170, v120
    v_mul_f32 v171, v171, v121
    v_cvt_pk_bf16_f32 v164, v170, v171
    v_mfma_f32_32x32x16_bf16 v[80:95], v[192:195], v[128:131], v[80:95]
    v_cvt_pk_bf16_f32 v169, v106, v107
    v_cvt_pk_bf16_f32 v171, v122, v123
    v_lshlrev_b32 v106, 16, v169
    buffer_load_dwordx4 v2, s[12:15], s42 offen offset:1024 lds
    s_waitcnt lgkmcnt(2)
    v_mfma_f32_32x32x16_bf16 v[64:79], a[100:103], v[132:135], v[64:79]
    ds_read_b128 v[144:147], v6 offset:28672
    v_and_b32 v107, 0xffff0000, v169
    v_lshlrev_b32 v122, 16, v171
    v_and_b32 v123, 0xffff0000, v171
    v_mul_f32 v168, v106, v106
    v_mfma_f32_32x32x16_bf16 v[80:95], v[196:199], v[132:135], v[80:95]
    v_mul_f32 v169, v107, v107
    v_mov_b32 v170, s44
    v_mov_b32 v171, s44
    buffer_load_dwordx4 v2, s[12:15], s42 offen offset:2048 lds
    s_waitcnt lgkmcnt(2)
    v_mfma_f32_32x32x16_bf16 v[64:79], a[104:107], v[136:139], v[64:79]
    ds_read_b128 v[148:151], v6 offset:29696
    v_fmac_f32 v170, s45, v168
    v_fmac_f32 v171, s45, v169
    v_mul_f32 v170, v170, v106
    v_mul_f32 v171, v171, v107
    v_mfma_f32_32x32x16_bf16 v[80:95], v[200:203], v[136:139], v[80:95]
    v_exp_f32 v170, v170
    v_exp_f32 v171, v171
    s_nop 0
    buffer_load_dwordx4 v2, s[12:15], s42 offen offset:3072 lds
    s_waitcnt lgkmcnt(2)
    v_mfma_f32_32x32x16_bf16 v[64:79], a[108:111], v[140:143], v[64:79]
    ds_read_b128 v[152:155], v6 offset:30720
    v_add_f32 v170, 1.0, v170
    v_add_f32 v171, 1.0, v171
    v_rcp_f32 v170, v170
    v_rcp_f32 v171, v171
    v_mfma_f32_32x32x16_bf16 v[80:95], v[204:207], v[140:143], v[80:95]
    s_nop 0
    v_mul_f32 v170, v170, v106
    v_mul_f32 v171, v171, v107
    s_add_u32 s41, s48, s40
    s_add_u32 s41, s41, 4096
    s_add_u32 s42, s39, 4096
    s_mov_b32 m0, s41
    s_nop 0
    buffer_load_dwordx4 v2, s[12:15], s42 offen offset:0 lds
    s_waitcnt lgkmcnt(2)
    v_mfma_f32_32x32x16_bf16 v[64:79], a[112:115], v[144:147], v[64:79]
    ds_read_b128 v[156:159], v6 offset:31744
    v_cvt_pk_bf16_f32 v168, v170, v171
    v_lshlrev_b32 v170, 16, v168
    v_and_b32 v171, 0xffff0000, v168
    v_mul_f32 v170, v170, v122
    v_mfma_f32_32x32x16_bf16 v[80:95], v[208:211], v[144:147], v[80:95]
    v_mul_f32 v171, v171, v123
    v_cvt_pk_bf16_f32 v165, v170, v171
    v_cvt_pk_bf16_f32 v169, v108, v109
    buffer_load_dwordx4 v2, s[12:15], s42 offen offset:1024 lds
    s_waitcnt lgkmcnt(2)
    v_mfma_f32_32x32x16_bf16 v[64:79], a[116:119], v[148:151], v[64:79]
    ds_read_b128 v[128:131], v6 offset:32768
    v_cvt_pk_bf16_f32 v171, v124, v125
    v_lshlrev_b32 v108, 16, v169
    v_and_b32 v109, 0xffff0000, v169
    v_lshlrev_b32 v124, 16, v171
    v_mfma_f32_32x32x16_bf16 v[80:95], v[212:215], v[148:151], v[80:95]
    v_and_b32 v125, 0xffff0000, v171
    v_mul_f32 v168, v108, v108
    v_mul_f32 v169, v109, v109
    buffer_load_dwordx4 v2, s[12:15], s42 offen offset:2048 lds
    s_waitcnt lgkmcnt(2)
    v_mfma_f32_32x32x16_bf16 v[64:79], a[120:123], v[152:155], v[64:79]
    ds_read_b128 v[132:135], v6 offset:33792
    v_mov_b32 v170, s44
    v_mov_b32 v171, s44
    v_fmac_f32 v170, s45, v168
    v_fmac_f32 v171, s45, v169
    v_mfma_f32_32x32x16_bf16 v[80:95], v[216:219], v[152:155], v[80:95]
    v_mul_f32 v170, v170, v108
    v_mul_f32 v171, v171, v109
    v_exp_f32 v170, v170
    buffer_load_dwordx4 v2, s[12:15], s42 offen offset:3072 lds
    s_waitcnt lgkmcnt(2)
    v_mfma_f32_32x32x16_bf16 v[64:79], a[124:127], v[156:159], v[64:79]
    ds_read_b128 v[136:139], v6 offset:34816
    v_exp_f32 v171, v171
    s_nop 0
    v_add_f32 v170, 1.0, v170
    v_add_f32 v171, 1.0, v171
    v_mfma_f32_32x32x16_bf16 v[80:95], v[220:223], v[156:159], v[80:95]
    v_rcp_f32 v170, v170
    v_rcp_f32 v171, v171
    s_nop 0
    s_add_u32 s41, s48, s40
    s_add_u32 s41, s41, 8192
    s_add_u32 s42, s39, 8192
    s_mov_b32 m0, s41
    s_nop 0
    buffer_load_dwordx4 v2, s[12:15], s42 offen offset:0 lds
    s_waitcnt lgkmcnt(2)
    v_mfma_f32_32x32x16_bf16 v[64:79], a[128:131], v[128:131], v[64:79]
    ds_read_b128 v[140:143], v6 offset:35840
    v_mul_f32 v170, v170, v108
    v_mul_f32 v171, v171, v109
    v_cvt_pk_bf16_f32 v168, v170, v171
    v_lshlrev_b32 v170, 16, v168
    v_mfma_f32_32x32x16_bf16 v[80:95], v[224:227], v[128:131], v[80:95]
    v_and_b32 v171, 0xffff0000, v168
    v_mul_f32 v170, v170, v124
    v_mul_f32 v171, v171, v125
    buffer_load_dwordx4 v2, s[12:15], s42 offen offset:1024 lds
    s_waitcnt lgkmcnt(2)
    v_mfma_f32_32x32x16_bf16 v[64:79], a[132:135], v[132:135], v[64:79]
    ds_read_b128 v[144:147], v6 offset:36864
    v_cvt_pk_bf16_f32 v166, v170, v171
    v_cvt_pk_bf16_f32 v169, v110, v111
    v_cvt_pk_bf16_f32 v171, v126, v127
    v_lshlrev_b32 v110, 16, v169
    v_mfma_f32_32x32x16_bf16 v[80:95], v[228:231], v[132:135], v[80:95]
    v_and_b32 v111, 0xffff0000, v169
    v_lshlrev_b32 v126, 16, v171
    v_and_b32 v127, 0xffff0000, v171
    s_waitcnt lgkmcnt(2)
    v_mfma_f32_32x32x16_bf16 v[64:79], a[136:139], v[136:139], v[64:79]
    ds_read_b128 v[148:151], v6 offset:37888
    v_mul_f32 v168, v110, v110
    v_mul_f32 v169, v111, v111
    v_mov_b32 v170, s44
    v_mov_b32 v171, s44
    v_mfma_f32_32x32x16_bf16 v[80:95], v[232:235], v[136:139], v[80:95]
    v_fmac_f32 v170, s45, v168
    v_fmac_f32 v171, s45, v169
    v_mul_f32 v170, v170, v110
    s_waitcnt lgkmcnt(2)
    v_mfma_f32_32x32x16_bf16 v[64:79], a[140:143], v[140:143], v[64:79]
    ds_read_b128 v[152:155], v6 offset:38912
    v_mul_f32 v171, v171, v111
    v_exp_f32 v170, v170
    v_exp_f32 v171, v171
    s_nop 0
    v_mfma_f32_32x32x16_bf16 v[80:95], v[236:239], v[140:143], v[80:95]
    v_add_f32 v170, 1.0, v170
    v_add_f32 v171, 1.0, v171
    v_rcp_f32 v170, v170
    s_waitcnt lgkmcnt(2)
    v_mfma_f32_32x32x16_bf16 v[64:79], a[144:147], v[144:147], v[64:79]
    ds_read_b128 v[156:159], v6 offset:39936
    v_rcp_f32 v171, v171
    s_nop 0
    v_mul_f32 v170, v170, v110
    v_mul_f32 v171, v171, v111
    v_mfma_f32_32x32x16_bf16 v[80:95], v[240:243], v[144:147], v[80:95]
    v_cvt_pk_bf16_f32 v168, v170, v171
    v_lshlrev_b32 v170, 16, v168
    v_and_b32 v171, 0xffff0000, v168
    s_waitcnt lgkmcnt(2)
    v_mfma_f32_32x32x16_bf16 v[64:79], a[148:151], v[148:151], v[64:79]
    ds_read_b128 v[128:131], v7 offset:0
    v_mul_f32 v170, v170, v126
    v_mul_f32 v171, v171, v127
    v_cvt_pk_bf16_f32 v167, v170, v171
    buffer_store_dwordx4 v[164:167], v4, s[12:15], s38 offen offset:1024 sc1
    v_mfma_f32_32x32x16_bf16 v[80:95], v[244:247], v[148:151], v[80:95]
    s_waitcnt lgkmcnt(2)
    v_mfma_f32_32x32x16_bf16 v[64:79], a[152:155], v[152:155], v[64:79]
    ds_read_b128 v[132:135], v7 offset:1024
    v_mfma_f32_32x32x16_bf16 v[80:95], v[248:251], v[152:155], v[80:95]
    s_waitcnt lgkmcnt(2)
    v_mfma_f32_32x32x16_bf16 v[64:79], a[156:159], v[156:159], v[64:79]
    ds_read_b128 v[136:139], v7 offset:2048
    v_mfma_f32_32x32x16_bf16 v[80:95], v[252:255], v[156:159], v[80:95]
    s_mov_b32 s38, s36
    s_add_u32 s36, s36, s37
    s_mov_b32 s27, s46
    s_mov_b32 s46, s47
    s_mov_b32 s47, s48
    s_mov_b32 s48, s27
    v_mov_b32 v6, v7
    v_add_u32 v7, s47, v3
    s_add_u32 s30, s30, 1
    s_cmp_ge_u32 s30, s31
    s_cbranch_scc1 G1_gu_f0
    s_waitcnt lgkmcnt(2)
    v_mfma_f32_32x32x16_bf16 v[96:111], a[0:3], v[128:131], 0
    ds_read_b128 v[140:143], v6 offset:3072
    v_mfma_f32_32x32x16_bf16 v[112:127], a[160:163], v[128:131], 0
    s_waitcnt lgkmcnt(2)
    v_mfma_f32_32x32x16_bf16 v[96:111], a[4:7], v[132:135], v[96:111]
    ds_read_b128 v[144:147], v6 offset:4096
    v_mfma_f32_32x32x16_bf16 v[112:127], a[164:167], v[132:135], v[112:127]
    s_waitcnt lgkmcnt(2)
    v_mfma_f32_32x32x16_bf16 v[96:111], a[8:11], v[136:139], v[96:111]
    ds_read_b128 v[148:151], v6 offset:5120
    v_mfma_f32_32x32x16_bf16 v[112:127], a[168:171], v[136:139], v[112:127]
    s_waitcnt lgkmcnt(2)
    v_mfma_f32_32x32x16_bf16 v[96:111], a[12:15], v[140:143], v[96:111]
    ds_read_b128 v[152:155], v6 offset:6144
    v_cvt_pk_bf16_f32 v169, v64, v65
    v_cvt_pk_bf16_f32 v171, v80, v81
    v_lshlrev_b32 v64, 16, v169
    v_and_b32 v65, 0xffff0000, v169
    v_mfma_f32_32x32x16_bf16 v[112:127], a[172:175], v[140:143], v[112:127]
    v_lshlrev_b32 v80, 16, v171
    v_and_b32 v81, 0xffff0000, v171
    v_mul_f32 v168, v64, v64
    s_waitcnt lgkmcnt(2)
    v_mfma_f32_32x32x16_bf16 v[96:111], a[16:19], v[144:147], v[96:111]
    ds_read_b128 v[156:159], v6 offset:7168
    v_mul_f32 v169, v65, v65
    v_mov_b32 v170, s44
    v_mov_b32 v171, s44
    v_fmac_f32 v170, s45, v168
    v_mfma_f32_32x32x16_bf16 v[112:127], a[176:179], v[144:147], v[112:127]
    v_fmac_f32 v171, s45, v169
    v_mul_f32 v170, v170, v64
    v_mul_f32 v171, v171, v65
    s_waitcnt lgkmcnt(2)
    v_mfma_f32_32x32x16_bf16 v[96:111], a[20:23], v[148:151], v[96:111]
    ds_read_b128 v[128:131], v6 offset:8192
    v_exp_f32 v170, v170
    v_exp_f32 v171, v171
    s_nop 0
    v_add_f32 v170, 1.0, v170
    v_mfma_f32_32x32x16_bf16 v[112:127], a[180:183], v[148:151], v[112:127]
    v_add_f32 v171, 1.0, v171
    v_rcp_f32 v170, v170
    v_rcp_f32 v171, v171
    s_waitcnt lgkmcnt(2)
    v_mfma_f32_32x32x16_bf16 v[96:111], a[24:27], v[152:155], v[96:111]
    ds_read_b128 v[132:135], v6 offset:9216
    s_nop 0
    v_mul_f32 v170, v170, v64
    v_mul_f32 v171, v171, v65
    v_cvt_pk_bf16_f32 v168, v170, v171
    v_mfma_f32_32x32x16_bf16 v[112:127], a[184:187], v[152:155], v[112:127]
    v_lshlrev_b32 v170, 16, v168
    v_and_b32 v171, 0xffff0000, v168
    v_mul_f32 v170, v170, v80
    s_waitcnt lgkmcnt(2)
    v_mfma_f32_32x32x16_bf16 v[96:111], a[28:31], v[156:159], v[96:111]
    ds_read_b128 v[136:139], v6 offset:10240
    v_mul_f32 v171, v171, v81
    v_cvt_pk_bf16_f32 v160, v170, v171
    v_cvt_pk_bf16_f32 v169, v66, v67
    v_cvt_pk_bf16_f32 v171, v82, v83
    v_mfma_f32_32x32x16_bf16 v[112:127], a[188:191], v[156:159], v[112:127]
    v_lshlrev_b32 v66, 16, v169
    v_and_b32 v67, 0xffff0000, v169
    v_lshlrev_b32 v82, 16, v171
    s_waitcnt lgkmcnt(2)
    v_mfma_f32_32x32x16_bf16 v[96:111], a[32:35], v[128:131], v[96:111]
    ds_read_b128 v[140:143], v6 offset:11264
    v_and_b32 v83, 0xffff0000, v171
    v_mul_f32 v168, v66, v66
    v_mul_f32 v169, v67, v67
    v_mov_b32 v170, s44
    v_mfma_f32_32x32x16_bf16 v[112:127], a[192:195], v[128:131], v[112:127]
    v_mov_b32 v171, s44
    v_fmac_f32 v170, s45, v168
    v_fmac_f32 v171, s45, v169
    s_waitcnt lgkmcnt(2)
    v_mfma_f32_32x32x16_bf16 v[96:111], a[36:39], v[132:135], v[96:111]
    ds_read_b128 v[144:147], v6 offset:12288
    v_mul_f32 v170, v170, v66
    v_mul_f32 v171, v171, v67
    v_exp_f32 v170, v170
    v_exp_f32 v171, v171
    v_mfma_f32_32x32x16_bf16 v[112:127], a[196:199], v[132:135], v[112:127]
    s_nop 0
    v_add_f32 v170, 1.0, v170
    v_add_f32 v171, 1.0, v171
    s_waitcnt lgkmcnt(2)
    v_mfma_f32_32x32x16_bf16 v[96:111], a[40:43], v[136:139], v[96:111]
    ds_read_b128 v[148:151], v6 offset:13312
    v_rcp_f32 v170, v170
    v_rcp_f32 v171, v171
    s_nop 0
    v_mul_f32 v170, v170, v66
    v_mfma_f32_32x32x16_bf16 v[112:127], a[200:203], v[136:139], v[112:127]
    v_mul_f32 v171, v171, v67
    v_cvt_pk_bf16_f32 v168, v170, v171
    v_lshlrev_b32 v170, 16, v168
    s_waitcnt lgkmcnt(2)
    v_mfma_f32_32x32x16_bf16 v[96:111], a[44:47], v[140:143], v[96:111]
    ds_read_b128 v[152:155], v6 offset:14336
    v_and_b32 v171, 0xffff0000, v168
    v_mul_f32 v170, v170, v82
    v_mul_f32 v171, v171, v83
    v_cvt_pk_bf16_f32 v161, v170, v171
    v_mfma_f32_32x32x16_bf16 v[112:127], a[204:207], v[140:143], v[112:127]
    v_cvt_pk_bf16_f32 v169, v68, v69
    v_cvt_pk_bf16_f32 v171, v84, v85
    v_lshlrev_b32 v68, 16, v169
    s_waitcnt lgkmcnt(2)
    v_mfma_f32_32x32x16_bf16 v[96:111], a[48:51], v[144:147], v[96:111]
    ds_read_b128 v[156:159], v6 offset:15360
    v_and_b32 v69, 0xffff0000, v169
    v_lshlrev_b32 v84, 16, v171
    v_and_b32 v85, 0xffff0000, v171
    v_mul_f32 v168, v68, v68
    v_mfma_f32_32x32x16_bf16 v[112:127], a[208:211], v[144:147], v[112:127]
    v_mul_f32 v169, v69, v69
    v_mov_b32 v170, s44
    v_mov_b32 v171, s44
    s_waitcnt lgkmcnt(2)
    v_mfma_f32_32x32x16_bf16 v[96:111], a[52:55], v[148:151], v[96:111]
    ds_read_b128 v[128:131], v6 offset:16384
    v_fmac_f32 v170, s45, v168
    v_fmac_f32 v171, s45, v169
    v_mul_f32 v170, v170, v68
    v_mul_f32 v171, v171, v69
    v_mfma_f32_32x32x16_bf16 v[112:127], a[212:215], v[148:151], v[112:127]
    v_exp_f32 v170, v170
    v_exp_f32 v171, v171
    s_nop 0
    s_waitcnt lgkmcnt(2)
    v_mfma_f32_32x32x16_bf16 v[96:111], a[56:59], v[152:155], v[96:111]
    ds_read_b128 v[132:135], v6 offset:17408
    v_add_f32 v170, 1.0, v170
    v_add_f32 v171, 1.0, v171
    v_rcp_f32 v170, v170
    v_rcp_f32 v171, v171
    v_mfma_f32_32x32x16_bf16 v[112:127], a[216:219], v[152:155], v[112:127]
    s_nop 0
    v_mul_f32 v170, v170, v68
    v_mul_f32 v171, v171, v69
    s_waitcnt lgkmcnt(2)
    v_mfma_f32_32x32x16_bf16 v[96:111], a[60:63], v[156:159], v[96:111]
    ds_read_b128 v[136:139], v6 offset:18432
    v_cvt_pk_bf16_f32 v168, v170, v171
    v_lshlrev_b32 v170, 16, v168
    v_and_b32 v171, 0xffff0000, v168
    v_mul_f32 v170, v170, v84
    v_mfma_f32_32x32x16_bf16 v[112:127], a[220:223], v[156:159], v[112:127]
    v_mul_f32 v171, v171, v85
    v_cvt_pk_bf16_f32 v162, v170, v171
    v_cvt_pk_bf16_f32 v169, v70, v71
    s_waitcnt lgkmcnt(2)
    v_mfma_f32_32x32x16_bf16 v[96:111], a[64:67], v[128:131], v[96:111]
    ds_read_b128 v[140:143], v6 offset:19456
    v_cvt_pk_bf16_f32 v171, v86, v87
    v_lshlrev_b32 v70, 16, v169
    v_and_b32 v71, 0xffff0000, v169
    v_lshlrev_b32 v86, 16, v171
    v_mfma_f32_32x32x16_bf16 v[112:127], a[224:227], v[128:131], v[112:127]
    v_and_b32 v87, 0xffff0000, v171
    v_mul_f32 v168, v70, v70
    v_mul_f32 v169, v71, v71
    s_waitcnt lgkmcnt(2)
    v_mfma_f32_32x32x16_bf16 v[96:111], a[68:71], v[132:135], v[96:111]
    ds_read_b128 v[144:147], v6 offset:20480
    v_mov_b32 v170, s44
    v_mov_b32 v171, s44
    v_fmac_f32 v170, s45, v168
    v_fmac_f32 v171, s45, v169
    v_mfma_f32_32x32x16_bf16 v[112:127], a[228:231], v[132:135], v[112:127]
    v_mul_f32 v170, v170, v70
    v_mul_f32 v171, v171, v71
    v_exp_f32 v170, v170
    s_waitcnt lgkmcnt(2)
    v_mfma_f32_32x32x16_bf16 v[96:111], a[72:75], v[136:139], v[96:111]
    ds_read_b128 v[148:151], v6 offset:21504
    v_exp_f32 v171, v171
    s_nop 0
    v_add_f32 v170, 1.0, v170
    v_add_f32 v171, 1.0, v171
    v_mfma_f32_32x32x16_bf16 v[112:127], a[232:235], v[136:139], v[112:127]
    v_rcp_f32 v170, v170
    v_rcp_f32 v171, v171
    s_nop 0
    s_waitcnt lgkmcnt(2)
    v_mfma_f32_32x32x16_bf16 v[96:111], a[76:79], v[140:143], v[96:111]
    ds_read_b128 v[152:155], v6 offset:22528
    v_mul_f32 v170, v170, v70
    v_mul_f32 v171, v171, v71
    v_cvt_pk_bf16_f32 v168, v170, v171
    v_lshlrev_b32 v170, 16, v168
    v_mfma_f32_32x32x16_bf16 v[112:127], a[236:239], v[140:143], v[112:127]
    v_and_b32 v171, 0xffff0000, v168
    v_mul_f32 v170, v170, v86
    v_mul_f32 v171, v171, v87
    s_waitcnt lgkmcnt(2)
    v_mfma_f32_32x32x16_bf16 v[96:111], a[80:83], v[144:147], v[96:111]
    ds_read_b128 v[156:159], v6 offset:23552
    v_cvt_pk_bf16_f32 v163, v170, v171
    buffer_store_dwordx4 v[160:163], v4, s[12:15], s38 offen offset:0 sc1
    v_cvt_pk_bf16_f32 v169, v72, v73
    v_cvt_pk_bf16_f32 v171, v88, v89
    v_mfma_f32_32x32x16_bf16 v[112:127], a[240:243], v[144:147], v[112:127]
    v_lshlrev_b32 v72, 16, v169
    v_and_b32 v73, 0xffff0000, v169
    v_lshlrev_b32 v88, 16, v171
    s_waitcnt lgkmcnt(2)
    v_mfma_f32_32x32x16_bf16 v[96:111], a[84:87], v[148:151], v[96:111]
    ds_read_b128 v[128:131], v6 offset:24576
    v_and_b32 v89, 0xffff0000, v171
    v_mul_f32 v168, v72, v72
    v_mul_f32 v169, v73, v73
    v_mov_b32 v170, s44
    v_mfma_f32_32x32x16_bf16 v[112:127], a[244:247], v[148:151], v[112:127]
    v_mov_b32 v171, s44
    v_fmac_f32 v170, s45, v168
    v_fmac_f32 v171, s45, v169
    s_waitcnt lgkmcnt(2)
    v_mfma_f32_32x32x16_bf16 v[96:111], a[88:91], v[152:155], v[96:111]
    ds_read_b128 v[132:135], v6 offset:25600
    v_mul_f32 v170, v170, v72
    v_mul_f32 v171, v171, v73
    v_exp_f32 v170, v170
    v_exp_f32 v171, v171
    v_mfma_f32_32x32x16_bf16 v[112:127], a[248:251], v[152:155], v[112:127]
    s_nop 0
    v_add_f32 v170, 1.0, v170
    v_add_f32 v171, 1.0, v171
    s_waitcnt vmcnt(1)
    s_barrier
    s_add_u32 s49, s49, 1
    s_cmp_lt_u32 s49, s31
    s_cselect_b32 s27, 40960, 0
    s_add_u32 s39, s39, s27
    s_max_u32 s61, s30, 1
    s_sub_u32 s61, s61, 1
    v_mov_b32 v9, s61
    s_mov_b64 exec, 1
    buffer_store_dword v9, v8, s[12:15], 0 offen sc1
    s_mov_b64 exec, -1
    s_cmp_lg_u32 s49, 8
    s_cbranch_scc1 G1_mw7d
    v_min_u32 v10, 35, v1
    v_lshlrev_b32 v10, 7, v10
    s_add_u32 s59, s62, 2080768
    v_add_u32 v10, s59, v10
    s_mov_b32 s58, 0
G1_mw7:
    buffer_load_dword v11, v10, s[12:15], 0 offen sc1
    s_waitcnt vmcnt(0)
    v_cmp_eq_u32 vcc, 0, v11
    s_cbranch_vccz G1_mw7d
    s_sleep 4
    s_add_u32 s58, s58, 1
    s_cmp_lt_u32 s58, 0x200000
    s_cbranch_scc1 G1_mw7
G1_mw7d:
    s_cmp_lg_u32 s49, 36
    s_cbranch_scc1 G1_mw8d
    v_min_u32 v10, 63, v1
    v_lshlrev_b32 v10, 7, v10
    s_add_u32 s59, s62, 2080768
    v_add_u32 v10, s59, v10
    s_mov_b32 s58, 0
G1_mw8:
    buffer_load_dword v11, v10, s[12:15], 0 offen sc1
    s_waitcnt vmcnt(0)
    v_cmp_eq_u32 vcc, 0, v11
    s_cbranch_vccz G1_mw8d
    s_sleep 4
    s_add_u32 s58, s58, 1
    s_cmp_lt_u32 s58, 0x200000
    s_cbranch_scc1 G1_mw8
G1_mw8d:
    s_waitcnt lgkmcnt(2)
    v_mfma_f32_32x32x16_bf16 v[96:111], a[92:95], v[156:159], v[96:111]
    ds_read_b128 v[136:139], v6 offset:26624
    v_rcp_f32 v170, v170
    v_rcp_f32 v171, v171
    s_nop 0
    v_mul_f32 v170, v170, v72
    v_mfma_f32_32x32x16_bf16 v[112:127], a[252:255], v[156:159], v[112:127]
    v_mul_f32 v171, v171, v73
    v_cvt_pk_bf16_f32 v168, v170, v171
    v_lshlrev_b32 v170, 16, v168
    s_add_u32 s41, s48, s40
    s_add_u32 s41, s41, 0
    s_add_u32 s42, s39, 0
    s_mov_b32 m0, s41
    s_nop 0
    buffer_load_dwordx4 v2, s[12:15], s42 offen offset:0 lds
    s_waitcnt lgkmcnt(2)
    v_mfma_f32_32x32x16_bf16 v[96:111], a[96:99], v[128:131], v[96:111]
    ds_read_b128 v[140:143], v6 offset:27648
    v_and_b32 v171, 0xffff0000, v168
    v_mul_f32 v170, v170, v88
    v_mul_f32 v171, v171, v89
    v_cvt_pk_bf16_f32 v164, v170, v171
    v_mfma_f32_32x32x16_bf16 v[112:127], v[192:195], v[128:131], v[112:127]
    v_cvt_pk_bf16_f32 v169, v74, v75
    v_cvt_pk_bf16_f32 v171, v90, v91
    v_lshlrev_b32 v74, 16, v169
    buffer_load_dwordx4 v2, s[12:15], s42 offen offset:1024 lds
    s_waitcnt lgkmcnt(2)
    v_mfma_f32_32x32x16_bf16 v[96:111], a[100:103], v[132:135], v[96:111]
    ds_read_b128 v[144:147], v6 offset:28672
    v_and_b32 v75, 0xffff0000, v169
    v_lshlrev_b32 v90, 16, v171
    v_and_b32 v91, 0xffff0000, v171
    v_mul_f32 v168, v74, v74
    v_mfma_f32_32x32x16_bf16 v[112:127], v[196:199], v[132:135], v[112:127]
    v_mul_f32 v169, v75, v75
    v_mov_b32 v170, s44
    v_mov_b32 v171, s44
    buffer_load_dwordx4 v2, s[12:15], s42 offen offset:2048 lds
    s_waitcnt lgkmcnt(2)
    v_mfma_f32_32x32x16_bf16 v[96:111], a[104:107], v[136:139], v[96:111]
    ds_read_b128 v[148:151], v6 offset:29696
    v_fmac_f32 v170, s45, v168
    v_fmac_f32 v171, s45, v169
    v_mul_f32 v170, v170, v74
    v_mul_f32 v171, v171, v75
    v_mfma_f32_32x32x16_bf16 v[112:127], v[200:203], v[136:139], v[112:127]
    v_exp_f32 v170, v170
    v_exp_f32 v171, v171
    s_nop 0
    buffer_load_dwordx4 v2, s[12:15], s42 offen offset:3072 lds
    s_waitcnt lgkmcnt(2)
    v_mfma_f32_32x32x16_bf16 v[96:111], a[108:111], v[140:143], v[96:111]
    ds_read_b128 v[152:155], v6 offset:30720
    v_add_f32 v170, 1.0, v170
    v_add_f32 v171, 1.0, v171
    v_rcp_f32 v170, v170
    v_rcp_f32 v171, v171
    v_mfma_f32_32x32x16_bf16 v[112:127], v[204:207], v[140:143], v[112:127]
    s_nop 0
    v_mul_f32 v170, v170, v74
    v_mul_f32 v171, v171, v75
    s_add_u32 s41, s48, s40
    s_add_u32 s41, s41, 4096
    s_add_u32 s42, s39, 4096
    s_mov_b32 m0, s41
    s_nop 0
    buffer_load_dwordx4 v2, s[12:15], s42 offen offset:0 lds
    s_waitcnt lgkmcnt(2)
    v_mfma_f32_32x32x16_bf16 v[96:111], a[112:115], v[144:147], v[96:111]
    ds_read_b128 v[156:159], v6 offset:31744
    v_cvt_pk_bf16_f32 v168, v170, v171
    v_lshlrev_b32 v170, 16, v168
    v_and_b32 v171, 0xffff0000, v168
    v_mul_f32 v170, v170, v90
    v_mfma_f32_32x32x16_bf16 v[112:127], v[208:211], v[144:147], v[112:127]
    v_mul_f32 v171, v171, v91
    v_cvt_pk_bf16_f32 v165, v170, v171
    v_cvt_pk_bf16_f32 v169, v76, v77
    buffer_load_dwordx4 v2, s[12:15], s42 offen offset:1024 lds
    s_waitcnt lgkmcnt(2)
    v_mfma_f32_32x32x16_bf16 v[96:111], a[116:119], v[148:151], v[96:111]
    ds_read_b128 v[128:131], v6 offset:32768
    v_cvt_pk_bf16_f32 v171, v92, v93
    v_lshlrev_b32 v76, 16, v169
    v_and_b32 v77, 0xffff0000, v169
    v_lshlrev_b32 v92, 16, v171
    v_mfma_f32_32x32x16_bf16 v[112:127], v[212:215], v[148:151], v[112:127]
    v_and_b32 v93, 0xffff0000, v171
    v_mul_f32 v168, v76, v76
    v_mul_f32 v169, v77, v77
    buffer_load_dwordx4 v2, s[12:15], s42 offen offset:2048 lds
    s_waitcnt lgkmcnt(2)
    v_mfma_f32_32x32x16_bf16 v[96:111], a[120:123], v[152:155], v[96:111]
    ds_read_b128 v[132:135], v6 offset:33792
    v_mov_b32 v170, s44
    v_mov_b32 v171, s44
    v_fmac_f32 v170, s45, v168
    v_fmac_f32 v171, s45, v169
    v_mfma_f32_32x32x16_bf16 v[112:127], v[216:219], v[152:155], v[112:127]
    v_mul_f32 v170, v170, v76
    v_mul_f32 v171, v171, v77
    v_exp_f32 v170, v170
    buffer_load_dwordx4 v2, s[12:15], s42 offen offset:3072 lds
    s_waitcnt lgkmcnt(2)
    v_mfma_f32_32x32x16_bf16 v[96:111], a[124:127], v[156:159], v[96:111]
    ds_read_b128 v[136:139], v6 offset:34816
    v_exp_f32 v171, v171
    s_nop 0
    v_add_f32 v170, 1.0, v170
    v_add_f32 v171, 1.0, v171
    v_mfma_f32_32x32x16_bf16 v[112:127], v[220:223], v[156:159], v[112:127]
    v_rcp_f32 v170, v170
    v_rcp_f32 v171, v171
    s_nop 0
    s_add_u32 s41, s48, s40
    s_add_u32 s41, s41, 8192
    s_add_u32 s42, s39, 8192
    s_mov_b32 m0, s41
    s_nop 0
    buffer_load_dwordx4 v2, s[12:15], s42 offen offset:0 lds
    s_waitcnt lgkmcnt(2)
    v_mfma_f32_32x32x16_bf16 v[96:111], a[128:131], v[128:131], v[96:111]
    ds_read_b128 v[140:143], v6 offset:35840
    v_mul_f32 v170, v170, v76
    v_mul_f32 v171, v171, v77
    v_cvt_pk_bf16_f32 v168, v170, v171
    v_lshlrev_b32 v170, 16, v168
    v_mfma_f32_32x32x16_bf16 v[112:127], v[224:227], v[128:131], v[112:127]
    v_and_b32 v171, 0xffff0000, v168
    v_mul_f32 v170, v170, v92
    v_mul_f32 v171, v171, v93
    buffer_load_dwordx4 v2, s[12:15], s42 offen offset:1024 lds
    s_waitcnt lgkmcnt(2)
    v_mfma_f32_32x32x16_bf16 v[96:111], a[132:135], v[132:135], v[96:111]
    ds_read_b128 v[144:147], v6 offset:36864
    v_cvt_pk_bf16_f32 v166, v170, v171
    v_cvt_pk_bf16_f32 v169, v78, v79
    v_cvt_pk_bf16_f32 v171, v94, v95
    v_lshlrev_b32 v78, 16, v169
    v_mfma_f32_32x32x16_bf16 v[112:127], v[228:231], v[132:135], v[112:127]
    v_and_b32 v79, 0xffff0000, v169
    v_lshlrev_b32 v94, 16, v171
    v_and_b32 v95, 0xffff0000, v171
    s_waitcnt lgkmcnt(2)
    v_mfma_f32_32x32x16_bf16 v[96:111], a[136:139], v[136:139], v[96:111]
    ds_read_b128 v[148:151], v6 offset:37888
    v_mul_f32 v168, v78, v78
    v_mul_f32 v169, v79, v79
    v_mov_b32 v170, s44
    v_mov_b32 v171, s44
    v_mfma_f32_32x32x16_bf16 v[112:127], v[232:235], v[136:139], v[112:127]
    v_fmac_f32 v170, s45, v168
    v_fmac_f32 v171, s45, v169
    v_mul_f32 v170, v170, v78
    s_waitcnt lgkmcnt(2)
    v_mfma_f32_32x32x16_bf16 v[96:111], a[140:143], v[140:143], v[96:111]
    ds_read_b128 v[152:155], v6 offset:38912
    v_mul_f32 v171, v171, v79
    v_exp_f32 v170, v170
    v_exp_f32 v171, v171
    s_nop 0
    v_mfma_f32_32x32x16_bf16 v[112:127], v[236:239], v[140:143], v[112:127]
    v_add_f32 v170, 1.0, v170
    v_add_f32 v171, 1.0, v171
    v_rcp_f32 v170, v170
    s_waitcnt lgkmcnt(2)
    v_mfma_f32_32x32x16_bf16 v[96:111], a[144:147], v[144:147], v[96:111]
    ds_read_b128 v[156:159], v6 offset:39936
    v_rcp_f32 v171, v171
    s_nop 0
    v_mul_f32 v170, v170, v78
    v_mul_f32 v171, v171, v79
    v_mfma_f32_32x32x16_bf16 v[112:127], v[240:243], v[144:147], v[112:127]
    v_cvt_pk_bf16_f32 v168, v170, v171
    v_lshlrev_b32 v170, 16, v168
    v_and_b32 v171, 0xffff0000, v168
    s_waitcnt lgkmcnt(2)
    v_mfma_f32_32x32x16_bf16 v[96:111], a[148:151], v[148:151], v[96:111]
    ds_read_b128 v[128:131], v7 offset:0
    v_mul_f32 v170, v170, v94
    v_mul_f32 v171, v171, v95
    v_cvt_pk_bf16_f32 v167, v170, v171
    buffer_store_dwordx4 v[164:167], v4, s[12:15], s38 offen offset:1024 sc1
    v_mfma_f32_32x32x16_bf16 v[112:127], v[244:247], v[148:151], v[112:127]
    s_waitcnt lgkmcnt(2)
    v_mfma_f32_32x32x16_bf16 v[96:111], a[152:155], v[152:155], v[96:111]
    ds_read_b128 v[132:135], v7 offset:1024
    v_mfma_f32_32x32x16_bf16 v[112:127], v[248:251], v[152:155], v[112:127]
    s_waitcnt lgkmcnt(2)
    v_mfma_f32_32x32x16_bf16 v[96:111], a[156:159], v[156:159], v[96:111]
    ds_read_b128 v[136:139], v7 offset:2048
    v_mfma_f32_32x32x16_bf16 v[112:127], v[252:255], v[156:159], v[112:127]
    s_mov_b32 s38, s36
    s_add_u32 s36, s36, s37
    s_mov_b32 s27, s46
    s_mov_b32 s46, s47
    s_mov_b32 s47, s48
    s_mov_b32 s48, s27
    v_mov_b32 v6, v7
    v_add_u32 v7, s47, v3
    s_add_u32 s30, s30, 1
    s_cmp_ge_u32 s30, s31
    s_cbranch_scc0 G1_gu
    s_nop 15
    v_cvt_pk_bf16_f32 v169, v96, v97
    v_cvt_pk_bf16_f32 v171, v112, v113
    v_lshlrev_b32 v96, 16, v169
    v_and_b32 v97, 0xffff0000, v169
    v_lshlrev_b32 v112, 16, v171
    v_and_b32 v113, 0xffff0000, v171
    v_mul_f32 v168, v96, v96
    v_mul_f32 v169, v97, v97
    v_mov_b32 v170, s44
    v_mov_b32 v171, s44
    v_fmac_f32 v170, s45, v168
    v_fmac_f32 v171, s45, v169
    v_mul_f32 v170, v170, v96
    v_mul_f32 v171, v171, v97
    v_exp_f32 v170, v170
    v_exp_f32 v171, v171
    s_nop 0
    v_add_f32 v170, 1.0, v170
    v_add_f32 v171, 1.0, v171
    v_rcp_f32 v170, v170
    v_rcp_f32 v171, v171
    s_nop 0
    v_mul_f32 v170, v170, v96
    v_mul_f32 v171, v171, v97
    v_cvt_pk_bf16_f32 v168, v170, v171
    v_lshlrev_b32 v170, 16, v168
    v_and_b32 v171, 0xffff0000, v168
    v_mul_f32 v170, v170, v112
    v_mul_f32 v171, v171, v113
    v_cvt_pk_bf16_f32 v160, v170, v171
    v_cvt_pk_bf16_f32 v169, v98, v99
    v_cvt_pk_bf16_f32 v171, v114, v115
    v_lshlrev_b32 v98, 16, v169
    v_and_b32 v99, 0xffff0000, v169
    v_lshlrev_b32 v114, 16, v171
    v_and_b32 v115, 0xffff0000, v171
    v_mul_f32 v168, v98, v98
    v_mul_f32 v169, v99, v99
    v_mov_b32 v170, s44
    v_mov_b32 v171, s44
    v_fmac_f32 v170, s45, v168
    v_fmac_f32 v171, s45, v169
    v_mul_f32 v170, v170, v98
    v_mul_f32 v171, v171, v99
    v_exp_f32 v170, v170
    v_exp_f32 v171, v171
    s_nop 0
    v_add_f32 v170, 1.0, v170
    v_add_f32 v171, 1.0, v171
    v_rcp_f32 v170, v170
    v_rcp_f32 v171, v171
    s_nop 0
    v_mul_f32 v170, v170, v98
    v_mul_f32 v171, v171, v99
    v_cvt_pk_bf16_f32 v168, v170, v171
    v_lshlrev_b32 v170, 16, v168
    v_and_b32 v171, 0xffff0000, v168
    v_mul_f32 v170, v170, v114
    v_mul_f32 v171, v171, v115
    v_cvt_pk_bf16_f32 v161, v170, v171
    v_cvt_pk_bf16_f32 v169, v100, v101
    v_cvt_pk_bf16_f32 v171, v116, v117
    v_lshlrev_b32 v100, 16, v169
    v_and_b32 v101, 0xffff0000, v169
    v_lshlrev_b32 v116, 16, v171
    v_and_b32 v117, 0xffff0000, v171
    v_mul_f32 v168, v100, v100
    v_mul_f32 v169, v101, v101
    v_mov_b32 v170, s44
    v_mov_b32 v171, s44
    v_fmac_f32 v170, s45, v168
    v_fmac_f32 v171, s45, v169
    v_mul_f32 v170, v170, v100
    v_mul_f32 v171, v171, v101
    v_exp_f32 v170, v170
    v_exp_f32 v171, v171
    s_nop 0
    v_add_f32 v170, 1.0, v170
    v_add_f32 v171, 1.0, v171
    v_rcp_f32 v170, v170
    v_rcp_f32 v171, v171
    s_nop 0
    v_mul_f32 v170, v170, v100
    v_mul_f32 v171, v171, v101
    v_cvt_pk_bf16_f32 v168, v170, v171
    v_lshlrev_b32 v170, 16, v168
    v_and_b32 v171, 0xffff0000, v168
    v_mul_f32 v170, v170, v116
    v_mul_f32 v171, v171, v117
    v_cvt_pk_bf16_f32 v162, v170, v171
    v_cvt_pk_bf16_f32 v169, v102, v103
    v_cvt_pk_bf16_f32 v171, v118, v119
    v_lshlrev_b32 v102, 16, v169
    v_and_b32 v103, 0xffff0000, v169
    v_lshlrev_b32 v118, 16, v171
    v_and_b32 v119, 0xffff0000, v171
    v_mul_f32 v168, v102, v102
    v_mul_f32 v169, v103, v103
    v_mov_b32 v170, s44
    v_mov_b32 v171, s44
    v_fmac_f32 v170, s45, v168
    v_fmac_f32 v171, s45, v169
    v_mul_f32 v170, v170, v102
    v_mul_f32 v171, v171, v103
    v_exp_f32 v170, v170
    v_exp_f32 v171, v171
    s_nop 0
    v_add_f32 v170, 1.0, v170
    v_add_f32 v171, 1.0, v171
    v_rcp_f32 v170, v170
    v_rcp_f32 v171, v171
    s_nop 0
    v_mul_f32 v170, v170, v102
    v_mul_f32 v171, v171, v103
    v_cvt_pk_bf16_f32 v168, v170, v171
    v_lshlrev_b32 v170, 16, v168
    v_and_b32 v171, 0xffff0000, v168
    v_mul_f32 v170, v170, v118
    v_mul_f32 v171, v171, v119
    v_cvt_pk_bf16_f32 v163, v170, v171
    buffer_store_dwordx4 v[160:163], v4, s[12:15], s38 offen offset:0 sc1
    v_cvt_pk_bf16_f32 v169, v104, v105
    v_cvt_pk_bf16_f32 v171, v120, v121
    v_lshlrev_b32 v104, 16, v169
    v_and_b32 v105, 0xffff0000, v169
    v_lshlrev_b32 v120, 16, v171
    v_and_b32 v121, 0xffff0000, v171
    v_mul_f32 v168, v104, v104
    v_mul_f32 v169, v105, v105
    v_mov_b32 v170, s44
    v_mov_b32 v171, s44
    v_fmac_f32 v170, s45, v168
    v_fmac_f32 v171, s45, v169
    v_mul_f32 v170, v170, v104
    v_mul_f32 v171, v171, v105
    v_exp_f32 v170, v170
    v_exp_f32 v171, v171
    s_nop 0
    v_add_f32 v170, 1.0, v170
    v_add_f32 v171, 1.0, v171
    v_rcp_f32 v170, v170
    v_rcp_f32 v171, v171
    s_nop 0
    v_mul_f32 v170, v170, v104
    v_mul_f32 v171, v171, v105
    v_cvt_pk_bf16_f32 v168, v170, v171
    v_lshlrev_b32 v170, 16, v168
    v_and_b32 v171, 0xffff0000, v168
    v_mul_f32 v170, v170, v120
    v_mul_f32 v171, v171, v121
    v_cvt_pk_bf16_f32 v164, v170, v171
    v_cvt_pk_bf16_f32 v169, v106, v107
    v_cvt_pk_bf16_f32 v171, v122, v123
    v_lshlrev_b32 v106, 16, v169
    v_and_b32 v107, 0xffff0000, v169
    v_lshlrev_b32 v122, 16, v171
    v_and_b32 v123, 0xffff0000, v171
    v_mul_f32 v168, v106, v106
    v_mul_f32 v169, v107, v107
    v_mov_b32 v170, s44
    v_mov_b32 v171, s44
    v_fmac_f32 v170, s45, v168
    v_fmac_f32 v171, s45, v169
    v_mul_f32 v170, v170, v106
    v_mul_f32 v171, v171, v107
    v_exp_f32 v170, v170
    v_exp_f32 v171, v171
    s_nop 0
    v_add_f32 v170, 1.0, v170
    v_add_f32 v171, 1.0, v171
    v_rcp_f32 v170, v170
    v_rcp_f32 v171, v171
    s_nop 0
    v_mul_f32 v170, v170, v106
    v_mul_f32 v171, v171, v107
    v_cvt_pk_bf16_f32 v168, v170, v171
    v_lshlrev_b32 v170, 16, v168
    v_and_b32 v171, 0xffff0000, v168
    v_mul_f32 v170, v170, v122
    v_mul_f32 v171, v171, v123
    v_cvt_pk_bf16_f32 v165, v170, v171
    v_cvt_pk_bf16_f32 v169, v108, v109
    v_cvt_pk_bf16_f32 v171, v124, v125
    v_lshlrev_b32 v108, 16, v169
    v_and_b32 v109, 0xffff0000, v169
    v_lshlrev_b32 v124, 16, v171
    v_and_b32 v125, 0xffff0000, v171
    v_mul_f32 v168, v108, v108
    v_mul_f32 v169, v109, v109
    v_mov_b32 v170, s44
    v_mov_b32 v171, s44
    v_fmac_f32 v170, s45, v168
    v_fmac_f32 v171, s45, v169
    v_mul_f32 v170, v170, v108
    v_mul_f32 v171, v171, v109
    v_exp_f32 v170, v170
    v_exp_f32 v171, v171
    s_nop 0
    v_add_f32 v170, 1.0, v170
    v_add_f32 v171, 1.0, v171
    v_rcp_f32 v170, v170
    v_rcp_f32 v171, v171
    s_nop 0
    v_mul_f32 v170, v170, v108
    v_mul_f32 v171, v171, v109
    v_cvt_pk_bf16_f32 v168, v170, v171
    v_lshlrev_b32 v170, 16, v168
    v_and_b32 v171, 0xffff0000, v168
    v_mul_f32 v170, v170, v124
    v_mul_f32 v171, v171, v125
    v_cvt_pk_bf16_f32 v166, v170, v171
    v_cvt_pk_bf16_f32 v169, v110, v111
    v_cvt_pk_bf16_f32 v171, v126, v127
    v_lshlrev_b32 v110, 16, v169
    v_and_b32 v111, 0xffff0000, v169
    v_lshlrev_b32 v126, 16, v171
    v_and_b32 v127, 0xffff0000, v171
    v_mul_f32 v168, v110, v110
    v_mul_f32 v169, v111, v111
    v_mov_b32 v170, s44
    v_mov_b32 v171, s44
    v_fmac_f32 v170, s45, v168
    v_fmac_f32 v171, s45, v169
    v_mul_f32 v170, v170, v110
    v_mul_f32 v171, v171, v111
    v_exp_f32 v170, v170
    v_exp_f32 v171, v171
    s_nop 0
    v_add_f32 v170, 1.0, v170
    v_add_f32 v171, 1.0, v171
    v_rcp_f32 v170, v170
    v_rcp_f32 v171, v171
    s_nop 0
    v_mul_f32 v170, v170, v110
    v_mul_f32 v171, v171, v111
    v_cvt_pk_bf16_f32 v168, v170, v171
    v_lshlrev_b32 v170, 16, v168
    v_and_b32 v171, 0xffff0000, v168
    v_mul_f32 v170, v170, v126
    v_mul_f32 v171, v171, v127
    v_cvt_pk_bf16_f32 v167, v170, v171
    buffer_store_dwordx4 v[164:167], v4, s[12:15], s38 offen offset:1024 sc1
    s_branch G1_fin
G1_gu_f0:
    s_nop 15
    v_cvt_pk_bf16_f32 v169, v64, v65
    v_cvt_pk_bf16_f32 v171, v80, v81
    v_lshlrev_b32 v64, 16, v169
    v_and_b32 v65, 0xffff0000, v169
    v_lshlrev_b32 v80, 16, v171
    v_and_b32 v81, 0xffff0000, v171
    v_mul_f32 v168, v64, v64
    v_mul_f32 v169, v65, v65
    v_mov_b32 v170, s44
    v_mov_b32 v171, s44
    v_fmac_f32 v170, s45, v168
    v_fmac_f32 v171, s45, v169
    v_mul_f32 v170, v170, v64
    v_mul_f32 v171, v171, v65
    v_exp_f32 v170, v170
    v_exp_f32 v171, v171
    s_nop 0
    v_add_f32 v170, 1.0, v170
    v_add_f32 v171, 1.0, v171
    v_rcp_f32 v170, v170
    v_rcp_f32 v171, v171
    s_nop 0
    v_mul_f32 v170, v170, v64
    v_mul_f32 v171, v171, v65
    v_cvt_pk_bf16_f32 v168, v170, v171
    v_lshlrev_b32 v170, 16, v168
    v_and_b32 v171, 0xffff0000, v168
    v_mul_f32 v170, v170, v80
    v_mul_f32 v171, v171, v81
    v_cvt_pk_bf16_f32 v160, v170, v171
    v_cvt_pk_bf16_f32 v169, v66, v67
    v_cvt_pk_bf16_f32 v171, v82, v83
    v_lshlrev_b32 v66, 16, v169
    v_and_b32 v67, 0xffff0000, v169
    v_lshlrev_b32 v82, 16, v171
    v_and_b32 v83, 0xffff0000, v171
    v_mul_f32 v168, v66, v66
    v_mul_f32 v169, v67, v67
    v_mov_b32 v170, s44
    v_mov_b32 v171, s44
    v_fmac_f32 v170, s45, v168
    v_fmac_f32 v171, s45, v169
    v_mul_f32 v170, v170, v66
    v_mul_f32 v171, v171, v67
    v_exp_f32 v170, v170
    v_exp_f32 v171, v171
    s_nop 0
    v_add_f32 v170, 1.0, v170
    v_add_f32 v171, 1.0, v171
    v_rcp_f32 v170, v170
    v_rcp_f32 v171, v171
    s_nop 0
    v_mul_f32 v170, v170, v66
    v_mul_f32 v171, v171, v67
    v_cvt_pk_bf16_f32 v168, v170, v171
    v_lshlrev_b32 v170, 16, v168
    v_and_b32 v171, 0xffff0000, v168
    v_mul_f32 v170, v170, v82
    v_mul_f32 v171, v171, v83
    v_cvt_pk_bf16_f32 v161, v170, v171
    v_cvt_pk_bf16_f32 v169, v68, v69
    v_cvt_pk_bf16_f32 v171, v84, v85
    v_lshlrev_b32 v68, 16, v169
    v_and_b32 v69, 0xffff0000, v169
    v_lshlrev_b32 v84, 16, v171
    v_and_b32 v85, 0xffff0000, v171
    v_mul_f32 v168, v68, v68
    v_mul_f32 v169, v69, v69
    v_mov_b32 v170, s44
    v_mov_b32 v171, s44
    v_fmac_f32 v170, s45, v168
    v_fmac_f32 v171, s45, v169
    v_mul_f32 v170, v170, v68
    v_mul_f32 v171, v171, v69
    v_exp_f32 v170, v170
    v_exp_f32 v171, v171
    s_nop 0
    v_add_f32 v170, 1.0, v170
    v_add_f32 v171, 1.0, v171
    v_rcp_f32 v170, v170
    v_rcp_f32 v171, v171
    s_nop 0
    v_mul_f32 v170, v170, v68
    v_mul_f32 v171, v171, v69
    v_cvt_pk_bf16_f32 v168, v170, v171
    v_lshlrev_b32 v170, 16, v168
    v_and_b32 v171, 0xffff0000, v168
    v_mul_f32 v170, v170, v84
    v_mul_f32 v171, v171, v85
    v_cvt_pk_bf16_f32 v162, v170, v171
    v_cvt_pk_bf16_f32 v169, v70, v71
    v_cvt_pk_bf16_f32 v171, v86, v87
    v_lshlrev_b32 v70, 16, v169
    v_and_b32 v71, 0xffff0000, v169
    v_lshlrev_b32 v86, 16, v171
    v_and_b32 v87, 0xffff0000, v171
    v_mul_f32 v168, v70, v70
    v_mul_f32 v169, v71, v71
    v_mov_b32 v170, s44
    v_mov_b32 v171, s44
    v_fmac_f32 v170, s45, v168
    v_fmac_f32 v171, s45, v169
    v_mul_f32 v170, v170, v70
    v_mul_f32 v171, v171, v71
    v_exp_f32 v170, v170
    v_exp_f32 v171, v171
    s_nop 0
    v_add_f32 v170, 1.0, v170
    v_add_f32 v171, 1.0, v171
    v_rcp_f32 v170, v170
    v_rcp_f32 v171, v171
    s_nop 0
    v_mul_f32 v170, v170, v70
    v_mul_f32 v171, v171, v71
    v_cvt_pk_bf16_f32 v168, v170, v171
    v_lshlrev_b32 v170, 16, v168
    v_and_b32 v171, 0xffff0000, v168
    v_mul_f32 v170, v170, v86
    v_mul_f32 v171, v171, v87
    v_cvt_pk_bf16_f32 v163, v170, v171
    buffer_store_dwordx4 v[160:163], v4, s[12:15], s38 offen offset:0 sc1
    v_cvt_pk_bf16_f32 v169, v72, v73
    v_cvt_pk_bf16_f32 v171, v88, v89
    v_lshlrev_b32 v72, 16, v169
    v_and_b32 v73, 0xffff0000, v169
    v_lshlrev_b32 v88, 16, v171
    v_and_b32 v89, 0xffff0000, v171
    v_mul_f32 v168, v72, v72
    v_mul_f32 v169, v73, v73
    v_mov_b32 v170, s44
    v_mov_b32 v171, s44
    v_fmac_f32 v170, s45, v168
    v_fmac_f32 v171, s45, v169
    v_mul_f32 v170, v170, v72
    v_mul_f32 v171, v171, v73
    v_exp_f32 v170, v170
    v_exp_f32 v171, v171
    s_nop 0
    v_add_f32 v170, 1.0, v170
    v_add_f32 v171, 1.0, v171
    v_rcp_f32 v170, v170
    v_rcp_f32 v171, v171
    s_nop 0
    v_mul_f32 v170, v170, v72
    v_mul_f32 v171, v171, v73
    v_cvt_pk_bf16_f32 v168, v170, v171
    v_lshlrev_b32 v170, 16, v168
    v_and_b32 v171, 0xffff0000, v168
    v_mul_f32 v170, v170, v88
    v_mul_f32 v171, v171, v89
    v_cvt_pk_bf16_f32 v164, v170, v171
    v_cvt_pk_bf16_f32 v169, v74, v75
    v_cvt_pk_bf16_f32 v171, v90, v91
    v_lshlrev_b32 v74, 16, v169
    v_and_b32 v75, 0xffff0000, v169
    v_lshlrev_b32 v90, 16, v171
    v_and_b32 v91, 0xffff0000, v171
    v_mul_f32 v168, v74, v74
    v_mul_f32 v169, v75, v75
    v_mov_b32 v170, s44
    v_mov_b32 v171, s44
    v_fmac_f32 v170, s45, v168
    v_fmac_f32 v171, s45, v169
    v_mul_f32 v170, v170, v74
    v_mul_f32 v171, v171, v75
    v_exp_f32 v170, v170
    v_exp_f32 v171, v171
    s_nop 0
    v_add_f32 v170, 1.0, v170
    v_add_f32 v171, 1.0, v171
    v_rcp_f32 v170, v170
    v_rcp_f32 v171, v171
    s_nop 0
    v_mul_f32 v170, v170, v74
    v_mul_f32 v171, v171, v75
    v_cvt_pk_bf16_f32 v168, v170, v171
    v_lshlrev_b32 v170, 16, v168
    v_and_b32 v171, 0xffff0000, v168
    v_mul_f32 v170, v170, v90
    v_mul_f32 v171, v171, v91
    v_cvt_pk_bf16_f32 v165, v170, v171
    v_cvt_pk_bf16_f32 v169, v76, v77
    v_cvt_pk_bf16_f32 v171, v92, v93
    v_lshlrev_b32 v76, 16, v169
    v_and_b32 v77, 0xffff0000, v169
    v_lshlrev_b32 v92, 16, v171
    v_and_b32 v93, 0xffff0000, v171
    v_mul_f32 v168, v76, v76
    v_mul_f32 v169, v77, v77
    v_mov_b32 v170, s44
    v_mov_b32 v171, s44
    v_fmac_f32 v170, s45, v168
    v_fmac_f32 v171, s45, v169
    v_mul_f32 v170, v170, v76
    v_mul_f32 v171, v171, v77
    v_exp_f32 v170, v170
    v_exp_f32 v171, v171
    s_nop 0
    v_add_f32 v170, 1.0, v170
    v_add_f32 v171, 1.0, v171
    v_rcp_f32 v170, v170
    v_rcp_f32 v171, v171
    s_nop 0
    v_mul_f32 v170, v170, v76
    v_mul_f32 v171, v171, v77
    v_cvt_pk_bf16_f32 v168, v170, v171
    v_lshlrev_b32 v170, 16, v168
    v_and_b32 v171, 0xffff0000, v168
    v_mul_f32 v170, v170, v92
    v_mul_f32 v171, v171, v93
    v_cvt_pk_bf16_f32 v166, v170, v171
    v_cvt_pk_bf16_f32 v169, v78, v79
    v_cvt_pk_bf16_f32 v171, v94, v95
    v_lshlrev_b32 v78, 16, v169
    v_and_b32 v79, 0xffff0000, v169
    v_lshlrev_b32 v94, 16, v171
    v_and_b32 v95, 0xffff0000, v171
    v_mul_f32 v168, v78, v78
    v_mul_f32 v169, v79, v79
    v_mov_b32 v170, s44
    v_mov_b32 v171, s44
    v_fmac_f32 v170, s45, v168
    v_fmac_f32 v171, s45, v169
    v_mul_f32 v170, v170, v78
    v_mul_f32 v171, v171, v79
    v_exp_f32 v170, v170
    v_exp_f32 v171, v171
    s_nop 0
    v_add_f32 v170, 1.0, v170
    v_add_f32 v171, 1.0, v171
    v_rcp_f32 v170, v170
    v_rcp_f32 v171, v171
    s_nop 0
    v_mul_f32 v170, v170, v78
    v_mul_f32 v171, v171, v79
    v_cvt_pk_bf16_f32 v168, v170, v171
    v_lshlrev_b32 v170, 16, v168
    v_and_b32 v171, 0xffff0000, v168
    v_mul_f32 v170, v170, v94
    v_mul_f32 v171, v171, v95
    v_cvt_pk_bf16_f32 v167, v170, v171
    buffer_store_dwordx4 v[164:167], v4, s[12:15], s38 offen offset:1024 sc1
    s_branch G1_fin
G1_fin:
    s_waitcnt vmcnt(0)
    v_mov_b32 v9, 64
    s_mov_b64 exec, 1
    buffer_store_dword v9, v8, s[12:15], 0 offen sc1
    s_mov_b64 exec, -1
    s_waitcnt vmcnt(0)
    s_branch M_post
M_y:
    s_cmp_ge_u32 s10, 29
    s_cbranch_scc1 M_init
    s_sub_u32 s63, s8, 4
    s_lshl_b32 s63, s63, 3
    s_add_u32 s63, s63, s10
    s_sub_u32 s63, s63, 21
    s_load_dwordx2 s[4:5], s[0:1], 96
    s_waitcnt lgkmcnt(0)
    s_mov_b32 s20, s4
    s_and_b32 s21, s5, 0xffff
    s_mov_b32 s22, 0x100
    s_mov_b32 s23, 0x00020000
    s_mov_b32 s30, s63
    s_load_dwordx2 s[16:17], s[0:1], 40
    s_waitcnt lgkmcnt(0)
    s_and_b32 s17, s17, 0xffff
    s_mov_b32 s18, 0x780000
    s_mov_b32 s19, 0x00020000
    v_lshrrev_b32 v3, 5, v1
    v_and_b32 v8, 15, v1
    v_lshrrev_b32 v8, 2, v8
    v_lshl_add_u32 v8, v3, 2, v8
    v_mul_u32_u24 v10, 320, v8
    v_bfe_u32 v8, v1, 4, 1
    v_lshl_add_u32 v10, v8, 5, v10
    v_and_b32 v8, 3, v1
    v_lshl_add_u32 v10, v8, 3, v10
    s_mul_i32 s33, s9, 30720
    v_add_u32 v10, s33, v10
    s_mul_i32 s36, s30, 245760
    s_mul_i32 s37, s9, 320
    s_add_u32 s36, s36, s37
    v_add_u32 v7, 0, v1
    v_mul_u32_u24 v8, 3277, v7
    v_lshrrev_b32 v8, 16, v8
    v_mul_u32_u24 v9, 20, v8
    v_sub_u32 v9, v7, v9
    v_mul_u32_u24 v8, 1280, v8
    v_lshl_add_u32 v16, v9, 4, v8
    v_add_u32 v7, 64, v1
    v_mul_u32_u24 v8, 3277, v7
    v_lshrrev_b32 v8, 16, v8
    v_mul_u32_u24 v9, 20, v8
    v_sub_u32 v9, v7, v9
    v_mul_u32_u24 v8, 1280, v8
    v_lshl_add_u32 v17, v9, 4, v8
    v_add_u32 v7, 128, v1
    v_mul_u32_u24 v8, 3277, v7
    v_lshrrev_b32 v8, 16, v8
    v_mul_u32_u24 v9, 20, v8
    v_sub_u32 v9, v7, v9
    v_mul_u32_u24 v8, 1280, v8
    v_lshl_add_u32 v18, v9, 4, v8
    v_add_u32 v7, 192, v1
    v_mul_u32_u24 v8, 3277, v7
    v_lshrrev_b32 v8, 16, v8
    v_mul_u32_u24 v9, 20, v8
    v_sub_u32 v9, v7, v9
    v_mul_u32_u24 v8, 1280, v8
    v_lshl_add_u32 v19, v9, 4, v8
    v_add_u32 v7, 256, v1
    v_mul_u32_u24 v8, 3277, v7
    v_lshrrev_b32 v8, 16, v8
    v_mul_u32_u24 v9, 20, v8
    v_sub_u32 v9, v7, v9
    v_mul_u32_u24 v8, 1280, v8
    v_lshl_add_u32 v20, v9, 4, v8
    v_add_u32 v7, 320, v1
    v_mul_u32_u24 v8, 3277, v7
    v_lshrrev_b32 v8, 16, v8
    v_mul_u32_u24 v9, 20, v8
    v_sub_u32 v9, v7, v9
    v_mul_u32_u24 v8, 1280, v8
    v_lshl_add_u32 v21, v9, 4, v8
    v_add_u32 v7, 384, v1
    v_mul_u32_u24 v8, 3277, v7
    v_lshrrev_b32 v8, 16, v8
    v_mul_u32_u24 v9, 20, v8
    v_sub_u32 v9, v7, v9
    v_mul_u32_u24 v8, 1280, v8
    v_lshl_add_u32 v22, v9, 4, v8
    v_add_u32 v7, 448, v1
    v_mul_u32_u24 v8, 3277, v7
    v_lshrrev_b32 v8, 16, v8
    v_mul_u32_u24 v9, 20, v8
    v_sub_u32 v9, v7, v9
    v_mul_u32_u24 v8, 1280, v8
    v_lshl_add_u32 v23, v9, 4, v8
    v_add_u32 v7, 512, v1
    v_mul_u32_u24 v8, 3277, v7
    v_lshrrev_b32 v8, 16, v8
    v_mul_u32_u24 v9, 20, v8
    v_sub_u32 v9, v7, v9
    v_mul_u32_u24 v8, 1280, v8
    v_lshl_add_u32 v24, v9, 4, v8
    v_add_u32 v7, 576, v1
    v_mul_u32_u24 v8, 3277, v7
    v_lshrrev_b32 v8, 16, v8
    v_mul_u32_u24 v9, 20, v8
    v_sub_u32 v9, v7, v9
    v_mul_u32_u24 v8, 1280, v8
    v_lshl_add_u32 v25, v9, 4, v8
    v_add_u32 v7, 640, v1
    v_mul_u32_u24 v8, 3277, v7
    v_lshrrev_b32 v8, 16, v8
    v_mul_u32_u24 v9, 20, v8
    v_sub_u32 v9, v7, v9
    v_mul_u32_u24 v8, 1280, v8
    v_lshl_add_u32 v26, v9, 4, v8
    v_add_u32 v7, 704, v1
    v_mul_u32_u24 v8, 3277, v7
    v_lshrrev_b32 v8, 16, v8
    v_mul_u32_u24 v9, 20, v8
    v_sub_u32 v9, v7, v9
    v_mul_u32_u24 v8, 1280, v8
    v_lshl_add_u32 v27, v9, 4, v8
    v_add_u32 v7, 768, v1
    v_mul_u32_u24 v8, 3277, v7
    v_lshrrev_b32 v8, 16, v8
    v_mul_u32_u24 v9, 20, v8
    v_sub_u32 v9, v7, v9
    v_mul_u32_u24 v8, 1280, v8
    v_lshl_add_u32 v28, v9, 4, v8
    v_add_u32 v7, 832, v1
    v_mul_u32_u24 v8, 3277, v7
    v_lshrrev_b32 v8, 16, v8
    v_mul_u32_u24 v9, 20, v8
    v_sub_u32 v9, v7, v9
    v_mul_u32_u24 v8, 1280, v8
    v_lshl_add_u32 v29, v9, 4, v8
    v_add_u32 v7, 896, v1
    v_mul_u32_u24 v8, 3277, v7
    v_lshrrev_b32 v8, 16, v8
    v_mul_u32_u24 v9, 20, v8
    v_sub_u32 v9, v7, v9
    v_mul_u32_u24 v8, 1280, v8
    v_lshl_add_u32 v30, v9, 4, v8
    s_add_u32 s34, s33, 0
    s_mov_b32 m0, s34
    s_nop 0
    buffer_load_dwordx4 v16, s[16:19], s36 offen lds
    s_add_u32 s34, s33, 1024
    s_mov_b32 m0, s34
    s_nop 0
    buffer_load_dwordx4 v17, s[16:19], s36 offen lds
    s_add_u32 s34, s33, 2048
    s_mov_b32 m0, s34
    s_nop 0
    buffer_load_dwordx4 v18, s[16:19], s36 offen lds
    s_add_u32 s34, s33, 3072
    s_mov_b32 m0, s34
    s_nop 0
    buffer_load_dwordx4 v19, s[16:19], s36 offen lds
    s_add_u32 s34, s33, 4096
    s_mov_b32 m0, s34
    s_nop 0
    buffer_load_dwordx4 v20, s[16:19], s36 offen lds
    s_add_u32 s34, s33, 5120
    s_mov_b32 m0, s34
    s_nop 0
    buffer_load_dwordx4 v21, s[16:19], s36 offen lds
    s_add_u32 s34, s33, 6144
    s_mov_b32 m0, s34
    s_nop 0
    buffer_load_dwordx4 v22, s[16:19], s36 offen lds
    s_add_u32 s34, s33, 7168
    s_mov_b32 m0, s34
    s_nop 0
    buffer_load_dwordx4 v23, s[16:19], s36 offen lds
    s_add_u32 s34, s33, 8192
    s_mov_b32 m0, s34
    s_nop 0
    buffer_load_dwordx4 v24, s[16:19], s36 offen lds
    s_add_u32 s34, s33, 9216
    s_mov_b32 m0, s34
    s_nop 0
    buffer_load_dwordx4 v25, s[16:19], s36 offen lds
    s_add_u32 s34, s33, 10240
    s_mov_b32 m0, s34
    s_nop 0
    buffer_load_dwordx4 v26, s[16:19], s36 offen lds
    s_add_u32 s34, s33, 11264
    s_mov_b32 m0, s34
    s_nop 0
    buffer_load_dwordx4 v27, s[16:19], s36 offen lds
    s_add_u32 s34, s33, 12288
    s_mov_b32 m0, s34
    s_nop 0
    buffer_load_dwordx4 v28, s[16:19], s36 offen lds
    s_add_u32 s34, s33, 13312
    s_mov_b32 m0, s34
    s_nop 0
    buffer_load_dwordx4 v29, s[16:19], s36 offen lds
    s_add_u32 s34, s33, 14336
    s_mov_b32 m0, s34
    s_nop 0
    buffer_load_dwordx4 v30, s[16:19], s36 offen lds
    s_add_u32 s36, s36, 61440
    s_add_u32 s34, s33, 15360
    s_mov_b32 m0, s34
    s_nop 0
    buffer_load_dwordx4 v16, s[16:19], s36 offen lds
    s_add_u32 s34, s33, 16384
    s_mov_b32 m0, s34
    s_nop 0
    buffer_load_dwordx4 v17, s[16:19], s36 offen lds
    s_add_u32 s34, s33, 17408
    s_mov_b32 m0, s34
    s_nop 0
    buffer_load_dwordx4 v18, s[16:19], s36 offen lds
    s_add_u32 s34, s33, 18432
    s_mov_b32 m0, s34
    s_nop 0
    buffer_load_dwordx4 v19, s[16:19], s36 offen lds
    s_add_u32 s34, s33, 19456
    s_mov_b32 m0, s34
    s_nop 0
    buffer_load_dwordx4 v20, s[16:19], s36 offen lds
    s_add_u32 s34, s33, 20480
    s_mov_b32 m0, s34
    s_nop 0
    buffer_load_dwordx4 v21, s[16:19], s36 offen lds
    s_add_u32 s34, s33, 21504
    s_mov_b32 m0, s34
    s_nop 0
    buffer_load_dwordx4 v22, s[16:19], s36 offen lds
    s_add_u32 s34, s33, 22528
    s_mov_b32 m0, s34
    s_nop 0
    buffer_load_dwordx4 v23, s[16:19], s36 offen lds
    s_add_u32 s34, s33, 23552
    s_mov_b32 m0, s34
    s_nop 0
    buffer_load_dwordx4 v24, s[16:19], s36 offen lds
    s_add_u32 s34, s33, 24576
    s_mov_b32 m0, s34
    s_nop 0
    buffer_load_dwordx4 v25, s[16:19], s36 offen lds
    s_add_u32 s34, s33, 25600
    s_mov_b32 m0, s34
    s_nop 0
    buffer_load_dwordx4 v26, s[16:19], s36 offen lds
    s_add_u32 s34, s33, 26624
    s_mov_b32 m0, s34
    s_nop 0
    buffer_load_dwordx4 v27, s[16:19], s36 offen lds
    s_add_u32 s34, s33, 27648
    s_mov_b32 m0, s34
    s_nop 0
    buffer_load_dwordx4 v28, s[16:19], s36 offen lds
    s_add_u32 s34, s33, 28672
    s_mov_b32 m0, s34
    s_nop 0
    buffer_load_dwordx4 v29, s[16:19], s36 offen lds
    s_add_u32 s34, s33, 29696
    s_mov_b32 m0, s34
    s_nop 0
    buffer_load_dwordx4 v30, s[16:19], s36 offen lds
    s_add_u32 s36, s36, 61440
    s_waitcnt vmcnt(15)
    ds_read_b64_tr_b16 a[0:1], v10 offset:0
    ds_read_b64_tr_b16 a[2:3], v10 offset:2560
    ds_read_b64_tr_b16 a[48:49], v10 offset:64
    ds_read_b64_tr_b16 a[50:51], v10 offset:2624
    ds_read_b64_tr_b16 a[96:97], v10 offset:128
    ds_read_b64_tr_b16 a[98:99], v10 offset:2688
    ds_read_b64_tr_b16 a[144:145], v10 offset:192
    ds_read_b64_tr_b16 a[146:147], v10 offset:2752
    ds_read_b64_tr_b16 a[192:193], v10 offset:256
    ds_read_b64_tr_b16 a[194:195], v10 offset:2816
    s_waitcnt lgkmcnt(0)
    ds_read_b64_tr_b16 a[4:5], v10 offset:5120
    ds_read_b64_tr_b16 a[6:7], v10 offset:7680
    ds_read_b64_tr_b16 a[52:53], v10 offset:5184
    ds_read_b64_tr_b16 a[54:55], v10 offset:7744
    ds_read_b64_tr_b16 a[100:101], v10 offset:5248
    ds_read_b64_tr_b16 a[102:103], v10 offset:7808
    ds_read_b64_tr_b16 a[148:149], v10 offset:5312
    ds_read_b64_tr_b16 a[150:151], v10 offset:7872
    ds_read_b64_tr_b16 a[196:197], v10 offset:5376
    ds_read_b64_tr_b16 a[198:199], v10 offset:7936
    s_waitcnt lgkmcnt(0)
    ds_read_b64_tr_b16 a[8:9], v10 offset:10240
    ds_read_b64_tr_b16 a[10:11], v10 offset:12800
    ds_read_b64_tr_b16 a[56:57], v10 offset:10304
    ds_read_b64_tr_b16 a[58:59], v10 offset:12864
    ds_read_b64_tr_b16 a[104:105], v10 offset:10368
    ds_read_b64_tr_b16 a[106:107], v10 offset:12928
    ds_read_b64_tr_b16 a[152:153], v10 offset:10432
    ds_read_b64_tr_b16 a[154:155], v10 offset:12992
    ds_read_b64_tr_b16 a[200:201], v10 offset:10496
    ds_read_b64_tr_b16 a[202:203], v10 offset:13056
    s_waitcnt lgkmcnt(0)
    s_add_u32 s34, s33, 0
    s_mov_b32 m0, s34
    s_nop 0
    buffer_load_dwordx4 v16, s[16:19], s36 offen lds
    s_add_u32 s34, s33, 1024
    s_mov_b32 m0, s34
    s_nop 0
    buffer_load_dwordx4 v17, s[16:19], s36 offen lds
    s_add_u32 s34, s33, 2048
    s_mov_b32 m0, s34
    s_nop 0
    buffer_load_dwordx4 v18, s[16:19], s36 offen lds
    s_add_u32 s34, s33, 3072
    s_mov_b32 m0, s34
    s_nop 0
    buffer_load_dwordx4 v19, s[16:19], s36 offen lds
    s_add_u32 s34, s33, 4096
    s_mov_b32 m0, s34
    s_nop 0
    buffer_load_dwordx4 v20, s[16:19], s36 offen lds
    s_add_u32 s34, s33, 5120
    s_mov_b32 m0, s34
    s_nop 0
    buffer_load_dwordx4 v21, s[16:19], s36 offen lds
    s_add_u32 s34, s33, 6144
    s_mov_b32 m0, s34
    s_nop 0
    buffer_load_dwordx4 v22, s[16:19], s36 offen lds
    s_add_u32 s34, s33, 7168
    s_mov_b32 m0, s34
    s_nop 0
    buffer_load_dwordx4 v23, s[16:19], s36 offen lds
    s_add_u32 s34, s33, 8192
    s_mov_b32 m0, s34
    s_nop 0
    buffer_load_dwordx4 v24, s[16:19], s36 offen lds
    s_add_u32 s34, s33, 9216
    s_mov_b32 m0, s34
    s_nop 0
    buffer_load_dwordx4 v25, s[16:19], s36 offen lds
    s_add_u32 s34, s33, 10240
    s_mov_b32 m0, s34
    s_nop 0
    buffer_load_dwordx4 v26, s[16:19], s36 offen lds
    s_add_u32 s34, s33, 11264
    s_mov_b32 m0, s34
    s_nop 0
    buffer_load_dwordx4 v27, s[16:19], s36 offen lds
    s_add_u32 s34, s33, 12288
    s_mov_b32 m0, s34
    s_nop 0
    buffer_load_dwordx4 v28, s[16:19], s36 offen lds
    s_add_u32 s34, s33, 13312
    s_mov_b32 m0, s34
    s_nop 0
    buffer_load_dwordx4 v29, s[16:19], s36 offen lds
    s_add_u32 s34, s33, 14336
    s_mov_b32 m0, s34
    s_nop 0
    buffer_load_dwordx4 v30, s[16:19], s36 offen lds
    s_add_u32 s36, s36, 61440
    s_waitcnt vmcnt(15)
    ds_read_b64_tr_b16 a[12:13], v10 offset:15360
    ds_read_b64_tr_b16 a[14:15], v10 offset:17920
    ds_read_b64_tr_b16 a[60:61], v10 offset:15424
    ds_read_b64_tr_b16 a[62:63], v10 offset:17984
    ds_read_b64_tr_b16 a[108:109], v10 offset:15488
    ds_read_b64_tr_b16 a[110:111], v10 offset:18048
    ds_read_b64_tr_b16 a[156:157], v10 offset:15552
    ds_read_b64_tr_b16 a[158:159], v10 offset:18112
    ds_read_b64_tr_b16 a[204:205], v10 offset:15616
    ds_read_b64_tr_b16 a[206:207], v10 offset:18176
    s_waitcnt lgkmcnt(0)
    ds_read_b64_tr_b16 a[16:17], v10 offset:20480
    ds_read_b64_tr_b16 a[18:19], v10 offset:23040
    ds_read_b64_tr_b16 a[64:65], v10 offset:20544
    ds_read_b64_tr_b16 a[66:67], v10 offset:23104
    ds_read_b64_tr_b16 a[112:113], v10 offset:20608
    ds_read_b64_tr_b16 a[114:115], v10 offset:23168
    ds_read_b64_tr_b16 a[160:161], v10 offset:20672
    ds_read_b64_tr_b16 a[162:163], v10 offset:23232
    ds_read_b64_tr_b16 a[208:209], v10 offset:20736
    ds_read_b64_tr_b16 a[210:211], v10 offset:23296
    s_waitcnt lgkmcnt(0)
    ds_read_b64_tr_b16 a[20:21], v10 offset:25600
    ds_read_b64_tr_b16 a[22:23], v10 offset:28160
    ds_read_b64_tr_b16 a[68:69], v10 offset:25664
    ds_read_b64_tr_b16 a[70:71], v10 offset:28224
    ds_read_b64_tr_b16 a[116:117], v10 offset:25728
    ds_read_b64_tr_b16 a[118:119], v10 offset:28288
    ds_read_b64_tr_b16 a[164:165], v10 offset:25792
    ds_read_b64_tr_b16 a[166:167], v10 offset:28352
    ds_read_b64_tr_b16 a[212:213], v10 offset:25856
    ds_read_b64_tr_b16 a[214:215], v10 offset:28416
    s_waitcnt lgkmcnt(0)
    s_add_u32 s34, s33, 15360
    s_mov_b32 m0, s34
    s_nop 0
    buffer_load_dwordx4 v16, s[16:19], s36 offen lds
    s_add_u32 s34, s33, 16384
    s_mov_b32 m0, s34
    s_nop 0
    buffer_load_dwordx4 v17, s[16:19], s36 offen lds
    s_add_u32 s34, s33, 17408
    s_mov_b32 m0, s34
    s_nop 0
    buffer_load_dwordx4 v18, s[16:19], s36 offen lds
    s_add_u32 s34, s33, 18432
    s_mov_b32 m0, s34
    s_nop 0
    buffer_load_dwordx4 v19, s[16:19], s36 offen lds
    s_add_u32 s34, s33, 19456
    s_mov_b32 m0, s34
    s_nop 0
    buffer_load_dwordx4 v20, s[16:19], s36 offen lds
    s_add_u32 s34, s33, 20480
    s_mov_b32 m0, s34
    s_nop 0
    buffer_load_dwordx4 v21, s[16:19], s36 offen lds
    s_add_u32 s34, s33, 21504
    s_mov_b32 m0, s34
    s_nop 0
    buffer_load_dwordx4 v22, s[16:19], s36 offen lds
    s_add_u32 s34, s33, 22528
    s_mov_b32 m0, s34
    s_nop 0
    buffer_load_dwordx4 v23, s[16:19], s36 offen lds
    s_add_u32 s34, s33, 23552
    s_mov_b32 m0, s34
    s_nop 0
    buffer_load_dwordx4 v24, s[16:19], s36 offen lds
    s_add_u32 s34, s33, 24576
    s_mov_b32 m0, s34
    s_nop 0
    buffer_load_dwordx4 v25, s[16:19], s36 offen lds
    s_add_u32 s34, s33, 25600
    s_mov_b32 m0, s34
    s_nop 0
    buffer_load_dwordx4 v26, s[16:19], s36 offen lds
    s_add_u32 s34, s33, 26624
    s_mov_b32 m0, s34
    s_nop 0
    buffer_load_dwordx4 v27, s[16:19], s36 offen lds
    s_add_u32 s34, s33, 27648
    s_mov_b32 m0, s34
    s_nop 0
    buffer_load_dwordx4 v28, s[16:19], s36 offen lds
    s_add_u32 s34, s33, 28672
    s_mov_b32 m0, s34
    s_nop 0
    buffer_load_dwordx4 v29, s[16:19], s36 offen lds
    s_add_u32 s34, s33, 29696
    s_mov_b32 m0, s34
    s_nop 0
    buffer_load_dwordx4 v30, s[16:19], s36 offen lds
    s_add_u32 s36, s36, 61440
    s_waitcnt vmcnt(15)
    ds_read_b64_tr_b16 a[24:25], v10 offset:0
    ds_read_b64_tr_b16 a[26:27], v10 offset:2560
    ds_read_b64_tr_b16 a[72:73], v10 offset:64
    ds_read_b64_tr_b16 a[74:75], v10 offset:2624
    ds_read_b64_tr_b16 a[120:121], v10 offset:128
    ds_read_b64_tr_b16 a[122:123], v10 offset:2688
    ds_read_b64_tr_b16 a[168:169], v10 offset:192
    ds_read_b64_tr_b16 a[170:171], v10 offset:2752
    ds_read_b64_tr_b16 a[216:217], v10 offset:256
    ds_read_b64_tr_b16 a[218:219], v10 offset:2816
    s_waitcnt lgkmcnt(0)
    ds_read_b64_tr_b16 a[28:29], v10 offset:5120
    ds_read_b64_tr_b16 a[30:31], v10 offset:7680
    ds_read_b64_tr_b16 a[76:77], v10 offset:5184
    ds_read_b64_tr_b16 a[78:79], v10 offset:7744
    ds_read_b64_tr_b16 a[124:125], v10 offset:5248
    ds_read_b64_tr_b16 a[126:127], v10 offset:7808
    ds_read_b64_tr_b16 a[172:173], v10 offset:5312
    ds_read_b64_tr_b16 a[174:175], v10 offset:7872
    ds_read_b64_tr_b16 a[220:221], v10 offset:5376
    ds_read_b64_tr_b16 a[222:223], v10 offset:7936
    s_waitcnt lgkmcnt(0)
    ds_read_b64_tr_b16 a[32:33], v10 offset:10240
    ds_read_b64_tr_b16 a[34:35], v10 offset:12800
    ds_read_b64_tr_b16 a[80:81], v10 offset:10304
    ds_read_b64_tr_b16 a[82:83], v10 offset:12864
    ds_read_b64_tr_b16 a[128:129], v10 offset:10368
    ds_read_b64_tr_b16 a[130:131], v10 offset:12928
    ds_read_b64_tr_b16 a[176:177], v10 offset:10432
    ds_read_b64_tr_b16 a[178:179], v10 offset:12992
    ds_read_b64_tr_b16 a[224:225], v10 offset:10496
    ds_read_b64_tr_b16 a[226:227], v10 offset:13056
    s_waitcnt lgkmcnt(0)
    s_waitcnt vmcnt(0)
    ds_read_b64_tr_b16 a[36:37], v10 offset:15360
    ds_read_b64_tr_b16 a[38:39], v10 offset:17920
    ds_read_b64_tr_b16 a[84:85], v10 offset:15424
    ds_read_b64_tr_b16 a[86:87], v10 offset:17984
    ds_read_b64_tr_b16 a[132:133], v10 offset:15488
    ds_read_b64_tr_b16 a[134:135], v10 offset:18048
    ds_read_b64_tr_b16 a[180:181], v10 offset:15552
    ds_read_b64_tr_b16 a[182:183], v10 offset:18112
    ds_read_b64_tr_b16 a[228:229], v10 offset:15616
    ds_read_b64_tr_b16 a[230:231], v10 offset:18176
    s_waitcnt lgkmcnt(0)
    ds_read_b64_tr_b16 a[40:41], v10 offset:20480
    ds_read_b64_tr_b16 a[42:43], v10 offset:23040
    ds_read_b64_tr_b16 a[88:89], v10 offset:20544
    ds_read_b64_tr_b16 a[90:91], v10 offset:23104
    ds_read_b64_tr_b16 a[136:137], v10 offset:20608
    ds_read_b64_tr_b16 a[138:139], v10 offset:23168
    ds_read_b64_tr_b16 a[184:185], v10 offset:20672
    ds_read_b64_tr_b16 a[186:187], v10 offset:23232
    ds_read_b64_tr_b16 a[232:233], v10 offset:20736
    ds_read_b64_tr_b16 a[234:235], v10 offset:23296
    s_waitcnt lgkmcnt(0)
    ds_read_b64_tr_b16 a[44:45], v10 offset:25600
    ds_read_b64_tr_b16 a[46:47], v10 offset:28160
    ds_read_b64_tr_b16 a[92:93], v10 offset:25664
    ds_read_b64_tr_b16 a[94:95], v10 offset:28224
    ds_read_b64_tr_b16 a[140:141], v10 offset:25728
    ds_read_b64_tr_b16 a[142:143], v10 offset:28288
    ds_read_b64_tr_b16 a[188:189], v10 offset:25792
    ds_read_b64_tr_b16 a[190:191], v10 offset:28352
    ds_read_b64_tr_b16 a[236:237], v10 offset:25856
    ds_read_b64_tr_b16 a[238:239], v10 offset:28416
    s_waitcnt lgkmcnt(0)
    s_cmp_lg_u32 s9, 0
    s_cbranch_scc1 dw_7b
    v_mov_b32 v20, 224
    s_mov_b32 s58, 0
dw_7:
    buffer_load_dword v21, v20, s[20:23], 0 offen sc1
    s_waitcnt vmcnt(0)
    v_readfirstlane_b32 s59, v21
    s_nop 3
    s_cmp_ge_u32 s59, 1
    s_cbranch_scc1 dw_7b
    s_sleep 16
    s_add_u32 s58, s58, 1
    s_cmp_lt_u32 s58, 0x80000
    s_cbranch_scc1 dw_7
dw_7b:
    s_barrier
    v_and_b32 v2, 31, v1
    v_lshlrev_b32 v4, 5, v2
    v_lshl_add_u32 v4, v3, 4, v4
    v_bfe_u32 v6, v1, 4, 1
    v_lshlrev_b32 v5, 10, v6
    v_lshl_add_u32 v5, v3, 8, v5
    v_and_b32 v6, 15, v1
    v_lshl_add_u32 v5, v6, 4, v5
    s_mul_i32 s38, s30, 12288
    s_add_u32 s38, s38, 29360128
    s_mul_i32 s39, s30, 40
    s_mul_i32 s40, s9, 10
    s_add_u32 s39, s39, s40
    s_lshl_b32 s39, s39, 10
    s_add_u32 s39, s39, 96468992
    s_mul_i32 s40, s30, 3
    s_add_u32 s40, s40, 192
    s_lshl_b32 s40, s40, 7
    s_add_u32 s40, s40, s62
    s_add_u32 s40, s40, 1986560
    v_min_u32 v6, 2, v1
    v_lshlrev_b32 v6, 7, v6
    v_add_u32 v6, s40, v6
    s_lshl_b32 s40, s30, 2
    s_add_u32 s40, s40, s9
    s_lshl_b32 s40, s40, 7
    s_add_u32 s40, s40, s62
    s_add_u32 s40, s40, 2031616
    v_mov_b32 v7, s40
    s_mov_b32 s41, 0
    s_mov_b32 s42, 0
    s_mov_b32 s45, 1
    s_cmp_ge_u32 s42, s45
    s_cbranch_scc1 Y_w0d
    s_mov_b32 s44, 0
Y_w0:
    buffer_load_dword v8, v6, s[12:15], 0 offen sc1
    s_waitcnt vmcnt(0)
    v_mov_b32 v9, v8
    s_nop 1
    v_min_u32_dpp v9, v9, v9 row_shr:1 row_mask:0xf bank_mask:0xf
    s_nop 1
    v_min_u32_dpp v9, v9, v9 row_shr:2 row_mask:0xf bank_mask:0xf
    s_nop 1
    v_readlane_b32 s42, v9, 3
    s_nop 3
    s_cmp_ge_u32 s42, s45
    s_cbranch_scc1 Y_w0d
    s_sleep 8
    s_add_u32 s44, s44, 1
    s_cmp_lt_u32 s44, 0x200000
    s_cbranch_scc1 Y_w0
Y_w0d:
    s_mov_b32 s43, s38
    buffer_load_dwordx4 v[32:35], v4, s[12:15], s43 offen offset:0 sc1
    buffer_load_dwordx4 v[36:39], v4, s[12:15], s43 offen offset:1024 sc1
    buffer_load_dwordx4 v[40:43], v4, s[12:15], s43 offen offset:2048 sc1
    buffer_load_dwordx4 v[44:47], v4, s[12:15], s43 offen offset:3072 sc1
    s_add_u32 s43, s43, 4096
    buffer_load_dwordx4 v[48:51], v4, s[12:15], s43 offen offset:0 sc1
    buffer_load_dwordx4 v[52:55], v4, s[12:15], s43 offen offset:1024 sc1
    buffer_load_dwordx4 v[56:59], v4, s[12:15], s43 offen offset:2048 sc1
    buffer_load_dwordx4 v[60:63], v4, s[12:15], s43 offen offset:3072 sc1
    s_add_u32 s43, s43, 4096
    buffer_load_dwordx4 v[64:67], v4, s[12:15], s43 offen offset:0 sc1
    buffer_load_dwordx4 v[68:71], v4, s[12:15], s43 offen offset:1024 sc1
    buffer_load_dwordx4 v[72:75], v4, s[12:15], s43 offen offset:2048 sc1
    buffer_load_dwordx4 v[76:79], v4, s[12:15], s43 offen offset:3072 sc1
    s_add_u32 s38, s38, 393216
Y_loop:
    s_add_u32 s45, s41, 2
    s_min_u32 s45, s45, 64
    s_cmp_ge_u32 s42, s45
    s_cbranch_scc1 Y_w1d
    s_mov_b32 s44, 0
Y_w1:
    buffer_load_dword v8, v6, s[12:15], 0 offen sc1
    s_waitcnt vmcnt(0)
    v_mov_b32 v9, v8
    s_nop 1
    v_min_u32_dpp v9, v9, v9 row_shr:1 row_mask:0xf bank_mask:0xf
    s_nop 1
    v_min_u32_dpp v9, v9, v9 row_shr:2 row_mask:0xf bank_mask:0xf
    s_nop 1
    v_readlane_b32 s42, v9, 3
    s_nop 3
    s_cmp_ge_u32 s42, s45
    s_cbranch_scc1 Y_w1d
    s_sleep 8
    s_add_u32 s44, s44, 1
    s_cmp_lt_u32 s44, 0x200000
    s_cbranch_scc1 Y_w1
Y_w1d:
    s_cmp_ge_u32 s41, 63
    s_cselect_b32 s46, 393216, 0
    s_sub_u32 s38, s38, s46
    s_mov_b32 s43, s38
    buffer_load_dwordx4 v[80:83], v4, s[12:15], s43 offen offset:0 sc1
    buffer_load_dwordx4 v[84:87], v4, s[12:15], s43 offen offset:1024 sc1
    buffer_load_dwordx4 v[88:91], v4, s[12:15], s43 offen offset:2048 sc1
    buffer_load_dwordx4 v[92:95], v4, s[12:15], s43 offen offset:3072 sc1
    s_add_u32 s43, s43, 4096
    buffer_load_dwordx4 v[96:99], v4, s[12:15], s43 offen offset:0 sc1
    buffer_load_dwordx4 v[100:103], v4, s[12:15], s43 offen offset:1024 sc1
    buffer_load_dwordx4 v[104:107], v4, s[12:15], s43 offen offset:2048 sc1
    buffer_load_dwordx4 v[108:111], v4, s[12:15], s43 offen offset:3072 sc1
    s_add_u32 s43, s43, 4096
    buffer_load_dwordx4 v[112:115], v4, s[12:15], s43 offen offset:0 sc1
    buffer_load_dwordx4 v[116:119], v4, s[12:15], s43 offen offset:1024 sc1
    buffer_load_dwordx4 v[120:123], v4, s[12:15], s43 offen offset:2048 sc1
    buffer_load_dwordx4 v[124:127], v4, s[12:15], s43 offen offset:3072 sc1
    s_add_u32 s38, s38, 393216
    s_waitcnt vmcnt(12)
    v_mov_b32 v8, s41
    s_mov_b64 exec, 1
    buffer_store_dword v8, v7, s[12:15], 0 offen sc1
    s_mov_b64 exec, -1
    v_mfma_f32_32x32x16_bf16 v[128:143], v[32:35], a[0:3], 0
    v_mfma_f32_32x32x16_bf16 v[144:159], v[32:35], a[48:51], 0
    v_mfma_f32_32x32x16_bf16 v[160:175], v[32:35], a[96:99], 0
    v_mfma_f32_32x32x16_bf16 v[176:191], v[32:35], a[144:147], 0
    v_mfma_f32_32x32x16_bf16 v[192:207], v[32:35], a[192:195], 0
    v_mfma_f32_32x32x16_bf16 v[128:143], v[36:39], a[4:7], v[128:143]
    v_mfma_f32_32x32x16_bf16 v[144:159], v[36:39], a[52:55], v[144:159]
    v_mfma_f32_32x32x16_bf16 v[160:175], v[36:39], a[100:103], v[160:175]
    v_mfma_f32_32x32x16_bf16 v[176:191], v[36:39], a[148:151], v[176:191]
    v_mfma_f32_32x32x16_bf16 v[192:207], v[36:39], a[196:199], v[192:207]
    v_mfma_f32_32x32x16_bf16 v[128:143], v[40:43], a[8:11], v[128:143]
    v_mfma_f32_32x32x16_bf16 v[144:159], v[40:43], a[56:59], v[144:159]
    v_mfma_f32_32x32x16_bf16 v[160:175], v[40:43], a[104:107], v[160:175]
    v_mfma_f32_32x32x16_bf16 v[176:191], v[40:43], a[152:155], v[176:191]
    v_mfma_f32_32x32x16_bf16 v[192:207], v[40:43], a[200:203], v[192:207]
    v_mfma_f32_32x32x16_bf16 v[128:143], v[44:47], a[12:15], v[128:143]
    v_mfma_f32_32x32x16_bf16 v[144:159], v[44:47], a[60:63], v[144:159]
    v_mfma_f32_32x32x16_bf16 v[160:175], v[44:47], a[108:111], v[160:175]
    v_mfma_f32_32x32x16_bf16 v[176:191], v[44:47], a[156:159], v[176:191]
    v_mfma_f32_32x32x16_bf16 v[192:207], v[44:47], a[204:207], v[192:207]
    v_mfma_f32_32x32x16_bf16 v[128:143], v[48:51], a[16:19], v[128:143]
    v_mfma_f32_32x32x16_bf16 v[144:159], v[48:51], a[64:67], v[144:159]
    v_mfma_f32_32x32x16_bf16 v[160:175], v[48:51], a[112:115], v[160:175]
    v_mfma_f32_32x32x16_bf16 v[176:191], v[48:51], a[160:163], v[176:191]
    v_mfma_f32_32x32x16_bf16 v[192:207], v[48:51], a[208:211], v[192:207]
    v_mfma_f32_32x32x16_bf16 v[128:143], v[52:55], a[20:23], v[128:143]
    v_mfma_f32_32x32x16_bf16 v[144:159], v[52:55], a[68:71], v[144:159]
    v_mfma_f32_32x32x16_bf16 v[160:175], v[52:55], a[116:119], v[160:175]
    v_mfma_f32_32x32x16_bf16 v[176:191], v[52:55], a[164:167], v[176:191]
    v_mfma_f32_32x32x16_bf16 v[192:207], v[52:55], a[212:215], v[192:207]
    v_mfma_f32_32x32x16_bf16 v[128:143], v[56:59], a[24:27], v[128:143]
    v_mfma_f32_32x32x16_bf16 v[144:159], v[56:59], a[72:75], v[144:159]
    v_mfma_f32_32x32x16_bf16 v[160:175], v[56:59], a[120:123], v[160:175]
    v_mfma_f32_32x32x16_bf16 v[176:191], v[56:59], a[168:171], v[176:191]
    v_mfma_f32_32x32x16_bf16 v[192:207], v[56:59], a[216:219], v[192:207]
    v_mfma_f32_32x32x16_bf16 v[128:143], v[60:63], a[28:31], v[128:143]
    v_mfma_f32_32x32x16_bf16 v[144:159], v[60:63], a[76:79], v[144:159]
    v_mfma_f32_32x32x16_bf16 v[160:175], v[60:63], a[124:127], v[160:175]
    v_mfma_f32_32x32x16_bf16 v[176:191], v[60:63], a[172:175], v[176:191]
    v_mfma_f32_32x32x16_bf16 v[192:207], v[60:63], a[220:223], v[192:207]
    v_mfma_f32_32x32x16_bf16 v[128:143], v[64:67], a[32:35], v[128:143]
    v_mfma_f32_32x32x16_bf16 v[144:159], v[64:67], a[80:83], v[144:159]
    v_mfma_f32_32x32x16_bf16 v[160:175], v[64:67], a[128:131], v[160:175]
    v_mfma_f32_32x32x16_bf16 v[176:191], v[64:67], a[176:179], v[176:191]
    v_mfma_f32_32x32x16_bf16 v[192:207], v[64:67], a[224:227], v[192:207]
    v_mfma_f32_32x32x16_bf16 v[128:143], v[68:71], a[36:39], v[128:143]
    v_mfma_f32_32x32x16_bf16 v[144:159], v[68:71], a[84:87], v[144:159]
    v_mfma_f32_32x32x16_bf16 v[160:175], v[68:71], a[132:135], v[160:175]
    v_mfma_f32_32x32x16_bf16 v[176:191], v[68:71], a[180:183], v[176:191]
    v_mfma_f32_32x32x16_bf16 v[192:207], v[68:71], a[228:231], v[192:207]
    v_mfma_f32_32x32x16_bf16 v[128:143], v[72:75], a[40:43], v[128:143]
    v_mfma_f32_32x32x16_bf16 v[144:159], v[72:75], a[88:91], v[144:159]
    v_mfma_f32_32x32x16_bf16 v[160:175], v[72:75], a[136:139], v[160:175]
    v_mfma_f32_32x32x16_bf16 v[176:191], v[72:75], a[184:187], v[176:191]
    v_mfma_f32_32x32x16_bf16 v[192:207], v[72:75], a[232:235], v[192:207]
    v_mfma_f32_32x32x16_bf16 v[128:143], v[76:79], a[44:47], v[128:143]
    v_mfma_f32_32x32x16_bf16 v[144:159], v[76:79], a[92:95], v[144:159]
    v_mfma_f32_32x32x16_bf16 v[160:175], v[76:79], a[140:143], v[160:175]
    v_mfma_f32_32x32x16_bf16 v[176:191], v[76:79], a[188:191], v[176:191]
    v_mfma_f32_32x32x16_bf16 v[192:207], v[76:79], a[236:239], v[192:207]
    s_nop 7
    v_cvt_pk_bf16_f32 v208, v128, v129
    v_cvt_pk_bf16_f32 v209, v130, v131
    v_cvt_pk_bf16_f32 v210, v136, v137
    v_cvt_pk_bf16_f32 v211, v138, v139
    buffer_store_dwordx4 v[208:211], v5, s[12:15], s39 offen offset:0 sc1
    v_cvt_pk_bf16_f32 v212, v132, v133
    v_cvt_pk_bf16_f32 v213, v134, v135
    v_cvt_pk_bf16_f32 v214, v140, v141
    v_cvt_pk_bf16_f32 v215, v142, v143
    buffer_store_dwordx4 v[212:215], v5, s[12:15], s39 offen offset:512 sc1
    v_cvt_pk_bf16_f32 v216, v144, v145
    v_cvt_pk_bf16_f32 v217, v146, v147
    v_cvt_pk_bf16_f32 v218, v152, v153
    v_cvt_pk_bf16_f32 v219, v154, v155
    buffer_store_dwordx4 v[216:219], v5, s[12:15], s39 offen offset:2048 sc1
    v_cvt_pk_bf16_f32 v220, v148, v149
    v_cvt_pk_bf16_f32 v221, v150, v151
    v_cvt_pk_bf16_f32 v222, v156, v157
    v_cvt_pk_bf16_f32 v223, v158, v159
    buffer_store_dwordx4 v[220:223], v5, s[12:15], s39 offen offset:2560 sc1
    v_cvt_pk_bf16_f32 v208, v160, v161
    v_cvt_pk_bf16_f32 v209, v162, v163
    v_cvt_pk_bf16_f32 v210, v168, v169
    v_cvt_pk_bf16_f32 v211, v170, v171
    s_add_u32 s47, s39, 4096
    buffer_store_dwordx4 v[208:211], v5, s[12:15], s47 offen offset:0 sc1
    v_cvt_pk_bf16_f32 v212, v164, v165
    v_cvt_pk_bf16_f32 v213, v166, v167
    v_cvt_pk_bf16_f32 v214, v172, v173
    v_cvt_pk_bf16_f32 v215, v174, v175
    s_add_u32 s47, s39, 4096
    buffer_store_dwordx4 v[212:215], v5, s[12:15], s47 offen offset:512 sc1
    v_cvt_pk_bf16_f32 v216, v176, v177
    v_cvt_pk_bf16_f32 v217, v178, v179
    v_cvt_pk_bf16_f32 v218, v184, v185
    v_cvt_pk_bf16_f32 v219, v186, v187
    s_add_u32 s47, s39, 4096
    buffer_store_dwordx4 v[216:219], v5, s[12:15], s47 offen offset:2048 sc1
    v_cvt_pk_bf16_f32 v220, v180, v181
    v_cvt_pk_bf16_f32 v221, v182, v183
    v_cvt_pk_bf16_f32 v222, v188, v189
    v_cvt_pk_bf16_f32 v223, v190, v191
    s_add_u32 s47, s39, 4096
    buffer_store_dwordx4 v[220:223], v5, s[12:15], s47 offen offset:2560 sc1
    v_cvt_pk_bf16_f32 v208, v192, v193
    v_cvt_pk_bf16_f32 v209, v194, v195
    v_cvt_pk_bf16_f32 v210, v200, v201
    v_cvt_pk_bf16_f32 v211, v202, v203
    s_add_u32 s47, s39, 8192
    buffer_store_dwordx4 v[208:211], v5, s[12:15], s47 offen offset:0 sc1
    v_cvt_pk_bf16_f32 v212, v196, v197
    v_cvt_pk_bf16_f32 v213, v198, v199
    v_cvt_pk_bf16_f32 v214, v204, v205
    v_cvt_pk_bf16_f32 v215, v206, v207
    s_add_u32 s47, s39, 8192
    buffer_store_dwordx4 v[212:215], v5, s[12:15], s47 offen offset:512 sc1
    s_add_u32 s39, s39, 1310720
    s_add_u32 s41, s41, 1
    s_cmp_ge_u32 s41, 64
    s_cbranch_scc1 Y_fin
    s_add_u32 s45, s41, 2
    s_min_u32 s45, s45, 64
    s_cmp_ge_u32 s42, s45
    s_cbranch_scc1 Y_w2d
    s_mov_b32 s44, 0
Y_w2:
    buffer_load_dword v8, v6, s[12:15], 0 offen sc1
    s_waitcnt vmcnt(0)
    v_mov_b32 v9, v8
    s_nop 1
    v_min_u32_dpp v9, v9, v9 row_shr:1 row_mask:0xf bank_mask:0xf
    s_nop 1
    v_min_u32_dpp v9, v9, v9 row_shr:2 row_mask:0xf bank_mask:0xf
    s_nop 1
    v_readlane_b32 s42, v9, 3
    s_nop 3
    s_cmp_ge_u32 s42, s45
    s_cbranch_scc1 Y_w2d
    s_sleep 8
    s_add_u32 s44, s44, 1
    s_cmp_lt_u32 s44, 0x200000
    s_cbranch_scc1 Y_w2
Y_w2d:
    s_cmp_ge_u32 s41, 63
    s_cselect_b32 s46, 393216, 0
    s_sub_u32 s38, s38, s46
    s_mov_b32 s43, s38
    buffer_load_dwordx4 v[32:35], v4, s[12:15], s43 offen offset:0 sc1
    buffer_load_dwordx4 v[36:39], v4, s[12:15], s43 offen offset:1024 sc1
    buffer_load_dwordx4 v[40:43], v4, s[12:15], s43 offen offset:2048 sc1
    buffer_load_dwordx4 v[44:47], v4, s[12:15], s43 offen offset:3072 sc1
    s_add_u32 s43, s43, 4096
    buffer_load_dwordx4 v[48:51], v4, s[12:15], s43 offen offset:0 sc1
    buffer_load_dwordx4 v[52:55], v4, s[12:15], s43 offen offset:1024 sc1
    buffer_load_dwordx4 v[56:59], v4, s[12:15], s43 offen offset:2048 sc1
    buffer_load_dwordx4 v[60:63], v4, s[12:15], s43 offen offset:3072 sc1
    s_add_u32 s43, s43, 4096
    buffer_load_dwordx4 v[64:67], v4, s[12:15], s43 offen offset:0 sc1
    buffer_load_dwordx4 v[68:71], v4, s[12:15], s43 offen offset:1024 sc1
    buffer_load_dwordx4 v[72:75], v4, s[12:15], s43 offen offset:2048 sc1
    buffer_load_dwordx4 v[76:79], v4, s[12:15], s43 offen offset:3072 sc1
    s_add_u32 s38, s38, 393216
    s_waitcnt vmcnt(12)
    v_mov_b32 v8, s41
    s_mov_b64 exec, 1
    buffer_store_dword v8, v7, s[12:15], 0 offen sc1
    s_mov_b64 exec, -1
    v_mfma_f32_32x32x16_bf16 v[128:143], v[80:83], a[0:3], 0
    v_mfma_f32_32x32x16_bf16 v[144:159], v[80:83], a[48:51], 0
    v_mfma_f32_32x32x16_bf16 v[160:175], v[80:83], a[96:99], 0
    v_mfma_f32_32x32x16_bf16 v[176:191], v[80:83], a[144:147], 0
    v_mfma_f32_32x32x16_bf16 v[192:207], v[80:83], a[192:195], 0
    v_mfma_f32_32x32x16_bf16 v[128:143], v[84:87], a[4:7], v[128:143]
    v_mfma_f32_32x32x16_bf16 v[144:159], v[84:87], a[52:55], v[144:159]
    v_mfma_f32_32x32x16_bf16 v[160:175], v[84:87], a[100:103], v[160:175]
    v_mfma_f32_32x32x16_bf16 v[176:191], v[84:87], a[148:151], v[176:191]
    v_mfma_f32_32x32x16_bf16 v[192:207], v[84:87], a[196:199], v[192:207]
    v_mfma_f32_32x32x16_bf16 v[128:143], v[88:91], a[8:11], v[128:143]
    v_mfma_f32_32x32x16_bf16 v[144:159], v[88:91], a[56:59], v[144:159]
    v_mfma_f32_32x32x16_bf16 v[160:175], v[88:91], a[104:107], v[160:175]
    v_mfma_f32_32x32x16_bf16 v[176:191], v[88:91], a[152:155], v[176:191]
    v_mfma_f32_32x32x16_bf16 v[192:207], v[88:91], a[200:203], v[192:207]
    v_mfma_f32_32x32x16_bf16 v[128:143], v[92:95], a[12:15], v[128:143]
    v_mfma_f32_32x32x16_bf16 v[144:159], v[92:95], a[60:63], v[144:159]
    v_mfma_f32_32x32x16_bf16 v[160:175], v[92:95], a[108:111], v[160:175]
    v_mfma_f32_32x32x16_bf16 v[176:191], v[92:95], a[156:159], v[176:191]
    v_mfma_f32_32x32x16_bf16 v[192:207], v[92:95], a[204:207], v[192:207]
    v_mfma_f32_32x32x16_bf16 v[128:143], v[96:99], a[16:19], v[128:143]
    v_mfma_f32_32x32x16_bf16 v[144:159], v[96:99], a[64:67], v[144:159]
    v_mfma_f32_32x32x16_bf16 v[160:175], v[96:99], a[112:115], v[160:175]
    v_mfma_f32_32x32x16_bf16 v[176:191], v[96:99], a[160:163], v[176:191]
    v_mfma_f32_32x32x16_bf16 v[192:207], v[96:99], a[208:211], v[192:207]
    v_mfma_f32_32x32x16_bf16 v[128:143], v[100:103], a[20:23], v[128:143]
    v_mfma_f32_32x32x16_bf16 v[144:159], v[100:103], a[68:71], v[144:159]
    v_mfma_f32_32x32x16_bf16 v[160:175], v[100:103], a[116:119], v[160:175]
    v_mfma_f32_32x32x16_bf16 v[176:191], v[100:103], a[164:167], v[176:191]
    v_mfma_f32_32x32x16_bf16 v[192:207], v[100:103], a[212:215], v[192:207]
    v_mfma_f32_32x32x16_bf16 v[128:143], v[104:107], a[24:27], v[128:143]
    v_mfma_f32_32x32x16_bf16 v[144:159], v[104:107], a[72:75], v[144:159]
    v_mfma_f32_32x32x16_bf16 v[160:175], v[104:107], a[120:123], v[160:175]
    v_mfma_f32_32x32x16_bf16 v[176:191], v[104:107], a[168:171], v[176:191]
    v_mfma_f32_32x32x16_bf16 v[192:207], v[104:107], a[216:219], v[192:207]
    v_mfma_f32_32x32x16_bf16 v[128:143], v[108:111], a[28:31], v[128:143]
    v_mfma_f32_32x32x16_bf16 v[144:159], v[108:111], a[76:79], v[144:159]
    v_mfma_f32_32x32x16_bf16 v[160:175], v[108:111], a[124:127], v[160:175]
    v_mfma_f32_32x32x16_bf16 v[176:191], v[108:111], a[172:175], v[176:191]
    v_mfma_f32_32x32x16_bf16 v[192:207], v[108:111], a[220:223], v[192:207]
    v_mfma_f32_32x32x16_bf16 v[128:143], v[112:115], a[32:35], v[128:143]
    v_mfma_f32_32x32x16_bf16 v[144:159], v[112:115], a[80:83], v[144:159]
    v_mfma_f32_32x32x16_bf16 v[160:175], v[112:115], a[128:131], v[160:175]
    v_mfma_f32_32x32x16_bf16 v[176:191], v[112:115], a[176:179], v[176:191]
    v_mfma_f32_32x32x16_bf16 v[192:207], v[112:115], a[224:227], v[192:207]
    v_mfma_f32_32x32x16_bf16 v[128:143], v[116:119], a[36:39], v[128:143]
    v_mfma_f32_32x32x16_bf16 v[144:159], v[116:119], a[84:87], v[144:159]
    v_mfma_f32_32x32x16_bf16 v[160:175], v[116:119], a[132:135], v[160:175]
    v_mfma_f32_32x32x16_bf16 v[176:191], v[116:119], a[180:183], v[176:191]
    v_mfma_f32_32x32x16_bf16 v[192:207], v[116:119], a[228:231], v[192:207]
    v_mfma_f32_32x32x16_bf16 v[128:143], v[120:123], a[40:43], v[128:143]
    v_mfma_f32_32x32x16_bf16 v[144:159], v[120:123], a[88:91], v[144:159]
    v_mfma_f32_32x32x16_bf16 v[160:175], v[120:123], a[136:139], v[160:175]
    v_mfma_f32_32x32x16_bf16 v[176:191], v[120:123], a[184:187], v[176:191]
    v_mfma_f32_32x32x16_bf16 v[192:207], v[120:123], a[232:235], v[192:207]
    v_mfma_f32_32x32x16_bf16 v[128:143], v[124:127], a[44:47], v[128:143]
    v_mfma_f32_32x32x16_bf16 v[144:159], v[124:127], a[92:95], v[144:159]
    v_mfma_f32_32x32x16_bf16 v[160:175], v[124:127], a[140:143], v[160:175]
    v_mfma_f32_32x32x16_bf16 v[176:191], v[124:127], a[188:191], v[176:191]
    v_mfma_f32_32x32x16_bf16 v[192:207], v[124:127], a[236:239], v[192:207]
    s_nop 7
    v_cvt_pk_bf16_f32 v208, v128, v129
    v_cvt_pk_bf16_f32 v209, v130, v131
    v_cvt_pk_bf16_f32 v210, v136, v137
    v_cvt_pk_bf16_f32 v211, v138, v139
    buffer_store_dwordx4 v[208:211], v5, s[12:15], s39 offen offset:0 sc1
    v_cvt_pk_bf16_f32 v212, v132, v133
    v_cvt_pk_bf16_f32 v213, v134, v135
    v_cvt_pk_bf16_f32 v214, v140, v141
    v_cvt_pk_bf16_f32 v215, v142, v143
    buffer_store_dwordx4 v[212:215], v5, s[12:15], s39 offen offset:512 sc1
    v_cvt_pk_bf16_f32 v216, v144, v145
    v_cvt_pk_bf16_f32 v217, v146, v147
    v_cvt_pk_bf16_f32 v218, v152, v153
    v_cvt_pk_bf16_f32 v219, v154, v155
    buffer_store_dwordx4 v[216:219], v5, s[12:15], s39 offen offset:2048 sc1
    v_cvt_pk_bf16_f32 v220, v148, v149
    v_cvt_pk_bf16_f32 v221, v150, v151
    v_cvt_pk_bf16_f32 v222, v156, v157
    v_cvt_pk_bf16_f32 v223, v158, v159
    buffer_store_dwordx4 v[220:223], v5, s[12:15], s39 offen offset:2560 sc1
    v_cvt_pk_bf16_f32 v208, v160, v161
    v_cvt_pk_bf16_f32 v209, v162, v163
    v_cvt_pk_bf16_f32 v210, v168, v169
    v_cvt_pk_bf16_f32 v211, v170, v171
    s_add_u32 s47, s39, 4096
    buffer_store_dwordx4 v[208:211], v5, s[12:15], s47 offen offset:0 sc1
    v_cvt_pk_bf16_f32 v212, v164, v165
    v_cvt_pk_bf16_f32 v213, v166, v167
    v_cvt_pk_bf16_f32 v214, v172, v173
    v_cvt_pk_bf16_f32 v215, v174, v175
    s_add_u32 s47, s39, 4096
    buffer_store_dwordx4 v[212:215], v5, s[12:15], s47 offen offset:512 sc1
    v_cvt_pk_bf16_f32 v216, v176, v177
    v_cvt_pk_bf16_f32 v217, v178, v179
    v_cvt_pk_bf16_f32 v218, v184, v185
    v_cvt_pk_bf16_f32 v219, v186, v187
    s_add_u32 s47, s39, 4096
    buffer_store_dwordx4 v[216:219], v5, s[12:15], s47 offen offset:2048 sc1
    v_cvt_pk_bf16_f32 v220, v180, v181
    v_cvt_pk_bf16_f32 v221, v182, v183
    v_cvt_pk_bf16_f32 v222, v188, v189
    v_cvt_pk_bf16_f32 v223, v190, v191
    s_add_u32 s47, s39, 4096
    buffer_store_dwordx4 v[220:223], v5, s[12:15], s47 offen offset:2560 sc1
    v_cvt_pk_bf16_f32 v208, v192, v193
    v_cvt_pk_bf16_f32 v209, v194, v195
    v_cvt_pk_bf16_f32 v210, v200, v201
    v_cvt_pk_bf16_f32 v211, v202, v203
    s_add_u32 s47, s39, 8192
    buffer_store_dwordx4 v[208:211], v5, s[12:15], s47 offen offset:0 sc1
    v_cvt_pk_bf16_f32 v212, v196, v197
    v_cvt_pk_bf16_f32 v213, v198, v199
    v_cvt_pk_bf16_f32 v214, v204, v205
    v_cvt_pk_bf16_f32 v215, v206, v207
    s_add_u32 s47, s39, 8192
    buffer_store_dwordx4 v[212:215], v5, s[12:15], s47 offen offset:512 sc1
    s_add_u32 s39, s39, 1310720
    s_add_u32 s41, s41, 1
    s_cmp_ge_u32 s41, 64
    s_cbranch_scc0 Y_loop
Y_fin:
    s_waitcnt vmcnt(0)
    v_mov_b32 v8, 64
    s_mov_b64 exec, 1
    buffer_store_dword v8, v7, s[12:15], 0 offen sc1
    s_mov_b64 exec, -1
    s_branch M_post
M_init:
    s_load_dwordx2 s[4:5], s[0:1], 96
    s_waitcnt lgkmcnt(0)
    s_mov_b32 s20, s4
    s_and_b32 s21, s5, 0xffff
    s_mov_b32 s22, 0x100
    s_mov_b32 s23, 0x00020000
    s_sub_u32 s30, s8, 4
    s_mul_i32 s30, s30, 3
    s_add_u32 s30, s30, s10
    s_sub_u32 s30, s30, 29
    v_lshlrev_b32 v4, 4, v0
    s_cmp_lg_u32 s30, 0
    s_cbranch_scc1 IN_noctl
    v_mov_b32 v24, 0
    v_mov_b32 v25, 0
    v_mov_b32 v26, 0
    v_mov_b32 v27, 0
    s_add_u32 s31, s62, 1982464
    buffer_store_dwordx4 v[24:27], v4, s[12:15], s31 offen sc1
    s_add_u32 s31, s31, 4096
    buffer_store_dwordx4 v[24:27], v4, s[12:15], s31 offen sc1
    s_add_u32 s31, s31, 4096
    buffer_store_dwordx4 v[24:27], v4, s[12:15], s31 offen sc1
    s_add_u32 s31, s31, 4096
    buffer_store_dwordx4 v[24:27], v4, s[12:15], s31 offen sc1
    s_add_u32 s31, s31, 4096
    buffer_store_dwordx4 v[24:27], v4, s[12:15], s31 offen sc1
    s_add_u32 s31, s31, 4096
    buffer_store_dwordx4 v[24:27], v4, s[12:15], s31 offen sc1
    s_add_u32 s31, s31, 4096
    buffer_store_dwordx4 v[24:27], v4, s[12:15], s31 offen sc1
    s_add_u32 s31, s31, 4096
    buffer_store_dwordx4 v[24:27], v4, s[12:15], s31 offen sc1
    s_add_u32 s31, s31, 4096
    buffer_store_dwordx4 v[24:27], v4, s[12:15], s31 offen sc1
    s_add_u32 s31, s31, 4096
    buffer_store_dwordx4 v[24:27], v4, s[12:15], s31 offen sc1
    s_add_u32 s31, s31, 4096
    buffer_store_dwordx4 v[24:27], v4, s[12:15], s31 offen sc1
    s_add_u32 s31, s31, 4096
    buffer_store_dwordx4 v[24:27], v4, s[12:15], s31 offen sc1
    s_add_u32 s31, s31, 4096
    buffer_store_dwordx4 v[24:27], v4, s[12:15], s31 offen sc1
    s_add_u32 s31, s31, 4096
    buffer_store_dwordx4 v[24:27], v4, s[12:15], s31 offen sc1
    s_add_u32 s31, s31, 4096
    buffer_store_dwordx4 v[24:27], v4, s[12:15], s31 offen sc1
    s_add_u32 s31, s31, 4096
    buffer_store_dwordx4 v[24:27], v4, s[12:15], s31 offen sc1
    s_add_u32 s31, s31, 4096
    buffer_store_dwordx4 v[24:27], v4, s[12:15], s31 offen sc1
    s_add_u32 s31, s31, 4096
    buffer_store_dwordx4 v[24:27], v4, s[12:15], s31 offen sc1
    s_add_u32 s31, s31, 4096
    buffer_store_dwordx4 v[24:27], v4, s[12:15], s31 offen sc1
    s_add_u32 s31, s31, 4096
    buffer_store_dwordx4 v[24:27], v4, s[12:15], s31 offen sc1
    s_add_u32 s31, s31, 4096
    buffer_store_dwordx4 v[24:27], v4, s[12:15], s31 offen sc1
    s_add_u32 s31, s31, 4096
    buffer_store_dwordx4 v[24:27], v4, s[12:15], s31 offen sc1
    s_add_u32 s31, s31, 4096
    buffer_store_dwordx4 v[24:27], v4, s[12:15], s31 offen sc1
    s_add_u32 s31, s31, 4096
    buffer_store_dwordx4 v[24:27], v4, s[12:15], s31 offen sc1
    s_add_u32 s31, s31, 4096
    buffer_store_dwordx4 v[24:27], v4, s[12:15], s31 offen sc1
    s_add_u32 s31, s31, 4096
    buffer_store_dwordx4 v[24:27], v4, s[12:15], s31 offen sc1
    s_add_u32 s31, s31, 4096
    buffer_store_dwordx4 v[24:27], v4, s[12:15], s31 offen sc1
    s_add_u32 s31, s31, 4096
    buffer_store_dwordx4 v[24:27], v4, s[12:15], s31 offen sc1
    s_add_u32 s31, s31, 4096
    s_waitcnt vmcnt(0)
    s_barrier
    s_cmp_lg_u32 s9, 0
    s_cbranch_scc1 da_8
    v_mov_b32 v20, 224
    v_mov_b32 v21, 1
    s_mov_b64 exec, 1
    buffer_atomic_add v21, v20, s[20:23], 0 offen
    s_mov_b64 exec, -1
da_8:
    s_cmp_lg_u32 s9, 0
    s_cbranch_scc1 IN_noctl
    s_waitcnt vmcnt(0)
    s_add_u32 s40, s62, 1966080
    v_mov_b32 v20, s40
    v_add_u32 v21, 8192, v20
    v_mov_b32 v22, 0
    s_mov_b64 exec, 1
    s_mov_b32 s42, -1
    s_mov_b32 s43, -1
    s_mov_b32 s44, 0
IN_cal:
    s_waitcnt vmcnt(0)
    s_memtime s[54:55]
    s_waitcnt lgkmcnt(0)
    buffer_store_dword v22, v20, s[12:15], 0 offen sc1
    s_waitcnt vmcnt(0)
    buffer_load_dword v23, v20, s[12:15], 0 offen sc1
    s_waitcnt vmcnt(0)
    s_memtime s[56:57]
    s_waitcnt lgkmcnt(0)
    s_sub_u32 s56, s56, s54
    s_min_u32 s42, s42, s56
    s_waitcnt vmcnt(0)
    s_memtime s[54:55]
    s_waitcnt lgkmcnt(0)
    buffer_store_dword v22, v21, s[12:15], 0 offen sc1
    s_waitcnt vmcnt(0)
    buffer_load_dword v23, v21, s[12:15], 0 offen sc1
    s_waitcnt vmcnt(0)
    s_memtime s[56:57]
    s_waitcnt lgkmcnt(0)
    s_sub_u32 s56, s56, s54
    s_min_u32 s43, s43, s56
    s_add_u32 s44, s44, 1
    s_cmp_lt_u32 s44, 5
    s_cbranch_scc1 IN_cal
    s_lshr_b32 s45, s8, 2
    s_and_b32 s45, s45, 1
    s_cmp_lt_u32 s42, s43
    s_cselect_b32 s40, 0, 1
    s_xor_b32 s40, s40, s45
    s_add_u32 s40, s40, 1
    v_mov_b32 v22, s40
    s_add_u32 s40, s62, 1982464
    v_mov_b32 v20, s40
    buffer_store_dword v22, v20, s[12:15], 0 offen sc1
    v_mov_b32 v22, s42
    v_mov_b32 v23, s43
    buffer_store_dwordx2 v[22:23], v20, s[12:15], 0 offen offset:8 sc1
    s_mov_b64 exec, -1
IN_noctl:
    s_mul_i32 s31, s30, 163840
    s_add_u32 s31, s31, s62
    v_mov_b32 v24, -1
    v_mov_b32 v25, -1
    v_mov_b32 v26, -1
    v_mov_b32 v27, -1
    buffer_store_dwordx4 v[24:27], v4, s[12:15], s31 offen sc1
    s_add_u32 s31, s31, 4096
    buffer_store_dwordx4 v[24:27], v4, s[12:15], s31 offen sc1
    s_add_u32 s31, s31, 4096
    buffer_store_dwordx4 v[24:27], v4, s[12:15], s31 offen sc1
    s_add_u32 s31, s31, 4096
    buffer_store_dwordx4 v[24:27], v4, s[12:15], s31 offen sc1
    s_add_u32 s31, s31, 4096
    buffer_store_dwordx4 v[24:27], v4, s[12:15], s31 offen sc1
    s_add_u32 s31, s31, 4096
    buffer_store_dwordx4 v[24:27], v4, s[12:15], s31 offen sc1
    s_add_u32 s31, s31, 4096
    buffer_store_dwordx4 v[24:27], v4, s[12:15], s31 offen sc1
    s_add_u32 s31, s31, 4096
    buffer_store_dwordx4 v[24:27], v4, s[12:15], s31 offen sc1
    s_add_u32 s31, s31, 4096
    buffer_store_dwordx4 v[24:27], v4, s[12:15], s31 offen sc1
    s_add_u32 s31, s31, 4096
    buffer_store_dwordx4 v[24:27], v4, s[12:15], s31 offen sc1
    s_add_u32 s31, s31, 4096
    buffer_store_dwordx4 v[24:27], v4, s[12:15], s31 offen sc1
    s_add_u32 s31, s31, 4096
    buffer_store_dwordx4 v[24:27], v4, s[12:15], s31 offen sc1
    s_add_u32 s31, s31, 4096
    buffer_store_dwordx4 v[24:27], v4, s[12:15], s31 offen sc1
    s_add_u32 s31, s31, 4096
    buffer_store_dwordx4 v[24:27], v4, s[12:15], s31 offen sc1
    s_add_u32 s31, s31, 4096
    buffer_store_dwordx4 v[24:27], v4, s[12:15], s31 offen sc1
    s_add_u32 s31, s31, 4096
    buffer_store_dwordx4 v[24:27], v4, s[12:15], s31 offen sc1
    s_add_u32 s31, s31, 4096
    buffer_store_dwordx4 v[24:27], v4, s[12:15], s31 offen sc1
    s_add_u32 s31, s31, 4096
    buffer_store_dwordx4 v[24:27], v4, s[12:15], s31 offen sc1
    s_add_u32 s31, s31, 4096
    buffer_store_dwordx4 v[24:27], v4, s[12:15], s31 offen sc1
    s_add_u32 s31, s31, 4096
    buffer_store_dwordx4 v[24:27], v4, s[12:15], s31 offen sc1
    s_add_u32 s31, s31, 4096
    buffer_store_dwordx4 v[24:27], v4, s[12:15], s31 offen sc1
    s_add_u32 s31, s31, 4096
    buffer_store_dwordx4 v[24:27], v4, s[12:15], s31 offen sc1
    s_add_u32 s31, s31, 4096
    buffer_store_dwordx4 v[24:27], v4, s[12:15], s31 offen sc1
    s_add_u32 s31, s31, 4096
    buffer_store_dwordx4 v[24:27], v4, s[12:15], s31 offen sc1
    s_add_u32 s31, s31, 4096
    buffer_store_dwordx4 v[24:27], v4, s[12:15], s31 offen sc1
    s_add_u32 s31, s31, 4096
    buffer_store_dwordx4 v[24:27], v4, s[12:15], s31 offen sc1
    s_add_u32 s31, s31, 4096
    buffer_store_dwordx4 v[24:27], v4, s[12:15], s31 offen sc1
    s_add_u32 s31, s31, 4096
    buffer_store_dwordx4 v[24:27], v4, s[12:15], s31 offen sc1
    s_add_u32 s31, s31, 4096
    buffer_store_dwordx4 v[24:27], v4, s[12:15], s31 offen sc1
    s_add_u32 s31, s31, 4096
    buffer_store_dwordx4 v[24:27], v4, s[12:15], s31 offen sc1
    s_add_u32 s31, s31, 4096
    buffer_store_dwordx4 v[24:27], v4, s[12:15], s31 offen sc1
    s_add_u32 s31, s31, 4096
    buffer_store_dwordx4 v[24:27], v4, s[12:15], s31 offen sc1
    s_add_u32 s31, s31, 4096
    buffer_store_dwordx4 v[24:27], v4, s[12:15], s31 offen sc1
    s_add_u32 s31, s31, 4096
    buffer_store_dwordx4 v[24:27], v4, s[12:15], s31 offen sc1
    s_add_u32 s31, s31, 4096
    buffer_store_dwordx4 v[24:27], v4, s[12:15], s31 offen sc1
    s_add_u32 s31, s31, 4096
    buffer_store_dwordx4 v[24:27], v4, s[12:15], s31 offen sc1
    s_add_u32 s31, s31, 4096
    buffer_store_dwordx4 v[24:27], v4, s[12:15], s31 offen sc1
    s_add_u32 s31, s31, 4096
    buffer_store_dwordx4 v[24:27], v4, s[12:15], s31 offen sc1
    s_add_u32 s31, s31, 4096
    buffer_store_dwordx4 v[24:27], v4, s[12:15], s31 offen sc1
    s_add_u32 s31, s31, 4096
    buffer_store_dwordx4 v[24:27], v4, s[12:15], s31 offen sc1
    s_add_u32 s31, s31, 4096
    s_waitcnt vmcnt(0)
    s_barrier
    s_cmp_lg_u32 s9, 0
    s_cbranch_scc1 da_9
    v_mov_b32 v20, 160
    v_mov_b32 v21, 1
    s_mov_b64 exec, 1
    buffer_atomic_add v21, v20, s[20:23], 0 offen
    s_mov_b64 exec, -1
da_9:
M_post:
    s_waitcnt vmcnt(0) lgkmcnt(0)
    s_barrier
    s_load_dwordx2 s[4:5], s[0:1], 96
    s_waitcnt lgkmcnt(0)
    s_mov_b32 s20, s4
    s_and_b32 s21, s5, 0xffff
    s_mov_b32 s22, 0x100
    s_mov_b32 s23, 0x00020000
    s_cmp_lg_u32 s9, 0
    s_cbranch_scc1 dw_10b
    v_mov_b32 v20, 224
    s_mov_b32 s58, 0
dw_10:
    buffer_load_dword v21, v20, s[20:23], 0 offen sc1
    s_waitcnt vmcnt(0)
    v_readfirstlane_b32 s59, v21
    s_nop 3
    s_cmp_ge_u32 s59, 1
    s_cbranch_scc1 dw_10b
    s_sleep 16
    s_add_u32 s58, s58, 1
    s_cmp_lt_u32 s58, 0x80000
    s_cbranch_scc1 dw_10
dw_10b:
    s_barrier
    s_mov_b32 s63, 2064512
PO_loop:
    s_cmp_lg_u32 s9, 0
    s_cbranch_scc1 PO_got
    s_add_u32 s40, s62, s63
    v_mov_b32 v20, s40
    v_mov_b32 v21, 1
    s_mov_b64 exec, 1
    buffer_atomic_add v21, v20, s[12:15], 0 offen sc0
    s_waitcnt vmcnt(0)
    v_mov_b32 v20, 135168
    ds_write_b32 v20, v21
    s_waitcnt lgkmcnt(0)
    s_mov_b64 exec, -1
PO_got:
    s_barrier
    v_mov_b32 v20, 135168
    ds_read_b32 v21, v20
    s_waitcnt lgkmcnt(0)
    v_readfirstlane_b32 s60, v21
    s_nop 3
    s_barrier
    s_cmp_eq_u32 s63, 2064384
    s_cbranch_scc1 PO_qb
    s_cmp_lt_u32 s60, 32
    s_cbranch_scc1 PO_g2
    s_mov_b32 s63, 2064384
    s_branch PO_loop
PO_qb:
    s_cmp_ge_u32 s60, 912
    s_cbranch_scc1 PO_exit
    s_cmp_ge_u32 s60, 792
    s_cbranch_scc1 PO_fine
    s_mul_i32 s58, s60, 5462
    s_lshr_b32 s58, s58, 16
    s_mul_i32 s59, s58, 12
    s_sub_u32 s59, s60, s59
    s_cmp_ge_u32 s59, 8
    s_cbranch_scc1 PO_out
    s_cmp_ge_u32 s58, 64
    s_cbranch_scc1 PO_loop
    s_mov_b32 s30, s58
    s_mov_b32 s57, s59
    s_add_u32 s56, s30, 1
    s_cmp_lg_u32 s9, 0
    s_cbranch_scc1 PO_wqb
    v_mul_u32_u24 v22, 43, v1
    v_lshrrev_b32 v22, 9, v22
    v_mul_u32_u24 v23, 12, v22
    v_sub_u32 v23, v1, v23
    v_and_b32 v22, 1, v22
    s_mul_i32 s40, s57, 12
    v_add_u32 v24, s40, v23
    v_mul_u32_u24 v25, 96, v22
    v_add_u32 v24, v24, v25
    v_lshlrev_b32 v24, 7, v24
    s_add_u32 s41, s62, 1986560
    v_add_u32 v20, s41, v24
    s_mov_b32 s61, 0
PO_wq:
    buffer_load_dword v26, v20, s[12:15], 0 offen sc1
    s_waitcnt vmcnt(0)
    v_cmp_gt_u32 vcc, s56, v26
    s_cbranch_vccz PO_wqd
    s_sleep 2
    s_add_u32 s61, s61, 1
    s_cmp_lt_u32 s61, 0x100000
    s_cbranch_scc1 PO_wq
    v_mov_b32 v20, 132
    v_mov_b32 v21, 0xbad
    s_mov_b64 exec, 1
    buffer_store_dword v21, v20, s[20:23], 0 offen
    s_mov_b64 exec, -1
PO_wqd:
PO_wqb:
    s_barrier
    s_lshl_b32 s31, s57, 2
    s_add_u32 s31, s31, s9
    v_and_b32 v2, 31, v1
    v_lshrrev_b32 v3, 5, v1
    v_lshlrev_b32 v4, 5, v2
    v_lshl_add_u32 v4, v3, 4, v4
    v_and_b32 v5, 7, v1
    v_lshlrev_b32 v5, 5, v5
    v_lshl_add_u32 v5, v3, 4, v5
    s_mul_i32 s32, s30, 393216
    s_mul_i32 s33, s31, 12288
    s_add_u32 s32, s32, s33
    s_mul_i32 s34, s30, 98304
    s_mul_i32 s33, s31, 3072
    s_add_u32 s34, s34, s33
    s_add_u32 s35, s32, 54525952
    s_add_u32 s36, s32, 4194304
    s_add_u32 s37, s34, 89128960
    buffer_load_dwordx4 v[32:35], v4, s[12:15], s35 offen offset:0 sc1
    buffer_load_dwordx4 v[80:83], v4, s[12:15], s36 offen offset:0 sc1
    buffer_load_dwordx4 v[36:39], v4, s[12:15], s35 offen offset:1024 sc1
    buffer_load_dwordx4 v[84:87], v4, s[12:15], s36 offen offset:1024 sc1
    buffer_load_dwordx4 v[40:43], v4, s[12:15], s35 offen offset:2048 sc1
    buffer_load_dwordx4 v[88:91], v4, s[12:15], s36 offen offset:2048 sc1
    buffer_load_dwordx4 v[44:47], v4, s[12:15], s35 offen offset:3072 sc1
    buffer_load_dwordx4 v[92:95], v4, s[12:15], s36 offen offset:3072 sc1
    s_add_u32 s35, s35, 4096
    s_add_u32 s36, s36, 4096
    buffer_load_dwordx4 v[48:51], v4, s[12:15], s35 offen offset:0 sc1
    buffer_load_dwordx4 v[96:99], v4, s[12:15], s36 offen offset:0 sc1
    buffer_load_dwordx4 v[52:55], v4, s[12:15], s35 offen offset:1024 sc1
    buffer_load_dwordx4 v[100:103], v4, s[12:15], s36 offen offset:1024 sc1
    buffer_load_dwordx4 v[56:59], v4, s[12:15], s35 offen offset:2048 sc1
    buffer_load_dwordx4 v[104:107], v4, s[12:15], s36 offen offset:2048 sc1
    buffer_load_dwordx4 v[60:63], v4, s[12:15], s35 offen offset:3072 sc1
    buffer_load_dwordx4 v[108:111], v4, s[12:15], s36 offen offset:3072 sc1
    s_add_u32 s35, s35, 4096
    s_add_u32 s36, s36, 4096
    buffer_load_dwordx4 v[64:67], v4, s[12:15], s35 offen offset:0 sc1
    buffer_load_dwordx4 v[112:115], v4, s[12:15], s36 offen offset:0 sc1
    buffer_load_dwordx4 v[68:71], v4, s[12:15], s35 offen offset:1024 sc1
    buffer_load_dwordx4 v[116:119], v4, s[12:15], s36 offen offset:1024 sc1
    buffer_load_dwordx4 v[72:75], v4, s[12:15], s35 offen offset:2048 sc1
    buffer_load_dwordx4 v[120:123], v4, s[12:15], s36 offen offset:2048 sc1
    buffer_load_dwordx4 v[76:79], v4, s[12:15], s35 offen offset:3072 sc1
    buffer_load_dwordx4 v[124:127], v4, s[12:15], s36 offen offset:3072 sc1
    s_cmp_lg_u32 s9, 0
    s_cbranch_scc1 PO_wkb
    v_mul_u32_u24 v22, 43, v1
    v_lshrrev_b32 v22, 9, v22
    v_mul_u32_u24 v23, 12, v22
    v_sub_u32 v23, v1, v23
    s_lshr_b32 s40, s57, 1
    s_lshl_b32 s40, s40, 5
    s_and_b32 s41, s57, 1
    s_mul_i32 s41, s41, 12
    s_add_u32 s40, s40, s41
    v_add_u32 v23, s40, v23
    v_lshlrev_b32 v23, 7, v23
    s_add_u32 s41, s62, 2048000
    v_add_u32 v20, s41, v23
    s_mov_b32 s61, 0
PO_wk:
    buffer_load_dword v26, v20, s[12:15], 0 offen sc1
    s_waitcnt vmcnt(0)
    v_cmp_gt_u32 vcc, s56, v26
    s_cbranch_vccz PO_wkd
    s_sleep 2
    s_add_u32 s61, s61, 1
    s_cmp_lt_u32 s61, 0x100000
    s_cbranch_scc1 PO_wk
    v_mov_b32 v20, 132
    v_mov_b32 v21, 0xbad
    s_mov_b64 exec, 1
    buffer_store_dword v21, v20, s[20:23], 0 offen
    s_mov_b64 exec, -1
PO_wkd:
PO_wkb:
    s_barrier
    buffer_load_dwordx4 v[128:131], v5, s[12:15], s37 offen offset:0 sc1
    buffer_load_dwordx4 v[132:135], v5, s[12:15], s37 offen offset:256 sc1
    buffer_load_dwordx4 v[136:139], v5, s[12:15], s37 offen offset:512 sc1
    buffer_load_dwordx4 v[140:143], v5, s[12:15], s37 offen offset:768 sc1
    buffer_load_dwordx4 v[144:147], v5, s[12:15], s37 offen offset:1024 sc1
    buffer_load_dwordx4 v[148:151], v5, s[12:15], s37 offen offset:1280 sc1
    buffer_load_dwordx4 v[152:155], v5, s[12:15], s37 offen offset:1536 sc1
    buffer_load_dwordx4 v[156:159], v5, s[12:15], s37 offen offset:1792 sc1
    buffer_load_dwordx4 v[160:163], v5, s[12:15], s37 offen offset:2048 sc1
    buffer_load_dwordx4 v[164:167], v5, s[12:15], s37 offen offset:2304 sc1
    buffer_load_dwordx4 v[168:171], v5, s[12:15], s37 offen offset:2560 sc1
    buffer_load_dwordx4 v[172:175], v5, s[12:15], s37 offen offset:2816 sc1
    s_waitcnt vmcnt(34)
    v_mfma_f32_32x32x16_bf16 v[176:191], v[80:83], v[32:35], 0
    s_waitcnt vmcnt(32)
    v_mfma_f32_32x32x16_bf16 v[176:191], v[84:87], v[36:39], v[176:191]
    s_waitcnt vmcnt(30)
    v_mfma_f32_32x32x16_bf16 v[176:191], v[88:91], v[40:43], v[176:191]
    s_waitcnt vmcnt(28)
    v_mfma_f32_32x32x16_bf16 v[176:191], v[92:95], v[44:47], v[176:191]
    s_waitcnt vmcnt(26)
    v_mfma_f32_32x32x16_bf16 v[176:191], v[96:99], v[48:51], v[176:191]
    s_waitcnt vmcnt(24)
    v_mfma_f32_32x32x16_bf16 v[176:191], v[100:103], v[52:55], v[176:191]
    s_waitcnt vmcnt(22)
    v_mfma_f32_32x32x16_bf16 v[176:191], v[104:107], v[56:59], v[176:191]
    s_waitcnt vmcnt(20)
    v_mfma_f32_32x32x16_bf16 v[176:191], v[108:111], v[60:63], v[176:191]
    s_waitcnt vmcnt(18)
    v_mfma_f32_32x32x16_bf16 v[176:191], v[112:115], v[64:67], v[176:191]
    s_waitcnt vmcnt(16)
    v_mfma_f32_32x32x16_bf16 v[176:191], v[116:119], v[68:71], v[176:191]
    s_waitcnt vmcnt(14)
    v_mfma_f32_32x32x16_bf16 v[176:191], v[120:123], v[72:75], v[176:191]
    s_waitcnt vmcnt(12)
    v_mfma_f32_32x32x16_bf16 v[176:191], v[124:127], v[76:79], v[176:191]
    s_waitcnt vmcnt(11)
    v_mfma_f32_32x32x16_bf16 v[192:207], v[128:131], v[32:35], 0
    s_waitcnt vmcnt(10)
    v_mfma_f32_32x32x16_bf16 v[192:207], v[132:135], v[36:39], v[192:207]
    s_waitcnt vmcnt(9)
    v_mfma_f32_32x32x16_bf16 v[192:207], v[136:139], v[40:43], v[192:207]
    s_waitcnt vmcnt(8)
    v_mfma_f32_32x32x16_bf16 v[192:207], v[140:143], v[44:47], v[192:207]
    s_waitcnt vmcnt(7)
    v_mfma_f32_32x32x16_bf16 v[192:207], v[144:147], v[48:51], v[192:207]
    s_waitcnt vmcnt(6)
    v_mfma_f32_32x32x16_bf16 v[192:207], v[148:151], v[52:55], v[192:207]
    s_waitcnt vmcnt(5)
    v_mfma_f32_32x32x16_bf16 v[192:207], v[152:155], v[56:59], v[192:207]
    s_waitcnt vmcnt(4)
    v_mfma_f32_32x32x16_bf16 v[192:207], v[156:159], v[60:63], v[192:207]
    s_waitcnt vmcnt(3)
    v_mfma_f32_32x32x16_bf16 v[192:207], v[160:163], v[64:67], v[192:207]
    s_waitcnt vmcnt(2)
    v_mfma_f32_32x32x16_bf16 v[192:207], v[164:167], v[68:71], v[192:207]
    s_waitcnt vmcnt(1)
    v_mfma_f32_32x32x16_bf16 v[192:207], v[168:171], v[72:75], v[192:207]
    s_waitcnt vmcnt(0)
    v_mfma_f32_32x32x16_bf16 v[192:207], v[172:175], v[76:79], v[192:207]
    v_lshlrev_b32 v10, 2, v3
    v_sub_u32 v10, v2, v10
    v_mov_b32 v11, 0xff800000
    s_mov_b32 s38, 0x3dd53b95
    v_cmp_le_i32 s[40:41], 0, v10
    v_cmp_le_i32 s[42:43], 1, v10
    v_cmp_le_i32 s[44:45], 2, v10
    v_cmp_le_i32 s[46:47], 3, v10
    s_nop 1
    v_cndmask_b32 v32, v11, v176, s[40:41]
    v_cndmask_b32 v33, v11, v177, s[42:43]
    v_cndmask_b32 v34, v11, v178, s[44:45]
    v_cndmask_b32 v35, v11, v179, s[46:47]
    v_cmp_le_i32 s[40:41], 8, v10
    v_cmp_le_i32 s[42:43], 9, v10
    v_cmp_le_i32 s[44:45], 10, v10
    v_cmp_le_i32 s[46:47], 11, v10
    s_nop 1
    v_cndmask_b32 v36, v11, v180, s[40:41]
    v_cndmask_b32 v37, v11, v181, s[42:43]
    v_cndmask_b32 v38, v11, v182, s[44:45]
    v_cndmask_b32 v39, v11, v183, s[46:47]
    v_cmp_le_i32 s[40:41], 16, v10
    v_cmp_le_i32 s[42:43], 17, v10
    v_cmp_le_i32 s[44:45], 18, v10
    v_cmp_le_i32 s[46:47], 19, v10
    s_nop 1
    v_cndmask_b32 v40, v11, v184, s[40:41]
    v_cndmask_b32 v41, v11, v185, s[42:43]
    v_cndmask_b32 v42, v11, v186, s[44:45]
    v_cndmask_b32 v43, v11, v187, s[46:47]
    v_cmp_le_i32 s[40:41], 24, v10
    v_cmp_le_i32 s[42:43], 25, v10
    v_cmp_le_i32 s[44:45], 26, v10
    v_cmp_le_i32 s[46:47], 27, v10
    s_nop 1
    v_cndmask_b32 v44, v11, v188, s[40:41]
    v_cndmask_b32 v45, v11, v189, s[42:43]
    v_cndmask_b32 v46, v11, v190, s[44:45]
    v_cndmask_b32 v47, v11, v191, s[46:47]
    v_max3_f32 v12, v192, v193, v194
    v_max3_f32 v13, v195, v32, v33
    v_max3_f32 v12, v12, v34, v35
    v_max3_f32 v13, v13, v36, v37
    v_max3_f32 v12, v12, v38, v39
    v_max3_f32 v13, v13, v40, v41
    v_max3_f32 v12, v12, v42, v43
    v_max3_f32 v13, v13, v44, v45
    v_max3_f32 v12, v12, v46, v47
    v_max_f32 v12, v12, v13
    v_mov_b32 v13, v12
    s_nop 1
    v_permlane32_swap_b32 v12, v13
    v_max_f32 v12, v12, v13
    v_mul_f32 v12, s38, v12
    v_fma_f32 v32, v32, s38, -v12
    v_fma_f32 v33, v33, s38, -v12
    v_fma_f32 v34, v34, s38, -v12
    v_fma_f32 v35, v35, s38, -v12
    v_fma_f32 v36, v36, s38, -v12
    v_fma_f32 v37, v37, s38, -v12
    v_fma_f32 v38, v38, s38, -v12
    v_fma_f32 v39, v39, s38, -v12
    v_fma_f32 v40, v40, s38, -v12
    v_fma_f32 v41, v41, s38, -v12
    v_fma_f32 v42, v42, s38, -v12
    v_fma_f32 v43, v43, s38, -v12
    v_fma_f32 v44, v44, s38, -v12
    v_fma_f32 v45, v45, s38, -v12
    v_fma_f32 v46, v46, s38, -v12
    v_fma_f32 v47, v47, s38, -v12
    v_fma_f32 v192, v192, s38, -v12
    v_fma_f32 v193, v193, s38, -v12
    v_fma_f32 v194, v194, s38, -v12
    v_fma_f32 v195, v195, s38, -v12
    v_exp_f32 v32, v32
    v_exp_f32 v33, v33
    v_exp_f32 v34, v34
    v_exp_f32 v35, v35
    v_exp_f32 v36, v36
    v_exp_f32 v37, v37
    v_exp_f32 v38, v38
    v_exp_f32 v39, v39
    v_exp_f32 v40, v40
    v_exp_f32 v41, v41
    v_exp_f32 v42, v42
    v_exp_f32 v43, v43
    v_exp_f32 v44, v44
    v_exp_f32 v45, v45
    v_exp_f32 v46, v46
    v_exp_f32 v47, v47
    v_exp_f32 v192, v192
    v_exp_f32 v193, v193
    v_exp_f32 v194, v194
    v_exp_f32 v195, v195
    s_nop 0
    v_add_f32 v14, v32, v33
    v_add_f32 v15, v34, v35
    v_add_f32 v14, v14, v36
    v_add_f32 v15, v15, v37
    v_add_f32 v14, v14, v38
    v_add_f32 v15, v15, v39
    v_add_f32 v14, v14, v40
    v_add_f32 v15, v15, v41
    v_add_f32 v14, v14, v42
    v_add_f32 v15, v15, v43
    v_add_f32 v14, v14, v44
    v_add_f32 v15, v15, v45
    v_add_f32 v14, v14, v46
    v_add_f32 v15, v15, v47
    v_add_f32 v14, v14, v192
    v_add_f32 v15, v15, v193
    v_add_f32 v14, v14, v194
    v_add_f32 v15, v15, v195
    v_add_f32 v14, v14, v15
    v_mov_b32 v15, v14
    s_nop 1
    v_permlane32_swap_b32 v14, v15
    v_add_f32 v14, v14, v15
    v_rcp_f32 v14, v14
    s_nop 0
    v_mul_f32 v32, v32, v14
    v_mul_f32 v33, v33, v14
    v_mul_f32 v34, v34, v14
    v_mul_f32 v35, v35, v14
    v_mul_f32 v36, v36, v14
    v_mul_f32 v37, v37, v14
    v_mul_f32 v38, v38, v14
    v_mul_f32 v39, v39, v14
    v_mul_f32 v40, v40, v14
    v_mul_f32 v41, v41, v14
    v_mul_f32 v42, v42, v14
    v_mul_f32 v43, v43, v14
    v_mul_f32 v44, v44, v14
    v_mul_f32 v45, v45, v14
    v_mul_f32 v46, v46, v14
    v_mul_f32 v47, v47, v14
    v_mul_f32 v192, v192, v14
    v_mul_f32 v193, v193, v14
    v_mul_f32 v194, v194, v14
    v_mul_f32 v195, v195, v14
    v_cvt_pk_bf16_f32 v48, v32, v33
    v_cvt_pk_bf16_f32 v49, v34, v35
    v_cvt_pk_bf16_f32 v50, v40, v41
    v_cvt_pk_bf16_f32 v51, v42, v43
    v_cvt_pk_bf16_f32 v52, v36, v37
    v_cvt_pk_bf16_f32 v53, v38, v39
    v_cvt_pk_bf16_f32 v54, v44, v45
    v_cvt_pk_bf16_f32 v55, v46, v47
    v_cvt_pk_bf16_f32 v56, v192, v193
    v_cvt_pk_bf16_f32 v57, v194, v195
    v_mov_b32 v58, 0
    v_mov_b32 v59, 0
    v_lshlrev_b32 v6, 4, v1
    s_lshl_b32 s35, s30, 5
    s_add_u32 s35, s35, s31
    s_mul_i32 s35, s35, 3072
    s_add_u32 s35, s35, 227540992
    buffer_store_dwordx4 v[48:51], v6, s[12:15], s35 offen sc1
    buffer_store_dwordx4 v[52:55], v6, s[12:15], s35 offen offset:1024 sc1
    buffer_store_dwordx4 v[56:59], v6, s[12:15], s35 offen offset:2048 sc1
    s_waitcnt vmcnt(0)
    s_barrier
    s_cmp_lg_u32 s9, 0
    s_cbranch_scc1 PO_loop
    s_lshl_b32 s40, s30, 7
    s_add_u32 s40, s40, s62
    s_add_u32 s40, s40, 2068480
    v_mov_b32 v20, s40
    v_mov_b32 v21, 1
    s_mov_b64 exec, 1
    buffer_atomic_add v21, v20, s[12:15], 0 offen
    s_mov_b64 exec, -1
    s_branch PO_loop
PO_out:
    s_cmp_lt_u32 s58, 2
    s_cbranch_scc1 PO_loop
    s_sub_u32 s30, s58, 2
    s_cmp_ge_u32 s30, 58
    s_cbranch_scc1 PO_loop
    s_sub_u32 s57, s59, 8
    s_add_u32 s56, s30, 1
    s_mov_b32 s55, 8
    s_mov_b32 s54, 2
    s_cmp_lg_u32 s9, 0
    s_cbranch_scc1 PO_wob
    v_and_b32 v26, 31, v1
    v_lshlrev_b32 v26, 2, v26
    v_add_u32 v26, s57, v26
    v_lshlrev_b32 v26, 7, v26
    s_add_u32 s41, s62, 2031616
    v_add_u32 v20, s41, v26
    v_lshlrev_b32 v26, 7, v1
    s_add_u32 s41, s62, 2048000
    v_add_u32 v21, s41, v26
    v_add_u32 v22, 8192, v21
    s_lshl_b32 s40, s30, 7
    s_add_u32 s40, s40, s62
    s_add_u32 s40, s40, 2068480
    v_mov_b32 v23, s40
    s_lshr_b32 s40, s30, 2
    s_lshl_b32 s40, s40, 7
    s_add_u32 s40, s40, s62
    s_add_u32 s40, s40, 2076672
    v_mov_b32 v24, s40
    s_mov_b32 s61, 0
PO_wo:
    buffer_load_dword v26, v20, s[12:15], 0 offen sc1
    buffer_load_dword v27, v21, s[12:15], 0 offen sc1
    buffer_load_dword v28, v22, s[12:15], 0 offen sc1
    buffer_load_dword v29, v23, s[12:15], 0 offen sc1
    buffer_load_dword v30, v24, s[12:15], 0 offen sc1
    s_waitcnt vmcnt(0)
    v_cmp_gt_u32 vcc, s56, v26
    v_cmp_gt_u32 s[46:47], s56, v27
    s_nop 3
    s_or_b64 vcc, vcc, s[46:47]
    v_cmp_gt_u32 s[46:47], s56, v28
    s_nop 3
    s_or_b64 vcc, vcc, s[46:47]
    v_cmp_gt_u32 s[46:47], s55, v29
    s_nop 3
    s_or_b64 vcc, vcc, s[46:47]
    v_cmp_gt_u32 s[46:47], s54, v30
    s_nop 3
    s_or_b64 vcc, vcc, s[46:47]
    s_cbranch_vccz PO_wod
    s_sleep 2
    s_add_u32 s61, s61, 1
    s_cmp_lt_u32 s61, 0x100000
    s_cbranch_scc1 PO_wo
    v_mov_b32 v20, 132
    v_mov_b32 v21, 0xbad
    s_mov_b64 exec, 1
    buffer_store_dword v21, v20, s[20:23], 0 offen
    s_mov_b64 exec, -1
PO_wod:
PO_wob:
    s_barrier
    s_mul_i32 s31, s57, 5
    v_and_b32 v2, 31, v1
    v_lshrrev_b32 v3, 5, v1
    v_lshlrev_b32 v4, 4, v1
    v_bfe_u32 v6, v1, 4, 1
    v_and_b32 v7, 15, v1
    v_lshlrev_b32 v5, 10, v6
    v_lshl_add_u32 v5, v3, 8, v5
    v_lshl_add_u32 v5, v7, 4, v5
    v_lshlrev_b32 v8, 8, v6
    v_lshl_add_u32 v8, v3, 7, v8
    v_lshl_add_u32 v8, v7, 3, v8
    s_lshl_b32 s32, s30, 5
    s_lshl_b32 s33, s9, 3
    s_add_u32 s32, s32, s33
    s_mul_i32 s34, s32, 3072
    s_add_u32 s34, s34, 227540992
    s_mul_i32 s35, s32, 40
    s_lshl_b32 s36, s31, 1
    s_add_u32 s35, s35, s36
    s_lshl_b32 s36, s35, 8
    s_add_u32 s36, s36, 180355072
    s_lshl_b32 s35, s35, 10
    s_add_u32 s35, s35, 96468992
    v_mov_b32 v70, 0
    v_mov_b32 v71, 0
    v_mov_b32 v74, 0
    v_mov_b32 v75, 0
    v_mov_b32 v78, 0
    v_mov_b32 v79, 0
    v_mov_b32 v82, 0
    v_mov_b32 v83, 0
    v_mov_b32 v86, 0
    v_mov_b32 v87, 0
    v_mov_b32 v142, 0
    v_mov_b32 v143, 0
    v_mov_b32 v146, 0
    v_mov_b32 v147, 0
    v_mov_b32 v150, 0
    v_mov_b32 v151, 0
    v_mov_b32 v154, 0
    v_mov_b32 v155, 0
    v_mov_b32 v158, 0
    v_mov_b32 v159, 0
    buffer_load_dwordx4 v[16:19], v4, s[12:15], s34 offen offset:0 sc1
    buffer_load_dwordx4 v[20:23], v4, s[12:15], s34 offen offset:1024 sc1
    buffer_load_dwordx4 v[24:27], v4, s[12:15], s34 offen offset:2048 sc1
    buffer_load_dwordx4 v[28:31], v5, s[12:15], s35 offen offset:0 sc1
    buffer_load_dwordx4 v[32:35], v5, s[12:15], s35 offen offset:512 sc1
    buffer_load_dwordx4 v[36:39], v5, s[12:15], s35 offen offset:2048 sc1
    buffer_load_dwordx4 v[40:43], v5, s[12:15], s35 offen offset:2560 sc1
    s_add_u32 s37, s35, 4096
    buffer_load_dwordx4 v[44:47], v5, s[12:15], s37 offen offset:0 sc1
    s_add_u32 s37, s35, 4096
    buffer_load_dwordx4 v[48:51], v5, s[12:15], s37 offen offset:512 sc1
    s_add_u32 s37, s35, 4096
    buffer_load_dwordx4 v[52:55], v5, s[12:15], s37 offen offset:2048 sc1
    s_add_u32 s37, s35, 4096
    buffer_load_dwordx4 v[56:59], v5, s[12:15], s37 offen offset:2560 sc1
    s_add_u32 s37, s35, 8192
    buffer_load_dwordx4 v[60:63], v5, s[12:15], s37 offen offset:0 sc1
    s_add_u32 s37, s35, 8192
    buffer_load_dwordx4 v[64:67], v5, s[12:15], s37 offen offset:512 sc1
    buffer_load_dwordx2 v[68:69], v8, s[12:15], s36 offen offset:0 sc1
    buffer_load_dwordx2 v[72:73], v8, s[12:15], s36 offen offset:512 sc1
    buffer_load_dwordx2 v[76:77], v8, s[12:15], s36 offen offset:1024 sc1
    buffer_load_dwordx2 v[80:81], v8, s[12:15], s36 offen offset:1536 sc1
    buffer_load_dwordx2 v[84:85], v8, s[12:15], s36 offen offset:2048 sc1
    s_add_u32 s34, s34, 3072
    s_add_u32 s35, s35, 40960
    s_add_u32 s36, s36, 10240
    s_waitcnt vmcnt(0)
    buffer_load_dwordx4 v[88:91], v4, s[12:15], s34 offen offset:0 sc1
    buffer_load_dwordx4 v[92:95], v4, s[12:15], s34 offen offset:1024 sc1
    buffer_load_dwordx4 v[96:99], v4, s[12:15], s34 offen offset:2048 sc1
    buffer_load_dwordx4 v[100:103], v5, s[12:15], s35 offen offset:0 sc1
    buffer_load_dwordx4 v[104:107], v5, s[12:15], s35 offen offset:512 sc1
    buffer_load_dwordx4 v[108:111], v5, s[12:15], s35 offen offset:2048 sc1
    buffer_load_dwordx4 v[112:115], v5, s[12:15], s35 offen offset:2560 sc1
    s_add_u32 s37, s35, 4096
    buffer_load_dwordx4 v[116:119], v5, s[12:15], s37 offen offset:0 sc1
    s_add_u32 s37, s35, 4096
    buffer_load_dwordx4 v[120:123], v5, s[12:15], s37 offen offset:512 sc1
    s_add_u32 s37, s35, 4096
    buffer_load_dwordx4 v[124:127], v5, s[12:15], s37 offen offset:2048 sc1
    s_add_u32 s37, s35, 4096
    buffer_load_dwordx4 v[128:131], v5, s[12:15], s37 offen offset:2560 sc1
    s_add_u32 s37, s35, 8192
    buffer_load_dwordx4 v[132:135], v5, s[12:15], s37 offen offset:0 sc1
    s_add_u32 s37, s35, 8192
    buffer_load_dwordx4 v[136:139], v5, s[12:15], s37 offen offset:512 sc1
    buffer_load_dwordx2 v[140:141], v8, s[12:15], s36 offen offset:0 sc1
    buffer_load_dwordx2 v[144:145], v8, s[12:15], s36 offen offset:512 sc1
    buffer_load_dwordx2 v[148:149], v8, s[12:15], s36 offen offset:1024 sc1
    buffer_load_dwordx2 v[152:153], v8, s[12:15], s36 offen offset:1536 sc1
    buffer_load_dwordx2 v[156:157], v8, s[12:15], s36 offen offset:2048 sc1
    s_add_u32 s34, s34, 3072
    s_add_u32 s35, s35, 40960
    s_add_u32 s36, s36, 10240
    v_mfma_f32_32x32x16_bf16 v[176:191], v[28:31], v[16:19], 0
    v_mfma_f32_32x32x16_bf16 v[192:207], v[36:39], v[16:19], 0
    v_mfma_f32_32x32x16_bf16 v[208:223], v[44:47], v[16:19], 0
    v_mfma_f32_32x32x16_bf16 v[224:239], v[52:55], v[16:19], 0
    v_mfma_f32_32x32x16_bf16 v[240:255], v[60:63], v[16:19], 0
    v_mfma_f32_32x32x16_bf16 v[176:191], v[32:35], v[20:23], v[176:191]
    v_mfma_f32_32x32x16_bf16 v[192:207], v[40:43], v[20:23], v[192:207]
    v_mfma_f32_32x32x16_bf16 v[208:223], v[48:51], v[20:23], v[208:223]
    v_mfma_f32_32x32x16_bf16 v[224:239], v[56:59], v[20:23], v[224:239]
    v_mfma_f32_32x32x16_bf16 v[240:255], v[64:67], v[20:23], v[240:255]
    v_mfma_f32_32x32x16_bf16 v[176:191], v[68:71], v[24:27], v[176:191]
    v_mfma_f32_32x32x16_bf16 v[192:207], v[72:75], v[24:27], v[192:207]
    v_mfma_f32_32x32x16_bf16 v[208:223], v[76:79], v[24:27], v[208:223]
    v_mfma_f32_32x32x16_bf16 v[224:239], v[80:83], v[24:27], v[224:239]
    v_mfma_f32_32x32x16_bf16 v[240:255], v[84:87], v[24:27], v[240:255]
    s_waitcnt vmcnt(0)
    buffer_load_dwordx4 v[16:19], v4, s[12:15], s34 offen offset:0 sc1
    buffer_load_dwordx4 v[20:23], v4, s[12:15], s34 offen offset:1024 sc1
    buffer_load_dwordx4 v[24:27], v4, s[12:15], s34 offen offset:2048 sc1
    buffer_load_dwordx4 v[28:31], v5, s[12:15], s35 offen offset:0 sc1
    buffer_load_dwordx4 v[32:35], v5, s[12:15], s35 offen offset:512 sc1
    buffer_load_dwordx4 v[36:39], v5, s[12:15], s35 offen offset:2048 sc1
    buffer_load_dwordx4 v[40:43], v5, s[12:15], s35 offen offset:2560 sc1
    s_add_u32 s37, s35, 4096
    buffer_load_dwordx4 v[44:47], v5, s[12:15], s37 offen offset:0 sc1
    s_add_u32 s37, s35, 4096
    buffer_load_dwordx4 v[48:51], v5, s[12:15], s37 offen offset:512 sc1
    s_add_u32 s37, s35, 4096
    buffer_load_dwordx4 v[52:55], v5, s[12:15], s37 offen offset:2048 sc1
    s_add_u32 s37, s35, 4096
    buffer_load_dwordx4 v[56:59], v5, s[12:15], s37 offen offset:2560 sc1
    s_add_u32 s37, s35, 8192
    buffer_load_dwordx4 v[60:63], v5, s[12:15], s37 offen offset:0 sc1
    s_add_u32 s37, s35, 8192
    buffer_load_dwordx4 v[64:67], v5, s[12:15], s37 offen offset:512 sc1
    buffer_load_dwordx2 v[68:69], v8, s[12:15], s36 offen offset:0 sc1
    buffer_load_dwordx2 v[72:73], v8, s[12:15], s36 offen offset:512 sc1
    buffer_load_dwordx2 v[76:77], v8, s[12:15], s36 offen offset:1024 sc1
    buffer_load_dwordx2 v[80:81], v8, s[12:15], s36 offen offset:1536 sc1
    buffer_load_dwordx2 v[84:85], v8, s[12:15], s36 offen offset:2048 sc1
    s_add_u32 s34, s34, 3072
    s_add_u32 s35, s35, 40960
    s_add_u32 s36, s36, 10240
    v_mfma_f32_32x32x16_bf16 v[176:191], v[100:103], v[88:91], v[176:191]
    v_mfma_f32_32x32x16_bf16 v[192:207], v[108:111], v[88:91], v[192:207]
    v_mfma_f32_32x32x16_bf16 v[208:223], v[116:119], v[88:91], v[208:223]
    v_mfma_f32_32x32x16_bf16 v[224:239], v[124:127], v[88:91], v[224:239]
    v_mfma_f32_32x32x16_bf16 v[240:255], v[132:135], v[88:91], v[240:255]
    v_mfma_f32_32x32x16_bf16 v[176:191], v[104:107], v[92:95], v[176:191]
    v_mfma_f32_32x32x16_bf16 v[192:207], v[112:115], v[92:95], v[192:207]
    v_mfma_f32_32x32x16_bf16 v[208:223], v[120:123], v[92:95], v[208:223]
    v_mfma_f32_32x32x16_bf16 v[224:239], v[128:131], v[92:95], v[224:239]
    v_mfma_f32_32x32x16_bf16 v[240:255], v[136:139], v[92:95], v[240:255]
    v_mfma_f32_32x32x16_bf16 v[176:191], v[140:143], v[96:99], v[176:191]
    v_mfma_f32_32x32x16_bf16 v[192:207], v[144:147], v[96:99], v[192:207]
    v_mfma_f32_32x32x16_bf16 v[208:223], v[148:151], v[96:99], v[208:223]
    v_mfma_f32_32x32x16_bf16 v[224:239], v[152:155], v[96:99], v[224:239]
    v_mfma_f32_32x32x16_bf16 v[240:255], v[156:159], v[96:99], v[240:255]
    s_waitcnt vmcnt(0)
    buffer_load_dwordx4 v[88:91], v4, s[12:15], s34 offen offset:0 sc1
    buffer_load_dwordx4 v[92:95], v4, s[12:15], s34 offen offset:1024 sc1
    buffer_load_dwordx4 v[96:99], v4, s[12:15], s34 offen offset:2048 sc1
    buffer_load_dwordx4 v[100:103], v5, s[12:15], s35 offen offset:0 sc1
    buffer_load_dwordx4 v[104:107], v5, s[12:15], s35 offen offset:512 sc1
    buffer_load_dwordx4 v[108:111], v5, s[12:15], s35 offen offset:2048 sc1
    buffer_load_dwordx4 v[112:115], v5, s[12:15], s35 offen offset:2560 sc1
    s_add_u32 s37, s35, 4096
    buffer_load_dwordx4 v[116:119], v5, s[12:15], s37 offen offset:0 sc1
    s_add_u32 s37, s35, 4096
    buffer_load_dwordx4 v[120:123], v5, s[12:15], s37 offen offset:512 sc1
    s_add_u32 s37, s35, 4096
    buffer_load_dwordx4 v[124:127], v5, s[12:15], s37 offen offset:2048 sc1
    s_add_u32 s37, s35, 4096
    buffer_load_dwordx4 v[128:131], v5, s[12:15], s37 offen offset:2560 sc1
    s_add_u32 s37, s35, 8192
    buffer_load_dwordx4 v[132:135], v5, s[12:15], s37 offen offset:0 sc1
    s_add_u32 s37, s35, 8192
    buffer_load_dwordx4 v[136:139], v5, s[12:15], s37 offen offset:512 sc1
    buffer_load_dwordx2 v[140:141], v8, s[12:15], s36 offen offset:0 sc1
    buffer_load_dwordx2 v[144:145], v8, s[12:15], s36 offen offset:512 sc1
    buffer_load_dwordx2 v[148:149], v8, s[12:15], s36 offen offset:1024 sc1
    buffer_load_dwordx2 v[152:153], v8, s[12:15], s36 offen offset:1536 sc1
    buffer_load_dwordx2 v[156:157], v8, s[12:15], s36 offen offset:2048 sc1
    s_add_u32 s34, s34, 3072
    s_add_u32 s35, s35, 40960
    s_add_u32 s36, s36, 10240
    v_mfma_f32_32x32x16_bf16 v[176:191], v[28:31], v[16:19], v[176:191]
    v_mfma_f32_32x32x16_bf16 v[192:207], v[36:39], v[16:19], v[192:207]
    v_mfma_f32_32x32x16_bf16 v[208:223], v[44:47], v[16:19], v[208:223]
    v_mfma_f32_32x32x16_bf16 v[224:239], v[52:55], v[16:19], v[224:239]
    v_mfma_f32_32x32x16_bf16 v[240:255], v[60:63], v[16:19], v[240:255]
    v_mfma_f32_32x32x16_bf16 v[176:191], v[32:35], v[20:23], v[176:191]
    v_mfma_f32_32x32x16_bf16 v[192:207], v[40:43], v[20:23], v[192:207]
    v_mfma_f32_32x32x16_bf16 v[208:223], v[48:51], v[20:23], v[208:223]
    v_mfma_f32_32x32x16_bf16 v[224:239], v[56:59], v[20:23], v[224:239]
    v_mfma_f32_32x32x16_bf16 v[240:255], v[64:67], v[20:23], v[240:255]
    v_mfma_f32_32x32x16_bf16 v[176:191], v[68:71], v[24:27], v[176:191]
    v_mfma_f32_32x32x16_bf16 v[192:207], v[72:75], v[24:27], v[192:207]
    v_mfma_f32_32x32x16_bf16 v[208:223], v[76:79], v[24:27], v[208:223]
    v_mfma_f32_32x32x16_bf16 v[224:239], v[80:83], v[24:27], v[224:239]
    v_mfma_f32_32x32x16_bf16 v[240:255], v[84:87], v[24:27], v[240:255]
    s_waitcnt vmcnt(0)
    buffer_load_dwordx4 v[16:19], v4, s[12:15], s34 offen offset:0 sc1
    buffer_load_dwordx4 v[20:23], v4, s[12:15], s34 offen offset:1024 sc1
    buffer_load_dwordx4 v[24:27], v4, s[12:15], s34 offen offset:2048 sc1
    buffer_load_dwordx4 v[28:31], v5, s[12:15], s35 offen offset:0 sc1
    buffer_load_dwordx4 v[32:35], v5, s[12:15], s35 offen offset:512 sc1
    buffer_load_dwordx4 v[36:39], v5, s[12:15], s35 offen offset:2048 sc1
    buffer_load_dwordx4 v[40:43], v5, s[12:15], s35 offen offset:2560 sc1
    s_add_u32 s37, s35, 4096
    buffer_load_dwordx4 v[44:47], v5, s[12:15], s37 offen offset:0 sc1
    s_add_u32 s37, s35, 4096
    buffer_load_dwordx4 v[48:51], v5, s[12:15], s37 offen offset:512 sc1
    s_add_u32 s37, s35, 4096
    buffer_load_dwordx4 v[52:55], v5, s[12:15], s37 offen offset:2048 sc1
    s_add_u32 s37, s35, 4096
    buffer_load_dwordx4 v[56:59], v5, s[12:15], s37 offen offset:2560 sc1
    s_add_u32 s37, s35, 8192
    buffer_load_dwordx4 v[60:63], v5, s[12:15], s37 offen offset:0 sc1
    s_add_u32 s37, s35, 8192
    buffer_load_dwordx4 v[64:67], v5, s[12:15], s37 offen offset:512 sc1
    buffer_load_dwordx2 v[68:69], v8, s[12:15], s36 offen offset:0 sc1
    buffer_load_dwordx2 v[72:73], v8, s[12:15], s36 offen offset:512 sc1
    buffer_load_dwordx2 v[76:77], v8, s[12:15], s36 offen offset:1024 sc1
    buffer_load_dwordx2 v[80:81], v8, s[12:15], s36 offen offset:1536 sc1
    buffer_load_dwordx2 v[84:85], v8, s[12:15], s36 offen offset:2048 sc1
    s_add_u32 s34, s34, 3072
    s_add_u32 s35, s35, 40960
    s_add_u32 s36, s36, 10240
    v_mfma_f32_32x32x16_bf16 v[176:191], v[100:103], v[88:91], v[176:191]
    v_mfma_f32_32x32x16_bf16 v[192:207], v[108:111], v[88:91], v[192:207]
    v_mfma_f32_32x32x16_bf16 v[208:223], v[116:119], v[88:91], v[208:223]
    v_mfma_f32_32x32x16_bf16 v[224:239], v[124:127], v[88:91], v[224:239]
    v_mfma_f32_32x32x16_bf16 v[240:255], v[132:135], v[88:91], v[240:255]
    v_mfma_f32_32x32x16_bf16 v[176:191], v[104:107], v[92:95], v[176:191]
    v_mfma_f32_32x32x16_bf16 v[192:207], v[112:115], v[92:95], v[192:207]
    v_mfma_f32_32x32x16_bf16 v[208:223], v[120:123], v[92:95], v[208:223]
    v_mfma_f32_32x32x16_bf16 v[224:239], v[128:131], v[92:95], v[224:239]
    v_mfma_f32_32x32x16_bf16 v[240:255], v[136:139], v[92:95], v[240:255]
    v_mfma_f32_32x32x16_bf16 v[176:191], v[140:143], v[96:99], v[176:191]
    v_mfma_f32_32x32x16_bf16 v[192:207], v[144:147], v[96:99], v[192:207]
    v_mfma_f32_32x32x16_bf16 v[208:223], v[148:151], v[96:99], v[208:223]
    v_mfma_f32_32x32x16_bf16 v[224:239], v[152:155], v[96:99], v[224:239]
    v_mfma_f32_32x32x16_bf16 v[240:255], v[156:159], v[96:99], v[240:255]
    s_waitcnt vmcnt(0)
    buffer_load_dwordx4 v[88:91], v4, s[12:15], s34 offen offset:0 sc1
    buffer_load_dwordx4 v[92:95], v4, s[12:15], s34 offen offset:1024 sc1
    buffer_load_dwordx4 v[96:99], v4, s[12:15], s34 offen offset:2048 sc1
    buffer_load_dwordx4 v[100:103], v5, s[12:15], s35 offen offset:0 sc1
    buffer_load_dwordx4 v[104:107], v5, s[12:15], s35 offen offset:512 sc1
    buffer_load_dwordx4 v[108:111], v5, s[12:15], s35 offen offset:2048 sc1
    buffer_load_dwordx4 v[112:115], v5, s[12:15], s35 offen offset:2560 sc1
    s_add_u32 s37, s35, 4096
    buffer_load_dwordx4 v[116:119], v5, s[12:15], s37 offen offset:0 sc1
    s_add_u32 s37, s35, 4096
    buffer_load_dwordx4 v[120:123], v5, s[12:15], s37 offen offset:512 sc1
    s_add_u32 s37, s35, 4096
    buffer_load_dwordx4 v[124:127], v5, s[12:15], s37 offen offset:2048 sc1
    s_add_u32 s37, s35, 4096
    buffer_load_dwordx4 v[128:131], v5, s[12:15], s37 offen offset:2560 sc1
    s_add_u32 s37, s35, 8192
    buffer_load_dwordx4 v[132:135], v5, s[12:15], s37 offen offset:0 sc1
    s_add_u32 s37, s35, 8192
    buffer_load_dwordx4 v[136:139], v5, s[12:15], s37 offen offset:512 sc1
    buffer_load_dwordx2 v[140:141], v8, s[12:15], s36 offen offset:0 sc1
    buffer_load_dwordx2 v[144:145], v8, s[12:15], s36 offen offset:512 sc1
    buffer_load_dwordx2 v[148:149], v8, s[12:15], s36 offen offset:1024 sc1
    buffer_load_dwordx2 v[152:153], v8, s[12:15], s36 offen offset:1536 sc1
    buffer_load_dwordx2 v[156:157], v8, s[12:15], s36 offen offset:2048 sc1
    s_add_u32 s34, s34, 3072
    s_add_u32 s35, s35, 40960
    s_add_u32 s36, s36, 10240
    v_mfma_f32_32x32x16_bf16 v[176:191], v[28:31], v[16:19], v[176:191]
    v_mfma_f32_32x32x16_bf16 v[192:207], v[36:39], v[16:19], v[192:207]
    v_mfma_f32_32x32x16_bf16 v[208:223], v[44:47], v[16:19], v[208:223]
    v_mfma_f32_32x32x16_bf16 v[224:239], v[52:55], v[16:19], v[224:239]
    v_mfma_f32_32x32x16_bf16 v[240:255], v[60:63], v[16:19], v[240:255]
    v_mfma_f32_32x32x16_bf16 v[176:191], v[32:35], v[20:23], v[176:191]
    v_mfma_f32_32x32x16_bf16 v[192:207], v[40:43], v[20:23], v[192:207]
    v_mfma_f32_32x32x16_bf16 v[208:223], v[48:51], v[20:23], v[208:223]
    v_mfma_f32_32x32x16_bf16 v[224:239], v[56:59], v[20:23], v[224:239]
    v_mfma_f32_32x32x16_bf16 v[240:255], v[64:67], v[20:23], v[240:255]
    v_mfma_f32_32x32x16_bf16 v[176:191], v[68:71], v[24:27], v[176:191]
    v_mfma_f32_32x32x16_bf16 v[192:207], v[72:75], v[24:27], v[192:207]
    v_mfma_f32_32x32x16_bf16 v[208:223], v[76:79], v[24:27], v[208:223]
    v_mfma_f32_32x32x16_bf16 v[224:239], v[80:83], v[24:27], v[224:239]
    v_mfma_f32_32x32x16_bf16 v[240:255], v[84:87], v[24:27], v[240:255]
    s_waitcnt vmcnt(0)
    buffer_load_dwordx4 v[16:19], v4, s[12:15], s34 offen offset:0 sc1
    buffer_load_dwordx4 v[20:23], v4, s[12:15], s34 offen offset:1024 sc1
    buffer_load_dwordx4 v[24:27], v4, s[12:15], s34 offen offset:2048 sc1
    buffer_load_dwordx4 v[28:31], v5, s[12:15], s35 offen offset:0 sc1
    buffer_load_dwordx4 v[32:35], v5, s[12:15], s35 offen offset:512 sc1
    buffer_load_dwordx4 v[36:39], v5, s[12:15], s35 offen offset:2048 sc1
    buffer_load_dwordx4 v[40:43], v5, s[12:15], s35 offen offset:2560 sc1
    s_add_u32 s37, s35, 4096
    buffer_load_dwordx4 v[44:47], v5, s[12:15], s37 offen offset:0 sc1
    s_add_u32 s37, s35, 4096
    buffer_load_dwordx4 v[48:51], v5, s[12:15], s37 offen offset:512 sc1
    s_add_u32 s37, s35, 4096
    buffer_load_dwordx4 v[52:55], v5, s[12:15], s37 offen offset:2048 sc1
    s_add_u32 s37, s35, 4096
    buffer_load_dwordx4 v[56:59], v5, s[12:15], s37 offen offset:2560 sc1
    s_add_u32 s37, s35, 8192
    buffer_load_dwordx4 v[60:63], v5, s[12:15], s37 offen offset:0 sc1
    s_add_u32 s37, s35, 8192
    buffer_load_dwordx4 v[64:67], v5, s[12:15], s37 offen offset:512 sc1
    buffer_load_dwordx2 v[68:69], v8, s[12:15], s36 offen offset:0 sc1
    buffer_load_dwordx2 v[72:73], v8, s[12:15], s36 offen offset:512 sc1
    buffer_load_dwordx2 v[76:77], v8, s[12:15], s36 offen offset:1024 sc1
    buffer_load_dwordx2 v[80:81], v8, s[12:15], s36 offen offset:1536 sc1
    buffer_load_dwordx2 v[84:85], v8, s[12:15], s36 offen offset:2048 sc1
    s_add_u32 s34, s34, 3072
    s_add_u32 s35, s35, 40960
    s_add_u32 s36, s36, 10240
    v_mfma_f32_32x32x16_bf16 v[176:191], v[100:103], v[88:91], v[176:191]
    v_mfma_f32_32x32x16_bf16 v[192:207], v[108:111], v[88:91], v[192:207]
    v_mfma_f32_32x32x16_bf16 v[208:223], v[116:119], v[88:91], v[208:223]
    v_mfma_f32_32x32x16_bf16 v[224:239], v[124:127], v[88:91], v[224:239]
    v_mfma_f32_32x32x16_bf16 v[240:255], v[132:135], v[88:91], v[240:255]
    v_mfma_f32_32x32x16_bf16 v[176:191], v[104:107], v[92:95], v[176:191]
    v_mfma_f32_32x32x16_bf16 v[192:207], v[112:115], v[92:95], v[192:207]
    v_mfma_f32_32x32x16_bf16 v[208:223], v[120:123], v[92:95], v[208:223]
    v_mfma_f32_32x32x16_bf16 v[224:239], v[128:131], v[92:95], v[224:239]
    v_mfma_f32_32x32x16_bf16 v[240:255], v[136:139], v[92:95], v[240:255]
    v_mfma_f32_32x32x16_bf16 v[176:191], v[140:143], v[96:99], v[176:191]
    v_mfma_f32_32x32x16_bf16 v[192:207], v[144:147], v[96:99], v[192:207]
    v_mfma_f32_32x32x16_bf16 v[208:223], v[148:151], v[96:99], v[208:223]
    v_mfma_f32_32x32x16_bf16 v[224:239], v[152:155], v[96:99], v[224:239]
    v_mfma_f32_32x32x16_bf16 v[240:255], v[156:159], v[96:99], v[240:255]
    s_waitcnt vmcnt(0)
    buffer_load_dwordx4 v[88:91], v4, s[12:15], s34 offen offset:0 sc1
    buffer_load_dwordx4 v[92:95], v4, s[12:15], s34 offen offset:1024 sc1
    buffer_load_dwordx4 v[96:99], v4, s[12:15], s34 offen offset:2048 sc1
    buffer_load_dwordx4 v[100:103], v5, s[12:15], s35 offen offset:0 sc1
    buffer_load_dwordx4 v[104:107], v5, s[12:15], s35 offen offset:512 sc1
    buffer_load_dwordx4 v[108:111], v5, s[12:15], s35 offen offset:2048 sc1
    buffer_load_dwordx4 v[112:115], v5, s[12:15], s35 offen offset:2560 sc1
    s_add_u32 s37, s35, 4096
    buffer_load_dwordx4 v[116:119], v5, s[12:15], s37 offen offset:0 sc1
    s_add_u32 s37, s35, 4096
    buffer_load_dwordx4 v[120:123], v5, s[12:15], s37 offen offset:512 sc1
    s_add_u32 s37, s35, 4096
    buffer_load_dwordx4 v[124:127], v5, s[12:15], s37 offen offset:2048 sc1
    s_add_u32 s37, s35, 4096
    buffer_load_dwordx4 v[128:131], v5, s[12:15], s37 offen offset:2560 sc1
    s_add_u32 s37, s35, 8192
    buffer_load_dwordx4 v[132:135], v5, s[12:15], s37 offen offset:0 sc1
    s_add_u32 s37, s35, 8192
    buffer_load_dwordx4 v[136:139], v5, s[12:15], s37 offen offset:512 sc1
    buffer_load_dwordx2 v[140:141], v8, s[12:15], s36 offen offset:0 sc1
    buffer_load_dwordx2 v[144:145], v8, s[12:15], s36 offen offset:512 sc1
    buffer_load_dwordx2 v[148:149], v8, s[12:15], s36 offen offset:1024 sc1
    buffer_load_dwordx2 v[152:153], v8, s[12:15], s36 offen offset:1536 sc1
    buffer_load_dwordx2 v[156:157], v8, s[12:15], s36 offen offset:2048 sc1
    s_add_u32 s34, s34, 3072
    s_add_u32 s35, s35, 40960
    s_add_u32 s36, s36, 10240
    v_mfma_f32_32x32x16_bf16 v[176:191], v[28:31], v[16:19], v[176:191]
    v_mfma_f32_32x32x16_bf16 v[192:207], v[36:39], v[16:19], v[192:207]
    v_mfma_f32_32x32x16_bf16 v[208:223], v[44:47], v[16:19], v[208:223]
    v_mfma_f32_32x32x16_bf16 v[224:239], v[52:55], v[16:19], v[224:239]
    v_mfma_f32_32x32x16_bf16 v[240:255], v[60:63], v[16:19], v[240:255]
    v_mfma_f32_32x32x16_bf16 v[176:191], v[32:35], v[20:23], v[176:191]
    v_mfma_f32_32x32x16_bf16 v[192:207], v[40:43], v[20:23], v[192:207]
    v_mfma_f32_32x32x16_bf16 v[208:223], v[48:51], v[20:23], v[208:223]
    v_mfma_f32_32x32x16_bf16 v[224:239], v[56:59], v[20:23], v[224:239]
    v_mfma_f32_32x32x16_bf16 v[240:255], v[64:67], v[20:23], v[240:255]
    v_mfma_f32_32x32x16_bf16 v[176:191], v[68:71], v[24:27], v[176:191]
    v_mfma_f32_32x32x16_bf16 v[192:207], v[72:75], v[24:27], v[192:207]
    v_mfma_f32_32x32x16_bf16 v[208:223], v[76:79], v[24:27], v[208:223]
    v_mfma_f32_32x32x16_bf16 v[224:239], v[80:83], v[24:27], v[224:239]
    v_mfma_f32_32x32x16_bf16 v[240:255], v[84:87], v[24:27], v[240:255]
    s_waitcnt vmcnt(0)
    v_mfma_f32_32x32x16_bf16 v[176:191], v[100:103], v[88:91], v[176:191]
    v_mfma_f32_32x32x16_bf16 v[192:207], v[108:111], v[88:91], v[192:207]
    v_mfma_f32_32x32x16_bf16 v[208:223], v[116:119], v[88:91], v[208:223]
    v_mfma_f32_32x32x16_bf16 v[224:239], v[124:127], v[88:91], v[224:239]
    v_mfma_f32_32x32x16_bf16 v[240:255], v[132:135], v[88:91], v[240:255]
    v_mfma_f32_32x32x16_bf16 v[176:191], v[104:107], v[92:95], v[176:191]
    v_mfma_f32_32x32x16_bf16 v[192:207], v[112:115], v[92:95], v[192:207]
    v_mfma_f32_32x32x16_bf16 v[208:223], v[120:123], v[92:95], v[208:223]
    v_mfma_f32_32x32x16_bf16 v[224:239], v[128:131], v[92:95], v[224:239]
    v_mfma_f32_32x32x16_bf16 v[240:255], v[136:139], v[92:95], v[240:255]
    v_mfma_f32_32x32x16_bf16 v[176:191], v[140:143], v[96:99], v[176:191]
    v_mfma_f32_32x32x16_bf16 v[192:207], v[144:147], v[96:99], v[192:207]
    v_mfma_f32_32x32x16_bf16 v[208:223], v[148:151], v[96:99], v[208:223]
    v_mfma_f32_32x32x16_bf16 v[224:239], v[152:155], v[96:99], v[224:239]
    v_mfma_f32_32x32x16_bf16 v[240:255], v[156:159], v[96:99], v[240:255]
    s_nop 15
    s_mul_i32 s37, s9, 20480
    v_add_u32 v9, s37, v4
    ds_write_b128 v9, v[176:179] offset:0
    ds_write_b128 v9, v[180:183] offset:1024
    ds_write_b128 v9, v[184:187] offset:2048
    ds_write_b128 v9, v[188:191] offset:3072
    ds_write_b128 v9, v[192:195] offset:4096
    ds_write_b128 v9, v[196:199] offset:5120
    ds_write_b128 v9, v[200:203] offset:6144
    ds_write_b128 v9, v[204:207] offset:7168
    ds_write_b128 v9, v[208:211] offset:8192
    ds_write_b128 v9, v[212:215] offset:9216
    ds_write_b128 v9, v[216:219] offset:10240
    ds_write_b128 v9, v[220:223] offset:11264
    ds_write_b128 v9, v[224:227] offset:12288
    ds_write_b128 v9, v[228:231] offset:13312
    ds_write_b128 v9, v[232:235] offset:14336
    ds_write_b128 v9, v[236:239] offset:15360
    ds_write_b128 v9, v[240:243] offset:16384
    ds_write_b128 v9, v[244:247] offset:17408
    ds_write_b128 v9, v[248:251] offset:18432
    ds_write_b128 v9, v[252:255] offset:19456
    s_load_dwordx2 s[16:17], s[0:1], 0
    s_load_dwordx2 s[24:25], s[0:1], 88
    s_waitcnt lgkmcnt(0)
    s_and_b32 s17, s17, 0xffff
    s_mov_b32 s18, 0x280000
    s_mov_b32 s19, 0x00020000
    s_and_b32 s25, s25, 0xffff
    s_mov_b32 s26, 0x280000
    s_mov_b32 s27, 0x00020000
    v_mul_u32_u24 v5, 1280, v2
    v_lshl_add_u32 v5, v3, 3, v5
    s_mul_i32 s34, s30, 40960
    s_lshl_b32 s33, s31, 6
    s_add_u32 s34, s34, s33
    s_lshl_b32 s33, s9, 4
    s_add_u32 s34, s34, s33
    s_lshr_b32 s32, s30, 2
    s_and_b32 s33, s30, 3
    s_lshl_b32 s32, s32, 3
    s_add_u32 s32, s32, s33
    s_mul_i32 s32, s32, 81920
    s_lshl_b32 s33, s31, 12
    s_add_u32 s32, s32, s33
    s_lshl_b32 s33, s9, 10
    s_add_u32 s32, s32, s33
    s_add_u32 s32, s32, 233832448
    buffer_load_dwordx2 v[16:17], v5, s[16:19], s34 offen offset:0
    buffer_load_dwordx2 v[18:19], v5, s[16:19], s34 offen offset:64
    buffer_load_dwordx2 v[20:21], v5, s[16:19], s34 offen offset:128
    buffer_load_dwordx2 v[22:23], v5, s[16:19], s34 offen offset:192
    buffer_load_dwordx2 v[24:25], v5, s[16:19], s34 offen offset:256
    s_add_u32 s35, s32, 0
    buffer_load_dwordx4 v[32:35], v4, s[12:15], s35 offen sc1
    s_add_u32 s35, s32, 4096
    buffer_load_dwordx4 v[36:39], v4, s[12:15], s35 offen sc1
    s_add_u32 s35, s32, 8192
    buffer_load_dwordx4 v[40:43], v4, s[12:15], s35 offen sc1
    s_add_u32 s35, s32, 12288
    buffer_load_dwordx4 v[44:47], v4, s[12:15], s35 offen sc1
    s_add_u32 s35, s32, 16384
    buffer_load_dwordx4 v[48:51], v4, s[12:15], s35 offen sc1
    s_add_u32 s35, s32, 327680
    buffer_load_dwordx4 v[52:55], v4, s[12:15], s35 offen sc1
    s_add_u32 s35, s32, 331776
    buffer_load_dwordx4 v[56:59], v4, s[12:15], s35 offen sc1
    s_add_u32 s35, s32, 335872
    buffer_load_dwordx4 v[60:63], v4, s[12:15], s35 offen sc1
    s_add_u32 s35, s32, 339968
    buffer_load_dwordx4 v[64:67], v4, s[12:15], s35 offen sc1
    s_add_u32 s35, s32, 344064
    buffer_load_dwordx4 v[68:71], v4, s[12:15], s35 offen sc1
    s_barrier
    s_lshl_b32 s37, s9, 10
    v_add_u32 v9, s37, v4
    ds_read_b128 v[80:83], v9 offset:0
    ds_read_b128 v[84:87], v9 offset:20480
    ds_read_b128 v[88:91], v9 offset:40960
    ds_read_b128 v[92:95], v9 offset:61440
    ds_read_b128 v[96:99], v9 offset:4096
    ds_read_b128 v[100:103], v9 offset:24576
    ds_read_b128 v[104:107], v9 offset:45056
    v_add_u32 v10, 0x10000, v9
    ds_read_b128 v[108:111], v10 offset:0
    s_waitcnt lgkmcnt(0)
    ds_read_b128 v[112:115], v9 offset:8192
    ds_read_b128 v[116:119], v9 offset:28672
    ds_read_b128 v[120:123], v9 offset:49152
    v_add_u32 v10, 0x10000, v9
    ds_read_b128 v[124:127], v10 offset:4096
    ds_read_b128 v[128:131], v9 offset:12288
    ds_read_b128 v[132:135], v9 offset:32768
    ds_read_b128 v[136:139], v9 offset:53248
    v_add_u32 v10, 0x10000, v9
    ds_read_b128 v[140:143], v10 offset:8192
    s_waitcnt lgkmcnt(0)
    ds_read_b128 v[144:147], v9 offset:16384
    ds_read_b128 v[148:151], v9 offset:36864
    ds_read_b128 v[152:155], v9 offset:57344
    v_add_u32 v10, 0x10000, v9
    ds_read_b128 v[156:159], v10 offset:12288
    s_waitcnt vmcnt(0) lgkmcnt(0)
    v_pk_add_f32 v[80:81], v[80:81], v[84:85]
    v_pk_add_f32 v[88:89], v[88:89], v[92:93]
    v_pk_add_f32 v[32:33], v[32:33], v[52:53]
    v_pk_add_f32 v[80:81], v[80:81], v[88:89]
    v_cvt_pk_bf16_f32 v7, v32, v33
    v_cvt_pk_bf16_f32 v6, v80, v81
    v_lshlrev_b32 v11, 16, v6
    v_and_b32 v6, 0xffff0000, v6
    v_lshlrev_b32 v12, 16, v16
    v_and_b32 v13, 0xffff0000, v16
    v_add_f32 v11, v11, v12
    v_add_f32 v6, v6, v13
    v_cvt_pk_bf16_f32 v6, v11, v6
    v_lshlrev_b32 v11, 16, v6
    v_and_b32 v6, 0xffff0000, v6
    v_lshlrev_b32 v12, 16, v7
    v_and_b32 v13, 0xffff0000, v7
    v_add_f32 v11, v11, v12
    v_add_f32 v6, v6, v13
    v_cvt_pk_bf16_f32 v16, v11, v6
    v_pk_add_f32 v[82:83], v[82:83], v[86:87]
    v_pk_add_f32 v[90:91], v[90:91], v[94:95]
    v_pk_add_f32 v[34:35], v[34:35], v[54:55]
    v_pk_add_f32 v[82:83], v[82:83], v[90:91]
    v_cvt_pk_bf16_f32 v7, v34, v35
    v_cvt_pk_bf16_f32 v6, v82, v83
    v_lshlrev_b32 v11, 16, v6
    v_and_b32 v6, 0xffff0000, v6
    v_lshlrev_b32 v12, 16, v17
    v_and_b32 v13, 0xffff0000, v17
    v_add_f32 v11, v11, v12
    v_add_f32 v6, v6, v13
    v_cvt_pk_bf16_f32 v6, v11, v6
    v_lshlrev_b32 v11, 16, v6
    v_and_b32 v6, 0xffff0000, v6
    v_lshlrev_b32 v12, 16, v7
    v_and_b32 v13, 0xffff0000, v7
    v_add_f32 v11, v11, v12
    v_add_f32 v6, v6, v13
    v_cvt_pk_bf16_f32 v17, v11, v6
    buffer_store_dwordx2 v[16:17], v5, s[24:27], s34 offen offset:0
    v_pk_add_f32 v[96:97], v[96:97], v[100:101]
    v_pk_add_f32 v[104:105], v[104:105], v[108:109]
    v_pk_add_f32 v[36:37], v[36:37], v[56:57]
    v_pk_add_f32 v[96:97], v[96:97], v[104:105]
    v_cvt_pk_bf16_f32 v7, v36, v37
    v_cvt_pk_bf16_f32 v6, v96, v97
    v_lshlrev_b32 v11, 16, v6
    v_and_b32 v6, 0xffff0000, v6
    v_lshlrev_b32 v12, 16, v18
    v_and_b32 v13, 0xffff0000, v18
    v_add_f32 v11, v11, v12
    v_add_f32 v6, v6, v13
    v_cvt_pk_bf16_f32 v6, v11, v6
    v_lshlrev_b32 v11, 16, v6
    v_and_b32 v6, 0xffff0000, v6
    v_lshlrev_b32 v12, 16, v7
    v_and_b32 v13, 0xffff0000, v7
    v_add_f32 v11, v11, v12
    v_add_f32 v6, v6, v13
    v_cvt_pk_bf16_f32 v18, v11, v6
    v_pk_add_f32 v[98:99], v[98:99], v[102:103]
    v_pk_add_f32 v[106:107], v[106:107], v[110:111]
    v_pk_add_f32 v[38:39], v[38:39], v[58:59]
    v_pk_add_f32 v[98:99], v[98:99], v[106:107]
    v_cvt_pk_bf16_f32 v7, v38, v39
    v_cvt_pk_bf16_f32 v6, v98, v99
    v_lshlrev_b32 v11, 16, v6
    v_and_b32 v6, 0xffff0000, v6
    v_lshlrev_b32 v12, 16, v19
    v_and_b32 v13, 0xffff0000, v19
    v_add_f32 v11, v11, v12
    v_add_f32 v6, v6, v13
    v_cvt_pk_bf16_f32 v6, v11, v6
    v_lshlrev_b32 v11, 16, v6
    v_and_b32 v6, 0xffff0000, v6
    v_lshlrev_b32 v12, 16, v7
    v_and_b32 v13, 0xffff0000, v7
    v_add_f32 v11, v11, v12
    v_add_f32 v6, v6, v13
    v_cvt_pk_bf16_f32 v19, v11, v6
    buffer_store_dwordx2 v[18:19], v5, s[24:27], s34 offen offset:64
    v_pk_add_f32 v[112:113], v[112:113], v[116:117]
    v_pk_add_f32 v[120:121], v[120:121], v[124:125]
    v_pk_add_f32 v[40:41], v[40:41], v[60:61]
    v_pk_add_f32 v[112:113], v[112:113], v[120:121]
    v_cvt_pk_bf16_f32 v7, v40, v41
    v_cvt_pk_bf16_f32 v6, v112, v113
    v_lshlrev_b32 v11, 16, v6
    v_and_b32 v6, 0xffff0000, v6
    v_lshlrev_b32 v12, 16, v20
    v_and_b32 v13, 0xffff0000, v20
    v_add_f32 v11, v11, v12
    v_add_f32 v6, v6, v13
    v_cvt_pk_bf16_f32 v6, v11, v6
    v_lshlrev_b32 v11, 16, v6
    v_and_b32 v6, 0xffff0000, v6
    v_lshlrev_b32 v12, 16, v7
    v_and_b32 v13, 0xffff0000, v7
    v_add_f32 v11, v11, v12
    v_add_f32 v6, v6, v13
    v_cvt_pk_bf16_f32 v20, v11, v6
    v_pk_add_f32 v[114:115], v[114:115], v[118:119]
    v_pk_add_f32 v[122:123], v[122:123], v[126:127]
    v_pk_add_f32 v[42:43], v[42:43], v[62:63]
    v_pk_add_f32 v[114:115], v[114:115], v[122:123]
    v_cvt_pk_bf16_f32 v7, v42, v43
    v_cvt_pk_bf16_f32 v6, v114, v115
    v_lshlrev_b32 v11, 16, v6
    v_and_b32 v6, 0xffff0000, v6
    v_lshlrev_b32 v12, 16, v21
    v_and_b32 v13, 0xffff0000, v21
    v_add_f32 v11, v11, v12
    v_add_f32 v6, v6, v13
    v_cvt_pk_bf16_f32 v6, v11, v6
    v_lshlrev_b32 v11, 16, v6
    v_and_b32 v6, 0xffff0000, v6
    v_lshlrev_b32 v12, 16, v7
    v_and_b32 v13, 0xffff0000, v7
    v_add_f32 v11, v11, v12
    v_add_f32 v6, v6, v13
    v_cvt_pk_bf16_f32 v21, v11, v6
    buffer_store_dwordx2 v[20:21], v5, s[24:27], s34 offen offset:128
    v_pk_add_f32 v[128:129], v[128:129], v[132:133]
    v_pk_add_f32 v[136:137], v[136:137], v[140:141]
    v_pk_add_f32 v[44:45], v[44:45], v[64:65]
    v_pk_add_f32 v[128:129], v[128:129], v[136:137]
    v_cvt_pk_bf16_f32 v7, v44, v45
    v_cvt_pk_bf16_f32 v6, v128, v129
    v_lshlrev_b32 v11, 16, v6
    v_and_b32 v6, 0xffff0000, v6
    v_lshlrev_b32 v12, 16, v22
    v_and_b32 v13, 0xffff0000, v22
    v_add_f32 v11, v11, v12
    v_add_f32 v6, v6, v13
    v_cvt_pk_bf16_f32 v6, v11, v6
    v_lshlrev_b32 v11, 16, v6
    v_and_b32 v6, 0xffff0000, v6
    v_lshlrev_b32 v12, 16, v7
    v_and_b32 v13, 0xffff0000, v7
    v_add_f32 v11, v11, v12
    v_add_f32 v6, v6, v13
    v_cvt_pk_bf16_f32 v22, v11, v6
    v_pk_add_f32 v[130:131], v[130:131], v[134:135]
    v_pk_add_f32 v[138:139], v[138:139], v[142:143]
    v_pk_add_f32 v[46:47], v[46:47], v[66:67]
    v_pk_add_f32 v[130:131], v[130:131], v[138:139]
    v_cvt_pk_bf16_f32 v7, v46, v47
    v_cvt_pk_bf16_f32 v6, v130, v131
    v_lshlrev_b32 v11, 16, v6
    v_and_b32 v6, 0xffff0000, v6
    v_lshlrev_b32 v12, 16, v23
    v_and_b32 v13, 0xffff0000, v23
    v_add_f32 v11, v11, v12
    v_add_f32 v6, v6, v13
    v_cvt_pk_bf16_f32 v6, v11, v6
    v_lshlrev_b32 v11, 16, v6
    v_and_b32 v6, 0xffff0000, v6
    v_lshlrev_b32 v12, 16, v7
    v_and_b32 v13, 0xffff0000, v7
    v_add_f32 v11, v11, v12
    v_add_f32 v6, v6, v13
    v_cvt_pk_bf16_f32 v23, v11, v6
    buffer_store_dwordx2 v[22:23], v5, s[24:27], s34 offen offset:192
    v_pk_add_f32 v[144:145], v[144:145], v[148:149]
    v_pk_add_f32 v[152:153], v[152:153], v[156:157]
    v_pk_add_f32 v[48:49], v[48:49], v[68:69]
    v_pk_add_f32 v[144:145], v[144:145], v[152:153]
    v_cvt_pk_bf16_f32 v7, v48, v49
    v_cvt_pk_bf16_f32 v6, v144, v145
    v_lshlrev_b32 v11, 16, v6
    v_and_b32 v6, 0xffff0000, v6
    v_lshlrev_b32 v12, 16, v24
    v_and_b32 v13, 0xffff0000, v24
    v_add_f32 v11, v11, v12
    v_add_f32 v6, v6, v13
    v_cvt_pk_bf16_f32 v6, v11, v6
    v_lshlrev_b32 v11, 16, v6
    v_and_b32 v6, 0xffff0000, v6
    v_lshlrev_b32 v12, 16, v7
    v_and_b32 v13, 0xffff0000, v7
    v_add_f32 v11, v11, v12
    v_add_f32 v6, v6, v13
    v_cvt_pk_bf16_f32 v24, v11, v6
    v_pk_add_f32 v[146:147], v[146:147], v[150:151]
    v_pk_add_f32 v[154:155], v[154:155], v[158:159]
    v_pk_add_f32 v[50:51], v[50:51], v[70:71]
    v_pk_add_f32 v[146:147], v[146:147], v[154:155]
    v_cvt_pk_bf16_f32 v7, v50, v51
    v_cvt_pk_bf16_f32 v6, v146, v147
    v_lshlrev_b32 v11, 16, v6
    v_and_b32 v6, 0xffff0000, v6
    v_lshlrev_b32 v12, 16, v25
    v_and_b32 v13, 0xffff0000, v25
    v_add_f32 v11, v11, v12
    v_add_f32 v6, v6, v13
    v_cvt_pk_bf16_f32 v6, v11, v6
    v_lshlrev_b32 v11, 16, v6
    v_and_b32 v6, 0xffff0000, v6
    v_lshlrev_b32 v12, 16, v7
    v_and_b32 v13, 0xffff0000, v7
    v_add_f32 v11, v11, v12
    v_add_f32 v6, v6, v13
    v_cvt_pk_bf16_f32 v25, v11, v6
    buffer_store_dwordx2 v[24:25], v5, s[24:27], s34 offen offset:256
    s_waitcnt vmcnt(0)
    s_barrier
    s_branch PO_loop
PO_fine:
    s_sub_u32 s59, s60, 792
    s_mul_i32 s58, s59, 3277
    s_lshr_b32 s58, s58, 16
    s_mul_i32 s40, s58, 20
    s_sub_u32 s53, s59, s40
    s_add_u32 s30, s58, 58
    s_mul_i32 s57, s53, 52
    s_lshr_b32 s57, s57, 8
    s_add_u32 s56, s30, 1
    s_mov_b32 s55, 8
    s_mov_b32 s54, 2
    s_add_u32 s60, s60, 32
    s_cmp_lg_u32 s9, 0
    s_cbranch_scc1 PO_wf1b
    v_and_b32 v26, 31, v1
    v_lshlrev_b32 v26, 2, v26
    v_add_u32 v26, s57, v26
    v_lshlrev_b32 v26, 7, v26
    s_add_u32 s41, s62, 2031616
    v_add_u32 v20, s41, v26
    s_lshr_b32 s40, s30, 2
    s_lshl_b32 s40, s40, 7
    s_add_u32 s40, s40, s62
    s_add_u32 s40, s40, 2076672
    v_mov_b32 v21, s40
    s_mov_b32 s61, 0
PO_wf1:
    buffer_load_dword v26, v20, s[12:15], 0 offen sc1
    buffer_load_dword v27, v21, s[12:15], 0 offen sc1
    s_waitcnt vmcnt(0)
    v_cmp_gt_u32 vcc, s56, v26
    v_cmp_gt_u32 s[46:47], s54, v27
    s_nop 3
    s_or_b64 vcc, vcc, s[46:47]
    s_cbranch_vccz PO_wf1d
    s_sleep 2
    s_add_u32 s61, s61, 1
    s_cmp_lt_u32 s61, 0x100000
    s_cbranch_scc1 PO_wf1
    v_mov_b32 v20, 132
    v_mov_b32 v21, 0xbad
    s_mov_b64 exec, 1
    buffer_store_dword v21, v20, s[20:23], 0 offen
    s_mov_b64 exec, -1
PO_wf1d:
PO_wf1b:
    s_barrier
    s_mov_b32 s31, s53
    v_and_b32 v2, 31, v1
    v_lshrrev_b32 v3, 5, v1
    v_lshlrev_b32 v4, 4, v1
    v_bfe_u32 v6, v1, 4, 1
    v_and_b32 v7, 15, v1
    v_lshlrev_b32 v5, 10, v6
    v_lshl_add_u32 v5, v3, 8, v5
    v_lshl_add_u32 v5, v7, 4, v5
    v_lshlrev_b32 v8, 8, v6
    v_lshl_add_u32 v8, v3, 7, v8
    v_lshl_add_u32 v8, v7, 3, v8
    s_lshl_b32 s32, s30, 5
    s_lshl_b32 s33, s9, 3
    s_add_u32 s32, s32, s33
    s_mul_i32 s34, s32, 3072
    s_add_u32 s34, s34, 227540992
    s_mul_i32 s35, s32, 40
    s_lshl_b32 s36, s31, 1
    s_add_u32 s35, s35, s36
    s_lshl_b32 s36, s35, 8
    s_add_u32 s36, s36, 180355072
    s_lshl_b32 s35, s35, 10
    s_add_u32 s35, s35, 96468992
    s_load_dwordx2 s[16:17], s[0:1], 0
    s_load_dwordx2 s[24:25], s[0:1], 88
    s_waitcnt lgkmcnt(0)
    s_and_b32 s17, s17, 0xffff
    s_mov_b32 s18, 0x280000
    s_mov_b32 s19, 0x00020000
    s_and_b32 s25, s25, 0xffff
    s_mov_b32 s26, 0x280000
    s_mov_b32 s27, 0x00020000
    v_mul_u32_u24 v9, 1280, v2
    v_lshl_add_u32 v9, v3, 3, v9
    s_mul_i32 s38, s30, 40960
    s_lshl_b32 s33, s31, 6
    s_add_u32 s38, s38, s33
    s_lshl_b32 s33, s9, 4
    s_add_u32 s38, s38, s33
    s_lshr_b32 s39, s30, 2
    s_and_b32 s33, s30, 3
    s_lshl_b32 s39, s39, 3
    s_add_u32 s39, s39, s33
    s_mul_i32 s39, s39, 81920
    s_lshl_b32 s33, s31, 12
    s_add_u32 s39, s39, s33
    s_lshl_b32 s33, s9, 10
    s_add_u32 s39, s39, s33
    s_add_u32 s39, s39, 233832448
    buffer_load_dwordx4 v[16:19], v5, s[12:15], s35 offen offset:0 sc1
    buffer_load_dwordx4 v[20:23], v5, s[12:15], s35 offen offset:512 sc1
    s_add_u32 s35, s35, 40960
    buffer_load_dwordx4 v[24:27], v5, s[12:15], s35 offen offset:0 sc1
    buffer_load_dwordx4 v[28:31], v5, s[12:15], s35 offen offset:512 sc1
    s_add_u32 s35, s35, 40960
    buffer_load_dwordx4 v[32:35], v5, s[12:15], s35 offen offset:0 sc1
    buffer_load_dwordx4 v[36:39], v5, s[12:15], s35 offen offset:512 sc1
    s_add_u32 s35, s35, 40960
    buffer_load_dwordx4 v[40:43], v5, s[12:15], s35 offen offset:0 sc1
    buffer_load_dwordx4 v[44:47], v5, s[12:15], s35 offen offset:512 sc1
    s_add_u32 s35, s35, 40960
    buffer_load_dwordx4 v[48:51], v5, s[12:15], s35 offen offset:0 sc1
    buffer_load_dwordx4 v[52:55], v5, s[12:15], s35 offen offset:512 sc1
    s_add_u32 s35, s35, 40960
    buffer_load_dwordx4 v[56:59], v5, s[12:15], s35 offen offset:0 sc1
    buffer_load_dwordx4 v[60:63], v5, s[12:15], s35 offen offset:512 sc1
    s_add_u32 s35, s35, 40960
    buffer_load_dwordx4 v[64:67], v5, s[12:15], s35 offen offset:0 sc1
    buffer_load_dwordx4 v[68:71], v5, s[12:15], s35 offen offset:512 sc1
    s_add_u32 s35, s35, 40960
    buffer_load_dwordx4 v[72:75], v5, s[12:15], s35 offen offset:0 sc1
    buffer_load_dwordx4 v[76:79], v5, s[12:15], s35 offen offset:512 sc1
    s_add_u32 s35, s35, 40960
    buffer_load_dwordx2 v[224:225], v9, s[16:19], s38 offen
    buffer_load_dwordx4 v[228:231], v4, s[12:15], s39 offen sc1
    s_add_u32 s39, s39, 327680
    buffer_load_dwordx4 v[232:235], v4, s[12:15], s39 offen sc1
    v_mov_b32 v178, 0
    v_mov_b32 v179, 0
    v_mov_b32 v182, 0
    v_mov_b32 v183, 0
    v_mov_b32 v186, 0
    v_mov_b32 v187, 0
    v_mov_b32 v190, 0
    v_mov_b32 v191, 0
    v_mov_b32 v194, 0
    v_mov_b32 v195, 0
    v_mov_b32 v198, 0
    v_mov_b32 v199, 0
    v_mov_b32 v202, 0
    v_mov_b32 v203, 0
    v_mov_b32 v206, 0
    v_mov_b32 v207, 0
    s_cmp_lg_u32 s9, 0
    s_cbranch_scc1 PO_wf2b
    v_lshlrev_b32 v14, 7, v1
    s_add_u32 s41, s62, 2048000
    v_add_u32 v10, s41, v14
    v_add_u32 v11, 8192, v10
    s_lshl_b32 s40, s30, 7
    s_add_u32 s40, s40, s62
    s_add_u32 s40, s40, 2068480
    v_mov_b32 v12, s40
    s_mov_b32 s61, 0
PO_wf2:
    buffer_load_dword v13, v10, s[12:15], 0 offen sc1
    buffer_load_dword v14, v11, s[12:15], 0 offen sc1
    buffer_load_dword v15, v12, s[12:15], 0 offen sc1
    s_waitcnt vmcnt(0)
    v_min_u32 v13, v13, v14
    v_cmp_gt_u32 vcc, s56, v13
    v_cmp_gt_u32 s[46:47], s55, v15
    s_nop 3
    s_or_b64 vcc, vcc, s[46:47]
    s_cbranch_vccz PO_wf2b
    s_sleep 1
    s_add_u32 s61, s61, 1
    s_cmp_lt_u32 s61, 0x400000
    s_cbranch_scc1 PO_wf2
PO_wf2b:
    s_barrier
    buffer_load_dwordx4 v[80:83], v4, s[12:15], s34 offen offset:0 sc1
    buffer_load_dwordx4 v[84:87], v4, s[12:15], s34 offen offset:1024 sc1
    buffer_load_dwordx4 v[88:91], v4, s[12:15], s34 offen offset:2048 sc1
    buffer_load_dwordx2 v[176:177], v8, s[12:15], s36 offen sc1
    s_add_u32 s34, s34, 3072
    s_add_u32 s36, s36, 10240
    buffer_load_dwordx4 v[92:95], v4, s[12:15], s34 offen offset:0 sc1
    buffer_load_dwordx4 v[96:99], v4, s[12:15], s34 offen offset:1024 sc1
    buffer_load_dwordx4 v[100:103], v4, s[12:15], s34 offen offset:2048 sc1
    buffer_load_dwordx2 v[180:181], v8, s[12:15], s36 offen sc1
    s_add_u32 s34, s34, 3072
    s_add_u32 s36, s36, 10240
    buffer_load_dwordx4 v[104:107], v4, s[12:15], s34 offen offset:0 sc1
    buffer_load_dwordx4 v[108:111], v4, s[12:15], s34 offen offset:1024 sc1
    buffer_load_dwordx4 v[112:115], v4, s[12:15], s34 offen offset:2048 sc1
    buffer_load_dwordx2 v[184:185], v8, s[12:15], s36 offen sc1
    s_add_u32 s34, s34, 3072
    s_add_u32 s36, s36, 10240
    buffer_load_dwordx4 v[116:119], v4, s[12:15], s34 offen offset:0 sc1
    buffer_load_dwordx4 v[120:123], v4, s[12:15], s34 offen offset:1024 sc1
    buffer_load_dwordx4 v[124:127], v4, s[12:15], s34 offen offset:2048 sc1
    buffer_load_dwordx2 v[188:189], v8, s[12:15], s36 offen sc1
    s_add_u32 s34, s34, 3072
    s_add_u32 s36, s36, 10240
    buffer_load_dwordx4 v[128:131], v4, s[12:15], s34 offen offset:0 sc1
    buffer_load_dwordx4 v[132:135], v4, s[12:15], s34 offen offset:1024 sc1
    buffer_load_dwordx4 v[136:139], v4, s[12:15], s34 offen offset:2048 sc1
    buffer_load_dwordx2 v[192:193], v8, s[12:15], s36 offen sc1
    s_add_u32 s34, s34, 3072
    s_add_u32 s36, s36, 10240
    buffer_load_dwordx4 v[140:143], v4, s[12:15], s34 offen offset:0 sc1
    buffer_load_dwordx4 v[144:147], v4, s[12:15], s34 offen offset:1024 sc1
    buffer_load_dwordx4 v[148:151], v4, s[12:15], s34 offen offset:2048 sc1
    buffer_load_dwordx2 v[196:197], v8, s[12:15], s36 offen sc1
    s_add_u32 s34, s34, 3072
    s_add_u32 s36, s36, 10240
    buffer_load_dwordx4 v[152:155], v4, s[12:15], s34 offen offset:0 sc1
    buffer_load_dwordx4 v[156:159], v4, s[12:15], s34 offen offset:1024 sc1
    buffer_load_dwordx4 v[160:163], v4, s[12:15], s34 offen offset:2048 sc1
    buffer_load_dwordx2 v[200:201], v8, s[12:15], s36 offen sc1
    s_add_u32 s34, s34, 3072
    s_add_u32 s36, s36, 10240
    buffer_load_dwordx4 v[164:167], v4, s[12:15], s34 offen offset:0 sc1
    buffer_load_dwordx4 v[168:171], v4, s[12:15], s34 offen offset:1024 sc1
    buffer_load_dwordx4 v[172:175], v4, s[12:15], s34 offen offset:2048 sc1
    buffer_load_dwordx2 v[204:205], v8, s[12:15], s36 offen sc1
    s_add_u32 s34, s34, 3072
    s_add_u32 s36, s36, 10240
    s_waitcnt vmcnt(28)
    v_mfma_f32_32x32x16_bf16 v[208:223], v[16:19], v[80:83], 0
    v_mfma_f32_32x32x16_bf16 v[208:223], v[20:23], v[84:87], v[208:223]
    v_mfma_f32_32x32x16_bf16 v[208:223], v[176:179], v[88:91], v[208:223]
    s_waitcnt vmcnt(24)
    v_mfma_f32_32x32x16_bf16 v[208:223], v[24:27], v[92:95], v[208:223]
    v_mfma_f32_32x32x16_bf16 v[208:223], v[28:31], v[96:99], v[208:223]
    v_mfma_f32_32x32x16_bf16 v[208:223], v[180:183], v[100:103], v[208:223]
    s_waitcnt vmcnt(20)
    v_mfma_f32_32x32x16_bf16 v[208:223], v[32:35], v[104:107], v[208:223]
    v_mfma_f32_32x32x16_bf16 v[208:223], v[36:39], v[108:111], v[208:223]
    v_mfma_f32_32x32x16_bf16 v[208:223], v[184:187], v[112:115], v[208:223]
    s_waitcnt vmcnt(16)
    v_mfma_f32_32x32x16_bf16 v[208:223], v[40:43], v[116:119], v[208:223]
    v_mfma_f32_32x32x16_bf16 v[208:223], v[44:47], v[120:123], v[208:223]
    v_mfma_f32_32x32x16_bf16 v[208:223], v[188:191], v[124:127], v[208:223]
    s_waitcnt vmcnt(12)
    v_mfma_f32_32x32x16_bf16 v[208:223], v[48:51], v[128:131], v[208:223]
    v_mfma_f32_32x32x16_bf16 v[208:223], v[52:55], v[132:135], v[208:223]
    v_mfma_f32_32x32x16_bf16 v[208:223], v[192:195], v[136:139], v[208:223]
    s_waitcnt vmcnt(8)
    v_mfma_f32_32x32x16_bf16 v[208:223], v[56:59], v[140:143], v[208:223]
    v_mfma_f32_32x32x16_bf16 v[208:223], v[60:63], v[144:147], v[208:223]
    v_mfma_f32_32x32x16_bf16 v[208:223], v[196:199], v[148:151], v[208:223]
    s_waitcnt vmcnt(4)
    v_mfma_f32_32x32x16_bf16 v[208:223], v[64:67], v[152:155], v[208:223]
    v_mfma_f32_32x32x16_bf16 v[208:223], v[68:71], v[156:159], v[208:223]
    v_mfma_f32_32x32x16_bf16 v[208:223], v[200:203], v[160:163], v[208:223]
    s_waitcnt vmcnt(0)
    v_mfma_f32_32x32x16_bf16 v[208:223], v[72:75], v[164:167], v[208:223]
    v_mfma_f32_32x32x16_bf16 v[208:223], v[76:79], v[168:171], v[208:223]
    v_mfma_f32_32x32x16_bf16 v[208:223], v[204:207], v[172:175], v[208:223]
    s_nop 15
    s_lshl_b32 s37, s9, 12
    v_add_u32 v10, s37, v4
    ds_write_b128 v10, v[208:211] offset:0
    ds_write_b128 v10, v[212:215] offset:1024
    ds_write_b128 v10, v[216:219] offset:2048
    ds_write_b128 v10, v[220:223] offset:3072
    s_waitcnt lgkmcnt(0)
    s_barrier
    s_lshl_b32 s37, s9, 10
    v_add_u32 v10, s37, v4
    ds_read_b128 v[236:239], v10 offset:0
    ds_read_b128 v[240:243], v10 offset:4096
    ds_read_b128 v[244:247], v10 offset:8192
    ds_read_b128 v[248:251], v10 offset:12288
    s_waitcnt lgkmcnt(0)
    v_pk_add_f32 v[236:237], v[236:237], v[240:241]
    v_pk_add_f32 v[244:245], v[244:245], v[248:249]
    v_pk_add_f32 v[228:229], v[228:229], v[232:233]
    v_pk_add_f32 v[236:237], v[236:237], v[244:245]
    v_cvt_pk_bf16_f32 v7, v228, v229
    v_cvt_pk_bf16_f32 v6, v236, v237
    v_lshlrev_b32 v11, 16, v6
    v_and_b32 v6, 0xffff0000, v6
    v_lshlrev_b32 v12, 16, v224
    v_and_b32 v13, 0xffff0000, v224
    v_add_f32 v11, v11, v12
    v_add_f32 v6, v6, v13
    v_cvt_pk_bf16_f32 v6, v11, v6
    v_lshlrev_b32 v11, 16, v6
    v_and_b32 v6, 0xffff0000, v6
    v_lshlrev_b32 v12, 16, v7
    v_and_b32 v13, 0xffff0000, v7
    v_add_f32 v11, v11, v12
    v_add_f32 v6, v6, v13
    v_cvt_pk_bf16_f32 v224, v11, v6
    v_pk_add_f32 v[238:239], v[238:239], v[242:243]
    v_pk_add_f32 v[246:247], v[246:247], v[250:251]
    v_pk_add_f32 v[230:231], v[230:231], v[234:235]
    v_pk_add_f32 v[238:239], v[238:239], v[246:247]
    v_cvt_pk_bf16_f32 v7, v230, v231
    v_cvt_pk_bf16_f32 v6, v238, v239
    v_lshlrev_b32 v11, 16, v6
    v_and_b32 v6, 0xffff0000, v6
    v_lshlrev_b32 v12, 16, v225
    v_and_b32 v13, 0xffff0000, v225
    v_add_f32 v11, v11, v12
    v_add_f32 v6, v6, v13
    v_cvt_pk_bf16_f32 v6, v11, v6
    v_lshlrev_b32 v11, 16, v6
    v_and_b32 v6, 0xffff0000, v6
    v_lshlrev_b32 v12, 16, v7
    v_and_b32 v13, 0xffff0000, v7
    v_add_f32 v11, v11, v12
    v_add_f32 v6, v6, v13
    v_cvt_pk_bf16_f32 v225, v11, v6
    buffer_store_dwordx2 v[224:225], v9, s[24:27], s38 offen
    s_waitcnt vmcnt(0)
    s_barrier
    s_branch PO_loop
PO_g2:
    s_lshr_b32 s30, s60, 1
    s_and_b32 s31, s60, 1
    s_add_u32 s31, s31, 8
    s_lshl_b32 s56, s30, 2
    s_add_u32 s56, s56, 4
    s_add_u32 s60, s60, 792
    s_cmp_lg_u32 s9, 0
    s_cbranch_scc1 PO_wgb
    v_mul_u32_u24 v22, 43, v1
    v_lshrrev_b32 v22, 10, v22
    v_mul_u32_u24 v22, 24, v22
    v_sub_u32 v22, v1, v22
    s_sub_u32 s40, s31, 8
    s_mul_i32 s40, s40, 24
    s_add_u32 s40, s40, 288
    v_add_u32 v22, s40, v22
    v_lshlrev_b32 v22, 7, v22
    s_add_u32 s41, s62, 1986560
    v_add_u32 v20, s41, v22
    s_mov_b32 s61, 0
PO_wg:
    buffer_load_dword v26, v20, s[12:15], 0 offen sc1
    s_waitcnt vmcnt(0)
    v_cmp_gt_u32 vcc, s56, v26
    s_cbranch_vccz PO_wgd
    s_sleep 2
    s_add_u32 s61, s61, 1
    s_cmp_lt_u32 s61, 0x100000
    s_cbranch_scc1 PO_wg
    v_mov_b32 v20, 132
    v_mov_b32 v21, 0xbad
    s_mov_b64 exec, 1
    buffer_store_dword v21, v20, s[20:23], 0 offen
    s_mov_b64 exec, -1
PO_wgd:
PO_wgb:
    s_barrier
    s_mov_b32 s57, s30
    s_cmp_ge_u32 s31, 8
    s_cbranch_scc1 POG_wd
    s_load_dwordx2 s[16:17], s[0:1], 40
    s_mov_b32 s18, 0x780000
    s_mul_i32 s36, s31, 983040
    s_lshl_b32 s33, s30, 2
    s_add_u32 s33, s33, s9
    s_mul_i32 s34, s33, 393216
    s_mul_i32 s35, s31, 49152
    s_add_u32 s34, s34, s35
    s_add_u32 s34, s34, 103809024
    s_branch POG_wj
POG_wd:
    s_load_dwordx2 s[16:17], s[0:1], 80
    s_mov_b32 s18, 0x1e0000
    s_sub_u32 s35, s31, 8
    s_mul_i32 s36, s35, 983040
    s_lshl_b32 s33, s30, 2
    s_add_u32 s33, s33, s9
    s_mul_i32 s34, s33, 98304
    s_mul_i32 s35, s35, 49152
    s_add_u32 s34, s34, s35
    s_add_u32 s34, s34, 79691776
POG_wj:
    s_waitcnt lgkmcnt(0)
    s_and_b32 s17, s17, 0xffff
    s_mov_b32 s19, 0x00020000
    s_mul_i32 s32, s9, 704
    s_add_u32 s32, s32, 0
    v_add_u32 v2, s32, v1
    v_mul_u32_u24 v3, 3121, v2
    v_lshrrev_b32 v3, 18, v3
    v_mul_u32_u24 v4, 84, v3
    v_sub_u32 v4, v2, v4
    v_min_u32 v4, 79, v4
    v_min_u32 v3, 31, v3
    v_mul_u32_u24 v3, 1280, v3
    v_lshl_add_u32 v8, v4, 4, v3
    s_mul_i32 s32, s9, 704
    s_add_u32 s32, s32, 64
    v_add_u32 v2, s32, v1
    v_mul_u32_u24 v3, 3121, v2
    v_lshrrev_b32 v3, 18, v3
    v_mul_u32_u24 v4, 84, v3
    v_sub_u32 v4, v2, v4
    v_min_u32 v4, 79, v4
    v_min_u32 v3, 31, v3
    v_mul_u32_u24 v3, 1280, v3
    v_lshl_add_u32 v9, v4, 4, v3
    s_mul_i32 s32, s9, 704
    s_add_u32 s32, s32, 128
    v_add_u32 v2, s32, v1
    v_mul_u32_u24 v3, 3121, v2
    v_lshrrev_b32 v3, 18, v3
    v_mul_u32_u24 v4, 84, v3
    v_sub_u32 v4, v2, v4
    v_min_u32 v4, 79, v4
    v_min_u32 v3, 31, v3
    v_mul_u32_u24 v3, 1280, v3
    v_lshl_add_u32 v10, v4, 4, v3
    s_mul_i32 s32, s9, 704
    s_add_u32 s32, s32, 192
    v_add_u32 v2, s32, v1
    v_mul_u32_u24 v3, 3121, v2
    v_lshrrev_b32 v3, 18, v3
    v_mul_u32_u24 v4, 84, v3
    v_sub_u32 v4, v2, v4
    v_min_u32 v4, 79, v4
    v_min_u32 v3, 31, v3
    v_mul_u32_u24 v3, 1280, v3
    v_lshl_add_u32 v11, v4, 4, v3
    s_mul_i32 s32, s9, 704
    s_add_u32 s32, s32, 256
    v_add_u32 v2, s32, v1
    v_mul_u32_u24 v3, 3121, v2
    v_lshrrev_b32 v3, 18, v3
    v_mul_u32_u24 v4, 84, v3
    v_sub_u32 v4, v2, v4
    v_min_u32 v4, 79, v4
    v_min_u32 v3, 31, v3
    v_mul_u32_u24 v3, 1280, v3
    v_lshl_add_u32 v12, v4, 4, v3
    s_mul_i32 s32, s9, 704
    s_add_u32 s32, s32, 320
    v_add_u32 v2, s32, v1
    v_mul_u32_u24 v3, 3121, v2
    v_lshrrev_b32 v3, 18, v3
    v_mul_u32_u24 v4, 84, v3
    v_sub_u32 v4, v2, v4
    v_min_u32 v4, 79, v4
    v_min_u32 v3, 31, v3
    v_mul_u32_u24 v3, 1280, v3
    v_lshl_add_u32 v13, v4, 4, v3
    s_mul_i32 s32, s9, 704
    s_add_u32 s32, s32, 384
    v_add_u32 v2, s32, v1
    v_mul_u32_u24 v3, 3121, v2
    v_lshrrev_b32 v3, 18, v3
    v_mul_u32_u24 v4, 84, v3
    v_sub_u32 v4, v2, v4
    v_min_u32 v4, 79, v4
    v_min_u32 v3, 31, v3
    v_mul_u32_u24 v3, 1280, v3
    v_lshl_add_u32 v14, v4, 4, v3
    s_mul_i32 s32, s9, 704
    s_add_u32 s32, s32, 448
    v_add_u32 v2, s32, v1
    v_mul_u32_u24 v3, 3121, v2
    v_lshrrev_b32 v3, 18, v3
    v_mul_u32_u24 v4, 84, v3
    v_sub_u32 v4, v2, v4
    v_min_u32 v4, 79, v4
    v_min_u32 v3, 31, v3
    v_mul_u32_u24 v3, 1280, v3
    v_lshl_add_u32 v15, v4, 4, v3
    s_mul_i32 s32, s9, 704
    s_add_u32 s32, s32, 512
    v_add_u32 v2, s32, v1
    v_mul_u32_u24 v3, 3121, v2
    v_lshrrev_b32 v3, 18, v3
    v_mul_u32_u24 v4, 84, v3
    v_sub_u32 v4, v2, v4
    v_min_u32 v4, 79, v4
    v_min_u32 v3, 31, v3
    v_mul_u32_u24 v3, 1280, v3
    v_lshl_add_u32 v16, v4, 4, v3
    s_mul_i32 s32, s9, 704
    s_add_u32 s32, s32, 576
    v_add_u32 v2, s32, v1
    v_mul_u32_u24 v3, 3121, v2
    v_lshrrev_b32 v3, 18, v3
    v_mul_u32_u24 v4, 84, v3
    v_sub_u32 v4, v2, v4
    v_min_u32 v4, 79, v4
    v_min_u32 v3, 31, v3
    v_mul_u32_u24 v3, 1280, v3
    v_lshl_add_u32 v17, v4, 4, v3
    s_mul_i32 s32, s9, 704
    s_add_u32 s32, s32, 640
    v_add_u32 v2, s32, v1
    v_mul_u32_u24 v3, 3121, v2
    v_lshrrev_b32 v3, 18, v3
    v_mul_u32_u24 v4, 84, v3
    v_sub_u32 v4, v2, v4
    v_min_u32 v4, 79, v4
    v_min_u32 v3, 31, v3
    v_mul_u32_u24 v3, 1280, v3
    v_lshl_add_u32 v18, v4, 4, v3
    v_lshrrev_b32 v2, 5, v1
    v_and_b32 v3, 15, v1
    v_lshrrev_b32 v3, 2, v3
    v_lshl_add_u32 v3, v2, 2, v3
    v_mul_u32_u24 v5, 1344, v3
    v_bfe_u32 v3, v1, 4, 1
    v_lshl_add_u32 v5, v3, 5, v5
    v_and_b32 v3, 3, v1
    v_lshl_add_u32 v5, v3, 3, v5
    v_and_b32 v3, 31, v1
    v_lshlrev_b32 v4, 5, v3
    v_lshl_add_u32 v4, v2, 4, v4
    s_mul_i32 s37, s9, 11264
    s_mov_b32 s38, 0
    s_mov_b32 s39, 45056
    s_mov_b32 s40, 90112
    s_mov_b32 s42, s34
    s_add_u32 s41, s38, s37
    s_add_u32 s41, s41, 0
    s_mov_b32 m0, s41
    s_nop 0
    buffer_load_dwordx4 v8, s[16:19], s36 offen lds
    s_add_u32 s41, s38, s37
    s_add_u32 s41, s41, 1024
    s_mov_b32 m0, s41
    s_nop 0
    buffer_load_dwordx4 v9, s[16:19], s36 offen lds
    s_add_u32 s41, s38, s37
    s_add_u32 s41, s41, 2048
    s_mov_b32 m0, s41
    s_nop 0
    buffer_load_dwordx4 v10, s[16:19], s36 offen lds
    s_add_u32 s41, s38, s37
    s_add_u32 s41, s41, 3072
    s_mov_b32 m0, s41
    s_nop 0
    buffer_load_dwordx4 v11, s[16:19], s36 offen lds
    s_add_u32 s41, s38, s37
    s_add_u32 s41, s41, 4096
    s_mov_b32 m0, s41
    s_nop 0
    buffer_load_dwordx4 v12, s[16:19], s36 offen lds
    s_add_u32 s41, s38, s37
    s_add_u32 s41, s41, 5120
    s_mov_b32 m0, s41
    s_nop 0
    buffer_load_dwordx4 v13, s[16:19], s36 offen lds
    s_add_u32 s41, s38, s37
    s_add_u32 s41, s41, 6144
    s_mov_b32 m0, s41
    s_nop 0
    buffer_load_dwordx4 v14, s[16:19], s36 offen lds
    s_add_u32 s41, s38, s37
    s_add_u32 s41, s41, 7168
    s_mov_b32 m0, s41
    s_nop 0
    buffer_load_dwordx4 v15, s[16:19], s36 offen lds
    s_add_u32 s41, s38, s37
    s_add_u32 s41, s41, 8192
    s_mov_b32 m0, s41
    s_nop 0
    buffer_load_dwordx4 v16, s[16:19], s36 offen lds
    s_add_u32 s41, s38, s37
    s_add_u32 s41, s41, 9216
    s_mov_b32 m0, s41
    s_nop 0
    buffer_load_dwordx4 v17, s[16:19], s36 offen lds
    s_add_u32 s41, s38, s37
    s_add_u32 s41, s41, 10240
    s_mov_b32 m0, s41
    s_nop 0
    buffer_load_dwordx4 v18, s[16:19], s36 offen lds
    s_add_u32 s36, s36, 40960
    s_add_u32 s41, s39, s37
    s_add_u32 s41, s41, 0
    s_mov_b32 m0, s41
    s_nop 0
    buffer_load_dwordx4 v8, s[16:19], s36 offen lds
    s_add_u32 s41, s39, s37
    s_add_u32 s41, s41, 1024
    s_mov_b32 m0, s41
    s_nop 0
    buffer_load_dwordx4 v9, s[16:19], s36 offen lds
    s_add_u32 s41, s39, s37
    s_add_u32 s41, s41, 2048
    s_mov_b32 m0, s41
    s_nop 0
    buffer_load_dwordx4 v10, s[16:19], s36 offen lds
    s_add_u32 s41, s39, s37
    s_add_u32 s41, s41, 3072
    s_mov_b32 m0, s41
    s_nop 0
    buffer_load_dwordx4 v11, s[16:19], s36 offen lds
    s_add_u32 s41, s39, s37
    s_add_u32 s41, s41, 4096
    s_mov_b32 m0, s41
    s_nop 0
    buffer_load_dwordx4 v12, s[16:19], s36 offen lds
    s_add_u32 s41, s39, s37
    s_add_u32 s41, s41, 5120
    s_mov_b32 m0, s41
    s_nop 0
    buffer_load_dwordx4 v13, s[16:19], s36 offen lds
    s_add_u32 s41, s39, s37
    s_add_u32 s41, s41, 6144
    s_mov_b32 m0, s41
    s_nop 0
    buffer_load_dwordx4 v14, s[16:19], s36 offen lds
    s_add_u32 s41, s39, s37
    s_add_u32 s41, s41, 7168
    s_mov_b32 m0, s41
    s_nop 0
    buffer_load_dwordx4 v15, s[16:19], s36 offen lds
    s_add_u32 s41, s39, s37
    s_add_u32 s41, s41, 8192
    s_mov_b32 m0, s41
    s_nop 0
    buffer_load_dwordx4 v16, s[16:19], s36 offen lds
    s_add_u32 s41, s39, s37
    s_add_u32 s41, s41, 9216
    s_mov_b32 m0, s41
    s_nop 0
    buffer_load_dwordx4 v17, s[16:19], s36 offen lds
    s_add_u32 s41, s39, s37
    s_add_u32 s41, s41, 10240
    s_mov_b32 m0, s41
    s_nop 0
    buffer_load_dwordx4 v18, s[16:19], s36 offen lds
    s_add_u32 s36, s36, 40960
    buffer_load_dwordx4 v[64:67], v4, s[12:15], s42 offen sc1
    s_add_u32 s42, s42, 1024
    buffer_load_dwordx4 v[68:71], v4, s[12:15], s42 offen sc1
    s_add_u32 s42, s42, 1024
    buffer_load_dwordx4 v[72:75], v4, s[12:15], s42 offen sc1
    s_add_u32 s42, s42, 1024
    buffer_load_dwordx4 v[76:79], v4, s[12:15], s42 offen sc1
    s_add_u32 s42, s42, 1024
    s_waitcnt vmcnt(15)
    s_barrier
    v_add_u32 v6, s38, v5
    ds_read_b64_tr_b16 v[32:33], v6 offset:0
    ds_read_b64_tr_b16 v[34:35], v6 offset:10752
    ds_read_b64_tr_b16 v[36:37], v6 offset:64
    ds_read_b64_tr_b16 v[38:39], v6 offset:10816
    ds_read_b64_tr_b16 v[40:41], v6 offset:128
    ds_read_b64_tr_b16 v[42:43], v6 offset:10880
    ds_read_b64_tr_b16 v[44:45], v6 offset:192
    ds_read_b64_tr_b16 v[46:47], v6 offset:10944
    s_waitcnt vmcnt(3)
    s_waitcnt lgkmcnt(6)
    v_mfma_f32_32x32x16_bf16 a[0:15], v[32:35], v[64:67], 0
    ds_read_b64_tr_b16 v[48:49], v6 offset:256
    ds_read_b64_tr_b16 v[50:51], v6 offset:11008
    s_waitcnt lgkmcnt(6)
    v_mfma_f32_32x32x16_bf16 a[16:31], v[36:39], v[64:67], 0
    ds_read_b64_tr_b16 v[52:53], v6 offset:320
    ds_read_b64_tr_b16 v[54:55], v6 offset:11072
    s_waitcnt lgkmcnt(6)
    v_mfma_f32_32x32x16_bf16 a[32:47], v[40:43], v[64:67], 0
    ds_read_b64_tr_b16 v[56:57], v6 offset:384
    ds_read_b64_tr_b16 v[58:59], v6 offset:11136
    s_waitcnt lgkmcnt(6)
    v_mfma_f32_32x32x16_bf16 a[48:63], v[44:47], v[64:67], 0
    ds_read_b64_tr_b16 v[60:61], v6 offset:448
    ds_read_b64_tr_b16 v[62:63], v6 offset:11200
    s_waitcnt lgkmcnt(6)
    v_mfma_f32_32x32x16_bf16 a[64:79], v[48:51], v[64:67], 0
    ds_read_b64_tr_b16 v[32:33], v6 offset:512
    ds_read_b64_tr_b16 v[34:35], v6 offset:11264
    s_waitcnt lgkmcnt(6)
    v_mfma_f32_32x32x16_bf16 a[80:95], v[52:55], v[64:67], 0
    ds_read_b64_tr_b16 v[36:37], v6 offset:576
    ds_read_b64_tr_b16 v[38:39], v6 offset:11328
    s_waitcnt lgkmcnt(6)
    v_mfma_f32_32x32x16_bf16 a[96:111], v[56:59], v[64:67], 0
    ds_read_b64_tr_b16 v[40:41], v6 offset:640
    ds_read_b64_tr_b16 v[42:43], v6 offset:11392
    s_waitcnt lgkmcnt(6)
    v_mfma_f32_32x32x16_bf16 a[112:127], v[60:63], v[64:67], 0
    ds_read_b64_tr_b16 v[44:45], v6 offset:704
    ds_read_b64_tr_b16 v[46:47], v6 offset:11456
    s_waitcnt lgkmcnt(6)
    v_mfma_f32_32x32x16_bf16 a[128:143], v[32:35], v[64:67], 0
    ds_read_b64_tr_b16 v[48:49], v6 offset:768
    ds_read_b64_tr_b16 v[50:51], v6 offset:11520
    s_waitcnt lgkmcnt(6)
    v_mfma_f32_32x32x16_bf16 a[144:159], v[36:39], v[64:67], 0
    ds_read_b64_tr_b16 v[52:53], v6 offset:832
    ds_read_b64_tr_b16 v[54:55], v6 offset:11584
    s_waitcnt lgkmcnt(6)
    v_mfma_f32_32x32x16_bf16 a[160:175], v[40:43], v[64:67], 0
    ds_read_b64_tr_b16 v[56:57], v6 offset:896
    ds_read_b64_tr_b16 v[58:59], v6 offset:11648
    s_waitcnt lgkmcnt(6)
    v_mfma_f32_32x32x16_bf16 a[176:191], v[44:47], v[64:67], 0
    ds_read_b64_tr_b16 v[60:61], v6 offset:960
    ds_read_b64_tr_b16 v[62:63], v6 offset:11712
    s_waitcnt lgkmcnt(6)
    v_mfma_f32_32x32x16_bf16 a[192:207], v[48:51], v[64:67], 0
    ds_read_b64_tr_b16 v[32:33], v6 offset:1024
    ds_read_b64_tr_b16 v[34:35], v6 offset:11776
    s_waitcnt lgkmcnt(6)
    v_mfma_f32_32x32x16_bf16 a[208:223], v[52:55], v[64:67], 0
    ds_read_b64_tr_b16 v[36:37], v6 offset:1088
    ds_read_b64_tr_b16 v[38:39], v6 offset:11840
    s_waitcnt lgkmcnt(6)
    v_mfma_f32_32x32x16_bf16 a[224:239], v[56:59], v[64:67], 0
    ds_read_b64_tr_b16 v[40:41], v6 offset:1152
    ds_read_b64_tr_b16 v[42:43], v6 offset:11904
    s_waitcnt lgkmcnt(6)
    v_mfma_f32_32x32x16_bf16 a[240:255], v[60:63], v[64:67], 0
    ds_read_b64_tr_b16 v[44:45], v6 offset:1216
    ds_read_b64_tr_b16 v[46:47], v6 offset:11968
    s_waitcnt lgkmcnt(6)
    v_mfma_f32_32x32x16_bf16 v[192:207], v[32:35], v[64:67], 0
    ds_read_b64_tr_b16 v[48:49], v6 offset:21504
    ds_read_b64_tr_b16 v[50:51], v6 offset:32256
    s_waitcnt lgkmcnt(6)
    v_mfma_f32_32x32x16_bf16 v[208:223], v[36:39], v[64:67], 0
    ds_read_b64_tr_b16 v[52:53], v6 offset:21568
    ds_read_b64_tr_b16 v[54:55], v6 offset:32320
    s_waitcnt lgkmcnt(6)
    v_mfma_f32_32x32x16_bf16 v[224:239], v[40:43], v[64:67], 0
    ds_read_b64_tr_b16 v[56:57], v6 offset:21632
    ds_read_b64_tr_b16 v[58:59], v6 offset:32384
    s_waitcnt lgkmcnt(6)
    v_mfma_f32_32x32x16_bf16 v[240:255], v[44:47], v[64:67], 0
    ds_read_b64_tr_b16 v[60:61], v6 offset:21696
    ds_read_b64_tr_b16 v[62:63], v6 offset:32448
    buffer_load_dwordx4 v[64:67], v4, s[12:15], s42 offen sc1
    s_add_u32 s42, s42, 1024
    s_waitcnt vmcnt(5)
    s_barrier
    v_add_u32 v7, s39, v5
    s_waitcnt vmcnt(3)
    s_waitcnt lgkmcnt(6)
    v_mfma_f32_32x32x16_bf16 a[0:15], v[48:51], v[68:71], a[0:15]
    ds_read_b64_tr_b16 v[32:33], v6 offset:21760
    ds_read_b64_tr_b16 v[34:35], v6 offset:32512
    s_add_u32 s41, s40, s37
    s_add_u32 s41, s41, 0
    s_mov_b32 m0, s41
    s_nop 0
    buffer_load_dwordx4 v8, s[16:19], s36 offen lds
    s_waitcnt lgkmcnt(6)
    v_mfma_f32_32x32x16_bf16 a[16:31], v[52:55], v[68:71], a[16:31]
    ds_read_b64_tr_b16 v[36:37], v6 offset:21824
    ds_read_b64_tr_b16 v[38:39], v6 offset:32576
    s_waitcnt lgkmcnt(6)
    v_mfma_f32_32x32x16_bf16 a[32:47], v[56:59], v[68:71], a[32:47]
    ds_read_b64_tr_b16 v[40:41], v6 offset:21888
    ds_read_b64_tr_b16 v[42:43], v6 offset:32640
    s_add_u32 s41, s40, s37
    s_add_u32 s41, s41, 1024
    s_mov_b32 m0, s41
    s_nop 0
    buffer_load_dwordx4 v9, s[16:19], s36 offen lds
    s_waitcnt lgkmcnt(6)
    v_mfma_f32_32x32x16_bf16 a[48:63], v[60:63], v[68:71], a[48:63]
    ds_read_b64_tr_b16 v[44:45], v6 offset:21952
    ds_read_b64_tr_b16 v[46:47], v6 offset:32704
    s_waitcnt lgkmcnt(6)
    v_mfma_f32_32x32x16_bf16 a[64:79], v[32:35], v[68:71], a[64:79]
    ds_read_b64_tr_b16 v[48:49], v6 offset:22016
    ds_read_b64_tr_b16 v[50:51], v6 offset:32768
    s_add_u32 s41, s40, s37
    s_add_u32 s41, s41, 2048
    s_mov_b32 m0, s41
    s_nop 0
    buffer_load_dwordx4 v10, s[16:19], s36 offen lds
    s_waitcnt lgkmcnt(6)
    v_mfma_f32_32x32x16_bf16 a[80:95], v[36:39], v[68:71], a[80:95]
    ds_read_b64_tr_b16 v[52:53], v6 offset:22080
    ds_read_b64_tr_b16 v[54:55], v6 offset:32832
    s_waitcnt lgkmcnt(6)
    v_mfma_f32_32x32x16_bf16 a[96:111], v[40:43], v[68:71], a[96:111]
    ds_read_b64_tr_b16 v[56:57], v6 offset:22144
    ds_read_b64_tr_b16 v[58:59], v6 offset:32896
    s_add_u32 s41, s40, s37
    s_add_u32 s41, s41, 3072
    s_mov_b32 m0, s41
    s_nop 0
    buffer_load_dwordx4 v11, s[16:19], s36 offen lds
    s_waitcnt lgkmcnt(6)
    v_mfma_f32_32x32x16_bf16 a[112:127], v[44:47], v[68:71], a[112:127]
    ds_read_b64_tr_b16 v[60:61], v6 offset:22208
    ds_read_b64_tr_b16 v[62:63], v6 offset:32960
    s_waitcnt lgkmcnt(6)
    v_mfma_f32_32x32x16_bf16 a[128:143], v[48:51], v[68:71], a[128:143]
    ds_read_b64_tr_b16 v[32:33], v6 offset:22272
    ds_read_b64_tr_b16 v[34:35], v6 offset:33024
    s_add_u32 s41, s40, s37
    s_add_u32 s41, s41, 4096
    s_mov_b32 m0, s41
    s_nop 0
    buffer_load_dwordx4 v12, s[16:19], s36 offen lds
    s_waitcnt lgkmcnt(6)
    v_mfma_f32_32x32x16_bf16 a[144:159], v[52:55], v[68:71], a[144:159]
    ds_read_b64_tr_b16 v[36:37], v6 offset:22336
    ds_read_b64_tr_b16 v[38:39], v6 offset:33088
    s_waitcnt lgkmcnt(6)
    v_mfma_f32_32x32x16_bf16 a[160:175], v[56:59], v[68:71], a[160:175]
    ds_read_b64_tr_b16 v[40:41], v6 offset:22400
    ds_read_b64_tr_b16 v[42:43], v6 offset:33152
    s_add_u32 s41, s40, s37
    s_add_u32 s41, s41, 5120
    s_mov_b32 m0, s41
    s_nop 0
    buffer_load_dwordx4 v13, s[16:19], s36 offen lds
    s_waitcnt lgkmcnt(6)
    v_mfma_f32_32x32x16_bf16 a[176:191], v[60:63], v[68:71], a[176:191]
    ds_read_b64_tr_b16 v[44:45], v6 offset:22464
    ds_read_b64_tr_b16 v[46:47], v6 offset:33216
    s_waitcnt lgkmcnt(6)
    v_mfma_f32_32x32x16_bf16 a[192:207], v[32:35], v[68:71], a[192:207]
    ds_read_b64_tr_b16 v[48:49], v6 offset:22528
    ds_read_b64_tr_b16 v[50:51], v6 offset:33280
    s_add_u32 s41, s40, s37
    s_add_u32 s41, s41, 6144
    s_mov_b32 m0, s41
    s_nop 0
    buffer_load_dwordx4 v14, s[16:19], s36 offen lds
    s_waitcnt lgkmcnt(6)
    v_mfma_f32_32x32x16_bf16 a[208:223], v[36:39], v[68:71], a[208:223]
    ds_read_b64_tr_b16 v[52:53], v6 offset:22592
    ds_read_b64_tr_b16 v[54:55], v6 offset:33344
    s_waitcnt lgkmcnt(6)
    v_mfma_f32_32x32x16_bf16 a[224:239], v[40:43], v[68:71], a[224:239]
    ds_read_b64_tr_b16 v[56:57], v6 offset:22656
    ds_read_b64_tr_b16 v[58:59], v6 offset:33408
    s_add_u32 s41, s40, s37
    s_add_u32 s41, s41, 7168
    s_mov_b32 m0, s41
    s_nop 0
    buffer_load_dwordx4 v15, s[16:19], s36 offen lds
    s_waitcnt lgkmcnt(6)
    v_mfma_f32_32x32x16_bf16 a[240:255], v[44:47], v[68:71], a[240:255]
    ds_read_b64_tr_b16 v[60:61], v6 offset:22720
    ds_read_b64_tr_b16 v[62:63], v6 offset:33472
    s_waitcnt lgkmcnt(6)
    v_mfma_f32_32x32x16_bf16 v[192:207], v[48:51], v[68:71], v[192:207]
    ds_read_b64_tr_b16 v[32:33], v7 offset:0
    ds_read_b64_tr_b16 v[34:35], v7 offset:10752
    s_add_u32 s41, s40, s37
    s_add_u32 s41, s41, 8192
    s_mov_b32 m0, s41
    s_nop 0
    buffer_load_dwordx4 v16, s[16:19], s36 offen lds
    s_waitcnt lgkmcnt(6)
    v_mfma_f32_32x32x16_bf16 v[208:223], v[52:55], v[68:71], v[208:223]
    ds_read_b64_tr_b16 v[36:37], v7 offset:64
    ds_read_b64_tr_b16 v[38:39], v7 offset:10816
    s_waitcnt lgkmcnt(6)
    v_mfma_f32_32x32x16_bf16 v[224:239], v[56:59], v[68:71], v[224:239]
    ds_read_b64_tr_b16 v[40:41], v7 offset:128
    ds_read_b64_tr_b16 v[42:43], v7 offset:10880
    s_add_u32 s41, s40, s37
    s_add_u32 s41, s41, 9216
    s_mov_b32 m0, s41
    s_nop 0
    buffer_load_dwordx4 v17, s[16:19], s36 offen lds
    s_waitcnt lgkmcnt(6)
    v_mfma_f32_32x32x16_bf16 v[240:255], v[60:63], v[68:71], v[240:255]
    ds_read_b64_tr_b16 v[44:45], v7 offset:192
    ds_read_b64_tr_b16 v[46:47], v7 offset:10944
    s_add_u32 s41, s40, s37
    s_add_u32 s41, s41, 10240
    s_mov_b32 m0, s41
    s_nop 0
    buffer_load_dwordx4 v18, s[16:19], s36 offen lds
    buffer_load_dwordx4 v[68:71], v4, s[12:15], s42 offen sc1
    s_add_u32 s42, s42, 1024
    s_add_u32 s36, s36, 40960
    s_mov_b32 s41, s38
    s_mov_b32 s38, s39
    s_mov_b32 s39, s40
    s_mov_b32 s40, s41
    v_mov_b32 v6, v7
    s_waitcnt vmcnt(14)
    s_waitcnt lgkmcnt(6)
    v_mfma_f32_32x32x16_bf16 a[0:15], v[32:35], v[72:75], a[0:15]
    ds_read_b64_tr_b16 v[48:49], v6 offset:256
    ds_read_b64_tr_b16 v[50:51], v6 offset:11008
    s_waitcnt lgkmcnt(6)
    v_mfma_f32_32x32x16_bf16 a[16:31], v[36:39], v[72:75], a[16:31]
    ds_read_b64_tr_b16 v[52:53], v6 offset:320
    ds_read_b64_tr_b16 v[54:55], v6 offset:11072
    s_waitcnt lgkmcnt(6)
    v_mfma_f32_32x32x16_bf16 a[32:47], v[40:43], v[72:75], a[32:47]
    ds_read_b64_tr_b16 v[56:57], v6 offset:384
    ds_read_b64_tr_b16 v[58:59], v6 offset:11136
    s_waitcnt lgkmcnt(6)
    v_mfma_f32_32x32x16_bf16 a[48:63], v[44:47], v[72:75], a[48:63]
    ds_read_b64_tr_b16 v[60:61], v6 offset:448
    ds_read_b64_tr_b16 v[62:63], v6 offset:11200
    s_waitcnt lgkmcnt(6)
    v_mfma_f32_32x32x16_bf16 a[64:79], v[48:51], v[72:75], a[64:79]
    ds_read_b64_tr_b16 v[32:33], v6 offset:512
    ds_read_b64_tr_b16 v[34:35], v6 offset:11264
    s_waitcnt lgkmcnt(6)
    v_mfma_f32_32x32x16_bf16 a[80:95], v[52:55], v[72:75], a[80:95]
    ds_read_b64_tr_b16 v[36:37], v6 offset:576
    ds_read_b64_tr_b16 v[38:39], v6 offset:11328
    s_waitcnt lgkmcnt(6)
    v_mfma_f32_32x32x16_bf16 a[96:111], v[56:59], v[72:75], a[96:111]
    ds_read_b64_tr_b16 v[40:41], v6 offset:640
    ds_read_b64_tr_b16 v[42:43], v6 offset:11392
    s_waitcnt lgkmcnt(6)
    v_mfma_f32_32x32x16_bf16 a[112:127], v[60:63], v[72:75], a[112:127]
    ds_read_b64_tr_b16 v[44:45], v6 offset:704
    ds_read_b64_tr_b16 v[46:47], v6 offset:11456
    s_waitcnt lgkmcnt(6)
    v_mfma_f32_32x32x16_bf16 a[128:143], v[32:35], v[72:75], a[128:143]
    ds_read_b64_tr_b16 v[48:49], v6 offset:768
    ds_read_b64_tr_b16 v[50:51], v6 offset:11520
    s_waitcnt lgkmcnt(6)
    v_mfma_f32_32x32x16_bf16 a[144:159], v[36:39], v[72:75], a[144:159]
    ds_read_b64_tr_b16 v[52:53], v6 offset:832
    ds_read_b64_tr_b16 v[54:55], v6 offset:11584
    s_waitcnt lgkmcnt(6)
    v_mfma_f32_32x32x16_bf16 a[160:175], v[40:43], v[72:75], a[160:175]
    ds_read_b64_tr_b16 v[56:57], v6 offset:896
    ds_read_b64_tr_b16 v[58:59], v6 offset:11648
    s_waitcnt lgkmcnt(6)
    v_mfma_f32_32x32x16_bf16 a[176:191], v[44:47], v[72:75], a[176:191]
    ds_read_b64_tr_b16 v[60:61], v6 offset:960
    ds_read_b64_tr_b16 v[62:63], v6 offset:11712
    s_waitcnt lgkmcnt(6)
    v_mfma_f32_32x32x16_bf16 a[192:207], v[48:51], v[72:75], a[192:207]
    ds_read_b64_tr_b16 v[32:33], v6 offset:1024
    ds_read_b64_tr_b16 v[34:35], v6 offset:11776
    s_waitcnt lgkmcnt(6)
    v_mfma_f32_32x32x16_bf16 a[208:223], v[52:55], v[72:75], a[208:223]
    ds_read_b64_tr_b16 v[36:37], v6 offset:1088
    ds_read_b64_tr_b16 v[38:39], v6 offset:11840
    s_waitcnt lgkmcnt(6)
    v_mfma_f32_32x32x16_bf16 a[224:239], v[56:59], v[72:75], a[224:239]
    ds_read_b64_tr_b16 v[40:41], v6 offset:1152
    ds_read_b64_tr_b16 v[42:43], v6 offset:11904
    s_waitcnt lgkmcnt(6)
    v_mfma_f32_32x32x16_bf16 a[240:255], v[60:63], v[72:75], a[240:255]
    ds_read_b64_tr_b16 v[44:45], v6 offset:1216
    ds_read_b64_tr_b16 v[46:47], v6 offset:11968
    s_waitcnt lgkmcnt(6)
    v_mfma_f32_32x32x16_bf16 v[192:207], v[32:35], v[72:75], v[192:207]
    ds_read_b64_tr_b16 v[48:49], v6 offset:21504
    ds_read_b64_tr_b16 v[50:51], v6 offset:32256
    s_waitcnt lgkmcnt(6)
    v_mfma_f32_32x32x16_bf16 v[208:223], v[36:39], v[72:75], v[208:223]
    ds_read_b64_tr_b16 v[52:53], v6 offset:21568
    ds_read_b64_tr_b16 v[54:55], v6 offset:32320
    s_waitcnt lgkmcnt(6)
    v_mfma_f32_32x32x16_bf16 v[224:239], v[40:43], v[72:75], v[224:239]
    ds_read_b64_tr_b16 v[56:57], v6 offset:21632
    ds_read_b64_tr_b16 v[58:59], v6 offset:32384
    s_waitcnt lgkmcnt(6)
    v_mfma_f32_32x32x16_bf16 v[240:255], v[44:47], v[72:75], v[240:255]
    ds_read_b64_tr_b16 v[60:61], v6 offset:21696
    ds_read_b64_tr_b16 v[62:63], v6 offset:32448
    buffer_load_dwordx4 v[72:75], v4, s[12:15], s42 offen sc1
    s_add_u32 s42, s42, 1024
    s_waitcnt vmcnt(2)
    s_barrier
    v_add_u32 v7, s39, v5
    s_waitcnt vmcnt(14)
    s_waitcnt lgkmcnt(6)
    v_mfma_f32_32x32x16_bf16 a[0:15], v[48:51], v[76:79], a[0:15]
    ds_read_b64_tr_b16 v[32:33], v6 offset:21760
    ds_read_b64_tr_b16 v[34:35], v6 offset:32512
    s_add_u32 s41, s40, s37
    s_add_u32 s41, s41, 0
    s_mov_b32 m0, s41
    s_nop 0
    buffer_load_dwordx4 v8, s[16:19], s36 offen lds
    s_waitcnt lgkmcnt(6)
    v_mfma_f32_32x32x16_bf16 a[16:31], v[52:55], v[76:79], a[16:31]
    ds_read_b64_tr_b16 v[36:37], v6 offset:21824
    ds_read_b64_tr_b16 v[38:39], v6 offset:32576
    s_waitcnt lgkmcnt(6)
    v_mfma_f32_32x32x16_bf16 a[32:47], v[56:59], v[76:79], a[32:47]
    ds_read_b64_tr_b16 v[40:41], v6 offset:21888
    ds_read_b64_tr_b16 v[42:43], v6 offset:32640
    s_add_u32 s41, s40, s37
    s_add_u32 s41, s41, 1024
    s_mov_b32 m0, s41
    s_nop 0
    buffer_load_dwordx4 v9, s[16:19], s36 offen lds
    s_waitcnt lgkmcnt(6)
    v_mfma_f32_32x32x16_bf16 a[48:63], v[60:63], v[76:79], a[48:63]
    ds_read_b64_tr_b16 v[44:45], v6 offset:21952
    ds_read_b64_tr_b16 v[46:47], v6 offset:32704
    s_waitcnt lgkmcnt(6)
    v_mfma_f32_32x32x16_bf16 a[64:79], v[32:35], v[76:79], a[64:79]
    ds_read_b64_tr_b16 v[48:49], v6 offset:22016
    ds_read_b64_tr_b16 v[50:51], v6 offset:32768
    s_add_u32 s41, s40, s37
    s_add_u32 s41, s41, 2048
    s_mov_b32 m0, s41
    s_nop 0
    buffer_load_dwordx4 v10, s[16:19], s36 offen lds
    s_waitcnt lgkmcnt(6)
    v_mfma_f32_32x32x16_bf16 a[80:95], v[36:39], v[76:79], a[80:95]
    ds_read_b64_tr_b16 v[52:53], v6 offset:22080
    ds_read_b64_tr_b16 v[54:55], v6 offset:32832
    s_waitcnt lgkmcnt(6)
    v_mfma_f32_32x32x16_bf16 a[96:111], v[40:43], v[76:79], a[96:111]
    ds_read_b64_tr_b16 v[56:57], v6 offset:22144
    ds_read_b64_tr_b16 v[58:59], v6 offset:32896
    s_add_u32 s41, s40, s37
    s_add_u32 s41, s41, 3072
    s_mov_b32 m0, s41
    s_nop 0
    buffer_load_dwordx4 v11, s[16:19], s36 offen lds
    s_waitcnt lgkmcnt(6)
    v_mfma_f32_32x32x16_bf16 a[112:127], v[44:47], v[76:79], a[112:127]
    ds_read_b64_tr_b16 v[60:61], v6 offset:22208
    ds_read_b64_tr_b16 v[62:63], v6 offset:32960
    s_waitcnt lgkmcnt(6)
    v_mfma_f32_32x32x16_bf16 a[128:143], v[48:51], v[76:79], a[128:143]
    ds_read_b64_tr_b16 v[32:33], v6 offset:22272
    ds_read_b64_tr_b16 v[34:35], v6 offset:33024
    s_add_u32 s41, s40, s37
    s_add_u32 s41, s41, 4096
    s_mov_b32 m0, s41
    s_nop 0
    buffer_load_dwordx4 v12, s[16:19], s36 offen lds
    s_waitcnt lgkmcnt(6)
    v_mfma_f32_32x32x16_bf16 a[144:159], v[52:55], v[76:79], a[144:159]
    ds_read_b64_tr_b16 v[36:37], v6 offset:22336
    ds_read_b64_tr_b16 v[38:39], v6 offset:33088
    s_waitcnt lgkmcnt(6)
    v_mfma_f32_32x32x16_bf16 a[160:175], v[56:59], v[76:79], a[160:175]
    ds_read_b64_tr_b16 v[40:41], v6 offset:22400
    ds_read_b64_tr_b16 v[42:43], v6 offset:33152
    s_add_u32 s41, s40, s37
    s_add_u32 s41, s41, 5120
    s_mov_b32 m0, s41
    s_nop 0
    buffer_load_dwordx4 v13, s[16:19], s36 offen lds
    s_waitcnt lgkmcnt(6)
    v_mfma_f32_32x32x16_bf16 a[176:191], v[60:63], v[76:79], a[176:191]
    ds_read_b64_tr_b16 v[44:45], v6 offset:22464
    ds_read_b64_tr_b16 v[46:47], v6 offset:33216
    s_waitcnt lgkmcnt(6)
    v_mfma_f32_32x32x16_bf16 a[192:207], v[32:35], v[76:79], a[192:207]
    ds_read_b64_tr_b16 v[48:49], v6 offset:22528
    ds_read_b64_tr_b16 v[50:51], v6 offset:33280
    s_add_u32 s41, s40, s37
    s_add_u32 s41, s41, 6144
    s_mov_b32 m0, s41
    s_nop 0
    buffer_load_dwordx4 v14, s[16:19], s36 offen lds
    s_waitcnt lgkmcnt(6)
    v_mfma_f32_32x32x16_bf16 a[208:223], v[36:39], v[76:79], a[208:223]
    ds_read_b64_tr_b16 v[52:53], v6 offset:22592
    ds_read_b64_tr_b16 v[54:55], v6 offset:33344
    s_waitcnt lgkmcnt(6)
    v_mfma_f32_32x32x16_bf16 a[224:239], v[40:43], v[76:79], a[224:239]
    ds_read_b64_tr_b16 v[56:57], v6 offset:22656
    ds_read_b64_tr_b16 v[58:59], v6 offset:33408
    s_add_u32 s41, s40, s37
    s_add_u32 s41, s41, 7168
    s_mov_b32 m0, s41
    s_nop 0
    buffer_load_dwordx4 v15, s[16:19], s36 offen lds
    s_waitcnt lgkmcnt(6)
    v_mfma_f32_32x32x16_bf16 a[240:255], v[44:47], v[76:79], a[240:255]
    ds_read_b64_tr_b16 v[60:61], v6 offset:22720
    ds_read_b64_tr_b16 v[62:63], v6 offset:33472
    s_waitcnt lgkmcnt(6)
    v_mfma_f32_32x32x16_bf16 v[192:207], v[48:51], v[76:79], v[192:207]
    ds_read_b64_tr_b16 v[32:33], v7 offset:0
    ds_read_b64_tr_b16 v[34:35], v7 offset:10752
    s_add_u32 s41, s40, s37
    s_add_u32 s41, s41, 8192
    s_mov_b32 m0, s41
    s_nop 0
    buffer_load_dwordx4 v16, s[16:19], s36 offen lds
    s_waitcnt lgkmcnt(6)
    v_mfma_f32_32x32x16_bf16 v[208:223], v[52:55], v[76:79], v[208:223]
    ds_read_b64_tr_b16 v[36:37], v7 offset:64
    ds_read_b64_tr_b16 v[38:39], v7 offset:10816
    s_waitcnt lgkmcnt(6)
    v_mfma_f32_32x32x16_bf16 v[224:239], v[56:59], v[76:79], v[224:239]
    ds_read_b64_tr_b16 v[40:41], v7 offset:128
    ds_read_b64_tr_b16 v[42:43], v7 offset:10880
    s_add_u32 s41, s40, s37
    s_add_u32 s41, s41, 9216
    s_mov_b32 m0, s41
    s_nop 0
    buffer_load_dwordx4 v17, s[16:19], s36 offen lds
    s_waitcnt lgkmcnt(6)
    v_mfma_f32_32x32x16_bf16 v[240:255], v[60:63], v[76:79], v[240:255]
    ds_read_b64_tr_b16 v[44:45], v7 offset:192
    ds_read_b64_tr_b16 v[46:47], v7 offset:10944
    s_add_u32 s41, s40, s37
    s_add_u32 s41, s41, 10240
    s_mov_b32 m0, s41
    s_nop 0
    buffer_load_dwordx4 v18, s[16:19], s36 offen lds
    buffer_load_dwordx4 v[76:79], v4, s[12:15], s42 offen sc1
    s_add_u32 s42, s42, 1024
    s_add_u32 s36, s36, 40960
    s_mov_b32 s41, s38
    s_mov_b32 s38, s39
    s_mov_b32 s39, s40
    s_mov_b32 s40, s41
    v_mov_b32 v6, v7
    s_mov_b32 s43, 2
POG_loop:
    s_waitcnt vmcnt(25)
    s_waitcnt lgkmcnt(6)
    v_mfma_f32_32x32x16_bf16 a[0:15], v[32:35], v[64:67], a[0:15]
    ds_read_b64_tr_b16 v[48:49], v6 offset:256
    ds_read_b64_tr_b16 v[50:51], v6 offset:11008
    s_waitcnt lgkmcnt(6)
    v_mfma_f32_32x32x16_bf16 a[16:31], v[36:39], v[64:67], a[16:31]
    ds_read_b64_tr_b16 v[52:53], v6 offset:320
    ds_read_b64_tr_b16 v[54:55], v6 offset:11072
    s_waitcnt lgkmcnt(6)
    v_mfma_f32_32x32x16_bf16 a[32:47], v[40:43], v[64:67], a[32:47]
    ds_read_b64_tr_b16 v[56:57], v6 offset:384
    ds_read_b64_tr_b16 v[58:59], v6 offset:11136
    s_waitcnt lgkmcnt(6)
    v_mfma_f32_32x32x16_bf16 a[48:63], v[44:47], v[64:67], a[48:63]
    ds_read_b64_tr_b16 v[60:61], v6 offset:448
    ds_read_b64_tr_b16 v[62:63], v6 offset:11200
    s_waitcnt lgkmcnt(6)
    v_mfma_f32_32x32x16_bf16 a[64:79], v[48:51], v[64:67], a[64:79]
    ds_read_b64_tr_b16 v[32:33], v6 offset:512
    ds_read_b64_tr_b16 v[34:35], v6 offset:11264
    s_waitcnt lgkmcnt(6)
    v_mfma_f32_32x32x16_bf16 a[80:95], v[52:55], v[64:67], a[80:95]
    ds_read_b64_tr_b16 v[36:37], v6 offset:576
    ds_read_b64_tr_b16 v[38:39], v6 offset:11328
    s_waitcnt lgkmcnt(6)
    v_mfma_f32_32x32x16_bf16 a[96:111], v[56:59], v[64:67], a[96:111]
    ds_read_b64_tr_b16 v[40:41], v6 offset:640
    ds_read_b64_tr_b16 v[42:43], v6 offset:11392
    s_waitcnt lgkmcnt(6)
    v_mfma_f32_32x32x16_bf16 a[112:127], v[60:63], v[64:67], a[112:127]
    ds_read_b64_tr_b16 v[44:45], v6 offset:704
    ds_read_b64_tr_b16 v[46:47], v6 offset:11456
    s_waitcnt lgkmcnt(6)
    v_mfma_f32_32x32x16_bf16 a[128:143], v[32:35], v[64:67], a[128:143]
    ds_read_b64_tr_b16 v[48:49], v6 offset:768
    ds_read_b64_tr_b16 v[50:51], v6 offset:11520
    s_waitcnt lgkmcnt(6)
    v_mfma_f32_32x32x16_bf16 a[144:159], v[36:39], v[64:67], a[144:159]
    ds_read_b64_tr_b16 v[52:53], v6 offset:832
    ds_read_b64_tr_b16 v[54:55], v6 offset:11584
    s_waitcnt lgkmcnt(6)
    v_mfma_f32_32x32x16_bf16 a[160:175], v[40:43], v[64:67], a[160:175]
    ds_read_b64_tr_b16 v[56:57], v6 offset:896
    ds_read_b64_tr_b16 v[58:59], v6 offset:11648
    s_waitcnt lgkmcnt(6)
    v_mfma_f32_32x32x16_bf16 a[176:191], v[44:47], v[64:67], a[176:191]
    ds_read_b64_tr_b16 v[60:61], v6 offset:960
    ds_read_b64_tr_b16 v[62:63], v6 offset:11712
    s_waitcnt lgkmcnt(6)
    v_mfma_f32_32x32x16_bf16 a[192:207], v[48:51], v[64:67], a[192:207]
    ds_read_b64_tr_b16 v[32:33], v6 offset:1024
    ds_read_b64_tr_b16 v[34:35], v6 offset:11776
    s_waitcnt lgkmcnt(6)
    v_mfma_f32_32x32x16_bf16 a[208:223], v[52:55], v[64:67], a[208:223]
    ds_read_b64_tr_b16 v[36:37], v6 offset:1088
    ds_read_b64_tr_b16 v[38:39], v6 offset:11840
    s_waitcnt lgkmcnt(6)
    v_mfma_f32_32x32x16_bf16 a[224:239], v[56:59], v[64:67], a[224:239]
    ds_read_b64_tr_b16 v[40:41], v6 offset:1152
    ds_read_b64_tr_b16 v[42:43], v6 offset:11904
    s_waitcnt lgkmcnt(6)
    v_mfma_f32_32x32x16_bf16 a[240:255], v[60:63], v[64:67], a[240:255]
    ds_read_b64_tr_b16 v[44:45], v6 offset:1216
    ds_read_b64_tr_b16 v[46:47], v6 offset:11968
    s_waitcnt lgkmcnt(6)
    v_mfma_f32_32x32x16_bf16 v[192:207], v[32:35], v[64:67], v[192:207]
    ds_read_b64_tr_b16 v[48:49], v6 offset:21504
    ds_read_b64_tr_b16 v[50:51], v6 offset:32256
    s_waitcnt lgkmcnt(6)
    v_mfma_f32_32x32x16_bf16 v[208:223], v[36:39], v[64:67], v[208:223]
    ds_read_b64_tr_b16 v[52:53], v6 offset:21568
    ds_read_b64_tr_b16 v[54:55], v6 offset:32320
    s_waitcnt lgkmcnt(6)
    v_mfma_f32_32x32x16_bf16 v[224:239], v[40:43], v[64:67], v[224:239]
    ds_read_b64_tr_b16 v[56:57], v6 offset:21632
    ds_read_b64_tr_b16 v[58:59], v6 offset:32384
    s_waitcnt lgkmcnt(6)
    v_mfma_f32_32x32x16_bf16 v[240:255], v[44:47], v[64:67], v[240:255]
    ds_read_b64_tr_b16 v[60:61], v6 offset:21696
    ds_read_b64_tr_b16 v[62:63], v6 offset:32448
    buffer_load_dwordx4 v[64:67], v4, s[12:15], s42 offen sc1
    s_add_u32 s42, s42, 1024
    s_waitcnt vmcnt(2)
    s_barrier
    v_add_u32 v7, s39, v5
    s_waitcnt vmcnt(14)
    s_waitcnt lgkmcnt(6)
    v_mfma_f32_32x32x16_bf16 a[0:15], v[48:51], v[68:71], a[0:15]
    ds_read_b64_tr_b16 v[32:33], v6 offset:21760
    ds_read_b64_tr_b16 v[34:35], v6 offset:32512
    s_add_u32 s41, s40, s37
    s_add_u32 s41, s41, 0
    s_mov_b32 m0, s41
    s_nop 0
    buffer_load_dwordx4 v8, s[16:19], s36 offen lds
    s_waitcnt lgkmcnt(6)
    v_mfma_f32_32x32x16_bf16 a[16:31], v[52:55], v[68:71], a[16:31]
    ds_read_b64_tr_b16 v[36:37], v6 offset:21824
    ds_read_b64_tr_b16 v[38:39], v6 offset:32576
    s_waitcnt lgkmcnt(6)
    v_mfma_f32_32x32x16_bf16 a[32:47], v[56:59], v[68:71], a[32:47]
    ds_read_b64_tr_b16 v[40:41], v6 offset:21888
    ds_read_b64_tr_b16 v[42:43], v6 offset:32640
    s_add_u32 s41, s40, s37
    s_add_u32 s41, s41, 1024
    s_mov_b32 m0, s41
    s_nop 0
    buffer_load_dwordx4 v9, s[16:19], s36 offen lds
    s_waitcnt lgkmcnt(6)
    v_mfma_f32_32x32x16_bf16 a[48:63], v[60:63], v[68:71], a[48:63]
    ds_read_b64_tr_b16 v[44:45], v6 offset:21952
    ds_read_b64_tr_b16 v[46:47], v6 offset:32704
    s_waitcnt lgkmcnt(6)
    v_mfma_f32_32x32x16_bf16 a[64:79], v[32:35], v[68:71], a[64:79]
    ds_read_b64_tr_b16 v[48:49], v6 offset:22016
    ds_read_b64_tr_b16 v[50:51], v6 offset:32768
    s_add_u32 s41, s40, s37
    s_add_u32 s41, s41, 2048
    s_mov_b32 m0, s41
    s_nop 0
    buffer_load_dwordx4 v10, s[16:19], s36 offen lds
    s_waitcnt lgkmcnt(6)
    v_mfma_f32_32x32x16_bf16 a[80:95], v[36:39], v[68:71], a[80:95]
    ds_read_b64_tr_b16 v[52:53], v6 offset:22080
    ds_read_b64_tr_b16 v[54:55], v6 offset:32832
    s_waitcnt lgkmcnt(6)
    v_mfma_f32_32x32x16_bf16 a[96:111], v[40:43], v[68:71], a[96:111]
    ds_read_b64_tr_b16 v[56:57], v6 offset:22144
    ds_read_b64_tr_b16 v[58:59], v6 offset:32896
    s_add_u32 s41, s40, s37
    s_add_u32 s41, s41, 3072
    s_mov_b32 m0, s41
    s_nop 0
    buffer_load_dwordx4 v11, s[16:19], s36 offen lds
    s_waitcnt lgkmcnt(6)
    v_mfma_f32_32x32x16_bf16 a[112:127], v[44:47], v[68:71], a[112:127]
    ds_read_b64_tr_b16 v[60:61], v6 offset:22208
    ds_read_b64_tr_b16 v[62:63], v6 offset:32960
    s_waitcnt lgkmcnt(6)
    v_mfma_f32_32x32x16_bf16 a[128:143], v[48:51], v[68:71], a[128:143]
    ds_read_b64_tr_b16 v[32:33], v6 offset:22272
    ds_read_b64_tr_b16 v[34:35], v6 offset:33024
    s_add_u32 s41, s40, s37
    s_add_u32 s41, s41, 4096
    s_mov_b32 m0, s41
    s_nop 0
    buffer_load_dwordx4 v12, s[16:19], s36 offen lds
    s_waitcnt lgkmcnt(6)
    v_mfma_f32_32x32x16_bf16 a[144:159], v[52:55], v[68:71], a[144:159]
    ds_read_b64_tr_b16 v[36:37], v6 offset:22336
    ds_read_b64_tr_b16 v[38:39], v6 offset:33088
    s_waitcnt lgkmcnt(6)
    v_mfma_f32_32x32x16_bf16 a[160:175], v[56:59], v[68:71], a[160:175]
    ds_read_b64_tr_b16 v[40:41], v6 offset:22400
    ds_read_b64_tr_b16 v[42:43], v6 offset:33152
    s_add_u32 s41, s40, s37
    s_add_u32 s41, s41, 5120
    s_mov_b32 m0, s41
    s_nop 0
    buffer_load_dwordx4 v13, s[16:19], s36 offen lds
    s_waitcnt lgkmcnt(6)
    v_mfma_f32_32x32x16_bf16 a[176:191], v[60:63], v[68:71], a[176:191]
    ds_read_b64_tr_b16 v[44:45], v6 offset:22464
    ds_read_b64_tr_b16 v[46:47], v6 offset:33216
    s_waitcnt lgkmcnt(6)
    v_mfma_f32_32x32x16_bf16 a[192:207], v[32:35], v[68:71], a[192:207]
    ds_read_b64_tr_b16 v[48:49], v6 offset:22528
    ds_read_b64_tr_b16 v[50:51], v6 offset:33280
    s_add_u32 s41, s40, s37
    s_add_u32 s41, s41, 6144
    s_mov_b32 m0, s41
    s_nop 0
    buffer_load_dwordx4 v14, s[16:19], s36 offen lds
    s_waitcnt lgkmcnt(6)
    v_mfma_f32_32x32x16_bf16 a[208:223], v[36:39], v[68:71], a[208:223]
    ds_read_b64_tr_b16 v[52:53], v6 offset:22592
    ds_read_b64_tr_b16 v[54:55], v6 offset:33344
    s_waitcnt lgkmcnt(6)
    v_mfma_f32_32x32x16_bf16 a[224:239], v[40:43], v[68:71], a[224:239]
    ds_read_b64_tr_b16 v[56:57], v6 offset:22656
    ds_read_b64_tr_b16 v[58:59], v6 offset:33408
    s_add_u32 s41, s40, s37
    s_add_u32 s41, s41, 7168
    s_mov_b32 m0, s41
    s_nop 0
    buffer_load_dwordx4 v15, s[16:19], s36 offen lds
    s_waitcnt lgkmcnt(6)
    v_mfma_f32_32x32x16_bf16 a[240:255], v[44:47], v[68:71], a[240:255]
    ds_read_b64_tr_b16 v[60:61], v6 offset:22720
    ds_read_b64_tr_b16 v[62:63], v6 offset:33472
    s_waitcnt lgkmcnt(6)
    v_mfma_f32_32x32x16_bf16 v[192:207], v[48:51], v[68:71], v[192:207]
    ds_read_b64_tr_b16 v[32:33], v7 offset:0
    ds_read_b64_tr_b16 v[34:35], v7 offset:10752
    s_add_u32 s41, s40, s37
    s_add_u32 s41, s41, 8192
    s_mov_b32 m0, s41
    s_nop 0
    buffer_load_dwordx4 v16, s[16:19], s36 offen lds
    s_waitcnt lgkmcnt(6)
    v_mfma_f32_32x32x16_bf16 v[208:223], v[52:55], v[68:71], v[208:223]
    ds_read_b64_tr_b16 v[36:37], v7 offset:64
    ds_read_b64_tr_b16 v[38:39], v7 offset:10816
    s_waitcnt lgkmcnt(6)
    v_mfma_f32_32x32x16_bf16 v[224:239], v[56:59], v[68:71], v[224:239]
    ds_read_b64_tr_b16 v[40:41], v7 offset:128
    ds_read_b64_tr_b16 v[42:43], v7 offset:10880
    s_add_u32 s41, s40, s37
    s_add_u32 s41, s41, 9216
    s_mov_b32 m0, s41
    s_nop 0
    buffer_load_dwordx4 v17, s[16:19], s36 offen lds
    s_waitcnt lgkmcnt(6)
    v_mfma_f32_32x32x16_bf16 v[240:255], v[60:63], v[68:71], v[240:255]
    ds_read_b64_tr_b16 v[44:45], v7 offset:192
    ds_read_b64_tr_b16 v[46:47], v7 offset:10944
    s_add_u32 s41, s40, s37
    s_add_u32 s41, s41, 10240
    s_mov_b32 m0, s41
    s_nop 0
    buffer_load_dwordx4 v18, s[16:19], s36 offen lds
    buffer_load_dwordx4 v[68:71], v4, s[12:15], s42 offen sc1
    s_add_u32 s42, s42, 1024
    s_add_u32 s36, s36, 40960
    s_mov_b32 s41, s38
    s_mov_b32 s38, s39
    s_mov_b32 s39, s40
    s_mov_b32 s40, s41
    v_mov_b32 v6, v7
    s_waitcnt vmcnt(25)
    s_waitcnt lgkmcnt(6)
    v_mfma_f32_32x32x16_bf16 a[0:15], v[32:35], v[72:75], a[0:15]
    ds_read_b64_tr_b16 v[48:49], v6 offset:256
    ds_read_b64_tr_b16 v[50:51], v6 offset:11008
    s_waitcnt lgkmcnt(6)
    v_mfma_f32_32x32x16_bf16 a[16:31], v[36:39], v[72:75], a[16:31]
    ds_read_b64_tr_b16 v[52:53], v6 offset:320
    ds_read_b64_tr_b16 v[54:55], v6 offset:11072
    s_waitcnt lgkmcnt(6)
    v_mfma_f32_32x32x16_bf16 a[32:47], v[40:43], v[72:75], a[32:47]
    ds_read_b64_tr_b16 v[56:57], v6 offset:384
    ds_read_b64_tr_b16 v[58:59], v6 offset:11136
    s_waitcnt lgkmcnt(6)
    v_mfma_f32_32x32x16_bf16 a[48:63], v[44:47], v[72:75], a[48:63]
    ds_read_b64_tr_b16 v[60:61], v6 offset:448
    ds_read_b64_tr_b16 v[62:63], v6 offset:11200
    s_waitcnt lgkmcnt(6)
    v_mfma_f32_32x32x16_bf16 a[64:79], v[48:51], v[72:75], a[64:79]
    ds_read_b64_tr_b16 v[32:33], v6 offset:512
    ds_read_b64_tr_b16 v[34:35], v6 offset:11264
    s_waitcnt lgkmcnt(6)
    v_mfma_f32_32x32x16_bf16 a[80:95], v[52:55], v[72:75], a[80:95]
    ds_read_b64_tr_b16 v[36:37], v6 offset:576
    ds_read_b64_tr_b16 v[38:39], v6 offset:11328
    s_waitcnt lgkmcnt(6)
    v_mfma_f32_32x32x16_bf16 a[96:111], v[56:59], v[72:75], a[96:111]
    ds_read_b64_tr_b16 v[40:41], v6 offset:640
    ds_read_b64_tr_b16 v[42:43], v6 offset:11392
    s_waitcnt lgkmcnt(6)
    v_mfma_f32_32x32x16_bf16 a[112:127], v[60:63], v[72:75], a[112:127]
    ds_read_b64_tr_b16 v[44:45], v6 offset:704
    ds_read_b64_tr_b16 v[46:47], v6 offset:11456
    s_waitcnt lgkmcnt(6)
    v_mfma_f32_32x32x16_bf16 a[128:143], v[32:35], v[72:75], a[128:143]
    ds_read_b64_tr_b16 v[48:49], v6 offset:768
    ds_read_b64_tr_b16 v[50:51], v6 offset:11520
    s_waitcnt lgkmcnt(6)
    v_mfma_f32_32x32x16_bf16 a[144:159], v[36:39], v[72:75], a[144:159]
    ds_read_b64_tr_b16 v[52:53], v6 offset:832
    ds_read_b64_tr_b16 v[54:55], v6 offset:11584
    s_waitcnt lgkmcnt(6)
    v_mfma_f32_32x32x16_bf16 a[160:175], v[40:43], v[72:75], a[160:175]
    ds_read_b64_tr_b16 v[56:57], v6 offset:896
    ds_read_b64_tr_b16 v[58:59], v6 offset:11648
    s_waitcnt lgkmcnt(6)
    v_mfma_f32_32x32x16_bf16 a[176:191], v[44:47], v[72:75], a[176:191]
    ds_read_b64_tr_b16 v[60:61], v6 offset:960
    ds_read_b64_tr_b16 v[62:63], v6 offset:11712
    s_waitcnt lgkmcnt(6)
    v_mfma_f32_32x32x16_bf16 a[192:207], v[48:51], v[72:75], a[192:207]
    ds_read_b64_tr_b16 v[32:33], v6 offset:1024
    ds_read_b64_tr_b16 v[34:35], v6 offset:11776
    s_waitcnt lgkmcnt(6)
    v_mfma_f32_32x32x16_bf16 a[208:223], v[52:55], v[72:75], a[208:223]
    ds_read_b64_tr_b16 v[36:37], v6 offset:1088
    ds_read_b64_tr_b16 v[38:39], v6 offset:11840
    s_waitcnt lgkmcnt(6)
    v_mfma_f32_32x32x16_bf16 a[224:239], v[56:59], v[72:75], a[224:239]
    ds_read_b64_tr_b16 v[40:41], v6 offset:1152
    ds_read_b64_tr_b16 v[42:43], v6 offset:11904
    s_waitcnt lgkmcnt(6)
    v_mfma_f32_32x32x16_bf16 a[240:255], v[60:63], v[72:75], a[240:255]
    ds_read_b64_tr_b16 v[44:45], v6 offset:1216
    ds_read_b64_tr_b16 v[46:47], v6 offset:11968
    s_waitcnt lgkmcnt(6)
    v_mfma_f32_32x32x16_bf16 v[192:207], v[32:35], v[72:75], v[192:207]
    ds_read_b64_tr_b16 v[48:49], v6 offset:21504
    ds_read_b64_tr_b16 v[50:51], v6 offset:32256
    s_waitcnt lgkmcnt(6)
    v_mfma_f32_32x32x16_bf16 v[208:223], v[36:39], v[72:75], v[208:223]
    ds_read_b64_tr_b16 v[52:53], v6 offset:21568
    ds_read_b64_tr_b16 v[54:55], v6 offset:32320
    s_waitcnt lgkmcnt(6)
    v_mfma_f32_32x32x16_bf16 v[224:239], v[40:43], v[72:75], v[224:239]
    ds_read_b64_tr_b16 v[56:57], v6 offset:21632
    ds_read_b64_tr_b16 v[58:59], v6 offset:32384
    s_waitcnt lgkmcnt(6)
    v_mfma_f32_32x32x16_bf16 v[240:255], v[44:47], v[72:75], v[240:255]
    ds_read_b64_tr_b16 v[60:61], v6 offset:21696
    ds_read_b64_tr_b16 v[62:63], v6 offset:32448
    buffer_load_dwordx4 v[72:75], v4, s[12:15], s42 offen sc1
    s_add_u32 s42, s42, 1024
    s_waitcnt vmcnt(2)
    s_barrier
    v_add_u32 v7, s39, v5
    s_waitcnt vmcnt(14)
    s_waitcnt lgkmcnt(6)
    v_mfma_f32_32x32x16_bf16 a[0:15], v[48:51], v[76:79], a[0:15]
    ds_read_b64_tr_b16 v[32:33], v6 offset:21760
    ds_read_b64_tr_b16 v[34:35], v6 offset:32512
    s_add_u32 s41, s40, s37
    s_add_u32 s41, s41, 0
    s_mov_b32 m0, s41
    s_nop 0
    buffer_load_dwordx4 v8, s[16:19], s36 offen lds
    s_waitcnt lgkmcnt(6)
    v_mfma_f32_32x32x16_bf16 a[16:31], v[52:55], v[76:79], a[16:31]
    ds_read_b64_tr_b16 v[36:37], v6 offset:21824
    ds_read_b64_tr_b16 v[38:39], v6 offset:32576
    s_waitcnt lgkmcnt(6)
    v_mfma_f32_32x32x16_bf16 a[32:47], v[56:59], v[76:79], a[32:47]
    ds_read_b64_tr_b16 v[40:41], v6 offset:21888
    ds_read_b64_tr_b16 v[42:43], v6 offset:32640
    s_add_u32 s41, s40, s37
    s_add_u32 s41, s41, 1024
    s_mov_b32 m0, s41
    s_nop 0
    buffer_load_dwordx4 v9, s[16:19], s36 offen lds
    s_waitcnt lgkmcnt(6)
    v_mfma_f32_32x32x16_bf16 a[48:63], v[60:63], v[76:79], a[48:63]
    ds_read_b64_tr_b16 v[44:45], v6 offset:21952
    ds_read_b64_tr_b16 v[46:47], v6 offset:32704
    s_waitcnt lgkmcnt(6)
    v_mfma_f32_32x32x16_bf16 a[64:79], v[32:35], v[76:79], a[64:79]
    ds_read_b64_tr_b16 v[48:49], v6 offset:22016
    ds_read_b64_tr_b16 v[50:51], v6 offset:32768
    s_add_u32 s41, s40, s37
    s_add_u32 s41, s41, 2048
    s_mov_b32 m0, s41
    s_nop 0
    buffer_load_dwordx4 v10, s[16:19], s36 offen lds
    s_waitcnt lgkmcnt(6)
    v_mfma_f32_32x32x16_bf16 a[80:95], v[36:39], v[76:79], a[80:95]
    ds_read_b64_tr_b16 v[52:53], v6 offset:22080
    ds_read_b64_tr_b16 v[54:55], v6 offset:32832
    s_waitcnt lgkmcnt(6)
    v_mfma_f32_32x32x16_bf16 a[96:111], v[40:43], v[76:79], a[96:111]
    ds_read_b64_tr_b16 v[56:57], v6 offset:22144
    ds_read_b64_tr_b16 v[58:59], v6 offset:32896
    s_add_u32 s41, s40, s37
    s_add_u32 s41, s41, 3072
    s_mov_b32 m0, s41
    s_nop 0
    buffer_load_dwordx4 v11, s[16:19], s36 offen lds
    s_waitcnt lgkmcnt(6)
    v_mfma_f32_32x32x16_bf16 a[112:127], v[44:47], v[76:79], a[112:127]
    ds_read_b64_tr_b16 v[60:61], v6 offset:22208
    ds_read_b64_tr_b16 v[62:63], v6 offset:32960
    s_waitcnt lgkmcnt(6)
    v_mfma_f32_32x32x16_bf16 a[128:143], v[48:51], v[76:79], a[128:143]
    ds_read_b64_tr_b16 v[32:33], v6 offset:22272
    ds_read_b64_tr_b16 v[34:35], v6 offset:33024
    s_add_u32 s41, s40, s37
    s_add_u32 s41, s41, 4096
    s_mov_b32 m0, s41
    s_nop 0
    buffer_load_dwordx4 v12, s[16:19], s36 offen lds
    s_waitcnt lgkmcnt(6)
    v_mfma_f32_32x32x16_bf16 a[144:159], v[52:55], v[76:79], a[144:159]
    ds_read_b64_tr_b16 v[36:37], v6 offset:22336
    ds_read_b64_tr_b16 v[38:39], v6 offset:33088
    s_waitcnt lgkmcnt(6)
    v_mfma_f32_32x32x16_bf16 a[160:175], v[56:59], v[76:79], a[160:175]
    ds_read_b64_tr_b16 v[40:41], v6 offset:22400
    ds_read_b64_tr_b16 v[42:43], v6 offset:33152
    s_add_u32 s41, s40, s37
    s_add_u32 s41, s41, 5120
    s_mov_b32 m0, s41
    s_nop 0
    buffer_load_dwordx4 v13, s[16:19], s36 offen lds
    s_waitcnt lgkmcnt(6)
    v_mfma_f32_32x32x16_bf16 a[176:191], v[60:63], v[76:79], a[176:191]
    ds_read_b64_tr_b16 v[44:45], v6 offset:22464
    ds_read_b64_tr_b16 v[46:47], v6 offset:33216
    s_waitcnt lgkmcnt(6)
    v_mfma_f32_32x32x16_bf16 a[192:207], v[32:35], v[76:79], a[192:207]
    ds_read_b64_tr_b16 v[48:49], v6 offset:22528
    ds_read_b64_tr_b16 v[50:51], v6 offset:33280
    s_add_u32 s41, s40, s37
    s_add_u32 s41, s41, 6144
    s_mov_b32 m0, s41
    s_nop 0
    buffer_load_dwordx4 v14, s[16:19], s36 offen lds
    s_waitcnt lgkmcnt(6)
    v_mfma_f32_32x32x16_bf16 a[208:223], v[36:39], v[76:79], a[208:223]
    ds_read_b64_tr_b16 v[52:53], v6 offset:22592
    ds_read_b64_tr_b16 v[54:55], v6 offset:33344
    s_waitcnt lgkmcnt(6)
    v_mfma_f32_32x32x16_bf16 a[224:239], v[40:43], v[76:79], a[224:239]
    ds_read_b64_tr_b16 v[56:57], v6 offset:22656
    ds_read_b64_tr_b16 v[58:59], v6 offset:33408
    s_add_u32 s41, s40, s37
    s_add_u32 s41, s41, 7168
    s_mov_b32 m0, s41
    s_nop 0
    buffer_load_dwordx4 v15, s[16:19], s36 offen lds
    s_waitcnt lgkmcnt(6)
    v_mfma_f32_32x32x16_bf16 a[240:255], v[44:47], v[76:79], a[240:255]
    ds_read_b64_tr_b16 v[60:61], v6 offset:22720
    ds_read_b64_tr_b16 v[62:63], v6 offset:33472
    s_waitcnt lgkmcnt(6)
    v_mfma_f32_32x32x16_bf16 v[192:207], v[48:51], v[76:79], v[192:207]
    ds_read_b64_tr_b16 v[32:33], v7 offset:0
    ds_read_b64_tr_b16 v[34:35], v7 offset:10752
    s_add_u32 s41, s40, s37
    s_add_u32 s41, s41, 8192
    s_mov_b32 m0, s41
    s_nop 0
    buffer_load_dwordx4 v16, s[16:19], s36 offen lds
    s_waitcnt lgkmcnt(6)
    v_mfma_f32_32x32x16_bf16 v[208:223], v[52:55], v[76:79], v[208:223]
    ds_read_b64_tr_b16 v[36:37], v7 offset:64
    ds_read_b64_tr_b16 v[38:39], v7 offset:10816
    s_waitcnt lgkmcnt(6)
    v_mfma_f32_32x32x16_bf16 v[224:239], v[56:59], v[76:79], v[224:239]
    ds_read_b64_tr_b16 v[40:41], v7 offset:128
    ds_read_b64_tr_b16 v[42:43], v7 offset:10880
    s_add_u32 s41, s40, s37
    s_add_u32 s41, s41, 9216
    s_mov_b32 m0, s41
    s_nop 0
    buffer_load_dwordx4 v17, s[16:19], s36 offen lds
    s_waitcnt lgkmcnt(6)
    v_mfma_f32_32x32x16_bf16 v[240:255], v[60:63], v[76:79], v[240:255]
    ds_read_b64_tr_b16 v[44:45], v7 offset:192
    ds_read_b64_tr_b16 v[46:47], v7 offset:10944
    s_add_u32 s41, s40, s37
    s_add_u32 s41, s41, 10240
    s_mov_b32 m0, s41
    s_nop 0
    buffer_load_dwordx4 v18, s[16:19], s36 offen lds
    buffer_load_dwordx4 v[76:79], v4, s[12:15], s42 offen sc1
    s_add_u32 s42, s42, 1024
    s_add_u32 s36, s36, 40960
    s_mov_b32 s41, s38
    s_mov_b32 s38, s39
    s_mov_b32 s39, s40
    s_mov_b32 s40, s41
    v_mov_b32 v6, v7
    s_add_u32 s43, s43, 2
    s_cmp_lt_u32 s43, 24
    s_cbranch_scc1 POG_loop
    s_mul_i32 s32, s30, 2
    s_add_u32 s32, s32, s31
    s_sub_u32 s32, s32, 8
    s_lshl_b32 s32, s32, 2
    s_add_u32 s32, s32, s9
    s_mul_i32 s32, s32, 81920
    s_add_u32 s32, s32, 233832448
    v_lshlrev_b32 v2, 4, v1
    s_waitcnt lgkmcnt(0)
    s_nop 15
    buffer_store_dwordx4 a[0:3], v2, s[12:15], s32 offen offset:0 sc1
    buffer_store_dwordx4 a[4:7], v2, s[12:15], s32 offen offset:1024 sc1
    buffer_store_dwordx4 a[8:11], v2, s[12:15], s32 offen offset:2048 sc1
    buffer_store_dwordx4 a[12:15], v2, s[12:15], s32 offen offset:3072 sc1
    s_add_u32 s32, s32, 4096
    buffer_store_dwordx4 a[16:19], v2, s[12:15], s32 offen offset:0 sc1
    buffer_store_dwordx4 a[20:23], v2, s[12:15], s32 offen offset:1024 sc1
    buffer_store_dwordx4 a[24:27], v2, s[12:15], s32 offen offset:2048 sc1
    buffer_store_dwordx4 a[28:31], v2, s[12:15], s32 offen offset:3072 sc1
    s_add_u32 s32, s32, 4096
    buffer_store_dwordx4 a[32:35], v2, s[12:15], s32 offen offset:0 sc1
    buffer_store_dwordx4 a[36:39], v2, s[12:15], s32 offen offset:1024 sc1
    buffer_store_dwordx4 a[40:43], v2, s[12:15], s32 offen offset:2048 sc1
    buffer_store_dwordx4 a[44:47], v2, s[12:15], s32 offen offset:3072 sc1
    s_add_u32 s32, s32, 4096
    buffer_store_dwordx4 a[48:51], v2, s[12:15], s32 offen offset:0 sc1
    buffer_store_dwordx4 a[52:55], v2, s[12:15], s32 offen offset:1024 sc1
    buffer_store_dwordx4 a[56:59], v2, s[12:15], s32 offen offset:2048 sc1
    buffer_store_dwordx4 a[60:63], v2, s[12:15], s32 offen offset:3072 sc1
    s_add_u32 s32, s32, 4096
    buffer_store_dwordx4 a[64:67], v2, s[12:15], s32 offen offset:0 sc1
    buffer_store_dwordx4 a[68:71], v2, s[12:15], s32 offen offset:1024 sc1
    buffer_store_dwordx4 a[72:75], v2, s[12:15], s32 offen offset:2048 sc1
    buffer_store_dwordx4 a[76:79], v2, s[12:15], s32 offen offset:3072 sc1
    s_add_u32 s32, s32, 4096
    buffer_store_dwordx4 a[80:83], v2, s[12:15], s32 offen offset:0 sc1
    buffer_store_dwordx4 a[84:87], v2, s[12:15], s32 offen offset:1024 sc1
    buffer_store_dwordx4 a[88:91], v2, s[12:15], s32 offen offset:2048 sc1
    buffer_store_dwordx4 a[92:95], v2, s[12:15], s32 offen offset:3072 sc1
    s_add_u32 s32, s32, 4096
    buffer_store_dwordx4 a[96:99], v2, s[12:15], s32 offen offset:0 sc1
    buffer_store_dwordx4 a[100:103], v2, s[12:15], s32 offen offset:1024 sc1
    buffer_store_dwordx4 a[104:107], v2, s[12:15], s32 offen offset:2048 sc1
    buffer_store_dwordx4 a[108:111], v2, s[12:15], s32 offen offset:3072 sc1
    s_add_u32 s32, s32, 4096
    buffer_store_dwordx4 a[112:115], v2, s[12:15], s32 offen offset:0 sc1
    buffer_store_dwordx4 a[116:119], v2, s[12:15], s32 offen offset:1024 sc1
    buffer_store_dwordx4 a[120:123], v2, s[12:15], s32 offen offset:2048 sc1
    buffer_store_dwordx4 a[124:127], v2, s[12:15], s32 offen offset:3072 sc1
    s_add_u32 s32, s32, 4096
    buffer_store_dwordx4 a[128:131], v2, s[12:15], s32 offen offset:0 sc1
    buffer_store_dwordx4 a[132:135], v2, s[12:15], s32 offen offset:1024 sc1
    buffer_store_dwordx4 a[136:139], v2, s[12:15], s32 offen offset:2048 sc1
    buffer_store_dwordx4 a[140:143], v2, s[12:15], s32 offen offset:3072 sc1
    s_add_u32 s32, s32, 4096
    buffer_store_dwordx4 a[144:147], v2, s[12:15], s32 offen offset:0 sc1
    buffer_store_dwordx4 a[148:151], v2, s[12:15], s32 offen offset:1024 sc1
    buffer_store_dwordx4 a[152:155], v2, s[12:15], s32 offen offset:2048 sc1
    buffer_store_dwordx4 a[156:159], v2, s[12:15], s32 offen offset:3072 sc1
    s_add_u32 s32, s32, 4096
    buffer_store_dwordx4 a[160:163], v2, s[12:15], s32 offen offset:0 sc1
    buffer_store_dwordx4 a[164:167], v2, s[12:15], s32 offen offset:1024 sc1
    buffer_store_dwordx4 a[168:171], v2, s[12:15], s32 offen offset:2048 sc1
    buffer_store_dwordx4 a[172:175], v2, s[12:15], s32 offen offset:3072 sc1
    s_add_u32 s32, s32, 4096
    buffer_store_dwordx4 a[176:179], v2, s[12:15], s32 offen offset:0 sc1
    buffer_store_dwordx4 a[180:183], v2, s[12:15], s32 offen offset:1024 sc1
    buffer_store_dwordx4 a[184:187], v2, s[12:15], s32 offen offset:2048 sc1
    buffer_store_dwordx4 a[188:191], v2, s[12:15], s32 offen offset:3072 sc1
    s_add_u32 s32, s32, 4096
    buffer_store_dwordx4 a[192:195], v2, s[12:15], s32 offen offset:0 sc1
    buffer_store_dwordx4 a[196:199], v2, s[12:15], s32 offen offset:1024 sc1
    buffer_store_dwordx4 a[200:203], v2, s[12:15], s32 offen offset:2048 sc1
    buffer_store_dwordx4 a[204:207], v2, s[12:15], s32 offen offset:3072 sc1
    s_add_u32 s32, s32, 4096
    buffer_store_dwordx4 a[208:211], v2, s[12:15], s32 offen offset:0 sc1
    buffer_store_dwordx4 a[212:215], v2, s[12:15], s32 offen offset:1024 sc1
    buffer_store_dwordx4 a[216:219], v2, s[12:15], s32 offen offset:2048 sc1
    buffer_store_dwordx4 a[220:223], v2, s[12:15], s32 offen offset:3072 sc1
    s_add_u32 s32, s32, 4096
    buffer_store_dwordx4 a[224:227], v2, s[12:15], s32 offen offset:0 sc1
    buffer_store_dwordx4 a[228:231], v2, s[12:15], s32 offen offset:1024 sc1
    buffer_store_dwordx4 a[232:235], v2, s[12:15], s32 offen offset:2048 sc1
    buffer_store_dwordx4 a[236:239], v2, s[12:15], s32 offen offset:3072 sc1
    s_add_u32 s32, s32, 4096
    buffer_store_dwordx4 a[240:243], v2, s[12:15], s32 offen offset:0 sc1
    buffer_store_dwordx4 a[244:247], v2, s[12:15], s32 offen offset:1024 sc1
    buffer_store_dwordx4 a[248:251], v2, s[12:15], s32 offen offset:2048 sc1
    buffer_store_dwordx4 a[252:255], v2, s[12:15], s32 offen offset:3072 sc1
    s_add_u32 s32, s32, 4096
    buffer_store_dwordx4 v[192:195], v2, s[12:15], s32 offen offset:0 sc1
    buffer_store_dwordx4 v[196:199], v2, s[12:15], s32 offen offset:1024 sc1
    buffer_store_dwordx4 v[200:203], v2, s[12:15], s32 offen offset:2048 sc1
    buffer_store_dwordx4 v[204:207], v2, s[12:15], s32 offen offset:3072 sc1
    s_add_u32 s32, s32, 4096
    buffer_store_dwordx4 v[208:211], v2, s[12:15], s32 offen offset:0 sc1
    buffer_store_dwordx4 v[212:215], v2, s[12:15], s32 offen offset:1024 sc1
    buffer_store_dwordx4 v[216:219], v2, s[12:15], s32 offen offset:2048 sc1
    buffer_store_dwordx4 v[220:223], v2, s[12:15], s32 offen offset:3072 sc1
    s_add_u32 s32, s32, 4096
    buffer_store_dwordx4 v[224:227], v2, s[12:15], s32 offen offset:0 sc1
    buffer_store_dwordx4 v[228:231], v2, s[12:15], s32 offen offset:1024 sc1
    buffer_store_dwordx4 v[232:235], v2, s[12:15], s32 offen offset:2048 sc1
    buffer_store_dwordx4 v[236:239], v2, s[12:15], s32 offen offset:3072 sc1
    s_add_u32 s32, s32, 4096
    buffer_store_dwordx4 v[240:243], v2, s[12:15], s32 offen offset:0 sc1
    buffer_store_dwordx4 v[244:247], v2, s[12:15], s32 offen offset:1024 sc1
    buffer_store_dwordx4 v[248:251], v2, s[12:15], s32 offen offset:2048 sc1
    buffer_store_dwordx4 v[252:255], v2, s[12:15], s32 offen offset:3072 sc1
    s_add_u32 s32, s32, 4096
    s_waitcnt vmcnt(0)
    s_barrier
    s_cmp_lg_u32 s9, 0
    s_cbranch_scc1 PO_loop
    s_lshl_b32 s40, s57, 7
    s_add_u32 s40, s40, s62
    s_add_u32 s40, s40, 2076672
    v_mov_b32 v20, s40
    v_mov_b32 v21, 1
    s_mov_b64 exec, 1
    buffer_atomic_add v21, v20, s[12:15], 0 offen
    s_mov_b64 exec, -1
    s_branch PO_loop
PO_exit:
M_end:
    s_endpgm
.section .rodata,"a"
.p2align 6
.amdhsa_kernel parallel_sum__memory_aug_recurrent_mem_tr__geglu_ffn__prompt_kernel
  .amdhsa_next_free_vgpr 512
  .amdhsa_next_free_sgpr 102
  .amdhsa_accum_offset 256
  .amdhsa_group_segment_fixed_size 0
  .amdhsa_kernarg_size 112
  .amdhsa_user_sgpr_count 2
  .amdhsa_user_sgpr_kernarg_segment_ptr 1
  .amdhsa_system_sgpr_workgroup_id_x 1
  .amdhsa_float_denorm_mode_32 3
.end_amdhsa_kernel
```
